```python
import torch

def _softmax(x, axis=-1):
    return torch.softmax(x, dim=axis)

def _gelu(x):
    return torch.nn.functional.gelu(x, approximate='tanh')

def _silu(x):
    return torch.nn.functional.silu(x)

def _sigmoid(x):
    return torch.sigmoid(x)

def _layernorm(x, axis=-1, eps=1e-05):
    m = x.mean(dim=axis, keepdim=True)
    v = x.var(dim=axis, keepdim=True, unbiased=False)
    return (x - m) / torch.sqrt(v + eps)

def _scatter_add(tgt, idx, src, axis=0):
    return tgt.clone().index_add_(axis, idx, src)

def _segment_sum(src, seg, n):
    out = torch.zeros((n,) + src.shape[1:], dtype=src.dtype)
    return out.index_add_(0, seg, src)

def _pad(x, pw):
    flat = tuple((v for pair in reversed(pw) for v in pair))
    return torch.nn.functional.pad(x, flat)
kernel_name = 'recurrent_scan__mha_block_cached__mixer_gmlp__prompt'

def setup_inputs():

    _w = lambda a: (lambda t: t.to(torch.bfloat16) if t.is_floating_point() else t)(torch.as_tensor(a))

    def _A_setup():
        B, Sq, D = (1, 2048, 1024)
        H, Sk, Dh = (32, 2048, 128)
        return {'x': _w((lambda *s: torch.randn(*s, dtype=torch.bfloat16) * 0.05)(B, Sq, D)), 'k_cache': _w((lambda *s: torch.randn(*s, dtype=torch.bfloat16) * 0.8)(B, H, Sk, Dh)), 'v_cache': _w((lambda *s: torch.randn(*s, dtype=torch.bfloat16) * 0.2)(B, H, Sk, Dh)), 'wq': _w((lambda *s: torch.randn(*s, dtype=torch.bfloat16) * 0.8)(D, H * Dh) * D ** (-0.5)), 'wo': _w((lambda *s: torch.randn(*s, dtype=torch.bfloat16) * 0.2)(H * Dh, D) * (H * Dh) ** (-0.5))}
    _A_in = _A_setup()

    def _B_setup():
        B, S, D, F = (1, 2048, 1024, 3584)
        Fh = F // 2
        return {'x': _w((lambda *s: torch.randn(*s, dtype=torch.bfloat16) * 0.05)(B, S, D)), 'w_in': _w((lambda *s: torch.randn(*s, dtype=torch.bfloat16) * 0.4)(D, 2 * Fh)), 'w_sp': _w(0.01 * (lambda *s: torch.randn(*s, dtype=torch.bfloat16) * 0.4)(S, S)), 'b_sp': _w(1.0 + 0.01 * (lambda *s: torch.randn(*s, dtype=torch.bfloat16) * 0.1)(S)), 'w_out': _w((lambda *s: torch.randn(*s, dtype=torch.bfloat16) * 0.1)(Fh, D))}
    _B_in = _B_setup()
    return {'A_x': _A_in['x'], 'A_k_cache': _A_in['k_cache'], 'A_v_cache': _A_in['v_cache'], 'A_wq': _A_in['wq'], 'A_wo': _A_in['wo'], 'B_x': _B_in['x'], 'B_w_in': _B_in['w_in'], 'B_w_sp': _B_in['w_sp'], 'B_b_sp': _B_in['b_sp'], 'B_w_out': _B_in['w_out']}

def reference(A_x, A_k_cache, A_v_cache, A_wq, A_wo, B_x, B_w_in, B_w_sp, B_b_sp, B_w_out):

    def _A_ref(x, k_cache, v_cache, wq, wo):
        B, Sq, D = x.shape
        H, Dh = (32, 128)
        q = (lambda x, *d: x.permute(*d))((x @ wq).reshape(B, Sq, H, Dh), 0, 2, 1, 3)
        scores = torch.einsum('bhqd,bhkd->bhqk', q, k_cache) * Dh ** (-0.5)
        p = _softmax(scores, axis=-1)
        o = torch.einsum('bhqk,bhkd->bhqd', p, v_cache)
        return (lambda x, *d: x.permute(*d))(o, 0, 2, 1, 3).reshape(B, Sq, H * Dh) @ wo

    def _B_ref(x, w_in, w_sp, b_sp, w_out):
        B, S, D = x.shape
        F = w_in.shape[-1]
        Fh = F // 2
        z = _gelu(torch.einsum('bsd,df->bsf', x, w_in))
        z1 = z[..., :Fh].clone()
        z2 = _layernorm(z[..., Fh:], axis=-1)
        g = torch.einsum('ts,bsf->btf', w_sp, z2) + b_sp[None, :, None]
        return torch.einsum('bsf,fd->bsd', z1 * g, w_out)
    x = A_x
    xn = _layernorm(x, axis=-1)
    s = _A_ref(xn, A_k_cache, A_v_cache, A_wq, A_wo)
    g = _silu(_B_ref(xn, B_w_in, B_w_sp, B_b_sp, B_w_out))
    return x + s * g
```

```asm
; @launch kernel=ln_kernel grid=(656,1,1) block=(256,1,1) lds=0
; @launch kernel=mega_kernel grid=(256,1,1) block=(256,1,1) lds=163840
.amdgcn_target "amdgcn-amd-amdhsa--gfx950"
.text
.globl ln_kernel
.p2align 8
.type ln_kernel,@function
ln_kernel:
  s_cmp_ge_u32 s2, 656
  s_cbranch_scc1 ln_done
  s_cmp_ge_u32 s2, 624
  s_cbranch_scc1 ln_qpf
  s_cmp_ge_u32 s2, 560
  s_cbranch_scc1 ln_cpf
  s_cmp_ge_u32 s2, 512
  s_cbranch_scc1 ln_pf
  s_load_dwordx2 s[4:5], s[0:1], 0
  s_load_dwordx2 s[6:7], s[0:1], 96
  s_cmp_lt_u32 s2, 64
  s_cbranch_scc0 ln_nocode
  s_getpc_b64 s[16:17]
  v_and_b32 v3, 31, v0
  v_lshlrev_b32 v3, 6, v3
  global_load_dword v9, v3, s[16:17]
ln_nocode:
  v_lshrrev_b32 v1, 6, v0
  s_nop 1
  v_readfirstlane_b32 s3, v1
  s_nop 3
  s_lshl_b32 s20, s2, 2
  s_add_u32 s20, s20, s3
  s_mul_i32 s21, s20, 2048
  s_mul_i32 s22, s20, 2048
  s_lshl_b32 s23, s20, 10
  v_and_b32 v2, 63, v0
  v_lshlrev_b32 v2, 4, v2
  s_mov_b32 s10, 4194304
  s_mov_b32 s11, 0x20000
  s_waitcnt lgkmcnt(0)
  s_mov_b32 s8, s4
  s_mov_b32 s9, s5
  buffer_load_dwordx4 v[16:19], v2, s[8:11], s21 offen offset:0
  buffer_load_dwordx4 v[20:23], v2, s[8:11], s21 offen offset:1024
  s_mov_b32 s12, s6
  s_mov_b32 s13, s7
  s_mov_b32 s14, 4194304
  s_mov_b32 s15, 0x20000
  s_add_u32 s24, s6, 75497472
  s_addc_u32 s25, s7, 0
  s_mov_b32 s26, 135168
  s_mov_b32 s27, 0x20000
  v_mov_b32 v4, 0
  v_mov_b32 v5, 0
  v_mov_b32 v6, 0
  v_mov_b32 v7, 0
  s_cmp_lt_u32 s20, 132
  s_cbranch_scc0 ln_go
  buffer_store_dwordx4 v[4:7], v2, s[24:27], s23 offen
ln_go:
  s_waitcnt vmcnt(0)
  v_lshlrev_b32 v24, 16, v16
  v_and_b32 v25, 0xffff0000, v16
  v_lshlrev_b32 v26, 16, v17
  v_and_b32 v27, 0xffff0000, v17
  v_lshlrev_b32 v28, 16, v18
  v_and_b32 v29, 0xffff0000, v18
  v_lshlrev_b32 v30, 16, v19
  v_and_b32 v31, 0xffff0000, v19
  v_lshlrev_b32 v32, 16, v20
  v_and_b32 v33, 0xffff0000, v20
  v_lshlrev_b32 v34, 16, v21
  v_and_b32 v35, 0xffff0000, v21
  v_lshlrev_b32 v36, 16, v22
  v_and_b32 v37, 0xffff0000, v22
  v_lshlrev_b32 v38, 16, v23
  v_and_b32 v39, 0xffff0000, v23
  v_pk_add_f32 v[40:41], v[24:25], v[26:27]
  v_pk_add_f32 v[42:43], v[28:29], v[30:31]
  v_pk_add_f32 v[44:45], v[32:33], v[34:35]
  v_pk_add_f32 v[46:47], v[36:37], v[38:39]
  v_pk_add_f32 v[40:41], v[40:41], v[42:43]
  v_pk_add_f32 v[44:45], v[44:45], v[46:47]
  v_pk_add_f32 v[40:41], v[40:41], v[44:45]
  v_add_f32 v40, v40, v41
  s_nop 1
  v_add_f32_dpp v40, v40, v40 row_shr:1 row_mask:0xf bank_mask:0xf bound_ctrl:0
  s_nop 1
  v_add_f32_dpp v40, v40, v40 row_shr:2 row_mask:0xf bank_mask:0xf bound_ctrl:0
  s_nop 1
  v_add_f32_dpp v40, v40, v40 row_shr:4 row_mask:0xf bank_mask:0xf bound_ctrl:0
  s_nop 1
  v_add_f32_dpp v40, v40, v40 row_shr:8 row_mask:0xf bank_mask:0xf bound_ctrl:0
  s_nop 1
  v_add_f32_dpp v40, v40, v40 row_bcast:15 row_mask:0xa bank_mask:0xf
  s_nop 1
  v_add_f32_dpp v40, v40, v40 row_bcast:31 row_mask:0xc bank_mask:0xf
  s_nop 1
  v_readlane_b32 s40, v40, 63
  s_nop 3
  v_mov_b32 v48, s40
  v_mul_f32 v48, 0xba800000, v48
  v_mov_b32 v49, v48
  v_pk_add_f32 v[52:53], v[24:25], v[48:49]
  v_pk_mul_f32 v[40:41], v[52:53], v[52:53]
  v_pk_add_f32 v[54:55], v[26:27], v[48:49]
  v_pk_mul_f32 v[42:43], v[54:55], v[54:55]
  v_pk_add_f32 v[52:53], v[28:29], v[48:49]
  v_pk_fma_f32 v[40:41], v[52:53], v[52:53], v[40:41]
  v_pk_add_f32 v[54:55], v[30:31], v[48:49]
  v_pk_fma_f32 v[42:43], v[54:55], v[54:55], v[42:43]
  v_pk_add_f32 v[52:53], v[32:33], v[48:49]
  v_pk_fma_f32 v[40:41], v[52:53], v[52:53], v[40:41]
  v_pk_add_f32 v[54:55], v[34:35], v[48:49]
  v_pk_fma_f32 v[42:43], v[54:55], v[54:55], v[42:43]
  v_pk_add_f32 v[52:53], v[36:37], v[48:49]
  v_pk_fma_f32 v[40:41], v[52:53], v[52:53], v[40:41]
  v_pk_add_f32 v[54:55], v[38:39], v[48:49]
  v_pk_fma_f32 v[42:43], v[54:55], v[54:55], v[42:43]
  v_pk_add_f32 v[40:41], v[40:41], v[42:43]
  v_add_f32 v40, v40, v41
  s_nop 1
  v_add_f32_dpp v40, v40, v40 row_shr:1 row_mask:0xf bank_mask:0xf bound_ctrl:0
  s_nop 1
  v_add_f32_dpp v40, v40, v40 row_shr:2 row_mask:0xf bank_mask:0xf bound_ctrl:0
  s_nop 1
  v_add_f32_dpp v40, v40, v40 row_shr:4 row_mask:0xf bank_mask:0xf bound_ctrl:0
  s_nop 1
  v_add_f32_dpp v40, v40, v40 row_shr:8 row_mask:0xf bank_mask:0xf bound_ctrl:0
  s_nop 1
  v_add_f32_dpp v40, v40, v40 row_bcast:15 row_mask:0xa bank_mask:0xf
  s_nop 1
  v_add_f32_dpp v40, v40, v40 row_bcast:31 row_mask:0xc bank_mask:0xf
  s_nop 1
  v_readlane_b32 s41, v40, 63
  v_cvt_pk_bf16_f32 v56, v48, v48
  v_lshlrev_b32 v48, 16, v56
  v_mov_b32 v49, v48
  s_nop 1
  v_mov_b32 v50, s41
  v_mul_f32 v50, 0x3a800000, v50
  v_pk_add_f32 v[24:25], v[24:25], v[48:49]
  v_pk_add_f32 v[26:27], v[26:27], v[48:49]
  v_pk_add_f32 v[28:29], v[28:29], v[48:49]
  v_pk_add_f32 v[30:31], v[30:31], v[48:49]
  v_pk_add_f32 v[32:33], v[32:33], v[48:49]
  v_pk_add_f32 v[34:35], v[34:35], v[48:49]
  v_pk_add_f32 v[36:37], v[36:37], v[48:49]
  v_pk_add_f32 v[38:39], v[38:39], v[48:49]
  v_cvt_pk_bf16_f32 v56, v50, v50
  v_lshlrev_b32 v50, 16, v56
  v_add_f32 v50, 0x3727c5ac, v50
  v_cvt_pk_bf16_f32 v56, v50, v50
  v_lshlrev_b32 v50, 16, v56
  v_sqrt_f32 v50, v50
  v_cvt_pk_bf16_f32 v16, v24, v25
  v_cvt_pk_bf16_f32 v17, v26, v27
  v_cvt_pk_bf16_f32 v18, v28, v29
  v_cvt_pk_bf16_f32 v19, v30, v31
  v_cvt_pk_bf16_f32 v20, v32, v33
  v_cvt_pk_bf16_f32 v21, v34, v35
  v_cvt_pk_bf16_f32 v22, v36, v37
  v_cvt_pk_bf16_f32 v23, v38, v39
  v_cvt_pk_bf16_f32 v56, v50, v50
  v_lshlrev_b32 v50, 16, v56
  v_rcp_f32 v50, v50
  v_lshlrev_b32 v24, 16, v16
  v_and_b32 v25, 0xffff0000, v16
  v_lshlrev_b32 v26, 16, v17
  v_and_b32 v27, 0xffff0000, v17
  v_lshlrev_b32 v28, 16, v18
  v_and_b32 v29, 0xffff0000, v18
  v_lshlrev_b32 v30, 16, v19
  v_and_b32 v31, 0xffff0000, v19
  v_lshlrev_b32 v32, 16, v20
  v_and_b32 v33, 0xffff0000, v20
  v_lshlrev_b32 v34, 16, v21
  v_and_b32 v35, 0xffff0000, v21
  v_lshlrev_b32 v36, 16, v22
  v_and_b32 v37, 0xffff0000, v22
  v_lshlrev_b32 v38, 16, v23
  v_and_b32 v39, 0xffff0000, v23
  v_mov_b32 v51, v50
  v_pk_mul_f32 v[24:25], v[24:25], v[50:51]
  v_pk_mul_f32 v[26:27], v[26:27], v[50:51]
  v_pk_mul_f32 v[28:29], v[28:29], v[50:51]
  v_pk_mul_f32 v[30:31], v[30:31], v[50:51]
  v_pk_mul_f32 v[32:33], v[32:33], v[50:51]
  v_pk_mul_f32 v[34:35], v[34:35], v[50:51]
  v_pk_mul_f32 v[36:37], v[36:37], v[50:51]
  v_pk_mul_f32 v[38:39], v[38:39], v[50:51]
  v_cvt_pk_bf16_f32 v16, v24, v25
  v_cvt_pk_bf16_f32 v17, v26, v27
  v_cvt_pk_bf16_f32 v18, v28, v29
  v_cvt_pk_bf16_f32 v19, v30, v31
  v_cvt_pk_bf16_f32 v20, v32, v33
  v_cvt_pk_bf16_f32 v21, v34, v35
  v_cvt_pk_bf16_f32 v22, v36, v37
  v_cvt_pk_bf16_f32 v23, v38, v39
  buffer_store_dwordx4 v[16:19], v2, s[12:15], s22 offen offset:0
  buffer_store_dwordx4 v[20:23], v2, s[12:15], s22 offen offset:1024
  s_endpgm
ln_pf:
  s_load_dwordx2 s[4:5], s[0:1], 48
  s_sub_u32 s20, s2, 512
  s_mul_i32 s20, s20, 57344
  v_lshrrev_b32 v1, 6, v0
  v_mul_u32_u24 v1, 14336, v1
  v_and_b32 v2, 63, v0
  v_lshl_add_u32 v2, v2, 4, v1
  v_add_u32 v2, s20, v2
  s_waitcnt lgkmcnt(0)
  s_mov_b32 s8, s4
  s_mov_b32 s9, s5
  s_mov_b32 s10, 7340032
  s_mov_b32 s11, 0x20000
  buffer_load_dwordx4 v[8:11], v2, s[8:11], 0 offen
  v_add_u32 v2, 1024, v2
  buffer_load_dwordx4 v[12:15], v2, s[8:11], 0 offen
  v_add_u32 v2, 1024, v2
  buffer_load_dwordx4 v[16:19], v2, s[8:11], 0 offen
  v_add_u32 v2, 1024, v2
  buffer_load_dwordx4 v[20:23], v2, s[8:11], 0 offen
  v_add_u32 v2, 1024, v2
  buffer_load_dwordx4 v[24:27], v2, s[8:11], 0 offen
  v_add_u32 v2, 1024, v2
  buffer_load_dwordx4 v[28:31], v2, s[8:11], 0 offen
  v_add_u32 v2, 1024, v2
  buffer_load_dwordx4 v[32:35], v2, s[8:11], 0 offen
  v_add_u32 v2, 1024, v2
  buffer_load_dwordx4 v[36:39], v2, s[8:11], 0 offen
  v_add_u32 v2, 1024, v2
  buffer_load_dwordx4 v[8:11], v2, s[8:11], 0 offen
  v_add_u32 v2, 1024, v2
  buffer_load_dwordx4 v[12:15], v2, s[8:11], 0 offen
  v_add_u32 v2, 1024, v2
  buffer_load_dwordx4 v[16:19], v2, s[8:11], 0 offen
  v_add_u32 v2, 1024, v2
  buffer_load_dwordx4 v[20:23], v2, s[8:11], 0 offen
  v_add_u32 v2, 1024, v2
  buffer_load_dwordx4 v[24:27], v2, s[8:11], 0 offen
  v_add_u32 v2, 1024, v2
  buffer_load_dwordx4 v[28:31], v2, s[8:11], 0 offen
  v_add_u32 v2, 1024, v2
  s_waitcnt vmcnt(0)
  s_endpgm
ln_qpf:
  s_load_dwordx2 s[4:5], s[0:1], 24
  s_sub_u32 s20, s2, 624
  s_mul_i32 s20, s20, 262144
  s_add_u32 s20, s20, 6144
  v_lshrrev_b32 v1, 6, v0
  v_mul_u32_u24 v1, 65536, v1
  v_and_b32 v2, 63, v0
  v_lshl_add_u32 v2, v2, 4, v1
  v_add_u32 v2, s20, v2
  s_waitcnt lgkmcnt(0)
  s_mov_b32 s8, s4
  s_mov_b32 s9, s5
  s_mov_b32 s10, 8388608
  s_mov_b32 s11, 0x20000
  buffer_load_dwordx4 v[8:11], v2, s[8:11], 0 offen offset:0
  buffer_load_dwordx4 v[12:15], v2, s[8:11], 0 offen offset:1024
  v_add_u32 v2, 8192, v2
  buffer_load_dwordx4 v[16:19], v2, s[8:11], 0 offen offset:0
  buffer_load_dwordx4 v[20:23], v2, s[8:11], 0 offen offset:1024
  v_add_u32 v2, 8192, v2
  buffer_load_dwordx4 v[24:27], v2, s[8:11], 0 offen offset:0
  buffer_load_dwordx4 v[28:31], v2, s[8:11], 0 offen offset:1024
  v_add_u32 v2, 8192, v2
  buffer_load_dwordx4 v[32:35], v2, s[8:11], 0 offen offset:0
  buffer_load_dwordx4 v[36:39], v2, s[8:11], 0 offen offset:1024
  v_add_u32 v2, 8192, v2
  buffer_load_dwordx4 v[8:11], v2, s[8:11], 0 offen offset:0
  buffer_load_dwordx4 v[12:15], v2, s[8:11], 0 offen offset:1024
  v_add_u32 v2, 8192, v2
  buffer_load_dwordx4 v[16:19], v2, s[8:11], 0 offen offset:0
  buffer_load_dwordx4 v[20:23], v2, s[8:11], 0 offen offset:1024
  v_add_u32 v2, 8192, v2
  buffer_load_dwordx4 v[24:27], v2, s[8:11], 0 offen offset:0
  buffer_load_dwordx4 v[28:31], v2, s[8:11], 0 offen offset:1024
  v_add_u32 v2, 8192, v2
  buffer_load_dwordx4 v[32:35], v2, s[8:11], 0 offen offset:0
  buffer_load_dwordx4 v[36:39], v2, s[8:11], 0 offen offset:1024
  v_add_u32 v2, 8192, v2
  s_waitcnt vmcnt(0)
  s_endpgm
ln_cpf:
  s_getpc_b64 s[4:5]
ln_pc:
  s_add_u32 s8, s4, mega_kernel-ln_pc
  s_addc_u32 s9, s5, 0
  s_mov_b32 s10, code_end-mega_kernel
  s_mov_b32 s11, 0x20000
  s_sub_u32 s20, s2, 560
  s_lshr_b32 s20, s20, 3
  s_mul_i32 s20, s20, 16384
  v_lshlrev_b32 v2, 4, v0
  v_add_u32 v2, s20, v2
  buffer_load_dwordx4 v[8:11], v2, s[8:11], 0 offen
  v_add_u32 v2, 4096, v2
  buffer_load_dwordx4 v[12:15], v2, s[8:11], 0 offen
  v_add_u32 v2, 4096, v2
  buffer_load_dwordx4 v[16:19], v2, s[8:11], 0 offen
  v_add_u32 v2, 4096, v2
  buffer_load_dwordx4 v[20:23], v2, s[8:11], 0 offen
  v_add_u32 v2, 4096, v2
  s_waitcnt vmcnt(0)
ln_done:
  s_endpgm
.globl mega_kernel
.p2align 8
.type mega_kernel,@function
mega_kernel:
  s_cmp_ge_u32 s2, 256
  s_cbranch_scc1 all_done
  s_load_dwordx2 s[4:5], s[0:1], 48
  s_load_dwordx2 s[6:7], s[0:1], 96
  s_load_dwordx4 s[20:23], s[0:1], 8
  s_load_dwordx2 s[44:45], s[0:1], 24
  s_load_dwordx2 s[46:47], s[0:1], 56
  s_load_dwordx2 s[96:97], s[0:1], 32
  s_load_dwordx2 s[98:99], s[0:1], 72
  v_lshrrev_b32 v1, 6, v0
  s_nop 1
  v_readfirstlane_b32 s3, v1
  s_nop 3
  s_and_b32 s24, s2, 31
  s_lshr_b32 s25, s2, 5
  s_mul_i32 s26, s25, 524288
  s_mov_b32 s32, s26
  s_cmp_ge_u32 s24, 28
  s_cselect_b32 s42, 4, 0
  s_sub_u32 s101, s24, s42
  s_lshl_b32 s27, s101, 8
  s_lshl_b32 s33, s24, 8
  s_cmp_ge_u32 s101, 14
  s_cselect_b32 s34, 1, 0
  s_and_b32 s42, s25, 1
  s_add_u32 s42, s42, 6
  s_lshr_b32 s43, s24, 2
  s_cmp_eq_u32 s42, s43
  s_cselect_b32 s34, 2, s34
  s_mul_i32 s28, s3, 8192
  s_mul_i32 s29, s3, 4096
  s_add_u32 s29, s29, 98304
  v_bfe_u32 v100, v0, 3, 3
  s_lshl_b32 s40, s3, 6
  v_add_u32 v100, s40, v100
  v_lshrrev_b32 v101, 1, v100
  v_xor_b32 v101, v0, v101
  v_and_b32 v101, 7, v101
  v_lshlrev_b32 v101, 4, v101
  v_mul_u32_u24 v100, 2048, v100
  v_add_u32 v2, v100, v101
  v_xor_b32 v100, 64, v2
  v_add_u32 v3, 15360, v100
  v_add_u32 v4, 30720, v2
  v_add_u32 v5, 46080, v100
  v_add_u32 v6, 65536, v2
  v_add_u32 v7, 80896, v100
  v_add_u32 v8, 96256, v2
  v_add_u32 v9, 111616, v100
  v_and_b32 v100, 15, v0
  v_bfe_u32 v101, v0, 4, 2
  v_lshlrev_b32 v10, 1, v101
  v_xor_b32 v100, v100, v10
  v_lshlrev_b32 v100, 4, v100
  s_lshl_b32 s40, s3, 4
  v_add_u32 v101, s40, v101
  v_mul_u32_u24 v101, 7168, v101
  v_add_u32 v10, v101, v100
  v_xor_b32 v100, 128, v10
  v_add_u32 v11, 27648, v10
  v_add_u32 v12, 55296, v100
  v_add_u32 v13, 82944, v100
  s_waitcnt lgkmcnt(0)
  s_mov_b32 s8, s6
  s_mov_b32 s9, s7
  s_mov_b32 s10, 4194304
  s_mov_b32 s11, 0x20000
  s_mov_b32 s12, s4
  s_mov_b32 s13, s5
  s_mov_b32 s14, 7340032
  s_mov_b32 s15, 0x20000
  s_add_u32 s70, s6, 75497472
  s_addc_u32 s71, s7, 0
  s_cmp_eq_u32 s34, 2
  s_cbranch_scc1 att_nz
  s_add_u32 m0, s28, 32768
  s_nop 0
  buffer_load_dwordx4 v2, s[8:11], s26 offen offset:0 lds
  v_and_b32 v100, 15, v0
  v_bfe_u32 v101, v0, 4, 2
  v_lshlrev_b32 v32, 1, v101
  v_xor_b32 v100, v100, v32
  v_lshlrev_b32 v100, 4, v100
  s_lshl_b32 s40, s3, 4
  v_add_u32 v101, s40, v101
  v_mul_u32_u24 v101, 8192, v101
  v_add_u32 v32, v101, v100
  buffer_load_dwordx4 v3, s[8:11], s26 offen offset:1024 lds
  v_xor_b32 v100, 128, v32
  v_add_u32 v33, 31744, v32
  v_add_u32 v34, 63488, v100
  v_add_u32 v35, 95232, v100
  s_mov_b32 s36, s44
  s_mov_b32 s37, s45
  s_mov_b32 s38, 8388608
  s_mov_b32 s39, 0x20000
  v_and_b32 v105, 63, v0
  s_and_b32 s40, s3, 3
  buffer_load_dwordx4 v4, s[8:11], s26 offen offset:2048 lds
  s_lshr_b32 s41, s3, 2
  v_and_b32 v100, 15, v105
  v_lshrrev_b32 v101, 4, v105
  v_lshrrev_b32 v102, 1, v100
  v_xor_b32 v102, v102, v101
  v_lshlrev_b32 v102, 4, v102
  s_mul_i32 s42, s40, 8192
  v_lshlrev_b32 v103, 7, v100
  v_add3_u32 v102, v102, v103, s42
  buffer_load_dwordx4 v5, s[8:11], s26 offen offset:3072 lds
  v_add_u32 v14, 0, v102
  v_xor_b32 v15, 64, v14
  v_add_u32 v16, 65536, v102
  v_xor_b32 v17, 64, v16
  v_lshrrev_b32 v102, 2, v100
  v_lshl_add_u32 v103, v101, 3, v102
  v_mul_u32_u24 v103, 256, v103
  v_and_b32 v104, 3, v100
  v_lshl_add_u32 v103, v104, 3, v103
  v_and_b32 v104, 1, v101
  s_add_u32 m0, s28, 36864
  s_nop 0
  buffer_load_dwordx4 v6, s[8:11], s26 offen offset:0 lds
  v_lshl_or_b32 v102, v104, 2, v102
  s_mul_i32 s42, s41, 8
  s_add_u32 s43, s42, 0
  v_xor_b32 v104, s43, v102
  v_lshl_add_u32 v104, v104, 5, v103
  v_add_u32 v18, 98304, v104
  s_add_u32 s43, s42, 1
  v_xor_b32 v104, s43, v102
  v_lshl_add_u32 v104, v104, 5, v103
  buffer_load_dwordx4 v7, s[8:11], s26 offen offset:1024 lds
  v_add_u32 v19, 98304, v104
  s_add_u32 s43, s42, 2
  v_xor_b32 v104, s43, v102
  v_lshl_add_u32 v104, v104, 5, v103
  v_add_u32 v20, 98304, v104
  s_add_u32 s43, s42, 3
  v_xor_b32 v104, s43, v102
  v_lshl_add_u32 v104, v104, 5, v103
  v_add_u32 v21, 98304, v104
  s_add_u32 s43, s42, 4
  buffer_load_dwordx4 v8, s[8:11], s26 offen offset:2048 lds
  v_xor_b32 v104, s43, v102
  v_lshl_add_u32 v104, v104, 5, v103
  v_add_u32 v22, 98304, v104
  s_add_u32 s43, s42, 5
  v_xor_b32 v104, s43, v102
  v_lshl_add_u32 v104, v104, 5, v103
  v_add_u32 v23, 98304, v104
  s_add_u32 s43, s42, 6
  v_xor_b32 v104, s43, v102
  buffer_load_dwordx4 v9, s[8:11], s26 offen offset:3072 lds
  v_lshl_add_u32 v104, v104, 5, v103
  v_add_u32 v24, 98304, v104
  s_add_u32 s43, s42, 7
  v_xor_b32 v104, s43, v102
  v_lshl_add_u32 v104, v104, 5, v103
  v_add_u32 v25, 98304, v104
  s_mov_b32 s52, s20
  s_mov_b32 s53, s21
  s_mov_b32 s54, 16777216
  s_mov_b32 s55, 0x20000
  s_add_u32 m0, s29, 16384
  s_nop 0
  buffer_load_dwordx4 v10, s[12:15], s27 offen offset:0 lds
  s_mov_b32 s56, s22
  s_mov_b32 s57, s23
  s_mov_b32 s58, 16777216
  s_mov_b32 s59, 0x20000
  s_add_u32 s64, s6, 33554432
  s_addc_u32 s65, s7, 0
  s_mov_b32 s66, 17301504
  s_mov_b32 s67, 0x20000
  s_lshl_b32 s50, s24, 19
  buffer_load_dwordx4 v11, s[12:15], s27 offen offset:1024 lds
  s_mov_b32 s51, s50
  v_and_b32 v103, 63, v0
  v_lshrrev_b32 v100, 4, v103
  v_and_b32 v101, 15, v103
  s_lshl_b32 s40, s3, 4
  v_add_u32 v102, 0, v100
  v_xor_b32 v102, v102, v101
  v_lshlrev_b32 v102, 4, v102
  v_add_u32 v26, s40, v100
  v_lshl_add_u32 v26, v26, 8, v102
  buffer_load_dwordx4 v12, s[12:15], s27 offen offset:2048 lds
  v_add_u32 v102, 4, v100
  v_xor_b32 v102, v102, v101
  v_lshlrev_b32 v102, 4, v102
  v_add_u32 v27, s40, v100
  v_lshl_add_u32 v27, v27, 8, v102
  v_add_u32 v102, 8, v100
  v_xor_b32 v102, v102, v101
  v_lshlrev_b32 v102, 4, v102
  v_add_u32 v28, s40, v100
  buffer_load_dwordx4 v13, s[12:15], s27 offen offset:3072 lds
  v_lshl_add_u32 v28, v28, 8, v102
  v_add_u32 v102, 12, v100
  v_xor_b32 v102, v102, v101
  v_lshlrev_b32 v102, 4, v102
  v_add_u32 v29, s40, v100
  v_lshl_add_u32 v29, v29, 8, v102
  v_add_u32 v102, 0, v100
  v_lshlrev_b32 v102, 1, v102
  v_xor_b32 v102, v102, v101
  v_lshlrev_b32 v102, 4, v102
  s_add_u32 s26, s26, 128
  s_add_u32 s27, s27, 458752
  s_add_u32 m0, s28, 65536
  s_nop 0
  buffer_load_dwordx4 v2, s[8:11], s26 offen offset:0 lds
  v_add_u32 v30, s40, v100
  v_lshl_add_u32 v30, v30, 8, v102
  v_add_u32 v102, 4, v100
  v_lshlrev_b32 v102, 1, v102
  v_xor_b32 v102, v102, v101
  v_lshlrev_b32 v102, 4, v102
  v_add_u32 v31, s40, v100
  v_lshl_add_u32 v31, v31, 8, v102
  s_lshl_b32 s60, s3, 12
  buffer_load_dwordx4 v3, s[8:11], s26 offen offset:1024 lds
  s_add_u32 s61, s60, 65536
  s_lshl_b32 s48, s3, 12
  s_add_u32 s48, s48, 147456
  v_and_b32 v103, 63, v0
  v_and_b32 v100, 15, v103
  v_lshrrev_b32 v101, 4, v103
  v_lshrrev_b32 v102, 1, v101
  v_xor_b32 v102, v102, v100
  v_lshlrev_b32 v102, 4, v102
  v_and_b32 v101, 1, v101
  buffer_load_dwordx4 v4, s[8:11], s26 offen offset:2048 lds
  v_lshl_add_u32 v102, v101, 3, v102
  v_lshl_add_u32 v102, v100, 8, v102
  v_add_u32 v36, s48, v102
  v_xor_b32 v37, 32, v36
  v_xor_b32 v38, 64, v36
  v_xor_b32 v39, 96, v36
  v_xor_b32 v40, 128, v36
  v_xor_b32 v41, 160, v36
  v_xor_b32 v42, 192, v36
  buffer_load_dwordx4 v5, s[8:11], s26 offen offset:3072 lds
  v_xor_b32 v43, 224, v36
  v_lshrrev_b32 v100, 4, v103
  v_and_b32 v101, 15, v103
  v_xor_b32 v102, v101, v100
  v_lshlrev_b32 v102, 4, v102
  v_lshl_add_u32 v102, v100, 8, v102
  v_add_u32 v44, s48, v102
  v_xor_b32 v45, 64, v44
  v_xor_b32 v46, 128, v44
  v_xor_b32 v47, 192, v44
  s_add_u32 m0, s28, 69632
  s_nop 0
  buffer_load_dwordx4 v6, s[8:11], s26 offen offset:0 lds
  s_lshl_b32 s35, s25, 2
  s_add_u32 s35, s35, s3
  s_mul_i32 s35, s35, 540672
  s_and_b32 s42, s24, 16
  s_and_b32 s43, s24, 1
  s_lshl_b32 s43, s43, 3
  s_or_b32 s42, s42, s43
  s_bfe_u32 s43, s24, 0x30001
  s_or_b32 s42, s42, s43
  buffer_load_dwordx4 v7, s[8:11], s26 offen offset:1024 lds
  s_lshl_b32 s42, s42, 8
  s_add_u32 s35, s35, s42
  s_cmp_lt_u32 s2, 80
  s_cselect_b32 s92, s46, s96
  s_cselect_b32 s93, s47, s97
  s_cselect_b32 s42, 0, 80
  s_mov_b32 s94, 8388608
  s_cmp_ge_u32 s2, 160
  s_cselect_b32 s92, s98, s92
  s_cselect_b32 s93, s99, s93
  s_cselect_b32 s42, 160, s42
  s_cselect_b32 s94, 3670016, s94
  buffer_load_dwordx4 v8, s[8:11], s26 offen offset:2048 lds
  s_cmp_ge_u32 s2, 200
  s_cselect_b32 s94, 0, s94
  s_mov_b32 s95, 0x20000
  s_sub_u32 s42, s2, s42
  s_lshl_b32 s42, s42, 2
  s_add_u32 s42, s42, s3
  s_mul_i32 s100, s42, 28672
  buffer_load_dwordx4 v9, s[8:11], s26 offen offset:3072 lds
  s_mov_b32 s42, 8388608
  s_cmp_eq_u32 s34, 1
  s_cselect_b32 s42, 16777216, s42
  s_cselect_b32 s43, 14, 0
  s_add_u32 s16, s6, s42
  s_addc_u32 s17, s7, 0
  s_cmp_eq_u32 s34, 2
  s_cselect_b32 s18, 0, 7340032
  s_mov_b32 s19, 0x20000
  s_sub_u32 s43, s101, s43
  s_add_u32 m0, s29, 32768
  s_nop 0
  buffer_load_dwordx4 v10, s[12:15], s27 offen offset:0 lds
  s_lshl_b32 s43, s43, 8
  s_lshl_b32 s30, s25, 2
  s_add_u32 s30, s30, s3
  s_mul_i32 s30, s30, 229376
  s_add_u32 s30, s30, s43
  v_and_b32 v100, 63, v0
  v_lshrrev_b32 v101, 4, v100
  v_and_b32 v100, 15, v100
  s_mov_b32 s41, 3584
  buffer_load_dwordx4 v11, s[12:15], s27 offen offset:1024 lds
  v_mul_lo_u32 v48, v101, s41
  v_lshl_add_u32 v48, v100, 4, v48
  v_bfe_u32 v100, v0, 4, 2
  v_and_b32 v101, 15, v0
  v_lshlrev_b32 v101, 4, v101
  v_lshl_add_u32 v49, v100, 13, v101
  s_lshl_b32 s49, s25, 2
  s_add_u32 s49, s49, s3
  s_lshl_b32 s49, s49, 18
  s_lshl_b32 s42, s24, 8
  buffer_load_dwordx4 v12, s[12:15], s27 offen offset:2048 lds
  s_add_u32 s49, s49, s42
  v_mov_b32 v96, 0xbdd2d3e8
  v_mov_b32 v97, 0xbdd2d3e8
  v_mov_b32 v98, 0xc0135761
  v_mov_b32 v99, 0xc0135761
  v_mov_b32 v100, 1.0
  v_mov_b32 v101, 1.0
  s_lshl_b32 s42, s25, 4
  s_add_u32 s42, s42, s101
  buffer_load_dwordx4 v13, s[12:15], s27 offen offset:3072 lds
  s_lshl_b32 s42, s42, 8
  s_add_u32 s42, s42, 2048
  s_lshl_b32 s43, s25, 8
  s_add_u32 s43, s43, 0
  s_cmp_eq_u32 s34, 1
  s_cselect_b32 s42, s43, s42
  v_mov_b32 v102, s42
  v_mov_b32 v103, 1
  s_cmp_eq_u32 s3, 0
  s_cselect_b32 s63, 1, 0
  s_add_u32 s26, s26, 128
  s_add_u32 s27, s27, 458752
  s_waitcnt vmcnt(12)
  s_barrier
  ds_read_b64_tr_b16 a[64:65], v18 offset:16384
  ds_read_b64_tr_b16 a[66:67], v18 offset:17408
  ds_read_b64_tr_b16 a[68:69], v18 offset:24576
  ds_read_b64_tr_b16 a[70:71], v18 offset:25600
  ds_read_b128 a[0:3], v14 offset:32768
  ds_read_b128 a[16:19], v15 offset:32768
  ds_read_b128 a[4:7], v14 offset:34816
  ds_read_b128 a[20:23], v15 offset:34816
  ds_read_b128 a[8:11], v14 offset:36864
  ds_read_b128 a[24:27], v15 offset:36864
  ds_read_b128 a[12:15], v14 offset:38912
  ds_read_b128 a[28:31], v15 offset:38912
  ds_read_b64_tr_b16 a[72:73], v19 offset:16384
  ds_read_b64_tr_b16 a[74:75], v19 offset:17408
  ds_read_b64_tr_b16 a[76:77], v19 offset:24576
  ds_read_b64_tr_b16 a[78:79], v19 offset:25600
  ds_read_b64_tr_b16 a[80:81], v20 offset:16384
  ds_read_b64_tr_b16 a[82:83], v20 offset:17408
  ds_read_b64_tr_b16 a[84:85], v20 offset:24576
  ds_read_b64_tr_b16 a[86:87], v20 offset:25600
  ds_read_b64_tr_b16 a[88:89], v21 offset:16384
  ds_read_b64_tr_b16 a[90:91], v21 offset:17408
  ds_read_b64_tr_b16 a[92:93], v21 offset:24576
  ds_read_b64_tr_b16 a[94:95], v21 offset:25600
  s_waitcnt lgkmcnt(0)
  v_mfma_f32_16x16x32_bf16 v[128:131], a[64:67], a[0:3], 0
  s_add_u32 m0, s28, 0
  ds_read_b64_tr_b16 a[96:97], v22 offset:16384
  v_mfma_f32_16x16x32_bf16 v[128:131], a[68:71], a[16:19], v[128:131]
  buffer_load_dwordx4 v2, s[8:11], s26 offen offset:0 lds
  v_mfma_f32_16x16x32_bf16 v[132:135], a[68:71], a[20:23], 0
  ds_read_b64_tr_b16 a[98:99], v22 offset:17408
  v_mfma_f32_16x16x32_bf16 v[132:135], a[64:67], a[4:7], v[132:135]
  buffer_load_dwordx4 v3, s[8:11], s26 offen offset:1024 lds
  v_mfma_f32_16x16x32_bf16 v[136:139], a[64:67], a[8:11], 0
  ds_read_b64_tr_b16 a[100:101], v22 offset:24576
  v_mfma_f32_16x16x32_bf16 v[136:139], a[68:71], a[24:27], v[136:139]
  buffer_load_dwordx4 v4, s[8:11], s26 offen offset:2048 lds
  ds_read_b64_tr_b16 a[102:103], v22 offset:25600
  v_mfma_f32_16x16x32_bf16 v[140:143], a[68:71], a[28:31], 0
  buffer_load_dwordx4 v5, s[8:11], s26 offen offset:3072 lds
  v_mfma_f32_16x16x32_bf16 v[140:143], a[64:67], a[12:15], v[140:143]
  s_add_u32 m0, s28, 4096
  v_mfma_f32_16x16x32_bf16 v[156:159], a[72:75], a[12:15], 0
  ds_read_b64_tr_b16 a[104:105], v23 offset:16384
  v_mfma_f32_16x16x32_bf16 v[156:159], a[76:79], a[28:31], v[156:159]
  buffer_load_dwordx4 v6, s[8:11], s26 offen offset:0 lds
  v_mfma_f32_16x16x32_bf16 v[152:155], a[76:79], a[24:27], 0
  ds_read_b64_tr_b16 a[106:107], v23 offset:17408
  v_mfma_f32_16x16x32_bf16 v[152:155], a[72:75], a[8:11], v[152:155]
  buffer_load_dwordx4 v7, s[8:11], s26 offen offset:1024 lds
  ds_read_b64_tr_b16 a[108:109], v23 offset:24576
  v_mfma_f32_16x16x32_bf16 v[148:151], a[72:75], a[4:7], 0
  buffer_load_dwordx4 v8, s[8:11], s26 offen offset:2048 lds
  v_mfma_f32_16x16x32_bf16 v[148:151], a[76:79], a[20:23], v[148:151]
  ds_read_b64_tr_b16 a[110:111], v23 offset:25600
  v_mfma_f32_16x16x32_bf16 v[144:147], a[76:79], a[16:19], 0
  ds_read_b64_tr_b16 a[112:113], v24 offset:16384
  v_mfma_f32_16x16x32_bf16 v[144:147], a[72:75], a[0:3], v[144:147]
  buffer_load_dwordx4 v9, s[8:11], s26 offen offset:3072 lds
  v_mfma_f32_16x16x32_bf16 v[160:163], a[80:83], a[0:3], 0
  s_add_u32 m0, s29, 0
  ds_read_b64_tr_b16 a[114:115], v24 offset:17408
  v_mfma_f32_16x16x32_bf16 v[160:163], a[84:87], a[16:19], v[160:163]
  buffer_load_dwordx4 v10, s[12:15], s27 offen offset:0 lds
  v_mfma_f32_16x16x32_bf16 v[164:167], a[84:87], a[20:23], 0
  ds_read_b64_tr_b16 a[116:117], v24 offset:24576
  v_mfma_f32_16x16x32_bf16 v[164:167], a[80:83], a[4:7], v[164:167]
  buffer_load_dwordx4 v11, s[12:15], s27 offen offset:1024 lds
  v_mfma_f32_16x16x32_bf16 v[168:171], a[80:83], a[8:11], 0
  ds_read_b64_tr_b16 a[118:119], v24 offset:25600
  v_mfma_f32_16x16x32_bf16 v[168:171], a[84:87], a[24:27], v[168:171]
  buffer_load_dwordx4 v12, s[12:15], s27 offen offset:2048 lds
  v_mfma_f32_16x16x32_bf16 v[172:175], a[84:87], a[28:31], 0
  ds_read_b64_tr_b16 a[120:121], v25 offset:16384
  buffer_load_dwordx4 v13, s[12:15], s27 offen offset:3072 lds
  v_mfma_f32_16x16x32_bf16 v[172:175], a[80:83], a[12:15], v[172:175]
  ds_read_b64_tr_b16 a[122:123], v25 offset:17408
  v_mfma_f32_16x16x32_bf16 v[188:191], a[88:91], a[12:15], 0
  s_add_u32 s26, s26, 128
  v_mfma_f32_16x16x32_bf16 v[188:191], a[92:95], a[28:31], v[188:191]
  ds_read_b64_tr_b16 a[124:125], v25 offset:24576
  v_mfma_f32_16x16x32_bf16 v[184:187], a[92:95], a[24:27], 0
  s_add_u32 s27, s27, 458752
  v_mfma_f32_16x16x32_bf16 v[184:187], a[88:91], a[8:11], v[184:187]
  ds_read_b64_tr_b16 a[126:127], v25 offset:25600
  v_mfma_f32_16x16x32_bf16 v[180:183], a[88:91], a[4:7], 0
  v_mfma_f32_16x16x32_bf16 v[180:183], a[92:95], a[20:23], v[180:183]
  v_mfma_f32_16x16x32_bf16 v[176:179], a[92:95], a[16:19], 0
  v_mfma_f32_16x16x32_bf16 v[176:179], a[88:91], a[0:3], v[176:179]
  s_waitcnt lgkmcnt(0) vmcnt(12)
  s_barrier
  v_mfma_f32_16x16x32_bf16 v[192:195], a[96:99], a[0:3], 0
  s_add_u32 m0, s28, 32768
  ds_read_b64_tr_b16 a[64:65], v18 offset:32768
  v_mfma_f32_16x16x32_bf16 v[192:195], a[100:103], a[16:19], v[192:195]
  buffer_load_dwordx4 v2, s[8:11], s26 offen offset:0 lds
  v_mfma_f32_16x16x32_bf16 v[196:199], a[100:103], a[20:23], 0
  ds_read_b64_tr_b16 a[66:67], v18 offset:33792
  v_mfma_f32_16x16x32_bf16 v[196:199], a[96:99], a[4:7], v[196:199]
  ds_read_b64_tr_b16 a[68:69], v18 offset:40960
  v_mfma_f32_16x16x32_bf16 v[200:203], a[96:99], a[8:11], 0
  ds_read_b64_tr_b16 a[70:71], v18 offset:41984
  v_mfma_f32_16x16x32_bf16 v[200:203], a[100:103], a[24:27], v[200:203]
  ds_read_b128 a[32:35], v16 offset:0
  v_mfma_f32_16x16x32_bf16 v[204:207], a[100:103], a[28:31], 0
  buffer_load_dwordx4 v3, s[8:11], s26 offen offset:1024 lds
  v_mfma_f32_16x16x32_bf16 v[204:207], a[96:99], a[12:15], v[204:207]
  ds_read_b128 a[48:51], v17 offset:0
  ds_read_b128 a[36:39], v16 offset:2048
  v_mfma_f32_16x16x32_bf16 v[220:223], a[104:107], a[12:15], 0
  ds_read_b128 a[52:55], v17 offset:2048
  v_mfma_f32_16x16x32_bf16 v[220:223], a[108:111], a[28:31], v[220:223]
  ds_read_b128 a[40:43], v16 offset:4096
  v_mfma_f32_16x16x32_bf16 v[216:219], a[108:111], a[24:27], 0
  buffer_load_dwordx4 v4, s[8:11], s26 offen offset:2048 lds
  v_mfma_f32_16x16x32_bf16 v[216:219], a[104:107], a[8:11], v[216:219]
  ds_read_b128 a[56:59], v17 offset:4096
  v_mfma_f32_16x16x32_bf16 v[212:215], a[104:107], a[4:7], 0
  ds_read_b128 a[44:47], v16 offset:6144
  v_mfma_f32_16x16x32_bf16 v[212:215], a[108:111], a[20:23], v[212:215]
  ds_read_b128 a[60:63], v17 offset:6144
  v_mfma_f32_16x16x32_bf16 v[208:211], a[108:111], a[16:19], 0
  ds_read_b64_tr_b16 a[72:73], v19 offset:32768
  buffer_load_dwordx4 v5, s[8:11], s26 offen offset:3072 lds
  v_mfma_f32_16x16x32_bf16 v[208:211], a[104:107], a[0:3], v[208:211]
  ds_read_b64_tr_b16 a[74:75], v19 offset:33792
  v_mfma_f32_16x16x32_bf16 v[224:227], a[112:115], a[0:3], 0
  ds_read_b64_tr_b16 a[76:77], v19 offset:40960
  v_mfma_f32_16x16x32_bf16 v[224:227], a[116:119], a[16:19], v[224:227]
  ds_read_b64_tr_b16 a[78:79], v19 offset:41984
  v_mfma_f32_16x16x32_bf16 v[228:231], a[116:119], a[20:23], 0
  s_add_u32 m0, s28, 36864
  v_mfma_f32_16x16x32_bf16 v[228:231], a[112:115], a[4:7], v[228:231]
  ds_read_b64_tr_b16 a[80:81], v20 offset:32768
  v_mfma_f32_16x16x32_bf16 v[232:235], a[112:115], a[8:11], 0
  buffer_load_dwordx4 v6, s[8:11], s26 offen offset:0 lds
  v_mfma_f32_16x16x32_bf16 v[232:235], a[116:119], a[24:27], v[232:235]
  ds_read_b64_tr_b16 a[82:83], v20 offset:33792
  ds_read_b64_tr_b16 a[84:85], v20 offset:40960
  v_mfma_f32_16x16x32_bf16 v[236:239], a[116:119], a[28:31], 0
  ds_read_b64_tr_b16 a[86:87], v20 offset:41984
  v_mfma_f32_16x16x32_bf16 v[236:239], a[112:115], a[12:15], v[236:239]
  ds_read_b64_tr_b16 a[88:89], v21 offset:32768
  v_mfma_f32_16x16x32_bf16 v[252:255], a[120:123], a[12:15], 0
  buffer_load_dwordx4 v7, s[8:11], s26 offen offset:1024 lds
  v_mfma_f32_16x16x32_bf16 v[252:255], a[124:127], a[28:31], v[252:255]
  ds_read_b64_tr_b16 a[90:91], v21 offset:33792
  v_mfma_f32_16x16x32_bf16 v[248:251], a[124:127], a[24:27], 0
  ds_read_b64_tr_b16 a[92:93], v21 offset:40960
  v_mfma_f32_16x16x32_bf16 v[248:251], a[120:123], a[8:11], v[248:251]
  ds_read_b64_tr_b16 a[94:95], v21 offset:41984
  v_mfma_f32_16x16x32_bf16 v[244:247], a[120:123], a[4:7], 0
  v_mfma_f32_16x16x32_bf16 v[244:247], a[124:127], a[20:23], v[244:247]
  v_mfma_f32_16x16x32_bf16 v[240:243], a[124:127], a[16:19], 0
  v_mfma_f32_16x16x32_bf16 v[240:243], a[120:123], a[0:3], v[240:243]
  s_waitcnt lgkmcnt(0)
  s_mov_b32 s31, 2
  .p2align 6
zq_loop_1:
  v_mfma_f32_16x16x32_bf16 v[128:131], a[64:67], a[32:35], v[128:131]
  s_add_u32 m0, s28, 36864
  v_mfma_f32_16x16x32_bf16 v[128:131], a[68:71], a[48:51], v[128:131]
  ds_read_b64_tr_b16 a[96:97], v22 offset:32768
  v_mfma_f32_16x16x32_bf16 v[132:135], a[68:71], a[52:55], v[132:135]
  buffer_load_dwordx4 v8, s[8:11], s26 offen offset:2048 lds
  v_mfma_f32_16x16x32_bf16 v[132:135], a[64:67], a[36:39], v[132:135]
  ds_read_b64_tr_b16 a[98:99], v22 offset:33792
  v_mfma_f32_16x16x32_bf16 v[136:139], a[64:67], a[40:43], v[136:139]
  ds_read_b64_tr_b16 a[100:101], v22 offset:40960
  v_mfma_f32_16x16x32_bf16 v[136:139], a[68:71], a[56:59], v[136:139]
  buffer_load_dwordx4 v9, s[8:11], s26 offen offset:3072 lds
  v_mfma_f32_16x16x32_bf16 v[140:143], a[68:71], a[60:63], v[140:143]
  v_mfma_f32_16x16x32_bf16 v[140:143], a[64:67], a[44:47], v[140:143]
  ds_read_b64_tr_b16 a[102:103], v22 offset:41984
  v_mfma_f32_16x16x32_bf16 v[156:159], a[72:75], a[44:47], v[156:159]
  ds_read_b64_tr_b16 a[104:105], v23 offset:32768
  v_mfma_f32_16x16x32_bf16 v[156:159], a[76:79], a[60:63], v[156:159]
  s_add_u32 m0, s29, 16384
  v_mfma_f32_16x16x32_bf16 v[152:155], a[76:79], a[56:59], v[152:155]
  ds_read_b64_tr_b16 a[106:107], v23 offset:33792
  v_mfma_f32_16x16x32_bf16 v[152:155], a[72:75], a[40:43], v[152:155]
  buffer_load_dwordx4 v10, s[12:15], s27 offen offset:0 lds
  v_mfma_f32_16x16x32_bf16 v[148:151], a[72:75], a[36:39], v[148:151]
  ds_read_b64_tr_b16 a[108:109], v23 offset:40960
  v_mfma_f32_16x16x32_bf16 v[148:151], a[76:79], a[52:55], v[148:151]
  v_mfma_f32_16x16x32_bf16 v[144:147], a[76:79], a[48:51], v[144:147]
  ds_read_b64_tr_b16 a[110:111], v23 offset:41984
  v_mfma_f32_16x16x32_bf16 v[144:147], a[72:75], a[32:35], v[144:147]
  ds_read_b64_tr_b16 a[112:113], v24 offset:32768
  v_mfma_f32_16x16x32_bf16 v[160:163], a[80:83], a[32:35], v[160:163]
  buffer_load_dwordx4 v11, s[12:15], s27 offen offset:1024 lds
  v_mfma_f32_16x16x32_bf16 v[160:163], a[84:87], a[48:51], v[160:163]
  ds_read_b64_tr_b16 a[114:115], v24 offset:33792
  v_mfma_f32_16x16x32_bf16 v[164:167], a[84:87], a[52:55], v[164:167]
  ds_read_b64_tr_b16 a[116:117], v24 offset:40960
  v_mfma_f32_16x16x32_bf16 v[164:167], a[80:83], a[36:39], v[164:167]
  buffer_load_dwordx4 v12, s[12:15], s27 offen offset:2048 lds
  v_mfma_f32_16x16x32_bf16 v[168:171], a[80:83], a[40:43], v[168:171]
  v_mfma_f32_16x16x32_bf16 v[168:171], a[84:87], a[56:59], v[168:171]
  ds_read_b64_tr_b16 a[118:119], v24 offset:41984
  v_mfma_f32_16x16x32_bf16 v[172:175], a[84:87], a[60:63], v[172:175]
  ds_read_b64_tr_b16 a[120:121], v25 offset:32768
  v_mfma_f32_16x16x32_bf16 v[172:175], a[80:83], a[44:47], v[172:175]
  ds_read_b64_tr_b16 a[122:123], v25 offset:33792
  v_mfma_f32_16x16x32_bf16 v[188:191], a[88:91], a[44:47], v[188:191]
  buffer_load_dwordx4 v13, s[12:15], s27 offen offset:3072 lds
  v_mfma_f32_16x16x32_bf16 v[188:191], a[92:95], a[60:63], v[188:191]
  ds_read_b64_tr_b16 a[124:125], v25 offset:40960
  v_mfma_f32_16x16x32_bf16 v[184:187], a[92:95], a[56:59], v[184:187]
  ds_read_b64_tr_b16 a[126:127], v25 offset:41984
  v_mfma_f32_16x16x32_bf16 v[184:187], a[88:91], a[40:43], v[184:187]
  v_mfma_f32_16x16x32_bf16 v[180:183], a[88:91], a[36:39], v[180:183]
  v_mfma_f32_16x16x32_bf16 v[180:183], a[92:95], a[52:55], v[180:183]
  v_mfma_f32_16x16x32_bf16 v[176:179], a[92:95], a[48:51], v[176:179]
  s_add_u32 s26, s26, 128
  v_mfma_f32_16x16x32_bf16 v[176:179], a[88:91], a[32:35], v[176:179]
  s_add_u32 s27, s27, 458752
  s_waitcnt lgkmcnt(0) vmcnt(12)
  s_barrier
  v_mfma_f32_16x16x32_bf16 v[192:195], a[96:99], a[32:35], v[192:195]
  s_add_u32 m0, s28, 65536
  ds_read_b64_tr_b16 a[64:65], v18 offset:0
  v_mfma_f32_16x16x32_bf16 v[192:195], a[100:103], a[48:51], v[192:195]
  buffer_load_dwordx4 v2, s[8:11], s26 offen offset:0 lds
  v_mfma_f32_16x16x32_bf16 v[196:199], a[100:103], a[52:55], v[196:199]
  ds_read_b64_tr_b16 a[66:67], v18 offset:1024
  v_mfma_f32_16x16x32_bf16 v[196:199], a[96:99], a[36:39], v[196:199]
  ds_read_b64_tr_b16 a[68:69], v18 offset:8192
  v_mfma_f32_16x16x32_bf16 v[200:203], a[96:99], a[40:43], v[200:203]
  ds_read_b64_tr_b16 a[70:71], v18 offset:9216
  v_mfma_f32_16x16x32_bf16 v[200:203], a[100:103], a[56:59], v[200:203]
  ds_read_b128 a[0:3], v14 offset:0
  v_mfma_f32_16x16x32_bf16 v[204:207], a[100:103], a[60:63], v[204:207]
  buffer_load_dwordx4 v3, s[8:11], s26 offen offset:1024 lds
  v_mfma_f32_16x16x32_bf16 v[204:207], a[96:99], a[44:47], v[204:207]
  ds_read_b128 a[16:19], v15 offset:0
  ds_read_b128 a[4:7], v14 offset:2048
  v_mfma_f32_16x16x32_bf16 v[220:223], a[104:107], a[44:47], v[220:223]
  ds_read_b128 a[20:23], v15 offset:2048
  v_mfma_f32_16x16x32_bf16 v[220:223], a[108:111], a[60:63], v[220:223]
  ds_read_b128 a[8:11], v14 offset:4096
  v_mfma_f32_16x16x32_bf16 v[216:219], a[108:111], a[56:59], v[216:219]
  buffer_load_dwordx4 v4, s[8:11], s26 offen offset:2048 lds
  v_mfma_f32_16x16x32_bf16 v[216:219], a[104:107], a[40:43], v[216:219]
  ds_read_b128 a[24:27], v15 offset:4096
  v_mfma_f32_16x16x32_bf16 v[212:215], a[104:107], a[36:39], v[212:215]
  ds_read_b128 a[12:15], v14 offset:6144
  v_mfma_f32_16x16x32_bf16 v[212:215], a[108:111], a[52:55], v[212:215]
  ds_read_b128 a[28:31], v15 offset:6144
  v_mfma_f32_16x16x32_bf16 v[208:211], a[108:111], a[48:51], v[208:211]
  ds_read_b64_tr_b16 a[72:73], v19 offset:0
  buffer_load_dwordx4 v5, s[8:11], s26 offen offset:3072 lds
  v_mfma_f32_16x16x32_bf16 v[208:211], a[104:107], a[32:35], v[208:211]
  ds_read_b64_tr_b16 a[74:75], v19 offset:1024
  v_mfma_f32_16x16x32_bf16 v[224:227], a[112:115], a[32:35], v[224:227]
  ds_read_b64_tr_b16 a[76:77], v19 offset:8192
  v_mfma_f32_16x16x32_bf16 v[224:227], a[116:119], a[48:51], v[224:227]
  ds_read_b64_tr_b16 a[78:79], v19 offset:9216
  v_mfma_f32_16x16x32_bf16 v[228:231], a[116:119], a[52:55], v[228:231]
  s_add_u32 m0, s28, 69632
  v_mfma_f32_16x16x32_bf16 v[228:231], a[112:115], a[36:39], v[228:231]
  ds_read_b64_tr_b16 a[80:81], v20 offset:0
  v_mfma_f32_16x16x32_bf16 v[232:235], a[112:115], a[40:43], v[232:235]
  buffer_load_dwordx4 v6, s[8:11], s26 offen offset:0 lds
  v_mfma_f32_16x16x32_bf16 v[232:235], a[116:119], a[56:59], v[232:235]
  ds_read_b64_tr_b16 a[82:83], v20 offset:1024
  ds_read_b64_tr_b16 a[84:85], v20 offset:8192
  v_mfma_f32_16x16x32_bf16 v[236:239], a[116:119], a[60:63], v[236:239]
  ds_read_b64_tr_b16 a[86:87], v20 offset:9216
  v_mfma_f32_16x16x32_bf16 v[236:239], a[112:115], a[44:47], v[236:239]
  ds_read_b64_tr_b16 a[88:89], v21 offset:0
  v_mfma_f32_16x16x32_bf16 v[252:255], a[120:123], a[44:47], v[252:255]
  buffer_load_dwordx4 v7, s[8:11], s26 offen offset:1024 lds
  v_mfma_f32_16x16x32_bf16 v[252:255], a[124:127], a[60:63], v[252:255]
  ds_read_b64_tr_b16 a[90:91], v21 offset:1024
  v_mfma_f32_16x16x32_bf16 v[248:251], a[124:127], a[56:59], v[248:251]
  ds_read_b64_tr_b16 a[92:93], v21 offset:8192
  v_mfma_f32_16x16x32_bf16 v[248:251], a[120:123], a[40:43], v[248:251]
  ds_read_b64_tr_b16 a[94:95], v21 offset:9216
  v_mfma_f32_16x16x32_bf16 v[244:247], a[120:123], a[36:39], v[244:247]
  v_mfma_f32_16x16x32_bf16 v[244:247], a[124:127], a[52:55], v[244:247]
  v_mfma_f32_16x16x32_bf16 v[240:243], a[124:127], a[48:51], v[240:243]
  v_mfma_f32_16x16x32_bf16 v[240:243], a[120:123], a[32:35], v[240:243]
  s_waitcnt lgkmcnt(0)
  v_mfma_f32_16x16x32_bf16 v[128:131], a[64:67], a[0:3], v[128:131]
  s_add_u32 m0, s28, 69632
  v_mfma_f32_16x16x32_bf16 v[128:131], a[68:71], a[16:19], v[128:131]
  ds_read_b64_tr_b16 a[96:97], v22 offset:0
  v_mfma_f32_16x16x32_bf16 v[132:135], a[68:71], a[20:23], v[132:135]
  buffer_load_dwordx4 v8, s[8:11], s26 offen offset:2048 lds
  v_mfma_f32_16x16x32_bf16 v[132:135], a[64:67], a[4:7], v[132:135]
  ds_read_b64_tr_b16 a[98:99], v22 offset:1024
  v_mfma_f32_16x16x32_bf16 v[136:139], a[64:67], a[8:11], v[136:139]
  ds_read_b64_tr_b16 a[100:101], v22 offset:8192
  v_mfma_f32_16x16x32_bf16 v[136:139], a[68:71], a[24:27], v[136:139]
  buffer_load_dwordx4 v9, s[8:11], s26 offen offset:3072 lds
  v_mfma_f32_16x16x32_bf16 v[140:143], a[68:71], a[28:31], v[140:143]
  v_mfma_f32_16x16x32_bf16 v[140:143], a[64:67], a[12:15], v[140:143]
  ds_read_b64_tr_b16 a[102:103], v22 offset:9216
  v_mfma_f32_16x16x32_bf16 v[156:159], a[72:75], a[12:15], v[156:159]
  ds_read_b64_tr_b16 a[104:105], v23 offset:0
  v_mfma_f32_16x16x32_bf16 v[156:159], a[76:79], a[28:31], v[156:159]
  s_add_u32 m0, s29, 32768
  v_mfma_f32_16x16x32_bf16 v[152:155], a[76:79], a[24:27], v[152:155]
  ds_read_b64_tr_b16 a[106:107], v23 offset:1024
  v_mfma_f32_16x16x32_bf16 v[152:155], a[72:75], a[8:11], v[152:155]
  buffer_load_dwordx4 v10, s[12:15], s27 offen offset:0 lds
  v_mfma_f32_16x16x32_bf16 v[148:151], a[72:75], a[4:7], v[148:151]
  ds_read_b64_tr_b16 a[108:109], v23 offset:8192
  v_mfma_f32_16x16x32_bf16 v[148:151], a[76:79], a[20:23], v[148:151]
  v_mfma_f32_16x16x32_bf16 v[144:147], a[76:79], a[16:19], v[144:147]
  ds_read_b64_tr_b16 a[110:111], v23 offset:9216
  v_mfma_f32_16x16x32_bf16 v[144:147], a[72:75], a[0:3], v[144:147]
  ds_read_b64_tr_b16 a[112:113], v24 offset:0
  v_mfma_f32_16x16x32_bf16 v[160:163], a[80:83], a[0:3], v[160:163]
  buffer_load_dwordx4 v11, s[12:15], s27 offen offset:1024 lds
  v_mfma_f32_16x16x32_bf16 v[160:163], a[84:87], a[16:19], v[160:163]
  ds_read_b64_tr_b16 a[114:115], v24 offset:1024
  v_mfma_f32_16x16x32_bf16 v[164:167], a[84:87], a[20:23], v[164:167]
  ds_read_b64_tr_b16 a[116:117], v24 offset:8192
  v_mfma_f32_16x16x32_bf16 v[164:167], a[80:83], a[4:7], v[164:167]
  buffer_load_dwordx4 v12, s[12:15], s27 offen offset:2048 lds
  v_mfma_f32_16x16x32_bf16 v[168:171], a[80:83], a[8:11], v[168:171]
  v_mfma_f32_16x16x32_bf16 v[168:171], a[84:87], a[24:27], v[168:171]
  ds_read_b64_tr_b16 a[118:119], v24 offset:9216
  v_mfma_f32_16x16x32_bf16 v[172:175], a[84:87], a[28:31], v[172:175]
  ds_read_b64_tr_b16 a[120:121], v25 offset:0
  v_mfma_f32_16x16x32_bf16 v[172:175], a[80:83], a[12:15], v[172:175]
  ds_read_b64_tr_b16 a[122:123], v25 offset:1024
  v_mfma_f32_16x16x32_bf16 v[188:191], a[88:91], a[12:15], v[188:191]
  buffer_load_dwordx4 v13, s[12:15], s27 offen offset:3072 lds
  v_mfma_f32_16x16x32_bf16 v[188:191], a[92:95], a[28:31], v[188:191]
  ds_read_b64_tr_b16 a[124:125], v25 offset:8192
  v_mfma_f32_16x16x32_bf16 v[184:187], a[92:95], a[24:27], v[184:187]
  ds_read_b64_tr_b16 a[126:127], v25 offset:9216
  v_mfma_f32_16x16x32_bf16 v[184:187], a[88:91], a[8:11], v[184:187]
  v_mfma_f32_16x16x32_bf16 v[180:183], a[88:91], a[4:7], v[180:183]
  v_mfma_f32_16x16x32_bf16 v[180:183], a[92:95], a[20:23], v[180:183]
  v_mfma_f32_16x16x32_bf16 v[176:179], a[92:95], a[16:19], v[176:179]
  s_add_u32 s26, s26, 128
  v_mfma_f32_16x16x32_bf16 v[176:179], a[88:91], a[0:3], v[176:179]
  s_add_u32 s27, s27, 458752
  s_waitcnt lgkmcnt(0) vmcnt(12)
  s_barrier
  v_mfma_f32_16x16x32_bf16 v[192:195], a[96:99], a[0:3], v[192:195]
  s_add_u32 m0, s28, 0
  ds_read_b64_tr_b16 a[64:65], v18 offset:16384
  v_mfma_f32_16x16x32_bf16 v[192:195], a[100:103], a[16:19], v[192:195]
  buffer_load_dwordx4 v2, s[8:11], s26 offen offset:0 lds
  v_mfma_f32_16x16x32_bf16 v[196:199], a[100:103], a[20:23], v[196:199]
  ds_read_b64_tr_b16 a[66:67], v18 offset:17408
  v_mfma_f32_16x16x32_bf16 v[196:199], a[96:99], a[4:7], v[196:199]
  ds_read_b64_tr_b16 a[68:69], v18 offset:24576
  v_mfma_f32_16x16x32_bf16 v[200:203], a[96:99], a[8:11], v[200:203]
  ds_read_b64_tr_b16 a[70:71], v18 offset:25600
  v_mfma_f32_16x16x32_bf16 v[200:203], a[100:103], a[24:27], v[200:203]
  ds_read_b128 a[32:35], v14 offset:32768
  v_mfma_f32_16x16x32_bf16 v[204:207], a[100:103], a[28:31], v[204:207]
  buffer_load_dwordx4 v3, s[8:11], s26 offen offset:1024 lds
  v_mfma_f32_16x16x32_bf16 v[204:207], a[96:99], a[12:15], v[204:207]
  ds_read_b128 a[48:51], v15 offset:32768
  ds_read_b128 a[36:39], v14 offset:34816
  v_mfma_f32_16x16x32_bf16 v[220:223], a[104:107], a[12:15], v[220:223]
  ds_read_b128 a[52:55], v15 offset:34816
  v_mfma_f32_16x16x32_bf16 v[220:223], a[108:111], a[28:31], v[220:223]
  ds_read_b128 a[40:43], v14 offset:36864
  v_mfma_f32_16x16x32_bf16 v[216:219], a[108:111], a[24:27], v[216:219]
  buffer_load_dwordx4 v4, s[8:11], s26 offen offset:2048 lds
  v_mfma_f32_16x16x32_bf16 v[216:219], a[104:107], a[8:11], v[216:219]
  ds_read_b128 a[56:59], v15 offset:36864
  v_mfma_f32_16x16x32_bf16 v[212:215], a[104:107], a[4:7], v[212:215]
  ds_read_b128 a[44:47], v14 offset:38912
  v_mfma_f32_16x16x32_bf16 v[212:215], a[108:111], a[20:23], v[212:215]
  ds_read_b128 a[60:63], v15 offset:38912
  v_mfma_f32_16x16x32_bf16 v[208:211], a[108:111], a[16:19], v[208:211]
  ds_read_b64_tr_b16 a[72:73], v19 offset:16384
  buffer_load_dwordx4 v5, s[8:11], s26 offen offset:3072 lds
  v_mfma_f32_16x16x32_bf16 v[208:211], a[104:107], a[0:3], v[208:211]
  ds_read_b64_tr_b16 a[74:75], v19 offset:17408
  v_mfma_f32_16x16x32_bf16 v[224:227], a[112:115], a[0:3], v[224:227]
  ds_read_b64_tr_b16 a[76:77], v19 offset:24576
  v_mfma_f32_16x16x32_bf16 v[224:227], a[116:119], a[16:19], v[224:227]
  ds_read_b64_tr_b16 a[78:79], v19 offset:25600
  v_mfma_f32_16x16x32_bf16 v[228:231], a[116:119], a[20:23], v[228:231]
  s_add_u32 m0, s28, 4096
  v_mfma_f32_16x16x32_bf16 v[228:231], a[112:115], a[4:7], v[228:231]
  ds_read_b64_tr_b16 a[80:81], v20 offset:16384
  v_mfma_f32_16x16x32_bf16 v[232:235], a[112:115], a[8:11], v[232:235]
  buffer_load_dwordx4 v6, s[8:11], s26 offen offset:0 lds
  v_mfma_f32_16x16x32_bf16 v[232:235], a[116:119], a[24:27], v[232:235]
  ds_read_b64_tr_b16 a[82:83], v20 offset:17408
  ds_read_b64_tr_b16 a[84:85], v20 offset:24576
  v_mfma_f32_16x16x32_bf16 v[236:239], a[116:119], a[28:31], v[236:239]
  ds_read_b64_tr_b16 a[86:87], v20 offset:25600
  v_mfma_f32_16x16x32_bf16 v[236:239], a[112:115], a[12:15], v[236:239]
  ds_read_b64_tr_b16 a[88:89], v21 offset:16384
  v_mfma_f32_16x16x32_bf16 v[252:255], a[120:123], a[12:15], v[252:255]
  buffer_load_dwordx4 v7, s[8:11], s26 offen offset:1024 lds
  v_mfma_f32_16x16x32_bf16 v[252:255], a[124:127], a[28:31], v[252:255]
  ds_read_b64_tr_b16 a[90:91], v21 offset:17408
  v_mfma_f32_16x16x32_bf16 v[248:251], a[124:127], a[24:27], v[248:251]
  ds_read_b64_tr_b16 a[92:93], v21 offset:24576
  v_mfma_f32_16x16x32_bf16 v[248:251], a[120:123], a[8:11], v[248:251]
  ds_read_b64_tr_b16 a[94:95], v21 offset:25600
  v_mfma_f32_16x16x32_bf16 v[244:247], a[120:123], a[4:7], v[244:247]
  v_mfma_f32_16x16x32_bf16 v[244:247], a[124:127], a[20:23], v[244:247]
  v_mfma_f32_16x16x32_bf16 v[240:243], a[124:127], a[16:19], v[240:243]
  v_mfma_f32_16x16x32_bf16 v[240:243], a[120:123], a[0:3], v[240:243]
  s_waitcnt lgkmcnt(0)
  v_mfma_f32_16x16x32_bf16 v[128:131], a[64:67], a[32:35], v[128:131]
  s_add_u32 m0, s28, 4096
  v_mfma_f32_16x16x32_bf16 v[128:131], a[68:71], a[48:51], v[128:131]
  ds_read_b64_tr_b16 a[96:97], v22 offset:16384
  v_mfma_f32_16x16x32_bf16 v[132:135], a[68:71], a[52:55], v[132:135]
  buffer_load_dwordx4 v8, s[8:11], s26 offen offset:2048 lds
  v_mfma_f32_16x16x32_bf16 v[132:135], a[64:67], a[36:39], v[132:135]
  ds_read_b64_tr_b16 a[98:99], v22 offset:17408
  v_mfma_f32_16x16x32_bf16 v[136:139], a[64:67], a[40:43], v[136:139]
  ds_read_b64_tr_b16 a[100:101], v22 offset:24576
  v_mfma_f32_16x16x32_bf16 v[136:139], a[68:71], a[56:59], v[136:139]
  buffer_load_dwordx4 v9, s[8:11], s26 offen offset:3072 lds
  v_mfma_f32_16x16x32_bf16 v[140:143], a[68:71], a[60:63], v[140:143]
  v_mfma_f32_16x16x32_bf16 v[140:143], a[64:67], a[44:47], v[140:143]
  ds_read_b64_tr_b16 a[102:103], v22 offset:25600
  v_mfma_f32_16x16x32_bf16 v[156:159], a[72:75], a[44:47], v[156:159]
  ds_read_b64_tr_b16 a[104:105], v23 offset:16384
  v_mfma_f32_16x16x32_bf16 v[156:159], a[76:79], a[60:63], v[156:159]
  s_add_u32 m0, s29, 0
  v_mfma_f32_16x16x32_bf16 v[152:155], a[76:79], a[56:59], v[152:155]
  ds_read_b64_tr_b16 a[106:107], v23 offset:17408
  v_mfma_f32_16x16x32_bf16 v[152:155], a[72:75], a[40:43], v[152:155]
  buffer_load_dwordx4 v10, s[12:15], s27 offen offset:0 lds
  v_mfma_f32_16x16x32_bf16 v[148:151], a[72:75], a[36:39], v[148:151]
  ds_read_b64_tr_b16 a[108:109], v23 offset:24576
  v_mfma_f32_16x16x32_bf16 v[148:151], a[76:79], a[52:55], v[148:151]
  v_mfma_f32_16x16x32_bf16 v[144:147], a[76:79], a[48:51], v[144:147]
  ds_read_b64_tr_b16 a[110:111], v23 offset:25600
  v_mfma_f32_16x16x32_bf16 v[144:147], a[72:75], a[32:35], v[144:147]
  ds_read_b64_tr_b16 a[112:113], v24 offset:16384
  v_mfma_f32_16x16x32_bf16 v[160:163], a[80:83], a[32:35], v[160:163]
  buffer_load_dwordx4 v11, s[12:15], s27 offen offset:1024 lds
  v_mfma_f32_16x16x32_bf16 v[160:163], a[84:87], a[48:51], v[160:163]
  ds_read_b64_tr_b16 a[114:115], v24 offset:17408
  v_mfma_f32_16x16x32_bf16 v[164:167], a[84:87], a[52:55], v[164:167]
  ds_read_b64_tr_b16 a[116:117], v24 offset:24576
  v_mfma_f32_16x16x32_bf16 v[164:167], a[80:83], a[36:39], v[164:167]
  buffer_load_dwordx4 v12, s[12:15], s27 offen offset:2048 lds
  v_mfma_f32_16x16x32_bf16 v[168:171], a[80:83], a[40:43], v[168:171]
  v_mfma_f32_16x16x32_bf16 v[168:171], a[84:87], a[56:59], v[168:171]
  ds_read_b64_tr_b16 a[118:119], v24 offset:25600
  v_mfma_f32_16x16x32_bf16 v[172:175], a[84:87], a[60:63], v[172:175]
  ds_read_b64_tr_b16 a[120:121], v25 offset:16384
  v_mfma_f32_16x16x32_bf16 v[172:175], a[80:83], a[44:47], v[172:175]
  ds_read_b64_tr_b16 a[122:123], v25 offset:17408
  v_mfma_f32_16x16x32_bf16 v[188:191], a[88:91], a[44:47], v[188:191]
  buffer_load_dwordx4 v13, s[12:15], s27 offen offset:3072 lds
  v_mfma_f32_16x16x32_bf16 v[188:191], a[92:95], a[60:63], v[188:191]
  ds_read_b64_tr_b16 a[124:125], v25 offset:24576
  v_mfma_f32_16x16x32_bf16 v[184:187], a[92:95], a[56:59], v[184:187]
  ds_read_b64_tr_b16 a[126:127], v25 offset:25600
  v_mfma_f32_16x16x32_bf16 v[184:187], a[88:91], a[40:43], v[184:187]
  v_mfma_f32_16x16x32_bf16 v[180:183], a[88:91], a[36:39], v[180:183]
  v_mfma_f32_16x16x32_bf16 v[180:183], a[92:95], a[52:55], v[180:183]
  v_mfma_f32_16x16x32_bf16 v[176:179], a[92:95], a[48:51], v[176:179]
  s_add_u32 s26, s26, 128
  v_mfma_f32_16x16x32_bf16 v[176:179], a[88:91], a[32:35], v[176:179]
  s_add_u32 s27, s27, 458752
  s_waitcnt lgkmcnt(0) vmcnt(12)
  s_barrier
  v_mfma_f32_16x16x32_bf16 v[192:195], a[96:99], a[32:35], v[192:195]
  s_add_u32 m0, s28, 32768
  ds_read_b64_tr_b16 a[64:65], v18 offset:32768
  v_mfma_f32_16x16x32_bf16 v[192:195], a[100:103], a[48:51], v[192:195]
  buffer_load_dwordx4 v2, s[8:11], s26 offen offset:0 lds
  v_mfma_f32_16x16x32_bf16 v[196:199], a[100:103], a[52:55], v[196:199]
  ds_read_b64_tr_b16 a[66:67], v18 offset:33792
  v_mfma_f32_16x16x32_bf16 v[196:199], a[96:99], a[36:39], v[196:199]
  ds_read_b64_tr_b16 a[68:69], v18 offset:40960
  v_mfma_f32_16x16x32_bf16 v[200:203], a[96:99], a[40:43], v[200:203]
  ds_read_b64_tr_b16 a[70:71], v18 offset:41984
  v_mfma_f32_16x16x32_bf16 v[200:203], a[100:103], a[56:59], v[200:203]
  ds_read_b128 a[0:3], v16 offset:0
  v_mfma_f32_16x16x32_bf16 v[204:207], a[100:103], a[60:63], v[204:207]
  buffer_load_dwordx4 v3, s[8:11], s26 offen offset:1024 lds
  v_mfma_f32_16x16x32_bf16 v[204:207], a[96:99], a[44:47], v[204:207]
  ds_read_b128 a[16:19], v17 offset:0
  ds_read_b128 a[4:7], v16 offset:2048
  v_mfma_f32_16x16x32_bf16 v[220:223], a[104:107], a[44:47], v[220:223]
  ds_read_b128 a[20:23], v17 offset:2048
  v_mfma_f32_16x16x32_bf16 v[220:223], a[108:111], a[60:63], v[220:223]
  ds_read_b128 a[8:11], v16 offset:4096
  v_mfma_f32_16x16x32_bf16 v[216:219], a[108:111], a[56:59], v[216:219]
  buffer_load_dwordx4 v4, s[8:11], s26 offen offset:2048 lds
  v_mfma_f32_16x16x32_bf16 v[216:219], a[104:107], a[40:43], v[216:219]
  ds_read_b128 a[24:27], v17 offset:4096
  v_mfma_f32_16x16x32_bf16 v[212:215], a[104:107], a[36:39], v[212:215]
  ds_read_b128 a[12:15], v16 offset:6144
  v_mfma_f32_16x16x32_bf16 v[212:215], a[108:111], a[52:55], v[212:215]
  ds_read_b128 a[28:31], v17 offset:6144
  v_mfma_f32_16x16x32_bf16 v[208:211], a[108:111], a[48:51], v[208:211]
  ds_read_b64_tr_b16 a[72:73], v19 offset:32768
  buffer_load_dwordx4 v5, s[8:11], s26 offen offset:3072 lds
  v_mfma_f32_16x16x32_bf16 v[208:211], a[104:107], a[32:35], v[208:211]
  ds_read_b64_tr_b16 a[74:75], v19 offset:33792
  v_mfma_f32_16x16x32_bf16 v[224:227], a[112:115], a[32:35], v[224:227]
  ds_read_b64_tr_b16 a[76:77], v19 offset:40960
  v_mfma_f32_16x16x32_bf16 v[224:227], a[116:119], a[48:51], v[224:227]
  ds_read_b64_tr_b16 a[78:79], v19 offset:41984
  v_mfma_f32_16x16x32_bf16 v[228:231], a[116:119], a[52:55], v[228:231]
  s_add_u32 m0, s28, 36864
  v_mfma_f32_16x16x32_bf16 v[228:231], a[112:115], a[36:39], v[228:231]
  ds_read_b64_tr_b16 a[80:81], v20 offset:32768
  v_mfma_f32_16x16x32_bf16 v[232:235], a[112:115], a[40:43], v[232:235]
  buffer_load_dwordx4 v6, s[8:11], s26 offen offset:0 lds
  v_mfma_f32_16x16x32_bf16 v[232:235], a[116:119], a[56:59], v[232:235]
  ds_read_b64_tr_b16 a[82:83], v20 offset:33792
  ds_read_b64_tr_b16 a[84:85], v20 offset:40960
  v_mfma_f32_16x16x32_bf16 v[236:239], a[116:119], a[60:63], v[236:239]
  ds_read_b64_tr_b16 a[86:87], v20 offset:41984
  v_mfma_f32_16x16x32_bf16 v[236:239], a[112:115], a[44:47], v[236:239]
  ds_read_b64_tr_b16 a[88:89], v21 offset:32768
  v_mfma_f32_16x16x32_bf16 v[252:255], a[120:123], a[44:47], v[252:255]
  buffer_load_dwordx4 v7, s[8:11], s26 offen offset:1024 lds
  v_mfma_f32_16x16x32_bf16 v[252:255], a[124:127], a[60:63], v[252:255]
  ds_read_b64_tr_b16 a[90:91], v21 offset:33792
  v_mfma_f32_16x16x32_bf16 v[248:251], a[124:127], a[56:59], v[248:251]
  ds_read_b64_tr_b16 a[92:93], v21 offset:40960
  v_mfma_f32_16x16x32_bf16 v[248:251], a[120:123], a[40:43], v[248:251]
  ds_read_b64_tr_b16 a[94:95], v21 offset:41984
  v_mfma_f32_16x16x32_bf16 v[244:247], a[120:123], a[36:39], v[244:247]
  v_mfma_f32_16x16x32_bf16 v[244:247], a[124:127], a[52:55], v[244:247]
  v_mfma_f32_16x16x32_bf16 v[240:243], a[124:127], a[48:51], v[240:243]
  v_mfma_f32_16x16x32_bf16 v[240:243], a[120:123], a[32:35], v[240:243]
  s_waitcnt lgkmcnt(0)
  v_mfma_f32_16x16x32_bf16 v[128:131], a[64:67], a[0:3], v[128:131]
  s_add_u32 m0, s28, 36864
  v_mfma_f32_16x16x32_bf16 v[128:131], a[68:71], a[16:19], v[128:131]
  ds_read_b64_tr_b16 a[96:97], v22 offset:32768
  v_mfma_f32_16x16x32_bf16 v[132:135], a[68:71], a[20:23], v[132:135]
  buffer_load_dwordx4 v8, s[8:11], s26 offen offset:2048 lds
  v_mfma_f32_16x16x32_bf16 v[132:135], a[64:67], a[4:7], v[132:135]
  ds_read_b64_tr_b16 a[98:99], v22 offset:33792
  v_mfma_f32_16x16x32_bf16 v[136:139], a[64:67], a[8:11], v[136:139]
  ds_read_b64_tr_b16 a[100:101], v22 offset:40960
  v_mfma_f32_16x16x32_bf16 v[136:139], a[68:71], a[24:27], v[136:139]
  buffer_load_dwordx4 v9, s[8:11], s26 offen offset:3072 lds
  v_mfma_f32_16x16x32_bf16 v[140:143], a[68:71], a[28:31], v[140:143]
  v_mfma_f32_16x16x32_bf16 v[140:143], a[64:67], a[12:15], v[140:143]
  ds_read_b64_tr_b16 a[102:103], v22 offset:41984
  v_mfma_f32_16x16x32_bf16 v[156:159], a[72:75], a[12:15], v[156:159]
  ds_read_b64_tr_b16 a[104:105], v23 offset:32768
  v_mfma_f32_16x16x32_bf16 v[156:159], a[76:79], a[28:31], v[156:159]
  s_add_u32 m0, s29, 16384
  v_mfma_f32_16x16x32_bf16 v[152:155], a[76:79], a[24:27], v[152:155]
  ds_read_b64_tr_b16 a[106:107], v23 offset:33792
  v_mfma_f32_16x16x32_bf16 v[152:155], a[72:75], a[8:11], v[152:155]
  buffer_load_dwordx4 v10, s[12:15], s27 offen offset:0 lds
  v_mfma_f32_16x16x32_bf16 v[148:151], a[72:75], a[4:7], v[148:151]
  ds_read_b64_tr_b16 a[108:109], v23 offset:40960
  v_mfma_f32_16x16x32_bf16 v[148:151], a[76:79], a[20:23], v[148:151]
  v_mfma_f32_16x16x32_bf16 v[144:147], a[76:79], a[16:19], v[144:147]
  ds_read_b64_tr_b16 a[110:111], v23 offset:41984
  v_mfma_f32_16x16x32_bf16 v[144:147], a[72:75], a[0:3], v[144:147]
  ds_read_b64_tr_b16 a[112:113], v24 offset:32768
  v_mfma_f32_16x16x32_bf16 v[160:163], a[80:83], a[0:3], v[160:163]
  buffer_load_dwordx4 v11, s[12:15], s27 offen offset:1024 lds
  v_mfma_f32_16x16x32_bf16 v[160:163], a[84:87], a[16:19], v[160:163]
  ds_read_b64_tr_b16 a[114:115], v24 offset:33792
  v_mfma_f32_16x16x32_bf16 v[164:167], a[84:87], a[20:23], v[164:167]
  ds_read_b64_tr_b16 a[116:117], v24 offset:40960
  v_mfma_f32_16x16x32_bf16 v[164:167], a[80:83], a[4:7], v[164:167]
  buffer_load_dwordx4 v12, s[12:15], s27 offen offset:2048 lds
  v_mfma_f32_16x16x32_bf16 v[168:171], a[80:83], a[8:11], v[168:171]
  v_mfma_f32_16x16x32_bf16 v[168:171], a[84:87], a[24:27], v[168:171]
  ds_read_b64_tr_b16 a[118:119], v24 offset:41984
  v_mfma_f32_16x16x32_bf16 v[172:175], a[84:87], a[28:31], v[172:175]
  ds_read_b64_tr_b16 a[120:121], v25 offset:32768
  v_mfma_f32_16x16x32_bf16 v[172:175], a[80:83], a[12:15], v[172:175]
  ds_read_b64_tr_b16 a[122:123], v25 offset:33792
  v_mfma_f32_16x16x32_bf16 v[188:191], a[88:91], a[12:15], v[188:191]
  buffer_load_dwordx4 v13, s[12:15], s27 offen offset:3072 lds
  v_mfma_f32_16x16x32_bf16 v[188:191], a[92:95], a[28:31], v[188:191]
  ds_read_b64_tr_b16 a[124:125], v25 offset:40960
  v_mfma_f32_16x16x32_bf16 v[184:187], a[92:95], a[24:27], v[184:187]
  ds_read_b64_tr_b16 a[126:127], v25 offset:41984
  v_mfma_f32_16x16x32_bf16 v[184:187], a[88:91], a[8:11], v[184:187]
  v_mfma_f32_16x16x32_bf16 v[180:183], a[88:91], a[4:7], v[180:183]
  v_mfma_f32_16x16x32_bf16 v[180:183], a[92:95], a[20:23], v[180:183]
  v_mfma_f32_16x16x32_bf16 v[176:179], a[92:95], a[16:19], v[176:179]
  s_add_u32 s26, s26, 128
  v_mfma_f32_16x16x32_bf16 v[176:179], a[88:91], a[0:3], v[176:179]
  s_add_u32 s27, s27, 458752
  s_waitcnt lgkmcnt(0) vmcnt(12)
  s_barrier
  v_mfma_f32_16x16x32_bf16 v[192:195], a[96:99], a[0:3], v[192:195]
  s_add_u32 m0, s28, 65536
  ds_read_b64_tr_b16 a[64:65], v18 offset:0
  v_mfma_f32_16x16x32_bf16 v[192:195], a[100:103], a[16:19], v[192:195]
  buffer_load_dwordx4 v2, s[8:11], s26 offen offset:0 lds
  v_mfma_f32_16x16x32_bf16 v[196:199], a[100:103], a[20:23], v[196:199]
  ds_read_b64_tr_b16 a[66:67], v18 offset:1024
  v_mfma_f32_16x16x32_bf16 v[196:199], a[96:99], a[4:7], v[196:199]
  ds_read_b64_tr_b16 a[68:69], v18 offset:8192
  v_mfma_f32_16x16x32_bf16 v[200:203], a[96:99], a[8:11], v[200:203]
  ds_read_b64_tr_b16 a[70:71], v18 offset:9216
  v_mfma_f32_16x16x32_bf16 v[200:203], a[100:103], a[24:27], v[200:203]
  ds_read_b128 a[32:35], v14 offset:0
  v_mfma_f32_16x16x32_bf16 v[204:207], a[100:103], a[28:31], v[204:207]
  buffer_load_dwordx4 v3, s[8:11], s26 offen offset:1024 lds
  v_mfma_f32_16x16x32_bf16 v[204:207], a[96:99], a[12:15], v[204:207]
  ds_read_b128 a[48:51], v15 offset:0
  ds_read_b128 a[36:39], v14 offset:2048
  v_mfma_f32_16x16x32_bf16 v[220:223], a[104:107], a[12:15], v[220:223]
  ds_read_b128 a[52:55], v15 offset:2048
  v_mfma_f32_16x16x32_bf16 v[220:223], a[108:111], a[28:31], v[220:223]
  ds_read_b128 a[40:43], v14 offset:4096
  v_mfma_f32_16x16x32_bf16 v[216:219], a[108:111], a[24:27], v[216:219]
  buffer_load_dwordx4 v4, s[8:11], s26 offen offset:2048 lds
  v_mfma_f32_16x16x32_bf16 v[216:219], a[104:107], a[8:11], v[216:219]
  ds_read_b128 a[56:59], v15 offset:4096
  v_mfma_f32_16x16x32_bf16 v[212:215], a[104:107], a[4:7], v[212:215]
  ds_read_b128 a[44:47], v14 offset:6144
  v_mfma_f32_16x16x32_bf16 v[212:215], a[108:111], a[20:23], v[212:215]
  ds_read_b128 a[60:63], v15 offset:6144
  v_mfma_f32_16x16x32_bf16 v[208:211], a[108:111], a[16:19], v[208:211]
  ds_read_b64_tr_b16 a[72:73], v19 offset:0
  buffer_load_dwordx4 v5, s[8:11], s26 offen offset:3072 lds
  v_mfma_f32_16x16x32_bf16 v[208:211], a[104:107], a[0:3], v[208:211]
  ds_read_b64_tr_b16 a[74:75], v19 offset:1024
  v_mfma_f32_16x16x32_bf16 v[224:227], a[112:115], a[0:3], v[224:227]
  ds_read_b64_tr_b16 a[76:77], v19 offset:8192
  v_mfma_f32_16x16x32_bf16 v[224:227], a[116:119], a[16:19], v[224:227]
  ds_read_b64_tr_b16 a[78:79], v19 offset:9216
  v_mfma_f32_16x16x32_bf16 v[228:231], a[116:119], a[20:23], v[228:231]
  s_add_u32 m0, s28, 69632
  v_mfma_f32_16x16x32_bf16 v[228:231], a[112:115], a[4:7], v[228:231]
  ds_read_b64_tr_b16 a[80:81], v20 offset:0
  v_mfma_f32_16x16x32_bf16 v[232:235], a[112:115], a[8:11], v[232:235]
  buffer_load_dwordx4 v6, s[8:11], s26 offen offset:0 lds
  v_mfma_f32_16x16x32_bf16 v[232:235], a[116:119], a[24:27], v[232:235]
  ds_read_b64_tr_b16 a[82:83], v20 offset:1024
  ds_read_b64_tr_b16 a[84:85], v20 offset:8192
  v_mfma_f32_16x16x32_bf16 v[236:239], a[116:119], a[28:31], v[236:239]
  ds_read_b64_tr_b16 a[86:87], v20 offset:9216
  v_mfma_f32_16x16x32_bf16 v[236:239], a[112:115], a[12:15], v[236:239]
  ds_read_b64_tr_b16 a[88:89], v21 offset:0
  v_mfma_f32_16x16x32_bf16 v[252:255], a[120:123], a[12:15], v[252:255]
  buffer_load_dwordx4 v7, s[8:11], s26 offen offset:1024 lds
  v_mfma_f32_16x16x32_bf16 v[252:255], a[124:127], a[28:31], v[252:255]
  ds_read_b64_tr_b16 a[90:91], v21 offset:1024
  v_mfma_f32_16x16x32_bf16 v[248:251], a[124:127], a[24:27], v[248:251]
  ds_read_b64_tr_b16 a[92:93], v21 offset:8192
  v_mfma_f32_16x16x32_bf16 v[248:251], a[120:123], a[8:11], v[248:251]
  ds_read_b64_tr_b16 a[94:95], v21 offset:9216
  v_mfma_f32_16x16x32_bf16 v[244:247], a[120:123], a[4:7], v[244:247]
  v_mfma_f32_16x16x32_bf16 v[244:247], a[124:127], a[20:23], v[244:247]
  v_mfma_f32_16x16x32_bf16 v[240:243], a[124:127], a[16:19], v[240:243]
  v_mfma_f32_16x16x32_bf16 v[240:243], a[120:123], a[0:3], v[240:243]
  s_waitcnt lgkmcnt(0)
  v_mfma_f32_16x16x32_bf16 v[128:131], a[64:67], a[32:35], v[128:131]
  s_add_u32 m0, s28, 69632
  v_mfma_f32_16x16x32_bf16 v[128:131], a[68:71], a[48:51], v[128:131]
  ds_read_b64_tr_b16 a[96:97], v22 offset:0
  v_mfma_f32_16x16x32_bf16 v[132:135], a[68:71], a[52:55], v[132:135]
  buffer_load_dwordx4 v8, s[8:11], s26 offen offset:2048 lds
  v_mfma_f32_16x16x32_bf16 v[132:135], a[64:67], a[36:39], v[132:135]
  ds_read_b64_tr_b16 a[98:99], v22 offset:1024
  v_mfma_f32_16x16x32_bf16 v[136:139], a[64:67], a[40:43], v[136:139]
  ds_read_b64_tr_b16 a[100:101], v22 offset:8192
  v_mfma_f32_16x16x32_bf16 v[136:139], a[68:71], a[56:59], v[136:139]
  buffer_load_dwordx4 v9, s[8:11], s26 offen offset:3072 lds
  v_mfma_f32_16x16x32_bf16 v[140:143], a[68:71], a[60:63], v[140:143]
  v_mfma_f32_16x16x32_bf16 v[140:143], a[64:67], a[44:47], v[140:143]
  ds_read_b64_tr_b16 a[102:103], v22 offset:9216
  v_mfma_f32_16x16x32_bf16 v[156:159], a[72:75], a[44:47], v[156:159]
  ds_read_b64_tr_b16 a[104:105], v23 offset:0
  v_mfma_f32_16x16x32_bf16 v[156:159], a[76:79], a[60:63], v[156:159]
  s_add_u32 m0, s29, 32768
  v_mfma_f32_16x16x32_bf16 v[152:155], a[76:79], a[56:59], v[152:155]
  ds_read_b64_tr_b16 a[106:107], v23 offset:1024
  v_mfma_f32_16x16x32_bf16 v[152:155], a[72:75], a[40:43], v[152:155]
  buffer_load_dwordx4 v10, s[12:15], s27 offen offset:0 lds
  v_mfma_f32_16x16x32_bf16 v[148:151], a[72:75], a[36:39], v[148:151]
  ds_read_b64_tr_b16 a[108:109], v23 offset:8192
  v_mfma_f32_16x16x32_bf16 v[148:151], a[76:79], a[52:55], v[148:151]
  v_mfma_f32_16x16x32_bf16 v[144:147], a[76:79], a[48:51], v[144:147]
  ds_read_b64_tr_b16 a[110:111], v23 offset:9216
  v_mfma_f32_16x16x32_bf16 v[144:147], a[72:75], a[32:35], v[144:147]
  ds_read_b64_tr_b16 a[112:113], v24 offset:0
  v_mfma_f32_16x16x32_bf16 v[160:163], a[80:83], a[32:35], v[160:163]
  buffer_load_dwordx4 v11, s[12:15], s27 offen offset:1024 lds
  v_mfma_f32_16x16x32_bf16 v[160:163], a[84:87], a[48:51], v[160:163]
  ds_read_b64_tr_b16 a[114:115], v24 offset:1024
  v_mfma_f32_16x16x32_bf16 v[164:167], a[84:87], a[52:55], v[164:167]
  ds_read_b64_tr_b16 a[116:117], v24 offset:8192
  v_mfma_f32_16x16x32_bf16 v[164:167], a[80:83], a[36:39], v[164:167]
  buffer_load_dwordx4 v12, s[12:15], s27 offen offset:2048 lds
  v_mfma_f32_16x16x32_bf16 v[168:171], a[80:83], a[40:43], v[168:171]
  v_mfma_f32_16x16x32_bf16 v[168:171], a[84:87], a[56:59], v[168:171]
  ds_read_b64_tr_b16 a[118:119], v24 offset:9216
  v_mfma_f32_16x16x32_bf16 v[172:175], a[84:87], a[60:63], v[172:175]
  ds_read_b64_tr_b16 a[120:121], v25 offset:0
  v_mfma_f32_16x16x32_bf16 v[172:175], a[80:83], a[44:47], v[172:175]
  ds_read_b64_tr_b16 a[122:123], v25 offset:1024
  v_mfma_f32_16x16x32_bf16 v[188:191], a[88:91], a[44:47], v[188:191]
  buffer_load_dwordx4 v13, s[12:15], s27 offen offset:3072 lds
  v_mfma_f32_16x16x32_bf16 v[188:191], a[92:95], a[60:63], v[188:191]
  ds_read_b64_tr_b16 a[124:125], v25 offset:8192
  v_mfma_f32_16x16x32_bf16 v[184:187], a[92:95], a[56:59], v[184:187]
  ds_read_b64_tr_b16 a[126:127], v25 offset:9216
  v_mfma_f32_16x16x32_bf16 v[184:187], a[88:91], a[40:43], v[184:187]
  v_mfma_f32_16x16x32_bf16 v[180:183], a[88:91], a[36:39], v[180:183]
  v_mfma_f32_16x16x32_bf16 v[180:183], a[92:95], a[52:55], v[180:183]
  v_mfma_f32_16x16x32_bf16 v[176:179], a[92:95], a[48:51], v[176:179]
  s_add_u32 s26, s26, 128
  v_mfma_f32_16x16x32_bf16 v[176:179], a[88:91], a[32:35], v[176:179]
  s_add_u32 s27, s27, 458752
  s_waitcnt lgkmcnt(0) vmcnt(12)
  s_barrier
  v_mfma_f32_16x16x32_bf16 v[192:195], a[96:99], a[32:35], v[192:195]
  s_add_u32 m0, s28, 0
  ds_read_b64_tr_b16 a[64:65], v18 offset:16384
  v_mfma_f32_16x16x32_bf16 v[192:195], a[100:103], a[48:51], v[192:195]
  buffer_load_dwordx4 v2, s[8:11], s26 offen offset:0 lds
  v_mfma_f32_16x16x32_bf16 v[196:199], a[100:103], a[52:55], v[196:199]
  ds_read_b64_tr_b16 a[66:67], v18 offset:17408
  v_mfma_f32_16x16x32_bf16 v[196:199], a[96:99], a[36:39], v[196:199]
  ds_read_b64_tr_b16 a[68:69], v18 offset:24576
  v_mfma_f32_16x16x32_bf16 v[200:203], a[96:99], a[40:43], v[200:203]
  ds_read_b64_tr_b16 a[70:71], v18 offset:25600
  v_mfma_f32_16x16x32_bf16 v[200:203], a[100:103], a[56:59], v[200:203]
  ds_read_b128 a[0:3], v14 offset:32768
  v_mfma_f32_16x16x32_bf16 v[204:207], a[100:103], a[60:63], v[204:207]
  buffer_load_dwordx4 v3, s[8:11], s26 offen offset:1024 lds
  v_mfma_f32_16x16x32_bf16 v[204:207], a[96:99], a[44:47], v[204:207]
  ds_read_b128 a[16:19], v15 offset:32768
  ds_read_b128 a[4:7], v14 offset:34816
  v_mfma_f32_16x16x32_bf16 v[220:223], a[104:107], a[44:47], v[220:223]
  ds_read_b128 a[20:23], v15 offset:34816
  v_mfma_f32_16x16x32_bf16 v[220:223], a[108:111], a[60:63], v[220:223]
  ds_read_b128 a[8:11], v14 offset:36864
  v_mfma_f32_16x16x32_bf16 v[216:219], a[108:111], a[56:59], v[216:219]
  buffer_load_dwordx4 v4, s[8:11], s26 offen offset:2048 lds
  v_mfma_f32_16x16x32_bf16 v[216:219], a[104:107], a[40:43], v[216:219]
  ds_read_b128 a[24:27], v15 offset:36864
  v_mfma_f32_16x16x32_bf16 v[212:215], a[104:107], a[36:39], v[212:215]
  ds_read_b128 a[12:15], v14 offset:38912
  v_mfma_f32_16x16x32_bf16 v[212:215], a[108:111], a[52:55], v[212:215]
  ds_read_b128 a[28:31], v15 offset:38912
  v_mfma_f32_16x16x32_bf16 v[208:211], a[108:111], a[48:51], v[208:211]
  ds_read_b64_tr_b16 a[72:73], v19 offset:16384
  buffer_load_dwordx4 v5, s[8:11], s26 offen offset:3072 lds
  v_mfma_f32_16x16x32_bf16 v[208:211], a[104:107], a[32:35], v[208:211]
  ds_read_b64_tr_b16 a[74:75], v19 offset:17408
  v_mfma_f32_16x16x32_bf16 v[224:227], a[112:115], a[32:35], v[224:227]
  ds_read_b64_tr_b16 a[76:77], v19 offset:24576
  v_mfma_f32_16x16x32_bf16 v[224:227], a[116:119], a[48:51], v[224:227]
  ds_read_b64_tr_b16 a[78:79], v19 offset:25600
  v_mfma_f32_16x16x32_bf16 v[228:231], a[116:119], a[52:55], v[228:231]
  s_add_u32 m0, s28, 4096
  v_mfma_f32_16x16x32_bf16 v[228:231], a[112:115], a[36:39], v[228:231]
  ds_read_b64_tr_b16 a[80:81], v20 offset:16384
  v_mfma_f32_16x16x32_bf16 v[232:235], a[112:115], a[40:43], v[232:235]
  buffer_load_dwordx4 v6, s[8:11], s26 offen offset:0 lds
  v_mfma_f32_16x16x32_bf16 v[232:235], a[116:119], a[56:59], v[232:235]
  ds_read_b64_tr_b16 a[82:83], v20 offset:17408
  ds_read_b64_tr_b16 a[84:85], v20 offset:24576
  v_mfma_f32_16x16x32_bf16 v[236:239], a[116:119], a[60:63], v[236:239]
  ds_read_b64_tr_b16 a[86:87], v20 offset:25600
  v_mfma_f32_16x16x32_bf16 v[236:239], a[112:115], a[44:47], v[236:239]
  ds_read_b64_tr_b16 a[88:89], v21 offset:16384
  v_mfma_f32_16x16x32_bf16 v[252:255], a[120:123], a[44:47], v[252:255]
  buffer_load_dwordx4 v7, s[8:11], s26 offen offset:1024 lds
  v_mfma_f32_16x16x32_bf16 v[252:255], a[124:127], a[60:63], v[252:255]
  ds_read_b64_tr_b16 a[90:91], v21 offset:17408
  v_mfma_f32_16x16x32_bf16 v[248:251], a[124:127], a[56:59], v[248:251]
  ds_read_b64_tr_b16 a[92:93], v21 offset:24576
  v_mfma_f32_16x16x32_bf16 v[248:251], a[120:123], a[40:43], v[248:251]
  ds_read_b64_tr_b16 a[94:95], v21 offset:25600
  v_mfma_f32_16x16x32_bf16 v[244:247], a[120:123], a[36:39], v[244:247]
  v_mfma_f32_16x16x32_bf16 v[244:247], a[124:127], a[52:55], v[244:247]
  v_mfma_f32_16x16x32_bf16 v[240:243], a[124:127], a[48:51], v[240:243]
  v_mfma_f32_16x16x32_bf16 v[240:243], a[120:123], a[32:35], v[240:243]
  s_waitcnt lgkmcnt(0)
  v_mfma_f32_16x16x32_bf16 v[128:131], a[64:67], a[0:3], v[128:131]
  s_add_u32 m0, s28, 4096
  v_mfma_f32_16x16x32_bf16 v[128:131], a[68:71], a[16:19], v[128:131]
  ds_read_b64_tr_b16 a[96:97], v22 offset:16384
  v_mfma_f32_16x16x32_bf16 v[132:135], a[68:71], a[20:23], v[132:135]
  buffer_load_dwordx4 v8, s[8:11], s26 offen offset:2048 lds
  v_mfma_f32_16x16x32_bf16 v[132:135], a[64:67], a[4:7], v[132:135]
  ds_read_b64_tr_b16 a[98:99], v22 offset:17408
  v_mfma_f32_16x16x32_bf16 v[136:139], a[64:67], a[8:11], v[136:139]
  ds_read_b64_tr_b16 a[100:101], v22 offset:24576
  v_mfma_f32_16x16x32_bf16 v[136:139], a[68:71], a[24:27], v[136:139]
  buffer_load_dwordx4 v9, s[8:11], s26 offen offset:3072 lds
  v_mfma_f32_16x16x32_bf16 v[140:143], a[68:71], a[28:31], v[140:143]
  v_mfma_f32_16x16x32_bf16 v[140:143], a[64:67], a[12:15], v[140:143]
  ds_read_b64_tr_b16 a[102:103], v22 offset:25600
  v_mfma_f32_16x16x32_bf16 v[156:159], a[72:75], a[12:15], v[156:159]
  ds_read_b64_tr_b16 a[104:105], v23 offset:16384
  v_mfma_f32_16x16x32_bf16 v[156:159], a[76:79], a[28:31], v[156:159]
  s_add_u32 m0, s29, 0
  v_mfma_f32_16x16x32_bf16 v[152:155], a[76:79], a[24:27], v[152:155]
  ds_read_b64_tr_b16 a[106:107], v23 offset:17408
  v_mfma_f32_16x16x32_bf16 v[152:155], a[72:75], a[8:11], v[152:155]
  buffer_load_dwordx4 v10, s[12:15], s27 offen offset:0 lds
  v_mfma_f32_16x16x32_bf16 v[148:151], a[72:75], a[4:7], v[148:151]
  ds_read_b64_tr_b16 a[108:109], v23 offset:24576
  v_mfma_f32_16x16x32_bf16 v[148:151], a[76:79], a[20:23], v[148:151]
  v_mfma_f32_16x16x32_bf16 v[144:147], a[76:79], a[16:19], v[144:147]
  ds_read_b64_tr_b16 a[110:111], v23 offset:25600
  v_mfma_f32_16x16x32_bf16 v[144:147], a[72:75], a[0:3], v[144:147]
  ds_read_b64_tr_b16 a[112:113], v24 offset:16384
  v_mfma_f32_16x16x32_bf16 v[160:163], a[80:83], a[0:3], v[160:163]
  buffer_load_dwordx4 v11, s[12:15], s27 offen offset:1024 lds
  v_mfma_f32_16x16x32_bf16 v[160:163], a[84:87], a[16:19], v[160:163]
  ds_read_b64_tr_b16 a[114:115], v24 offset:17408
  v_mfma_f32_16x16x32_bf16 v[164:167], a[84:87], a[20:23], v[164:167]
  ds_read_b64_tr_b16 a[116:117], v24 offset:24576
  v_mfma_f32_16x16x32_bf16 v[164:167], a[80:83], a[4:7], v[164:167]
  buffer_load_dwordx4 v12, s[12:15], s27 offen offset:2048 lds
  v_mfma_f32_16x16x32_bf16 v[168:171], a[80:83], a[8:11], v[168:171]
  v_mfma_f32_16x16x32_bf16 v[168:171], a[84:87], a[24:27], v[168:171]
  ds_read_b64_tr_b16 a[118:119], v24 offset:25600
  v_mfma_f32_16x16x32_bf16 v[172:175], a[84:87], a[28:31], v[172:175]
  ds_read_b64_tr_b16 a[120:121], v25 offset:16384
  v_mfma_f32_16x16x32_bf16 v[172:175], a[80:83], a[12:15], v[172:175]
  ds_read_b64_tr_b16 a[122:123], v25 offset:17408
  v_mfma_f32_16x16x32_bf16 v[188:191], a[88:91], a[12:15], v[188:191]
  buffer_load_dwordx4 v13, s[12:15], s27 offen offset:3072 lds
  v_mfma_f32_16x16x32_bf16 v[188:191], a[92:95], a[28:31], v[188:191]
  ds_read_b64_tr_b16 a[124:125], v25 offset:24576
  v_mfma_f32_16x16x32_bf16 v[184:187], a[92:95], a[24:27], v[184:187]
  ds_read_b64_tr_b16 a[126:127], v25 offset:25600
  v_mfma_f32_16x16x32_bf16 v[184:187], a[88:91], a[8:11], v[184:187]
  v_mfma_f32_16x16x32_bf16 v[180:183], a[88:91], a[4:7], v[180:183]
  v_mfma_f32_16x16x32_bf16 v[180:183], a[92:95], a[20:23], v[180:183]
  v_mfma_f32_16x16x32_bf16 v[176:179], a[92:95], a[16:19], v[176:179]
  s_add_u32 s26, s26, 128
  v_mfma_f32_16x16x32_bf16 v[176:179], a[88:91], a[0:3], v[176:179]
  s_add_u32 s27, s27, 458752
  s_waitcnt lgkmcnt(0) vmcnt(12)
  s_barrier
  v_mfma_f32_16x16x32_bf16 v[192:195], a[96:99], a[0:3], v[192:195]
  s_add_u32 m0, s28, 32768
  ds_read_b64_tr_b16 a[64:65], v18 offset:32768
  v_mfma_f32_16x16x32_bf16 v[192:195], a[100:103], a[16:19], v[192:195]
  buffer_load_dwordx4 v2, s[8:11], s26 offen offset:0 lds
  v_mfma_f32_16x16x32_bf16 v[196:199], a[100:103], a[20:23], v[196:199]
  ds_read_b64_tr_b16 a[66:67], v18 offset:33792
  v_mfma_f32_16x16x32_bf16 v[196:199], a[96:99], a[4:7], v[196:199]
  ds_read_b64_tr_b16 a[68:69], v18 offset:40960
  v_mfma_f32_16x16x32_bf16 v[200:203], a[96:99], a[8:11], v[200:203]
  ds_read_b64_tr_b16 a[70:71], v18 offset:41984
  v_mfma_f32_16x16x32_bf16 v[200:203], a[100:103], a[24:27], v[200:203]
  ds_read_b128 a[32:35], v16 offset:0
  v_mfma_f32_16x16x32_bf16 v[204:207], a[100:103], a[28:31], v[204:207]
  buffer_load_dwordx4 v3, s[8:11], s26 offen offset:1024 lds
  v_mfma_f32_16x16x32_bf16 v[204:207], a[96:99], a[12:15], v[204:207]
  ds_read_b128 a[48:51], v17 offset:0
  ds_read_b128 a[36:39], v16 offset:2048
  v_mfma_f32_16x16x32_bf16 v[220:223], a[104:107], a[12:15], v[220:223]
  ds_read_b128 a[52:55], v17 offset:2048
  v_mfma_f32_16x16x32_bf16 v[220:223], a[108:111], a[28:31], v[220:223]
  ds_read_b128 a[40:43], v16 offset:4096
  v_mfma_f32_16x16x32_bf16 v[216:219], a[108:111], a[24:27], v[216:219]
  buffer_load_dwordx4 v4, s[8:11], s26 offen offset:2048 lds
  v_mfma_f32_16x16x32_bf16 v[216:219], a[104:107], a[8:11], v[216:219]
  ds_read_b128 a[56:59], v17 offset:4096
  v_mfma_f32_16x16x32_bf16 v[212:215], a[104:107], a[4:7], v[212:215]
  ds_read_b128 a[44:47], v16 offset:6144
  v_mfma_f32_16x16x32_bf16 v[212:215], a[108:111], a[20:23], v[212:215]
  ds_read_b128 a[60:63], v17 offset:6144
  v_mfma_f32_16x16x32_bf16 v[208:211], a[108:111], a[16:19], v[208:211]
  ds_read_b64_tr_b16 a[72:73], v19 offset:32768
  buffer_load_dwordx4 v5, s[8:11], s26 offen offset:3072 lds
  v_mfma_f32_16x16x32_bf16 v[208:211], a[104:107], a[0:3], v[208:211]
  ds_read_b64_tr_b16 a[74:75], v19 offset:33792
  v_mfma_f32_16x16x32_bf16 v[224:227], a[112:115], a[0:3], v[224:227]
  ds_read_b64_tr_b16 a[76:77], v19 offset:40960
  v_mfma_f32_16x16x32_bf16 v[224:227], a[116:119], a[16:19], v[224:227]
  ds_read_b64_tr_b16 a[78:79], v19 offset:41984
  v_mfma_f32_16x16x32_bf16 v[228:231], a[116:119], a[20:23], v[228:231]
  s_add_u32 m0, s28, 36864
  v_mfma_f32_16x16x32_bf16 v[228:231], a[112:115], a[4:7], v[228:231]
  ds_read_b64_tr_b16 a[80:81], v20 offset:32768
  v_mfma_f32_16x16x32_bf16 v[232:235], a[112:115], a[8:11], v[232:235]
  buffer_load_dwordx4 v6, s[8:11], s26 offen offset:0 lds
  v_mfma_f32_16x16x32_bf16 v[232:235], a[116:119], a[24:27], v[232:235]
  ds_read_b64_tr_b16 a[82:83], v20 offset:33792
  ds_read_b64_tr_b16 a[84:85], v20 offset:40960
  v_mfma_f32_16x16x32_bf16 v[236:239], a[116:119], a[28:31], v[236:239]
  ds_read_b64_tr_b16 a[86:87], v20 offset:41984
  v_mfma_f32_16x16x32_bf16 v[236:239], a[112:115], a[12:15], v[236:239]
  ds_read_b64_tr_b16 a[88:89], v21 offset:32768
  v_mfma_f32_16x16x32_bf16 v[252:255], a[120:123], a[12:15], v[252:255]
  buffer_load_dwordx4 v7, s[8:11], s26 offen offset:1024 lds
  v_mfma_f32_16x16x32_bf16 v[252:255], a[124:127], a[28:31], v[252:255]
  ds_read_b64_tr_b16 a[90:91], v21 offset:33792
  v_mfma_f32_16x16x32_bf16 v[248:251], a[124:127], a[24:27], v[248:251]
  ds_read_b64_tr_b16 a[92:93], v21 offset:40960
  v_mfma_f32_16x16x32_bf16 v[248:251], a[120:123], a[8:11], v[248:251]
  ds_read_b64_tr_b16 a[94:95], v21 offset:41984
  v_mfma_f32_16x16x32_bf16 v[244:247], a[120:123], a[4:7], v[244:247]
  v_mfma_f32_16x16x32_bf16 v[244:247], a[124:127], a[20:23], v[244:247]
  v_mfma_f32_16x16x32_bf16 v[240:243], a[124:127], a[16:19], v[240:243]
  v_mfma_f32_16x16x32_bf16 v[240:243], a[120:123], a[0:3], v[240:243]
  s_waitcnt lgkmcnt(0)
  s_sub_u32 s31, s31, 1
  s_cmp_lg_u32 s31, 0
  s_cbranch_scc1 zq_loop_1
  v_mfma_f32_16x16x32_bf16 v[128:131], a[64:67], a[32:35], v[128:131]
  s_add_u32 m0, s28, 36864
  v_mfma_f32_16x16x32_bf16 v[128:131], a[68:71], a[48:51], v[128:131]
  ds_read_b64_tr_b16 a[96:97], v22 offset:32768
  v_mfma_f32_16x16x32_bf16 v[132:135], a[68:71], a[52:55], v[132:135]
  buffer_load_dwordx4 v8, s[8:11], s26 offen offset:2048 lds
  v_mfma_f32_16x16x32_bf16 v[132:135], a[64:67], a[36:39], v[132:135]
  ds_read_b64_tr_b16 a[98:99], v22 offset:33792
  v_mfma_f32_16x16x32_bf16 v[136:139], a[64:67], a[40:43], v[136:139]
  ds_read_b64_tr_b16 a[100:101], v22 offset:40960
  v_mfma_f32_16x16x32_bf16 v[136:139], a[68:71], a[56:59], v[136:139]
  buffer_load_dwordx4 v9, s[8:11], s26 offen offset:3072 lds
  v_mfma_f32_16x16x32_bf16 v[140:143], a[68:71], a[60:63], v[140:143]
  v_mfma_f32_16x16x32_bf16 v[140:143], a[64:67], a[44:47], v[140:143]
  ds_read_b64_tr_b16 a[102:103], v22 offset:41984
  v_mfma_f32_16x16x32_bf16 v[156:159], a[72:75], a[44:47], v[156:159]
  ds_read_b64_tr_b16 a[104:105], v23 offset:32768
  v_mfma_f32_16x16x32_bf16 v[156:159], a[76:79], a[60:63], v[156:159]
  s_add_u32 m0, s29, 16384
  v_mfma_f32_16x16x32_bf16 v[152:155], a[76:79], a[56:59], v[152:155]
  ds_read_b64_tr_b16 a[106:107], v23 offset:33792
  v_mfma_f32_16x16x32_bf16 v[152:155], a[72:75], a[40:43], v[152:155]
  buffer_load_dwordx4 v10, s[12:15], s27 offen offset:0 lds
  v_mfma_f32_16x16x32_bf16 v[148:151], a[72:75], a[36:39], v[148:151]
  ds_read_b64_tr_b16 a[108:109], v23 offset:40960
  v_mfma_f32_16x16x32_bf16 v[148:151], a[76:79], a[52:55], v[148:151]
  v_mfma_f32_16x16x32_bf16 v[144:147], a[76:79], a[48:51], v[144:147]
  ds_read_b64_tr_b16 a[110:111], v23 offset:41984
  v_mfma_f32_16x16x32_bf16 v[144:147], a[72:75], a[32:35], v[144:147]
  ds_read_b64_tr_b16 a[112:113], v24 offset:32768
  v_mfma_f32_16x16x32_bf16 v[160:163], a[80:83], a[32:35], v[160:163]
  buffer_load_dwordx4 v11, s[12:15], s27 offen offset:1024 lds
  v_mfma_f32_16x16x32_bf16 v[160:163], a[84:87], a[48:51], v[160:163]
  ds_read_b64_tr_b16 a[114:115], v24 offset:33792
  v_mfma_f32_16x16x32_bf16 v[164:167], a[84:87], a[52:55], v[164:167]
  ds_read_b64_tr_b16 a[116:117], v24 offset:40960
  v_mfma_f32_16x16x32_bf16 v[164:167], a[80:83], a[36:39], v[164:167]
  buffer_load_dwordx4 v12, s[12:15], s27 offen offset:2048 lds
  v_mfma_f32_16x16x32_bf16 v[168:171], a[80:83], a[40:43], v[168:171]
  v_mfma_f32_16x16x32_bf16 v[168:171], a[84:87], a[56:59], v[168:171]
  ds_read_b64_tr_b16 a[118:119], v24 offset:41984
  v_mfma_f32_16x16x32_bf16 v[172:175], a[84:87], a[60:63], v[172:175]
  ds_read_b64_tr_b16 a[120:121], v25 offset:32768
  v_mfma_f32_16x16x32_bf16 v[172:175], a[80:83], a[44:47], v[172:175]
  ds_read_b64_tr_b16 a[122:123], v25 offset:33792
  v_mfma_f32_16x16x32_bf16 v[188:191], a[88:91], a[44:47], v[188:191]
  buffer_load_dwordx4 v13, s[12:15], s27 offen offset:3072 lds
  v_mfma_f32_16x16x32_bf16 v[188:191], a[92:95], a[60:63], v[188:191]
  ds_read_b64_tr_b16 a[124:125], v25 offset:40960
  v_mfma_f32_16x16x32_bf16 v[184:187], a[92:95], a[56:59], v[184:187]
  ds_read_b64_tr_b16 a[126:127], v25 offset:41984
  v_mfma_f32_16x16x32_bf16 v[184:187], a[88:91], a[40:43], v[184:187]
  v_mfma_f32_16x16x32_bf16 v[180:183], a[88:91], a[36:39], v[180:183]
  v_mfma_f32_16x16x32_bf16 v[180:183], a[92:95], a[52:55], v[180:183]
  v_mfma_f32_16x16x32_bf16 v[176:179], a[92:95], a[48:51], v[176:179]
  s_add_u32 s26, s26, 128
  v_mfma_f32_16x16x32_bf16 v[176:179], a[88:91], a[32:35], v[176:179]
  s_add_u32 s27, s27, 458752
  s_waitcnt lgkmcnt(0) vmcnt(12)
  s_barrier
  v_mfma_f32_16x16x32_bf16 v[192:195], a[96:99], a[32:35], v[192:195]
  s_add_u32 m0, s28, 65536
  ds_read_b64_tr_b16 a[64:65], v18 offset:0
  v_mfma_f32_16x16x32_bf16 v[192:195], a[100:103], a[48:51], v[192:195]
  buffer_load_dwordx4 v2, s[8:11], s32 offen offset:0 lds
  v_mfma_f32_16x16x32_bf16 v[196:199], a[100:103], a[52:55], v[196:199]
  ds_read_b64_tr_b16 a[66:67], v18 offset:1024
  v_mfma_f32_16x16x32_bf16 v[196:199], a[96:99], a[36:39], v[196:199]
  ds_read_b64_tr_b16 a[68:69], v18 offset:8192
  v_mfma_f32_16x16x32_bf16 v[200:203], a[96:99], a[40:43], v[200:203]
  ds_read_b64_tr_b16 a[70:71], v18 offset:9216
  v_mfma_f32_16x16x32_bf16 v[200:203], a[100:103], a[56:59], v[200:203]
  ds_read_b128 a[0:3], v14 offset:0
  v_mfma_f32_16x16x32_bf16 v[204:207], a[100:103], a[60:63], v[204:207]
  buffer_load_dwordx4 v3, s[8:11], s32 offen offset:1024 lds
  v_mfma_f32_16x16x32_bf16 v[204:207], a[96:99], a[44:47], v[204:207]
  ds_read_b128 a[16:19], v15 offset:0
  ds_read_b128 a[4:7], v14 offset:2048
  v_mfma_f32_16x16x32_bf16 v[220:223], a[104:107], a[44:47], v[220:223]
  ds_read_b128 a[20:23], v15 offset:2048
  v_mfma_f32_16x16x32_bf16 v[220:223], a[108:111], a[60:63], v[220:223]
  ds_read_b128 a[8:11], v14 offset:4096
  v_mfma_f32_16x16x32_bf16 v[216:219], a[108:111], a[56:59], v[216:219]
  buffer_load_dwordx4 v4, s[8:11], s32 offen offset:2048 lds
  v_mfma_f32_16x16x32_bf16 v[216:219], a[104:107], a[40:43], v[216:219]
  ds_read_b128 a[24:27], v15 offset:4096
  v_mfma_f32_16x16x32_bf16 v[212:215], a[104:107], a[36:39], v[212:215]
  ds_read_b128 a[12:15], v14 offset:6144
  v_mfma_f32_16x16x32_bf16 v[212:215], a[108:111], a[52:55], v[212:215]
  ds_read_b128 a[28:31], v15 offset:6144
  v_mfma_f32_16x16x32_bf16 v[208:211], a[108:111], a[48:51], v[208:211]
  ds_read_b64_tr_b16 a[72:73], v19 offset:0
  buffer_load_dwordx4 v5, s[8:11], s32 offen offset:3072 lds
  v_mfma_f32_16x16x32_bf16 v[208:211], a[104:107], a[32:35], v[208:211]
  ds_read_b64_tr_b16 a[74:75], v19 offset:1024
  v_mfma_f32_16x16x32_bf16 v[224:227], a[112:115], a[32:35], v[224:227]
  ds_read_b64_tr_b16 a[76:77], v19 offset:8192
  v_mfma_f32_16x16x32_bf16 v[224:227], a[116:119], a[48:51], v[224:227]
  ds_read_b64_tr_b16 a[78:79], v19 offset:9216
  v_mfma_f32_16x16x32_bf16 v[228:231], a[116:119], a[52:55], v[228:231]
  s_add_u32 m0, s28, 69632
  v_mfma_f32_16x16x32_bf16 v[228:231], a[112:115], a[36:39], v[228:231]
  ds_read_b64_tr_b16 a[80:81], v20 offset:0
  v_mfma_f32_16x16x32_bf16 v[232:235], a[112:115], a[40:43], v[232:235]
  buffer_load_dwordx4 v6, s[8:11], s32 offen offset:0 lds
  v_mfma_f32_16x16x32_bf16 v[232:235], a[116:119], a[56:59], v[232:235]
  ds_read_b64_tr_b16 a[82:83], v20 offset:1024
  ds_read_b64_tr_b16 a[84:85], v20 offset:8192
  v_mfma_f32_16x16x32_bf16 v[236:239], a[116:119], a[60:63], v[236:239]
  ds_read_b64_tr_b16 a[86:87], v20 offset:9216
  v_mfma_f32_16x16x32_bf16 v[236:239], a[112:115], a[44:47], v[236:239]
  ds_read_b64_tr_b16 a[88:89], v21 offset:0
  v_mfma_f32_16x16x32_bf16 v[252:255], a[120:123], a[44:47], v[252:255]
  buffer_load_dwordx4 v7, s[8:11], s32 offen offset:1024 lds
  v_mfma_f32_16x16x32_bf16 v[252:255], a[124:127], a[60:63], v[252:255]
  ds_read_b64_tr_b16 a[90:91], v21 offset:1024
  v_mfma_f32_16x16x32_bf16 v[248:251], a[124:127], a[56:59], v[248:251]
  ds_read_b64_tr_b16 a[92:93], v21 offset:8192
  v_mfma_f32_16x16x32_bf16 v[248:251], a[120:123], a[40:43], v[248:251]
  ds_read_b64_tr_b16 a[94:95], v21 offset:9216
  v_mfma_f32_16x16x32_bf16 v[244:247], a[120:123], a[36:39], v[244:247]
  v_mfma_f32_16x16x32_bf16 v[244:247], a[124:127], a[52:55], v[244:247]
  v_mfma_f32_16x16x32_bf16 v[240:243], a[124:127], a[48:51], v[240:243]
  v_mfma_f32_16x16x32_bf16 v[240:243], a[120:123], a[32:35], v[240:243]
  s_waitcnt lgkmcnt(0)
  v_mfma_f32_16x16x32_bf16 v[128:131], a[64:67], a[0:3], v[128:131]
  s_add_u32 m0, s28, 69632
  v_mfma_f32_16x16x32_bf16 v[128:131], a[68:71], a[16:19], v[128:131]
  ds_read_b64_tr_b16 a[96:97], v22 offset:0
  v_mfma_f32_16x16x32_bf16 v[132:135], a[68:71], a[20:23], v[132:135]
  buffer_load_dwordx4 v8, s[8:11], s32 offen offset:2048 lds
  v_mfma_f32_16x16x32_bf16 v[132:135], a[64:67], a[4:7], v[132:135]
  ds_read_b64_tr_b16 a[98:99], v22 offset:1024
  v_mfma_f32_16x16x32_bf16 v[136:139], a[64:67], a[8:11], v[136:139]
  ds_read_b64_tr_b16 a[100:101], v22 offset:8192
  v_mfma_f32_16x16x32_bf16 v[136:139], a[68:71], a[24:27], v[136:139]
  buffer_load_dwordx4 v9, s[8:11], s32 offen offset:3072 lds
  v_mfma_f32_16x16x32_bf16 v[140:143], a[68:71], a[28:31], v[140:143]
  v_mfma_f32_16x16x32_bf16 v[140:143], a[64:67], a[12:15], v[140:143]
  ds_read_b64_tr_b16 a[102:103], v22 offset:9216
  v_mfma_f32_16x16x32_bf16 v[156:159], a[72:75], a[12:15], v[156:159]
  ds_read_b64_tr_b16 a[104:105], v23 offset:0
  v_mfma_f32_16x16x32_bf16 v[156:159], a[76:79], a[28:31], v[156:159]
  s_add_u32 m0, s29, 32768
  v_mfma_f32_16x16x32_bf16 v[152:155], a[76:79], a[24:27], v[152:155]
  ds_read_b64_tr_b16 a[106:107], v23 offset:1024
  v_mfma_f32_16x16x32_bf16 v[152:155], a[72:75], a[8:11], v[152:155]
  buffer_load_dwordx4 v32, s[36:39], s33 offen offset:0 lds
  v_mfma_f32_16x16x32_bf16 v[148:151], a[72:75], a[4:7], v[148:151]
  ds_read_b64_tr_b16 a[108:109], v23 offset:8192
  v_mfma_f32_16x16x32_bf16 v[148:151], a[76:79], a[20:23], v[148:151]
  v_mfma_f32_16x16x32_bf16 v[144:147], a[76:79], a[16:19], v[144:147]
  ds_read_b64_tr_b16 a[110:111], v23 offset:9216
  v_mfma_f32_16x16x32_bf16 v[144:147], a[72:75], a[0:3], v[144:147]
  ds_read_b64_tr_b16 a[112:113], v24 offset:0
  v_mfma_f32_16x16x32_bf16 v[160:163], a[80:83], a[0:3], v[160:163]
  buffer_load_dwordx4 v33, s[36:39], s33 offen offset:1024 lds
  v_mfma_f32_16x16x32_bf16 v[160:163], a[84:87], a[16:19], v[160:163]
  ds_read_b64_tr_b16 a[114:115], v24 offset:1024
  v_mfma_f32_16x16x32_bf16 v[164:167], a[84:87], a[20:23], v[164:167]
  ds_read_b64_tr_b16 a[116:117], v24 offset:8192
  v_mfma_f32_16x16x32_bf16 v[164:167], a[80:83], a[4:7], v[164:167]
  buffer_load_dwordx4 v34, s[36:39], s33 offen offset:2048 lds
  v_mfma_f32_16x16x32_bf16 v[168:171], a[80:83], a[8:11], v[168:171]
  v_mfma_f32_16x16x32_bf16 v[168:171], a[84:87], a[24:27], v[168:171]
  ds_read_b64_tr_b16 a[118:119], v24 offset:9216
  v_mfma_f32_16x16x32_bf16 v[172:175], a[84:87], a[28:31], v[172:175]
  ds_read_b64_tr_b16 a[120:121], v25 offset:0
  v_mfma_f32_16x16x32_bf16 v[172:175], a[80:83], a[12:15], v[172:175]
  ds_read_b64_tr_b16 a[122:123], v25 offset:1024
  v_mfma_f32_16x16x32_bf16 v[188:191], a[88:91], a[12:15], v[188:191]
  buffer_load_dwordx4 v35, s[36:39], s33 offen offset:3072 lds
  v_mfma_f32_16x16x32_bf16 v[188:191], a[92:95], a[28:31], v[188:191]
  ds_read_b64_tr_b16 a[124:125], v25 offset:8192
  v_mfma_f32_16x16x32_bf16 v[184:187], a[92:95], a[24:27], v[184:187]
  ds_read_b64_tr_b16 a[126:127], v25 offset:9216
  v_mfma_f32_16x16x32_bf16 v[184:187], a[88:91], a[8:11], v[184:187]
  v_mfma_f32_16x16x32_bf16 v[180:183], a[88:91], a[4:7], v[180:183]
  v_mfma_f32_16x16x32_bf16 v[180:183], a[92:95], a[20:23], v[180:183]
  v_mfma_f32_16x16x32_bf16 v[176:179], a[92:95], a[16:19], v[176:179]
  s_add_u32 s32, s32, 128
  v_mfma_f32_16x16x32_bf16 v[176:179], a[88:91], a[0:3], v[176:179]
  s_add_u32 s33, s33, 524288
  s_waitcnt lgkmcnt(0) vmcnt(12)
  s_barrier
  v_mfma_f32_16x16x32_bf16 v[192:195], a[96:99], a[0:3], v[192:195]
  s_add_u32 m0, s28, 0
  ds_read_b64_tr_b16 a[64:65], v18 offset:16384
  v_mfma_f32_16x16x32_bf16 v[192:195], a[100:103], a[16:19], v[192:195]
  buffer_load_dwordx4 v2, s[8:11], s32 offen offset:0 lds
  v_mfma_f32_16x16x32_bf16 v[196:199], a[100:103], a[20:23], v[196:199]
  ds_read_b64_tr_b16 a[66:67], v18 offset:17408
  v_mfma_f32_16x16x32_bf16 v[196:199], a[96:99], a[4:7], v[196:199]
  ds_read_b64_tr_b16 a[68:69], v18 offset:24576
  v_mfma_f32_16x16x32_bf16 v[200:203], a[96:99], a[8:11], v[200:203]
  ds_read_b64_tr_b16 a[70:71], v18 offset:25600
  v_mfma_f32_16x16x32_bf16 v[200:203], a[100:103], a[24:27], v[200:203]
  ds_read_b128 a[32:35], v14 offset:32768
  v_mfma_f32_16x16x32_bf16 v[204:207], a[100:103], a[28:31], v[204:207]
  buffer_load_dwordx4 v3, s[8:11], s32 offen offset:1024 lds
  v_mfma_f32_16x16x32_bf16 v[204:207], a[96:99], a[12:15], v[204:207]
  ds_read_b128 a[48:51], v15 offset:32768
  ds_read_b128 a[36:39], v14 offset:34816
  v_mfma_f32_16x16x32_bf16 v[220:223], a[104:107], a[12:15], v[220:223]
  ds_read_b128 a[52:55], v15 offset:34816
  v_mfma_f32_16x16x32_bf16 v[220:223], a[108:111], a[28:31], v[220:223]
  ds_read_b128 a[40:43], v14 offset:36864
  v_mfma_f32_16x16x32_bf16 v[216:219], a[108:111], a[24:27], v[216:219]
  buffer_load_dwordx4 v4, s[8:11], s32 offen offset:2048 lds
  v_mfma_f32_16x16x32_bf16 v[216:219], a[104:107], a[8:11], v[216:219]
  ds_read_b128 a[56:59], v15 offset:36864
  v_mfma_f32_16x16x32_bf16 v[212:215], a[104:107], a[4:7], v[212:215]
  ds_read_b128 a[44:47], v14 offset:38912
  v_mfma_f32_16x16x32_bf16 v[212:215], a[108:111], a[20:23], v[212:215]
  ds_read_b128 a[60:63], v15 offset:38912
  v_mfma_f32_16x16x32_bf16 v[208:211], a[108:111], a[16:19], v[208:211]
  ds_read_b64_tr_b16 a[72:73], v19 offset:16384
  buffer_load_dwordx4 v5, s[8:11], s32 offen offset:3072 lds
  v_mfma_f32_16x16x32_bf16 v[208:211], a[104:107], a[0:3], v[208:211]
  ds_read_b64_tr_b16 a[74:75], v19 offset:17408
  v_mfma_f32_16x16x32_bf16 v[224:227], a[112:115], a[0:3], v[224:227]
  ds_read_b64_tr_b16 a[76:77], v19 offset:24576
  v_mfma_f32_16x16x32_bf16 v[224:227], a[116:119], a[16:19], v[224:227]
  ds_read_b64_tr_b16 a[78:79], v19 offset:25600
  v_mfma_f32_16x16x32_bf16 v[228:231], a[116:119], a[20:23], v[228:231]
  s_add_u32 m0, s28, 4096
  v_mfma_f32_16x16x32_bf16 v[228:231], a[112:115], a[4:7], v[228:231]
  ds_read_b64_tr_b16 a[80:81], v20 offset:16384
  v_mfma_f32_16x16x32_bf16 v[232:235], a[112:115], a[8:11], v[232:235]
  buffer_load_dwordx4 v6, s[8:11], s32 offen offset:0 lds
  v_mfma_f32_16x16x32_bf16 v[232:235], a[116:119], a[24:27], v[232:235]
  ds_read_b64_tr_b16 a[82:83], v20 offset:17408
  ds_read_b64_tr_b16 a[84:85], v20 offset:24576
  v_mfma_f32_16x16x32_bf16 v[236:239], a[116:119], a[28:31], v[236:239]
  ds_read_b64_tr_b16 a[86:87], v20 offset:25600
  v_mfma_f32_16x16x32_bf16 v[236:239], a[112:115], a[12:15], v[236:239]
  ds_read_b64_tr_b16 a[88:89], v21 offset:16384
  v_mfma_f32_16x16x32_bf16 v[252:255], a[120:123], a[12:15], v[252:255]
  buffer_load_dwordx4 v7, s[8:11], s32 offen offset:1024 lds
  v_mfma_f32_16x16x32_bf16 v[252:255], a[124:127], a[28:31], v[252:255]
  ds_read_b64_tr_b16 a[90:91], v21 offset:17408
  v_mfma_f32_16x16x32_bf16 v[248:251], a[124:127], a[24:27], v[248:251]
  ds_read_b64_tr_b16 a[92:93], v21 offset:24576
  v_mfma_f32_16x16x32_bf16 v[248:251], a[120:123], a[8:11], v[248:251]
  ds_read_b64_tr_b16 a[94:95], v21 offset:25600
  v_mfma_f32_16x16x32_bf16 v[244:247], a[120:123], a[4:7], v[244:247]
  v_mfma_f32_16x16x32_bf16 v[244:247], a[124:127], a[20:23], v[244:247]
  v_mfma_f32_16x16x32_bf16 v[240:243], a[124:127], a[16:19], v[240:243]
  v_mfma_f32_16x16x32_bf16 v[240:243], a[120:123], a[0:3], v[240:243]
  s_waitcnt lgkmcnt(0)
  v_mfma_f32_16x16x32_bf16 v[128:131], a[64:67], a[32:35], v[128:131]
  s_add_u32 m0, s28, 4096
  v_mfma_f32_16x16x32_bf16 v[128:131], a[68:71], a[48:51], v[128:131]
  ds_read_b64_tr_b16 a[96:97], v22 offset:16384
  v_mfma_f32_16x16x32_bf16 v[132:135], a[68:71], a[52:55], v[132:135]
  buffer_load_dwordx4 v8, s[8:11], s32 offen offset:2048 lds
  v_mfma_f32_16x16x32_bf16 v[132:135], a[64:67], a[36:39], v[132:135]
  ds_read_b64_tr_b16 a[98:99], v22 offset:17408
  v_mfma_f32_16x16x32_bf16 v[136:139], a[64:67], a[40:43], v[136:139]
  ds_read_b64_tr_b16 a[100:101], v22 offset:24576
  v_mfma_f32_16x16x32_bf16 v[136:139], a[68:71], a[56:59], v[136:139]
  buffer_load_dwordx4 v9, s[8:11], s32 offen offset:3072 lds
  v_mfma_f32_16x16x32_bf16 v[140:143], a[68:71], a[60:63], v[140:143]
  v_mfma_f32_16x16x32_bf16 v[140:143], a[64:67], a[44:47], v[140:143]
  ds_read_b64_tr_b16 a[102:103], v22 offset:25600
  v_mfma_f32_16x16x32_bf16 v[156:159], a[72:75], a[44:47], v[156:159]
  ds_read_b64_tr_b16 a[104:105], v23 offset:16384
  v_mfma_f32_16x16x32_bf16 v[156:159], a[76:79], a[60:63], v[156:159]
  s_add_u32 m0, s29, 0
  v_mfma_f32_16x16x32_bf16 v[152:155], a[76:79], a[56:59], v[152:155]
  ds_read_b64_tr_b16 a[106:107], v23 offset:17408
  v_mfma_f32_16x16x32_bf16 v[152:155], a[72:75], a[40:43], v[152:155]
  buffer_load_dwordx4 v32, s[36:39], s33 offen offset:0 lds
  v_mfma_f32_16x16x32_bf16 v[148:151], a[72:75], a[36:39], v[148:151]
  ds_read_b64_tr_b16 a[108:109], v23 offset:24576
  v_mfma_f32_16x16x32_bf16 v[148:151], a[76:79], a[52:55], v[148:151]
  v_mfma_f32_16x16x32_bf16 v[144:147], a[76:79], a[48:51], v[144:147]
  ds_read_b64_tr_b16 a[110:111], v23 offset:25600
  v_mfma_f32_16x16x32_bf16 v[144:147], a[72:75], a[32:35], v[144:147]
  ds_read_b64_tr_b16 a[112:113], v24 offset:16384
  v_mfma_f32_16x16x32_bf16 v[160:163], a[80:83], a[32:35], v[160:163]
  buffer_load_dwordx4 v33, s[36:39], s33 offen offset:1024 lds
  v_mfma_f32_16x16x32_bf16 v[160:163], a[84:87], a[48:51], v[160:163]
  ds_read_b64_tr_b16 a[114:115], v24 offset:17408
  v_mfma_f32_16x16x32_bf16 v[164:167], a[84:87], a[52:55], v[164:167]
  ds_read_b64_tr_b16 a[116:117], v24 offset:24576
  v_mfma_f32_16x16x32_bf16 v[164:167], a[80:83], a[36:39], v[164:167]
  buffer_load_dwordx4 v34, s[36:39], s33 offen offset:2048 lds
  v_mfma_f32_16x16x32_bf16 v[168:171], a[80:83], a[40:43], v[168:171]
  v_mfma_f32_16x16x32_bf16 v[168:171], a[84:87], a[56:59], v[168:171]
  ds_read_b64_tr_b16 a[118:119], v24 offset:25600
  v_mfma_f32_16x16x32_bf16 v[172:175], a[84:87], a[60:63], v[172:175]
  ds_read_b64_tr_b16 a[120:121], v25 offset:16384
  v_mfma_f32_16x16x32_bf16 v[172:175], a[80:83], a[44:47], v[172:175]
  ds_read_b64_tr_b16 a[122:123], v25 offset:17408
  v_mfma_f32_16x16x32_bf16 v[188:191], a[88:91], a[44:47], v[188:191]
  buffer_load_dwordx4 v35, s[36:39], s33 offen offset:3072 lds
  v_mfma_f32_16x16x32_bf16 v[188:191], a[92:95], a[60:63], v[188:191]
  ds_read_b64_tr_b16 a[124:125], v25 offset:24576
  v_mfma_f32_16x16x32_bf16 v[184:187], a[92:95], a[56:59], v[184:187]
  ds_read_b64_tr_b16 a[126:127], v25 offset:25600
  v_mfma_f32_16x16x32_bf16 v[184:187], a[88:91], a[40:43], v[184:187]
  v_mfma_f32_16x16x32_bf16 v[180:183], a[88:91], a[36:39], v[180:183]
  v_mfma_f32_16x16x32_bf16 v[180:183], a[92:95], a[52:55], v[180:183]
  v_mfma_f32_16x16x32_bf16 v[176:179], a[92:95], a[48:51], v[176:179]
  s_add_u32 s32, s32, 128
  v_mfma_f32_16x16x32_bf16 v[176:179], a[88:91], a[32:35], v[176:179]
  s_add_u32 s33, s33, 524288
  s_waitcnt lgkmcnt(0) vmcnt(12)
  s_barrier
  v_mfma_f32_16x16x32_bf16 v[192:195], a[96:99], a[32:35], v[192:195]
  s_add_u32 m0, s28, 32768
  ds_read_b64_tr_b16 a[64:65], v18 offset:32768
  v_mfma_f32_16x16x32_bf16 v[192:195], a[100:103], a[48:51], v[192:195]
  buffer_load_dwordx4 v2, s[8:11], s32 offen offset:0 lds
  v_mfma_f32_16x16x32_bf16 v[196:199], a[100:103], a[52:55], v[196:199]
  ds_read_b64_tr_b16 a[66:67], v18 offset:33792
  v_mfma_f32_16x16x32_bf16 v[196:199], a[96:99], a[36:39], v[196:199]
  ds_read_b64_tr_b16 a[68:69], v18 offset:40960
  v_mfma_f32_16x16x32_bf16 v[200:203], a[96:99], a[40:43], v[200:203]
  ds_read_b64_tr_b16 a[70:71], v18 offset:41984
  v_mfma_f32_16x16x32_bf16 v[200:203], a[100:103], a[56:59], v[200:203]
  ds_read_b128 a[0:3], v16 offset:0
  v_mfma_f32_16x16x32_bf16 v[204:207], a[100:103], a[60:63], v[204:207]
  buffer_load_dwordx4 v3, s[8:11], s32 offen offset:1024 lds
  v_mfma_f32_16x16x32_bf16 v[204:207], a[96:99], a[44:47], v[204:207]
  ds_read_b128 a[16:19], v17 offset:0
  ds_read_b128 a[4:7], v16 offset:2048
  v_mfma_f32_16x16x32_bf16 v[220:223], a[104:107], a[44:47], v[220:223]
  ds_read_b128 a[20:23], v17 offset:2048
  v_mfma_f32_16x16x32_bf16 v[220:223], a[108:111], a[60:63], v[220:223]
  ds_read_b128 a[8:11], v16 offset:4096
  v_mfma_f32_16x16x32_bf16 v[216:219], a[108:111], a[56:59], v[216:219]
  buffer_load_dwordx4 v4, s[8:11], s32 offen offset:2048 lds
  v_mfma_f32_16x16x32_bf16 v[216:219], a[104:107], a[40:43], v[216:219]
  ds_read_b128 a[24:27], v17 offset:4096
  v_mfma_f32_16x16x32_bf16 v[212:215], a[104:107], a[36:39], v[212:215]
  ds_read_b128 a[12:15], v16 offset:6144
  v_mfma_f32_16x16x32_bf16 v[212:215], a[108:111], a[52:55], v[212:215]
  ds_read_b128 a[28:31], v17 offset:6144
  v_mfma_f32_16x16x32_bf16 v[208:211], a[108:111], a[48:51], v[208:211]
  ds_read_b64_tr_b16 a[72:73], v19 offset:32768
  buffer_load_dwordx4 v5, s[8:11], s32 offen offset:3072 lds
  v_mfma_f32_16x16x32_bf16 v[208:211], a[104:107], a[32:35], v[208:211]
  ds_read_b64_tr_b16 a[74:75], v19 offset:33792
  v_mfma_f32_16x16x32_bf16 v[224:227], a[112:115], a[32:35], v[224:227]
  ds_read_b64_tr_b16 a[76:77], v19 offset:40960
  v_mfma_f32_16x16x32_bf16 v[224:227], a[116:119], a[48:51], v[224:227]
  ds_read_b64_tr_b16 a[78:79], v19 offset:41984
  v_mfma_f32_16x16x32_bf16 v[228:231], a[116:119], a[52:55], v[228:231]
  s_add_u32 m0, s28, 36864
  v_mfma_f32_16x16x32_bf16 v[228:231], a[112:115], a[36:39], v[228:231]
  ds_read_b64_tr_b16 a[80:81], v20 offset:32768
  v_mfma_f32_16x16x32_bf16 v[232:235], a[112:115], a[40:43], v[232:235]
  buffer_load_dwordx4 v6, s[8:11], s32 offen offset:0 lds
  v_mfma_f32_16x16x32_bf16 v[232:235], a[116:119], a[56:59], v[232:235]
  ds_read_b64_tr_b16 a[82:83], v20 offset:33792
  ds_read_b64_tr_b16 a[84:85], v20 offset:40960
  v_mfma_f32_16x16x32_bf16 v[236:239], a[116:119], a[60:63], v[236:239]
  ds_read_b64_tr_b16 a[86:87], v20 offset:41984
  v_mfma_f32_16x16x32_bf16 v[236:239], a[112:115], a[44:47], v[236:239]
  ds_read_b64_tr_b16 a[88:89], v21 offset:32768
  v_mfma_f32_16x16x32_bf16 v[252:255], a[120:123], a[44:47], v[252:255]
  buffer_load_dwordx4 v7, s[8:11], s32 offen offset:1024 lds
  v_mfma_f32_16x16x32_bf16 v[252:255], a[124:127], a[60:63], v[252:255]
  ds_read_b64_tr_b16 a[90:91], v21 offset:33792
  v_mfma_f32_16x16x32_bf16 v[248:251], a[124:127], a[56:59], v[248:251]
  ds_read_b64_tr_b16 a[92:93], v21 offset:40960
  v_mfma_f32_16x16x32_bf16 v[248:251], a[120:123], a[40:43], v[248:251]
  ds_read_b64_tr_b16 a[94:95], v21 offset:41984
  v_mfma_f32_16x16x32_bf16 v[244:247], a[120:123], a[36:39], v[244:247]
  v_mfma_f32_16x16x32_bf16 v[244:247], a[124:127], a[52:55], v[244:247]
  v_mfma_f32_16x16x32_bf16 v[240:243], a[124:127], a[48:51], v[240:243]
  v_mfma_f32_16x16x32_bf16 v[240:243], a[120:123], a[32:35], v[240:243]
  s_waitcnt lgkmcnt(0)
  s_nop 7
  buffer_load_dwordx4 v[60:63], v49, s[36:39], s49 offen
  s_add_u32 s49, s49, 32768
  buffer_load_dwordx4 v[60:63], v49, s[36:39], s49 offen
  s_add_u32 s49, s49, 32768
  buffer_load_dwordx4 v[60:63], v49, s[36:39], s49 offen
  s_add_u32 s49, s49, 32768
  buffer_load_dwordx4 v[60:63], v49, s[36:39], s49 offen
  s_add_u32 s49, s49, 32768
  buffer_load_dwordx4 v[60:63], v49, s[36:39], s49 offen
  s_add_u32 s49, s49, 32768
  buffer_load_dwordx4 v[60:63], v49, s[36:39], s49 offen
  s_add_u32 s49, s49, 32768
  buffer_load_dwordx4 v[60:63], v49, s[36:39], s49 offen
  s_add_u32 s49, s49, 32768
  buffer_load_dwordx4 v[60:63], v49, s[36:39], s49 offen
  s_add_u32 s49, s49, 32768
  v_pk_mul_f32 v[104:105], v[128:129], v[128:129]
  v_pk_mul_f32 v[106:107], v[130:131], v[130:131]
  v_pk_mul_f32 v[108:109], v[144:145], v[144:145]
  v_pk_mul_f32 v[110:111], v[146:147], v[146:147]
  v_pk_fma_f32 v[104:105], v[104:105], v[96:97], v[98:99]
  v_pk_fma_f32 v[106:107], v[106:107], v[96:97], v[98:99]
  v_pk_fma_f32 v[108:109], v[108:109], v[96:97], v[98:99]
  v_pk_fma_f32 v[110:111], v[110:111], v[96:97], v[98:99]
  v_pk_mul_f32 v[104:105], v[104:105], v[128:129]
  v_pk_mul_f32 v[106:107], v[106:107], v[130:131]
  v_pk_mul_f32 v[108:109], v[108:109], v[144:145]
  v_pk_mul_f32 v[110:111], v[110:111], v[146:147]
  v_exp_f32 v104, v104
  v_pk_mul_f32 v[112:113], v[160:161], v[160:161]
  v_exp_f32 v105, v105
  v_pk_mul_f32 v[114:115], v[162:163], v[162:163]
  v_exp_f32 v106, v106
  v_exp_f32 v107, v107
  v_pk_fma_f32 v[112:113], v[112:113], v[96:97], v[98:99]
  v_exp_f32 v108, v108
  v_pk_add_f32 v[104:105], v[104:105], v[100:101]
  v_exp_f32 v109, v109
  v_pk_add_f32 v[106:107], v[106:107], v[100:101]
  v_exp_f32 v110, v110
  v_pk_fma_f32 v[114:115], v[114:115], v[96:97], v[98:99]
  v_rcp_f32 v104, v104
  v_rcp_f32 v105, v105
  v_pk_mul_f32 v[112:113], v[112:113], v[160:161]
  v_rcp_f32 v106, v106
  v_pk_mul_f32 v[114:115], v[114:115], v[162:163]
  v_rcp_f32 v107, v107
  v_exp_f32 v111, v111
  v_pk_mul_f32 v[104:105], v[104:105], v[128:129]
  v_exp_f32 v112, v112
  v_pk_mul_f32 v[106:107], v[106:107], v[130:131]
  v_exp_f32 v113, v113
  v_pk_add_f32 v[108:109], v[108:109], v[100:101]
  v_exp_f32 v114, v114
  v_cvt_pk_bf16_f32 v50, v104, v105
  v_exp_f32 v115, v115
  v_cvt_pk_bf16_f32 v51, v106, v107
  v_pk_add_f32 v[110:111], v[110:111], v[100:101]
  v_pk_add_f32 v[112:113], v[112:113], v[100:101]
  ds_write_b64 v36, v[50:51] offset:0
  v_rcp_f32 v108, v108
  v_pk_add_f32 v[114:115], v[114:115], v[100:101]
  v_rcp_f32 v109, v109
  v_pk_mul_f32 v[116:117], v[176:177], v[176:177]
  v_rcp_f32 v110, v110
  v_pk_mul_f32 v[118:119], v[178:179], v[178:179]
  v_rcp_f32 v111, v111
  v_rcp_f32 v112, v112
  v_pk_mul_f32 v[108:109], v[108:109], v[144:145]
  v_rcp_f32 v113, v113
  v_pk_mul_f32 v[110:111], v[110:111], v[146:147]
  v_rcp_f32 v114, v114
  v_pk_fma_f32 v[116:117], v[116:117], v[96:97], v[98:99]
  v_rcp_f32 v115, v115
  v_cvt_pk_bf16_f32 v52, v108, v109
  v_cvt_pk_bf16_f32 v53, v110, v111
  v_pk_mul_f32 v[112:113], v[112:113], v[160:161]
  v_pk_mul_f32 v[114:115], v[114:115], v[162:163]
  ds_write_b64 v37, v[52:53] offset:0
  v_pk_fma_f32 v[118:119], v[118:119], v[96:97], v[98:99]
  v_cvt_pk_bf16_f32 v54, v112, v113
  v_cvt_pk_bf16_f32 v55, v114, v115
  v_pk_mul_f32 v[116:117], v[116:117], v[176:177]
  v_pk_mul_f32 v[118:119], v[118:119], v[178:179]
  ds_write_b64 v38, v[54:55] offset:0
  v_pk_mul_f32 v[104:105], v[192:193], v[192:193]
  v_exp_f32 v116, v116
  v_pk_mul_f32 v[106:107], v[194:195], v[194:195]
  v_exp_f32 v117, v117
  v_pk_mul_f32 v[108:109], v[208:209], v[208:209]
  v_exp_f32 v118, v118
  v_pk_fma_f32 v[104:105], v[104:105], v[96:97], v[98:99]
  v_exp_f32 v119, v119
  v_pk_fma_f32 v[106:107], v[106:107], v[96:97], v[98:99]
  v_pk_add_f32 v[116:117], v[116:117], v[100:101]
  v_pk_add_f32 v[118:119], v[118:119], v[100:101]
  v_pk_mul_f32 v[104:105], v[104:105], v[192:193]
  v_pk_mul_f32 v[106:107], v[106:107], v[194:195]
  v_rcp_f32 v116, v116
  v_pk_mul_f32 v[110:111], v[210:211], v[210:211]
  v_rcp_f32 v117, v117
  v_rcp_f32 v118, v118
  v_pk_fma_f32 v[108:109], v[108:109], v[96:97], v[98:99]
  v_rcp_f32 v119, v119
  v_pk_fma_f32 v[110:111], v[110:111], v[96:97], v[98:99]
  v_exp_f32 v104, v104
  v_pk_mul_f32 v[116:117], v[116:117], v[176:177]
  v_exp_f32 v105, v105
  v_pk_mul_f32 v[118:119], v[118:119], v[178:179]
  v_exp_f32 v106, v106
  v_pk_mul_f32 v[108:109], v[108:109], v[208:209]
  v_exp_f32 v107, v107
  v_cvt_pk_bf16_f32 v56, v116, v117
  v_cvt_pk_bf16_f32 v57, v118, v119
  v_pk_add_f32 v[104:105], v[104:105], v[100:101]
  v_pk_add_f32 v[106:107], v[106:107], v[100:101]
  ds_write_b64 v39, v[56:57] offset:0
  v_pk_mul_f32 v[110:111], v[110:111], v[210:211]
  v_rcp_f32 v104, v104
  v_pk_mul_f32 v[112:113], v[224:225], v[224:225]
  v_rcp_f32 v105, v105
  v_pk_mul_f32 v[114:115], v[226:227], v[226:227]
  v_rcp_f32 v106, v106
  v_rcp_f32 v107, v107
  v_pk_fma_f32 v[112:113], v[112:113], v[96:97], v[98:99]
  v_exp_f32 v108, v108
  v_pk_mul_f32 v[104:105], v[104:105], v[192:193]
  v_exp_f32 v109, v109
  v_pk_mul_f32 v[106:107], v[106:107], v[194:195]
  v_exp_f32 v110, v110
  v_pk_fma_f32 v[114:115], v[114:115], v[96:97], v[98:99]
  v_exp_f32 v111, v111
  v_cvt_pk_bf16_f32 v50, v104, v105
  v_cvt_pk_bf16_f32 v51, v106, v107
  v_pk_add_f32 v[108:109], v[108:109], v[100:101]
  v_pk_add_f32 v[110:111], v[110:111], v[100:101]
  ds_write_b64 v40, v[50:51] offset:0
  v_pk_mul_f32 v[112:113], v[112:113], v[224:225]
  v_rcp_f32 v108, v108
  v_pk_mul_f32 v[114:115], v[114:115], v[226:227]
  v_rcp_f32 v109, v109
  v_pk_mul_f32 v[116:117], v[240:241], v[240:241]
  v_rcp_f32 v110, v110
  v_pk_mul_f32 v[118:119], v[242:243], v[242:243]
  v_rcp_f32 v111, v111
  v_exp_f32 v112, v112
  v_pk_mul_f32 v[108:109], v[108:109], v[208:209]
  v_exp_f32 v113, v113
  v_pk_mul_f32 v[110:111], v[110:111], v[210:211]
  v_exp_f32 v114, v114
  v_pk_fma_f32 v[116:117], v[116:117], v[96:97], v[98:99]
  v_exp_f32 v115, v115
  v_cvt_pk_bf16_f32 v52, v108, v109
  v_cvt_pk_bf16_f32 v53, v110, v111
  v_pk_add_f32 v[112:113], v[112:113], v[100:101]
  v_pk_add_f32 v[114:115], v[114:115], v[100:101]
  ds_write_b64 v41, v[52:53] offset:0
  v_pk_fma_f32 v[118:119], v[118:119], v[96:97], v[98:99]
  v_rcp_f32 v112, v112
  v_rcp_f32 v113, v113
  v_pk_mul_f32 v[116:117], v[116:117], v[240:241]
  v_rcp_f32 v114, v114
  v_pk_mul_f32 v[118:119], v[118:119], v[242:243]
  v_rcp_f32 v115, v115
  v_pk_mul_f32 v[112:113], v[112:113], v[224:225]
  v_exp_f32 v116, v116
  v_pk_mul_f32 v[114:115], v[114:115], v[226:227]
  v_exp_f32 v117, v117
  v_exp_f32 v118, v118
  v_cvt_pk_bf16_f32 v54, v112, v113
  v_exp_f32 v119, v119
  v_cvt_pk_bf16_f32 v55, v114, v115
  v_pk_add_f32 v[116:117], v[116:117], v[100:101]
  v_pk_add_f32 v[118:119], v[118:119], v[100:101]
  ds_write_b64 v42, v[54:55] offset:0
  v_rcp_f32 v116, v116
  v_rcp_f32 v117, v117
  v_rcp_f32 v118, v118
  v_rcp_f32 v119, v119
  v_pk_mul_f32 v[116:117], v[116:117], v[240:241]
  v_pk_mul_f32 v[118:119], v[118:119], v[242:243]
  v_cvt_pk_bf16_f32 v56, v116, v117
  v_cvt_pk_bf16_f32 v57, v118, v119
  ds_write_b64 v43, v[56:57] offset:0
  ds_read_b128 v[64:67], v44 offset:0
  ds_read_b128 v[68:71], v45 offset:1024
  ds_read_b128 v[72:75], v46 offset:2048
  ds_read_b128 v[76:79], v47 offset:3072
  v_pk_mul_f32 v[104:105], v[132:133], v[132:133]
  v_pk_mul_f32 v[106:107], v[134:135], v[134:135]
  v_pk_mul_f32 v[108:109], v[148:149], v[148:149]
  v_pk_mul_f32 v[110:111], v[150:151], v[150:151]
  v_pk_fma_f32 v[104:105], v[104:105], v[96:97], v[98:99]
  v_pk_fma_f32 v[106:107], v[106:107], v[96:97], v[98:99]
  v_pk_fma_f32 v[108:109], v[108:109], v[96:97], v[98:99]
  v_pk_fma_f32 v[110:111], v[110:111], v[96:97], v[98:99]
  v_pk_mul_f32 v[104:105], v[104:105], v[132:133]
  v_pk_mul_f32 v[106:107], v[106:107], v[134:135]
  v_pk_mul_f32 v[108:109], v[108:109], v[148:149]
  v_pk_mul_f32 v[110:111], v[110:111], v[150:151]
  v_exp_f32 v104, v104
  v_pk_mul_f32 v[112:113], v[164:165], v[164:165]
  v_exp_f32 v105, v105
  v_pk_mul_f32 v[114:115], v[166:167], v[166:167]
  v_exp_f32 v106, v106
  v_exp_f32 v107, v107
  v_pk_fma_f32 v[112:113], v[112:113], v[96:97], v[98:99]
  v_exp_f32 v108, v108
  v_pk_add_f32 v[104:105], v[104:105], v[100:101]
  v_exp_f32 v109, v109
  v_pk_add_f32 v[106:107], v[106:107], v[100:101]
  v_exp_f32 v110, v110
  v_pk_fma_f32 v[114:115], v[114:115], v[96:97], v[98:99]
  v_rcp_f32 v104, v104
  v_rcp_f32 v105, v105
  v_pk_mul_f32 v[112:113], v[112:113], v[164:165]
  v_rcp_f32 v106, v106
  v_pk_mul_f32 v[114:115], v[114:115], v[166:167]
  v_rcp_f32 v107, v107
  v_exp_f32 v111, v111
  v_pk_mul_f32 v[104:105], v[104:105], v[132:133]
  v_exp_f32 v112, v112
  v_pk_mul_f32 v[106:107], v[106:107], v[134:135]
  v_exp_f32 v113, v113
  v_pk_add_f32 v[108:109], v[108:109], v[100:101]
  v_exp_f32 v114, v114
  v_cvt_pk_bf16_f32 v50, v104, v105
  v_exp_f32 v115, v115
  v_cvt_pk_bf16_f32 v51, v106, v107
  v_pk_add_f32 v[110:111], v[110:111], v[100:101]
  v_pk_add_f32 v[112:113], v[112:113], v[100:101]
  ds_write_b64 v36, v[50:51] offset:0
  v_rcp_f32 v108, v108
  v_pk_add_f32 v[114:115], v[114:115], v[100:101]
  v_rcp_f32 v109, v109
  v_pk_mul_f32 v[116:117], v[180:181], v[180:181]
  v_rcp_f32 v110, v110
  v_pk_mul_f32 v[118:119], v[182:183], v[182:183]
  v_rcp_f32 v111, v111
  v_rcp_f32 v112, v112
  v_pk_mul_f32 v[108:109], v[108:109], v[148:149]
  v_rcp_f32 v113, v113
  v_pk_mul_f32 v[110:111], v[110:111], v[150:151]
  v_rcp_f32 v114, v114
  v_pk_fma_f32 v[116:117], v[116:117], v[96:97], v[98:99]
  v_rcp_f32 v115, v115
  v_cvt_pk_bf16_f32 v52, v108, v109
  v_cvt_pk_bf16_f32 v53, v110, v111
  v_pk_mul_f32 v[112:113], v[112:113], v[164:165]
  v_pk_mul_f32 v[114:115], v[114:115], v[166:167]
  ds_write_b64 v37, v[52:53] offset:0
  v_pk_fma_f32 v[118:119], v[118:119], v[96:97], v[98:99]
  v_cvt_pk_bf16_f32 v54, v112, v113
  v_cvt_pk_bf16_f32 v55, v114, v115
  v_pk_mul_f32 v[116:117], v[116:117], v[180:181]
  v_pk_mul_f32 v[118:119], v[118:119], v[182:183]
  ds_write_b64 v38, v[54:55] offset:0
  v_pk_mul_f32 v[104:105], v[196:197], v[196:197]
  v_exp_f32 v116, v116
  v_pk_mul_f32 v[106:107], v[198:199], v[198:199]
  v_exp_f32 v117, v117
  v_pk_mul_f32 v[108:109], v[212:213], v[212:213]
  v_exp_f32 v118, v118
  v_pk_fma_f32 v[104:105], v[104:105], v[96:97], v[98:99]
  v_exp_f32 v119, v119
  v_pk_fma_f32 v[106:107], v[106:107], v[96:97], v[98:99]
  v_pk_add_f32 v[116:117], v[116:117], v[100:101]
  v_pk_add_f32 v[118:119], v[118:119], v[100:101]
  v_pk_mul_f32 v[104:105], v[104:105], v[196:197]
  v_pk_mul_f32 v[106:107], v[106:107], v[198:199]
  v_rcp_f32 v116, v116
  v_pk_mul_f32 v[110:111], v[214:215], v[214:215]
  v_rcp_f32 v117, v117
  v_rcp_f32 v118, v118
  v_pk_fma_f32 v[108:109], v[108:109], v[96:97], v[98:99]
  v_rcp_f32 v119, v119
  v_pk_fma_f32 v[110:111], v[110:111], v[96:97], v[98:99]
  v_exp_f32 v104, v104
  v_pk_mul_f32 v[116:117], v[116:117], v[180:181]
  v_exp_f32 v105, v105
  v_pk_mul_f32 v[118:119], v[118:119], v[182:183]
  v_exp_f32 v106, v106
  v_pk_mul_f32 v[108:109], v[108:109], v[212:213]
  v_exp_f32 v107, v107
  v_cvt_pk_bf16_f32 v56, v116, v117
  v_cvt_pk_bf16_f32 v57, v118, v119
  v_pk_add_f32 v[104:105], v[104:105], v[100:101]
  v_pk_add_f32 v[106:107], v[106:107], v[100:101]
  ds_write_b64 v39, v[56:57] offset:0
  v_pk_mul_f32 v[110:111], v[110:111], v[214:215]
  v_rcp_f32 v104, v104
  v_pk_mul_f32 v[112:113], v[228:229], v[228:229]
  v_rcp_f32 v105, v105
  v_pk_mul_f32 v[114:115], v[230:231], v[230:231]
  v_rcp_f32 v106, v106
  v_rcp_f32 v107, v107
  v_pk_fma_f32 v[112:113], v[112:113], v[96:97], v[98:99]
  v_exp_f32 v108, v108
  v_pk_mul_f32 v[104:105], v[104:105], v[196:197]
  v_exp_f32 v109, v109
  v_pk_mul_f32 v[106:107], v[106:107], v[198:199]
  v_exp_f32 v110, v110
  v_pk_fma_f32 v[114:115], v[114:115], v[96:97], v[98:99]
  v_exp_f32 v111, v111
  v_cvt_pk_bf16_f32 v50, v104, v105
  v_cvt_pk_bf16_f32 v51, v106, v107
  v_pk_add_f32 v[108:109], v[108:109], v[100:101]
  v_pk_add_f32 v[110:111], v[110:111], v[100:101]
  ds_write_b64 v40, v[50:51] offset:0
  v_pk_mul_f32 v[112:113], v[112:113], v[228:229]
  v_rcp_f32 v108, v108
  v_pk_mul_f32 v[114:115], v[114:115], v[230:231]
  v_rcp_f32 v109, v109
  v_pk_mul_f32 v[116:117], v[244:245], v[244:245]
  v_rcp_f32 v110, v110
  v_pk_mul_f32 v[118:119], v[246:247], v[246:247]
  v_rcp_f32 v111, v111
  v_exp_f32 v112, v112
  v_pk_mul_f32 v[108:109], v[108:109], v[212:213]
  v_exp_f32 v113, v113
  v_pk_mul_f32 v[110:111], v[110:111], v[214:215]
  v_exp_f32 v114, v114
  v_pk_fma_f32 v[116:117], v[116:117], v[96:97], v[98:99]
  v_exp_f32 v115, v115
  v_cvt_pk_bf16_f32 v52, v108, v109
  v_cvt_pk_bf16_f32 v53, v110, v111
  v_pk_add_f32 v[112:113], v[112:113], v[100:101]
  v_pk_add_f32 v[114:115], v[114:115], v[100:101]
  ds_write_b64 v41, v[52:53] offset:0
  v_pk_fma_f32 v[118:119], v[118:119], v[96:97], v[98:99]
  v_rcp_f32 v112, v112
  v_rcp_f32 v113, v113
  v_pk_mul_f32 v[116:117], v[116:117], v[244:245]
  v_rcp_f32 v114, v114
  v_pk_mul_f32 v[118:119], v[118:119], v[246:247]
  v_rcp_f32 v115, v115
  v_pk_mul_f32 v[112:113], v[112:113], v[228:229]
  v_exp_f32 v116, v116
  v_pk_mul_f32 v[114:115], v[114:115], v[230:231]
  v_exp_f32 v117, v117
  v_exp_f32 v118, v118
  v_cvt_pk_bf16_f32 v54, v112, v113
  v_exp_f32 v119, v119
  v_cvt_pk_bf16_f32 v55, v114, v115
  v_pk_add_f32 v[116:117], v[116:117], v[100:101]
  v_pk_add_f32 v[118:119], v[118:119], v[100:101]
  ds_write_b64 v42, v[54:55] offset:0
  v_rcp_f32 v116, v116
  v_rcp_f32 v117, v117
  v_rcp_f32 v118, v118
  v_rcp_f32 v119, v119
  v_pk_mul_f32 v[116:117], v[116:117], v[244:245]
  v_pk_mul_f32 v[118:119], v[118:119], v[246:247]
  v_cvt_pk_bf16_f32 v56, v116, v117
  v_cvt_pk_bf16_f32 v57, v118, v119
  ds_write_b64 v43, v[56:57] offset:0
  s_waitcnt lgkmcnt(8)
  buffer_store_dwordx4 v[64:67], v48, s[16:19], s30 offen sc1
  s_add_u32 s30, s30, 14336
  buffer_store_dwordx4 v[68:71], v48, s[16:19], s30 offen sc1
  s_add_u32 s30, s30, 14336
  buffer_store_dwordx4 v[72:75], v48, s[16:19], s30 offen sc1
  s_add_u32 s30, s30, 14336
  buffer_store_dwordx4 v[76:79], v48, s[16:19], s30 offen sc1
  s_add_u32 s30, s30, 14336
  ds_read_b128 v[80:83], v44 offset:0
  ds_read_b128 v[84:87], v45 offset:1024
  ds_read_b128 v[88:91], v46 offset:2048
  ds_read_b128 v[92:95], v47 offset:3072
  v_pk_mul_f32 v[104:105], v[136:137], v[136:137]
  v_pk_mul_f32 v[106:107], v[138:139], v[138:139]
  v_pk_mul_f32 v[108:109], v[152:153], v[152:153]
  v_pk_mul_f32 v[110:111], v[154:155], v[154:155]
  v_pk_fma_f32 v[104:105], v[104:105], v[96:97], v[98:99]
  v_pk_fma_f32 v[106:107], v[106:107], v[96:97], v[98:99]
  v_pk_fma_f32 v[108:109], v[108:109], v[96:97], v[98:99]
  v_pk_fma_f32 v[110:111], v[110:111], v[96:97], v[98:99]
  v_pk_mul_f32 v[104:105], v[104:105], v[136:137]
  v_pk_mul_f32 v[106:107], v[106:107], v[138:139]
  v_pk_mul_f32 v[108:109], v[108:109], v[152:153]
  v_pk_mul_f32 v[110:111], v[110:111], v[154:155]
  v_exp_f32 v104, v104
  v_pk_mul_f32 v[112:113], v[168:169], v[168:169]
  v_exp_f32 v105, v105
  v_pk_mul_f32 v[114:115], v[170:171], v[170:171]
  v_exp_f32 v106, v106
  v_exp_f32 v107, v107
  v_pk_fma_f32 v[112:113], v[112:113], v[96:97], v[98:99]
  v_exp_f32 v108, v108
  v_pk_add_f32 v[104:105], v[104:105], v[100:101]
  v_exp_f32 v109, v109
  v_pk_add_f32 v[106:107], v[106:107], v[100:101]
  v_exp_f32 v110, v110
  v_pk_fma_f32 v[114:115], v[114:115], v[96:97], v[98:99]
  v_rcp_f32 v104, v104
  v_rcp_f32 v105, v105
  v_pk_mul_f32 v[112:113], v[112:113], v[168:169]
  v_rcp_f32 v106, v106
  v_pk_mul_f32 v[114:115], v[114:115], v[170:171]
  v_rcp_f32 v107, v107
  v_exp_f32 v111, v111
  v_pk_mul_f32 v[104:105], v[104:105], v[136:137]
  v_exp_f32 v112, v112
  v_pk_mul_f32 v[106:107], v[106:107], v[138:139]
  v_exp_f32 v113, v113
  v_pk_add_f32 v[108:109], v[108:109], v[100:101]
  v_exp_f32 v114, v114
  v_cvt_pk_bf16_f32 v50, v104, v105
  v_exp_f32 v115, v115
  v_cvt_pk_bf16_f32 v51, v106, v107
  v_pk_add_f32 v[110:111], v[110:111], v[100:101]
  v_pk_add_f32 v[112:113], v[112:113], v[100:101]
  ds_write_b64 v36, v[50:51] offset:0
  v_rcp_f32 v108, v108
  v_pk_add_f32 v[114:115], v[114:115], v[100:101]
  v_rcp_f32 v109, v109
  v_pk_mul_f32 v[116:117], v[184:185], v[184:185]
  v_rcp_f32 v110, v110
  v_pk_mul_f32 v[118:119], v[186:187], v[186:187]
  v_rcp_f32 v111, v111
  v_rcp_f32 v112, v112
  v_pk_mul_f32 v[108:109], v[108:109], v[152:153]
  v_rcp_f32 v113, v113
  v_pk_mul_f32 v[110:111], v[110:111], v[154:155]
  v_rcp_f32 v114, v114
  v_pk_fma_f32 v[116:117], v[116:117], v[96:97], v[98:99]
  v_rcp_f32 v115, v115
  v_cvt_pk_bf16_f32 v52, v108, v109
  v_cvt_pk_bf16_f32 v53, v110, v111
  v_pk_mul_f32 v[112:113], v[112:113], v[168:169]
  v_pk_mul_f32 v[114:115], v[114:115], v[170:171]
  ds_write_b64 v37, v[52:53] offset:0
  v_pk_fma_f32 v[118:119], v[118:119], v[96:97], v[98:99]
  v_cvt_pk_bf16_f32 v54, v112, v113
  v_cvt_pk_bf16_f32 v55, v114, v115
  v_pk_mul_f32 v[116:117], v[116:117], v[184:185]
  v_pk_mul_f32 v[118:119], v[118:119], v[186:187]
  ds_write_b64 v38, v[54:55] offset:0
  v_pk_mul_f32 v[104:105], v[200:201], v[200:201]
  v_exp_f32 v116, v116
  v_pk_mul_f32 v[106:107], v[202:203], v[202:203]
  v_exp_f32 v117, v117
  v_pk_mul_f32 v[108:109], v[216:217], v[216:217]
  v_exp_f32 v118, v118
  v_pk_fma_f32 v[104:105], v[104:105], v[96:97], v[98:99]
  v_exp_f32 v119, v119
  v_pk_fma_f32 v[106:107], v[106:107], v[96:97], v[98:99]
  v_pk_add_f32 v[116:117], v[116:117], v[100:101]
  v_pk_add_f32 v[118:119], v[118:119], v[100:101]
  v_pk_mul_f32 v[104:105], v[104:105], v[200:201]
  v_pk_mul_f32 v[106:107], v[106:107], v[202:203]
  v_rcp_f32 v116, v116
  v_pk_mul_f32 v[110:111], v[218:219], v[218:219]
  v_rcp_f32 v117, v117
  v_rcp_f32 v118, v118
  v_pk_fma_f32 v[108:109], v[108:109], v[96:97], v[98:99]
  v_rcp_f32 v119, v119
  v_pk_fma_f32 v[110:111], v[110:111], v[96:97], v[98:99]
  v_exp_f32 v104, v104
  v_pk_mul_f32 v[116:117], v[116:117], v[184:185]
  v_exp_f32 v105, v105
  v_pk_mul_f32 v[118:119], v[118:119], v[186:187]
  v_exp_f32 v106, v106
  v_pk_mul_f32 v[108:109], v[108:109], v[216:217]
  v_exp_f32 v107, v107
  v_cvt_pk_bf16_f32 v56, v116, v117
  v_cvt_pk_bf16_f32 v57, v118, v119
  v_pk_add_f32 v[104:105], v[104:105], v[100:101]
  v_pk_add_f32 v[106:107], v[106:107], v[100:101]
  ds_write_b64 v39, v[56:57] offset:0
  v_pk_mul_f32 v[110:111], v[110:111], v[218:219]
  v_rcp_f32 v104, v104
  v_pk_mul_f32 v[112:113], v[232:233], v[232:233]
  v_rcp_f32 v105, v105
  v_pk_mul_f32 v[114:115], v[234:235], v[234:235]
  v_rcp_f32 v106, v106
  v_rcp_f32 v107, v107
  v_pk_fma_f32 v[112:113], v[112:113], v[96:97], v[98:99]
  v_exp_f32 v108, v108
  v_pk_mul_f32 v[104:105], v[104:105], v[200:201]
  v_exp_f32 v109, v109
  v_pk_mul_f32 v[106:107], v[106:107], v[202:203]
  v_exp_f32 v110, v110
  v_pk_fma_f32 v[114:115], v[114:115], v[96:97], v[98:99]
  v_exp_f32 v111, v111
  v_cvt_pk_bf16_f32 v50, v104, v105
  v_cvt_pk_bf16_f32 v51, v106, v107
  v_pk_add_f32 v[108:109], v[108:109], v[100:101]
  v_pk_add_f32 v[110:111], v[110:111], v[100:101]
  ds_write_b64 v40, v[50:51] offset:0
  v_pk_mul_f32 v[112:113], v[112:113], v[232:233]
  v_rcp_f32 v108, v108
  v_pk_mul_f32 v[114:115], v[114:115], v[234:235]
  v_rcp_f32 v109, v109
  v_pk_mul_f32 v[116:117], v[248:249], v[248:249]
  v_rcp_f32 v110, v110
  v_pk_mul_f32 v[118:119], v[250:251], v[250:251]
  v_rcp_f32 v111, v111
  v_exp_f32 v112, v112
  v_pk_mul_f32 v[108:109], v[108:109], v[216:217]
  v_exp_f32 v113, v113
  v_pk_mul_f32 v[110:111], v[110:111], v[218:219]
  v_exp_f32 v114, v114
  v_pk_fma_f32 v[116:117], v[116:117], v[96:97], v[98:99]
  v_exp_f32 v115, v115
  v_cvt_pk_bf16_f32 v52, v108, v109
  v_cvt_pk_bf16_f32 v53, v110, v111
  v_pk_add_f32 v[112:113], v[112:113], v[100:101]
  v_pk_add_f32 v[114:115], v[114:115], v[100:101]
  ds_write_b64 v41, v[52:53] offset:0
  v_pk_fma_f32 v[118:119], v[118:119], v[96:97], v[98:99]
  v_rcp_f32 v112, v112
  v_rcp_f32 v113, v113
  v_pk_mul_f32 v[116:117], v[116:117], v[248:249]
  v_rcp_f32 v114, v114
  v_pk_mul_f32 v[118:119], v[118:119], v[250:251]
  v_rcp_f32 v115, v115
  v_pk_mul_f32 v[112:113], v[112:113], v[232:233]
  v_exp_f32 v116, v116
  v_pk_mul_f32 v[114:115], v[114:115], v[234:235]
  v_exp_f32 v117, v117
  v_exp_f32 v118, v118
  v_cvt_pk_bf16_f32 v54, v112, v113
  v_exp_f32 v119, v119
  v_cvt_pk_bf16_f32 v55, v114, v115
  v_pk_add_f32 v[116:117], v[116:117], v[100:101]
  v_pk_add_f32 v[118:119], v[118:119], v[100:101]
  ds_write_b64 v42, v[54:55] offset:0
  v_rcp_f32 v116, v116
  v_rcp_f32 v117, v117
  v_rcp_f32 v118, v118
  v_rcp_f32 v119, v119
  v_pk_mul_f32 v[116:117], v[116:117], v[248:249]
  v_pk_mul_f32 v[118:119], v[118:119], v[250:251]
  v_cvt_pk_bf16_f32 v56, v116, v117
  v_cvt_pk_bf16_f32 v57, v118, v119
  ds_write_b64 v43, v[56:57] offset:0
  s_waitcnt lgkmcnt(8)
  buffer_store_dwordx4 v[80:83], v48, s[16:19], s30 offen sc1
  s_add_u32 s30, s30, 14336
  buffer_store_dwordx4 v[84:87], v48, s[16:19], s30 offen sc1
  s_add_u32 s30, s30, 14336
  buffer_store_dwordx4 v[88:91], v48, s[16:19], s30 offen sc1
  s_add_u32 s30, s30, 14336
  buffer_store_dwordx4 v[92:95], v48, s[16:19], s30 offen sc1
  s_add_u32 s30, s30, 14336
  ds_read_b128 v[64:67], v44 offset:0
  ds_read_b128 v[68:71], v45 offset:1024
  ds_read_b128 v[72:75], v46 offset:2048
  ds_read_b128 v[76:79], v47 offset:3072
  v_pk_mul_f32 v[104:105], v[140:141], v[140:141]
  v_pk_mul_f32 v[106:107], v[142:143], v[142:143]
  v_pk_mul_f32 v[108:109], v[156:157], v[156:157]
  v_pk_mul_f32 v[110:111], v[158:159], v[158:159]
  v_pk_fma_f32 v[104:105], v[104:105], v[96:97], v[98:99]
  v_pk_fma_f32 v[106:107], v[106:107], v[96:97], v[98:99]
  v_pk_fma_f32 v[108:109], v[108:109], v[96:97], v[98:99]
  v_pk_fma_f32 v[110:111], v[110:111], v[96:97], v[98:99]
  v_pk_mul_f32 v[104:105], v[104:105], v[140:141]
  v_pk_mul_f32 v[106:107], v[106:107], v[142:143]
  v_pk_mul_f32 v[108:109], v[108:109], v[156:157]
  v_pk_mul_f32 v[110:111], v[110:111], v[158:159]
  v_exp_f32 v104, v104
  v_pk_mul_f32 v[112:113], v[172:173], v[172:173]
  v_exp_f32 v105, v105
  v_pk_mul_f32 v[114:115], v[174:175], v[174:175]
  v_exp_f32 v106, v106
  v_exp_f32 v107, v107
  v_pk_fma_f32 v[112:113], v[112:113], v[96:97], v[98:99]
  v_exp_f32 v108, v108
  v_pk_add_f32 v[104:105], v[104:105], v[100:101]
  v_exp_f32 v109, v109
  v_pk_add_f32 v[106:107], v[106:107], v[100:101]
  v_exp_f32 v110, v110
  v_pk_fma_f32 v[114:115], v[114:115], v[96:97], v[98:99]
  v_rcp_f32 v104, v104
  v_rcp_f32 v105, v105
  v_pk_mul_f32 v[112:113], v[112:113], v[172:173]
  v_rcp_f32 v106, v106
  v_pk_mul_f32 v[114:115], v[114:115], v[174:175]
  v_rcp_f32 v107, v107
  v_exp_f32 v111, v111
  v_pk_mul_f32 v[104:105], v[104:105], v[140:141]
  v_exp_f32 v112, v112
  v_pk_mul_f32 v[106:107], v[106:107], v[142:143]
  v_exp_f32 v113, v113
  v_pk_add_f32 v[108:109], v[108:109], v[100:101]
  v_exp_f32 v114, v114
  v_cvt_pk_bf16_f32 v50, v104, v105
  v_exp_f32 v115, v115
  v_cvt_pk_bf16_f32 v51, v106, v107
  v_pk_add_f32 v[110:111], v[110:111], v[100:101]
  v_pk_add_f32 v[112:113], v[112:113], v[100:101]
  ds_write_b64 v36, v[50:51] offset:0
  v_rcp_f32 v108, v108
  v_pk_add_f32 v[114:115], v[114:115], v[100:101]
  v_rcp_f32 v109, v109
  v_pk_mul_f32 v[116:117], v[188:189], v[188:189]
  v_rcp_f32 v110, v110
  v_pk_mul_f32 v[118:119], v[190:191], v[190:191]
  v_rcp_f32 v111, v111
  v_rcp_f32 v112, v112
  v_pk_mul_f32 v[108:109], v[108:109], v[156:157]
  v_rcp_f32 v113, v113
  v_pk_mul_f32 v[110:111], v[110:111], v[158:159]
  v_rcp_f32 v114, v114
  v_pk_fma_f32 v[116:117], v[116:117], v[96:97], v[98:99]
  v_rcp_f32 v115, v115
  v_cvt_pk_bf16_f32 v52, v108, v109
  v_cvt_pk_bf16_f32 v53, v110, v111
  v_pk_mul_f32 v[112:113], v[112:113], v[172:173]
  v_pk_mul_f32 v[114:115], v[114:115], v[174:175]
  ds_write_b64 v37, v[52:53] offset:0
  v_pk_fma_f32 v[118:119], v[118:119], v[96:97], v[98:99]
  v_cvt_pk_bf16_f32 v54, v112, v113
  v_cvt_pk_bf16_f32 v55, v114, v115
  v_pk_mul_f32 v[116:117], v[116:117], v[188:189]
  v_pk_mul_f32 v[118:119], v[118:119], v[190:191]
  ds_write_b64 v38, v[54:55] offset:0
  v_pk_mul_f32 v[104:105], v[204:205], v[204:205]
  v_exp_f32 v116, v116
  v_pk_mul_f32 v[106:107], v[206:207], v[206:207]
  v_exp_f32 v117, v117
  v_pk_mul_f32 v[108:109], v[220:221], v[220:221]
  v_exp_f32 v118, v118
  v_pk_fma_f32 v[104:105], v[104:105], v[96:97], v[98:99]
  v_exp_f32 v119, v119
  v_pk_fma_f32 v[106:107], v[106:107], v[96:97], v[98:99]
  v_pk_add_f32 v[116:117], v[116:117], v[100:101]
  v_pk_add_f32 v[118:119], v[118:119], v[100:101]
  v_pk_mul_f32 v[104:105], v[104:105], v[204:205]
  v_pk_mul_f32 v[106:107], v[106:107], v[206:207]
  v_rcp_f32 v116, v116
  v_pk_mul_f32 v[110:111], v[222:223], v[222:223]
  v_rcp_f32 v117, v117
  v_rcp_f32 v118, v118
  v_pk_fma_f32 v[108:109], v[108:109], v[96:97], v[98:99]
  v_rcp_f32 v119, v119
  v_pk_fma_f32 v[110:111], v[110:111], v[96:97], v[98:99]
  v_exp_f32 v104, v104
  v_pk_mul_f32 v[116:117], v[116:117], v[188:189]
  v_exp_f32 v105, v105
  v_pk_mul_f32 v[118:119], v[118:119], v[190:191]
  v_exp_f32 v106, v106
  v_pk_mul_f32 v[108:109], v[108:109], v[220:221]
  v_exp_f32 v107, v107
  v_cvt_pk_bf16_f32 v56, v116, v117
  v_cvt_pk_bf16_f32 v57, v118, v119
  v_pk_add_f32 v[104:105], v[104:105], v[100:101]
  v_pk_add_f32 v[106:107], v[106:107], v[100:101]
  ds_write_b64 v39, v[56:57] offset:0
  v_pk_mul_f32 v[110:111], v[110:111], v[222:223]
  v_rcp_f32 v104, v104
  v_pk_mul_f32 v[112:113], v[236:237], v[236:237]
  v_rcp_f32 v105, v105
  v_pk_mul_f32 v[114:115], v[238:239], v[238:239]
  v_rcp_f32 v106, v106
  v_rcp_f32 v107, v107
  v_pk_fma_f32 v[112:113], v[112:113], v[96:97], v[98:99]
  v_exp_f32 v108, v108
  v_pk_mul_f32 v[104:105], v[104:105], v[204:205]
  v_exp_f32 v109, v109
  v_pk_mul_f32 v[106:107], v[106:107], v[206:207]
  v_exp_f32 v110, v110
  v_pk_fma_f32 v[114:115], v[114:115], v[96:97], v[98:99]
  v_exp_f32 v111, v111
  v_cvt_pk_bf16_f32 v50, v104, v105
  v_cvt_pk_bf16_f32 v51, v106, v107
  v_pk_add_f32 v[108:109], v[108:109], v[100:101]
  v_pk_add_f32 v[110:111], v[110:111], v[100:101]
  ds_write_b64 v40, v[50:51] offset:0
  v_pk_mul_f32 v[112:113], v[112:113], v[236:237]
  v_rcp_f32 v108, v108
  v_pk_mul_f32 v[114:115], v[114:115], v[238:239]
  v_rcp_f32 v109, v109
  v_pk_mul_f32 v[116:117], v[252:253], v[252:253]
  v_rcp_f32 v110, v110
  v_pk_mul_f32 v[118:119], v[254:255], v[254:255]
  v_rcp_f32 v111, v111
  v_exp_f32 v112, v112
  v_pk_mul_f32 v[108:109], v[108:109], v[220:221]
  v_exp_f32 v113, v113
  v_pk_mul_f32 v[110:111], v[110:111], v[222:223]
  v_exp_f32 v114, v114
  v_pk_fma_f32 v[116:117], v[116:117], v[96:97], v[98:99]
  v_exp_f32 v115, v115
  v_cvt_pk_bf16_f32 v52, v108, v109
  v_cvt_pk_bf16_f32 v53, v110, v111
  v_pk_add_f32 v[112:113], v[112:113], v[100:101]
  v_pk_add_f32 v[114:115], v[114:115], v[100:101]
  ds_write_b64 v41, v[52:53] offset:0
  v_pk_fma_f32 v[118:119], v[118:119], v[96:97], v[98:99]
  v_rcp_f32 v112, v112
  v_rcp_f32 v113, v113
  v_pk_mul_f32 v[116:117], v[116:117], v[252:253]
  v_rcp_f32 v114, v114
  v_pk_mul_f32 v[118:119], v[118:119], v[254:255]
  v_rcp_f32 v115, v115
  v_pk_mul_f32 v[112:113], v[112:113], v[236:237]
  v_exp_f32 v116, v116
  v_pk_mul_f32 v[114:115], v[114:115], v[238:239]
  v_exp_f32 v117, v117
  v_exp_f32 v118, v118
  v_cvt_pk_bf16_f32 v54, v112, v113
  v_exp_f32 v119, v119
  v_cvt_pk_bf16_f32 v55, v114, v115
  v_pk_add_f32 v[116:117], v[116:117], v[100:101]
  v_pk_add_f32 v[118:119], v[118:119], v[100:101]
  ds_write_b64 v42, v[54:55] offset:0
  v_rcp_f32 v116, v116
  v_rcp_f32 v117, v117
  v_rcp_f32 v118, v118
  v_rcp_f32 v119, v119
  v_pk_mul_f32 v[116:117], v[116:117], v[252:253]
  v_pk_mul_f32 v[118:119], v[118:119], v[254:255]
  v_cvt_pk_bf16_f32 v56, v116, v117
  v_cvt_pk_bf16_f32 v57, v118, v119
  ds_write_b64 v43, v[56:57] offset:0
  s_waitcnt lgkmcnt(8)
  buffer_store_dwordx4 v[64:67], v48, s[16:19], s30 offen sc1
  s_add_u32 s30, s30, 14336
  buffer_store_dwordx4 v[68:71], v48, s[16:19], s30 offen sc1
  s_add_u32 s30, s30, 14336
  buffer_store_dwordx4 v[72:75], v48, s[16:19], s30 offen sc1
  s_add_u32 s30, s30, 14336
  buffer_store_dwordx4 v[76:79], v48, s[16:19], s30 offen sc1
  s_add_u32 s30, s30, 14336
  ds_read_b128 v[80:83], v44 offset:0
  ds_read_b128 v[84:87], v45 offset:1024
  ds_read_b128 v[88:91], v46 offset:2048
  ds_read_b128 v[92:95], v47 offset:3072
  s_waitcnt lgkmcnt(0)
  buffer_store_dwordx4 v[80:83], v48, s[16:19], s30 offen sc1
  s_add_u32 s30, s30, 14336
  buffer_store_dwordx4 v[84:87], v48, s[16:19], s30 offen sc1
  s_add_u32 s30, s30, 14336
  buffer_store_dwordx4 v[88:91], v48, s[16:19], s30 offen sc1
  s_add_u32 s30, s30, 14336
  buffer_store_dwordx4 v[92:95], v48, s[16:19], s30 offen sc1
  s_add_u32 s30, s30, 14336
att_q:
  v_mfma_f32_16x16x32_bf16 v[128:131], a[64:67], a[0:3], 0
  s_add_u32 m0, s28, 36864
  v_mfma_f32_16x16x32_bf16 v[128:131], a[68:71], a[16:19], v[128:131]
  ds_read_b64_tr_b16 a[96:97], v22 offset:32768
  v_mfma_f32_16x16x32_bf16 v[132:135], a[68:71], a[20:23], 0
  buffer_load_dwordx4 v8, s[8:11], s32 offen offset:2048 lds
  v_mfma_f32_16x16x32_bf16 v[132:135], a[64:67], a[4:7], v[132:135]
  ds_read_b64_tr_b16 a[98:99], v22 offset:33792
  v_mfma_f32_16x16x32_bf16 v[136:139], a[64:67], a[8:11], 0
  ds_read_b64_tr_b16 a[100:101], v22 offset:40960
  v_mfma_f32_16x16x32_bf16 v[136:139], a[68:71], a[24:27], v[136:139]
  buffer_load_dwordx4 v9, s[8:11], s32 offen offset:3072 lds
  v_mfma_f32_16x16x32_bf16 v[140:143], a[68:71], a[28:31], 0
  v_mfma_f32_16x16x32_bf16 v[140:143], a[64:67], a[12:15], v[140:143]
  ds_read_b64_tr_b16 a[102:103], v22 offset:41984
  v_mfma_f32_16x16x32_bf16 v[156:159], a[72:75], a[12:15], 0
  ds_read_b64_tr_b16 a[104:105], v23 offset:32768
  v_mfma_f32_16x16x32_bf16 v[156:159], a[76:79], a[28:31], v[156:159]
  s_add_u32 m0, s29, 16384
  v_mfma_f32_16x16x32_bf16 v[152:155], a[76:79], a[24:27], 0
  ds_read_b64_tr_b16 a[106:107], v23 offset:33792
  v_mfma_f32_16x16x32_bf16 v[152:155], a[72:75], a[8:11], v[152:155]
  buffer_load_dwordx4 v32, s[36:39], s33 offen offset:0 lds
  v_mfma_f32_16x16x32_bf16 v[148:151], a[72:75], a[4:7], 0
  ds_read_b64_tr_b16 a[108:109], v23 offset:40960
  v_mfma_f32_16x16x32_bf16 v[148:151], a[76:79], a[20:23], v[148:151]
  v_mfma_f32_16x16x32_bf16 v[144:147], a[76:79], a[16:19], 0
  ds_read_b64_tr_b16 a[110:111], v23 offset:41984
  v_mfma_f32_16x16x32_bf16 v[144:147], a[72:75], a[0:3], v[144:147]
  ds_read_b64_tr_b16 a[112:113], v24 offset:32768
  v_mfma_f32_16x16x32_bf16 v[160:163], a[80:83], a[0:3], 0
  buffer_load_dwordx4 v33, s[36:39], s33 offen offset:1024 lds
  v_mfma_f32_16x16x32_bf16 v[160:163], a[84:87], a[16:19], v[160:163]
  ds_read_b64_tr_b16 a[114:115], v24 offset:33792
  v_mfma_f32_16x16x32_bf16 v[164:167], a[84:87], a[20:23], 0
  ds_read_b64_tr_b16 a[116:117], v24 offset:40960
  v_mfma_f32_16x16x32_bf16 v[164:167], a[80:83], a[4:7], v[164:167]
  buffer_load_dwordx4 v34, s[36:39], s33 offen offset:2048 lds
  v_mfma_f32_16x16x32_bf16 v[168:171], a[80:83], a[8:11], 0
  v_mfma_f32_16x16x32_bf16 v[168:171], a[84:87], a[24:27], v[168:171]
  ds_read_b64_tr_b16 a[118:119], v24 offset:41984
  v_mfma_f32_16x16x32_bf16 v[172:175], a[84:87], a[28:31], 0
  ds_read_b64_tr_b16 a[120:121], v25 offset:32768
  v_mfma_f32_16x16x32_bf16 v[172:175], a[80:83], a[12:15], v[172:175]
  ds_read_b64_tr_b16 a[122:123], v25 offset:33792
  v_mfma_f32_16x16x32_bf16 v[188:191], a[88:91], a[12:15], 0
  buffer_load_dwordx4 v35, s[36:39], s33 offen offset:3072 lds
  v_mfma_f32_16x16x32_bf16 v[188:191], a[92:95], a[28:31], v[188:191]
  ds_read_b64_tr_b16 a[124:125], v25 offset:40960
  v_mfma_f32_16x16x32_bf16 v[184:187], a[92:95], a[24:27], 0
  ds_read_b64_tr_b16 a[126:127], v25 offset:41984
  v_mfma_f32_16x16x32_bf16 v[184:187], a[88:91], a[8:11], v[184:187]
  v_mfma_f32_16x16x32_bf16 v[180:183], a[88:91], a[4:7], 0
  v_mfma_f32_16x16x32_bf16 v[180:183], a[92:95], a[20:23], v[180:183]
  v_mfma_f32_16x16x32_bf16 v[176:179], a[92:95], a[16:19], 0
  s_add_u32 s32, s32, 128
  v_mfma_f32_16x16x32_bf16 v[176:179], a[88:91], a[0:3], v[176:179]
  s_add_u32 s33, s33, 524288
  s_waitcnt lgkmcnt(0) vmcnt(36)
  s_barrier
  v_mfma_f32_16x16x32_bf16 v[192:195], a[96:99], a[0:3], 0
  s_add_u32 m0, s28, 65536
  ds_read_b64_tr_b16 a[64:65], v18 offset:0
  v_mfma_f32_16x16x32_bf16 v[192:195], a[100:103], a[16:19], v[192:195]
  buffer_load_dwordx4 v2, s[8:11], s32 offen offset:0 lds
  v_mfma_f32_16x16x32_bf16 v[196:199], a[100:103], a[20:23], 0
  ds_read_b64_tr_b16 a[66:67], v18 offset:1024
  v_mfma_f32_16x16x32_bf16 v[196:199], a[96:99], a[4:7], v[196:199]
  ds_read_b64_tr_b16 a[68:69], v18 offset:8192
  v_mfma_f32_16x16x32_bf16 v[200:203], a[96:99], a[8:11], 0
  ds_read_b64_tr_b16 a[70:71], v18 offset:9216
  v_mfma_f32_16x16x32_bf16 v[200:203], a[100:103], a[24:27], v[200:203]
  ds_read_b128 a[32:35], v14 offset:0
  v_mfma_f32_16x16x32_bf16 v[204:207], a[100:103], a[28:31], 0
  buffer_load_dwordx4 v3, s[8:11], s32 offen offset:1024 lds
  v_mfma_f32_16x16x32_bf16 v[204:207], a[96:99], a[12:15], v[204:207]
  ds_read_b128 a[48:51], v15 offset:0
  ds_read_b128 a[36:39], v14 offset:2048
  v_mfma_f32_16x16x32_bf16 v[220:223], a[104:107], a[12:15], 0
  ds_read_b128 a[52:55], v15 offset:2048
  v_mfma_f32_16x16x32_bf16 v[220:223], a[108:111], a[28:31], v[220:223]
  ds_read_b128 a[40:43], v14 offset:4096
  v_mfma_f32_16x16x32_bf16 v[216:219], a[108:111], a[24:27], 0
  buffer_load_dwordx4 v4, s[8:11], s32 offen offset:2048 lds
  v_mfma_f32_16x16x32_bf16 v[216:219], a[104:107], a[8:11], v[216:219]
  ds_read_b128 a[56:59], v15 offset:4096
  v_mfma_f32_16x16x32_bf16 v[212:215], a[104:107], a[4:7], 0
  ds_read_b128 a[44:47], v14 offset:6144
  v_mfma_f32_16x16x32_bf16 v[212:215], a[108:111], a[20:23], v[212:215]
  ds_read_b128 a[60:63], v15 offset:6144
  v_mfma_f32_16x16x32_bf16 v[208:211], a[108:111], a[16:19], 0
  ds_read_b64_tr_b16 a[72:73], v19 offset:0
  buffer_load_dwordx4 v5, s[8:11], s32 offen offset:3072 lds
  v_mfma_f32_16x16x32_bf16 v[208:211], a[104:107], a[0:3], v[208:211]
  ds_read_b64_tr_b16 a[74:75], v19 offset:1024
  v_mfma_f32_16x16x32_bf16 v[224:227], a[112:115], a[0:3], 0
  ds_read_b64_tr_b16 a[76:77], v19 offset:8192
  v_mfma_f32_16x16x32_bf16 v[224:227], a[116:119], a[16:19], v[224:227]
  ds_read_b64_tr_b16 a[78:79], v19 offset:9216
  v_mfma_f32_16x16x32_bf16 v[228:231], a[116:119], a[20:23], 0
  s_add_u32 m0, s28, 69632
  v_mfma_f32_16x16x32_bf16 v[228:231], a[112:115], a[4:7], v[228:231]
  ds_read_b64_tr_b16 a[80:81], v20 offset:0
  v_mfma_f32_16x16x32_bf16 v[232:235], a[112:115], a[8:11], 0
  buffer_load_dwordx4 v6, s[8:11], s32 offen offset:0 lds
  v_mfma_f32_16x16x32_bf16 v[232:235], a[116:119], a[24:27], v[232:235]
  ds_read_b64_tr_b16 a[82:83], v20 offset:1024
  ds_read_b64_tr_b16 a[84:85], v20 offset:8192
  v_mfma_f32_16x16x32_bf16 v[236:239], a[116:119], a[28:31], 0
  ds_read_b64_tr_b16 a[86:87], v20 offset:9216
  v_mfma_f32_16x16x32_bf16 v[236:239], a[112:115], a[12:15], v[236:239]
  ds_read_b64_tr_b16 a[88:89], v21 offset:0
  v_mfma_f32_16x16x32_bf16 v[252:255], a[120:123], a[12:15], 0
  buffer_load_dwordx4 v7, s[8:11], s32 offen offset:1024 lds
  v_mfma_f32_16x16x32_bf16 v[252:255], a[124:127], a[28:31], v[252:255]
  ds_read_b64_tr_b16 a[90:91], v21 offset:1024
  v_mfma_f32_16x16x32_bf16 v[248:251], a[124:127], a[24:27], 0
  ds_read_b64_tr_b16 a[92:93], v21 offset:8192
  v_mfma_f32_16x16x32_bf16 v[248:251], a[120:123], a[8:11], v[248:251]
  ds_read_b64_tr_b16 a[94:95], v21 offset:9216
  v_mfma_f32_16x16x32_bf16 v[244:247], a[120:123], a[4:7], 0
  v_mfma_f32_16x16x32_bf16 v[244:247], a[124:127], a[20:23], v[244:247]
  v_mfma_f32_16x16x32_bf16 v[240:243], a[124:127], a[16:19], 0
  v_mfma_f32_16x16x32_bf16 v[240:243], a[120:123], a[0:3], v[240:243]
  s_waitcnt lgkmcnt(0)
  v_mfma_f32_16x16x32_bf16 v[128:131], a[64:67], a[32:35], v[128:131]
  s_add_u32 m0, s28, 69632
  v_mfma_f32_16x16x32_bf16 v[128:131], a[68:71], a[48:51], v[128:131]
  ds_read_b64_tr_b16 a[96:97], v22 offset:0
  v_mfma_f32_16x16x32_bf16 v[132:135], a[68:71], a[52:55], v[132:135]
  buffer_load_dwordx4 v8, s[8:11], s32 offen offset:2048 lds
  v_mfma_f32_16x16x32_bf16 v[132:135], a[64:67], a[36:39], v[132:135]
  ds_read_b64_tr_b16 a[98:99], v22 offset:1024
  v_mfma_f32_16x16x32_bf16 v[136:139], a[64:67], a[40:43], v[136:139]
  ds_read_b64_tr_b16 a[100:101], v22 offset:8192
  v_mfma_f32_16x16x32_bf16 v[136:139], a[68:71], a[56:59], v[136:139]
  buffer_load_dwordx4 v9, s[8:11], s32 offen offset:3072 lds
  v_mfma_f32_16x16x32_bf16 v[140:143], a[68:71], a[60:63], v[140:143]
  v_mfma_f32_16x16x32_bf16 v[140:143], a[64:67], a[44:47], v[140:143]
  ds_read_b64_tr_b16 a[102:103], v22 offset:9216
  v_mfma_f32_16x16x32_bf16 v[156:159], a[72:75], a[44:47], v[156:159]
  ds_read_b64_tr_b16 a[104:105], v23 offset:0
  v_mfma_f32_16x16x32_bf16 v[156:159], a[76:79], a[60:63], v[156:159]
  s_add_u32 m0, s29, 32768
  v_mfma_f32_16x16x32_bf16 v[152:155], a[76:79], a[56:59], v[152:155]
  ds_read_b64_tr_b16 a[106:107], v23 offset:1024
  v_mfma_f32_16x16x32_bf16 v[152:155], a[72:75], a[40:43], v[152:155]
  buffer_load_dwordx4 v32, s[36:39], s33 offen offset:0 lds
  v_mfma_f32_16x16x32_bf16 v[148:151], a[72:75], a[36:39], v[148:151]
  ds_read_b64_tr_b16 a[108:109], v23 offset:8192
  v_mfma_f32_16x16x32_bf16 v[148:151], a[76:79], a[52:55], v[148:151]
  v_mfma_f32_16x16x32_bf16 v[144:147], a[76:79], a[48:51], v[144:147]
  ds_read_b64_tr_b16 a[110:111], v23 offset:9216
  v_mfma_f32_16x16x32_bf16 v[144:147], a[72:75], a[32:35], v[144:147]
  ds_read_b64_tr_b16 a[112:113], v24 offset:0
  v_mfma_f32_16x16x32_bf16 v[160:163], a[80:83], a[32:35], v[160:163]
  buffer_load_dwordx4 v33, s[36:39], s33 offen offset:1024 lds
  v_mfma_f32_16x16x32_bf16 v[160:163], a[84:87], a[48:51], v[160:163]
  ds_read_b64_tr_b16 a[114:115], v24 offset:1024
  v_mfma_f32_16x16x32_bf16 v[164:167], a[84:87], a[52:55], v[164:167]
  ds_read_b64_tr_b16 a[116:117], v24 offset:8192
  v_mfma_f32_16x16x32_bf16 v[164:167], a[80:83], a[36:39], v[164:167]
  buffer_load_dwordx4 v34, s[36:39], s33 offen offset:2048 lds
  v_mfma_f32_16x16x32_bf16 v[168:171], a[80:83], a[40:43], v[168:171]
  v_mfma_f32_16x16x32_bf16 v[168:171], a[84:87], a[56:59], v[168:171]
  ds_read_b64_tr_b16 a[118:119], v24 offset:9216
  v_mfma_f32_16x16x32_bf16 v[172:175], a[84:87], a[60:63], v[172:175]
  ds_read_b64_tr_b16 a[120:121], v25 offset:0
  v_mfma_f32_16x16x32_bf16 v[172:175], a[80:83], a[44:47], v[172:175]
  ds_read_b64_tr_b16 a[122:123], v25 offset:1024
  v_mfma_f32_16x16x32_bf16 v[188:191], a[88:91], a[44:47], v[188:191]
  buffer_load_dwordx4 v35, s[36:39], s33 offen offset:3072 lds
  v_mfma_f32_16x16x32_bf16 v[188:191], a[92:95], a[60:63], v[188:191]
  ds_read_b64_tr_b16 a[124:125], v25 offset:8192
  v_mfma_f32_16x16x32_bf16 v[184:187], a[92:95], a[56:59], v[184:187]
  ds_read_b64_tr_b16 a[126:127], v25 offset:9216
  v_mfma_f32_16x16x32_bf16 v[184:187], a[88:91], a[40:43], v[184:187]
  v_mfma_f32_16x16x32_bf16 v[180:183], a[88:91], a[36:39], v[180:183]
  v_mfma_f32_16x16x32_bf16 v[180:183], a[92:95], a[52:55], v[180:183]
  v_mfma_f32_16x16x32_bf16 v[176:179], a[92:95], a[48:51], v[176:179]
  s_add_u32 s32, s32, 128
  v_mfma_f32_16x16x32_bf16 v[176:179], a[88:91], a[32:35], v[176:179]
  s_add_u32 s33, s33, 524288
  s_waitcnt lgkmcnt(0) vmcnt(12)
  s_barrier
  s_cmp_eq_u32 s63, 1
  s_cbranch_scc0 att_noflag
  s_mov_b64 exec, 1
  global_atomic_add v102, v103, s[70:71] sc1
  s_mov_b64 exec, -1
att_noflag:
  v_mfma_f32_16x16x32_bf16 v[192:195], a[96:99], a[32:35], v[192:195]
  s_add_u32 m0, s28, 0
  ds_read_b64_tr_b16 a[64:65], v18 offset:16384
  v_mfma_f32_16x16x32_bf16 v[192:195], a[100:103], a[48:51], v[192:195]
  buffer_load_dwordx4 v2, s[8:11], s32 offen offset:0 lds
  v_mfma_f32_16x16x32_bf16 v[196:199], a[100:103], a[52:55], v[196:199]
  ds_read_b64_tr_b16 a[66:67], v18 offset:17408
  v_mfma_f32_16x16x32_bf16 v[196:199], a[96:99], a[36:39], v[196:199]
  ds_read_b64_tr_b16 a[68:69], v18 offset:24576
  v_mfma_f32_16x16x32_bf16 v[200:203], a[96:99], a[40:43], v[200:203]
  ds_read_b64_tr_b16 a[70:71], v18 offset:25600
  v_mfma_f32_16x16x32_bf16 v[200:203], a[100:103], a[56:59], v[200:203]
  ds_read_b128 a[0:3], v14 offset:32768
  v_mfma_f32_16x16x32_bf16 v[204:207], a[100:103], a[60:63], v[204:207]
  buffer_load_dwordx4 v3, s[8:11], s32 offen offset:1024 lds
  v_mfma_f32_16x16x32_bf16 v[204:207], a[96:99], a[44:47], v[204:207]
  ds_read_b128 a[16:19], v15 offset:32768
  ds_read_b128 a[4:7], v14 offset:34816
  v_mfma_f32_16x16x32_bf16 v[220:223], a[104:107], a[44:47], v[220:223]
  ds_read_b128 a[20:23], v15 offset:34816
  v_mfma_f32_16x16x32_bf16 v[220:223], a[108:111], a[60:63], v[220:223]
  ds_read_b128 a[8:11], v14 offset:36864
  v_mfma_f32_16x16x32_bf16 v[216:219], a[108:111], a[56:59], v[216:219]
  buffer_load_dwordx4 v4, s[8:11], s32 offen offset:2048 lds
  v_mfma_f32_16x16x32_bf16 v[216:219], a[104:107], a[40:43], v[216:219]
  ds_read_b128 a[24:27], v15 offset:36864
  v_mfma_f32_16x16x32_bf16 v[212:215], a[104:107], a[36:39], v[212:215]
  ds_read_b128 a[12:15], v14 offset:38912
  v_mfma_f32_16x16x32_bf16 v[212:215], a[108:111], a[52:55], v[212:215]
  ds_read_b128 a[28:31], v15 offset:38912
  v_mfma_f32_16x16x32_bf16 v[208:211], a[108:111], a[48:51], v[208:211]
  ds_read_b64_tr_b16 a[72:73], v19 offset:16384
  buffer_load_dwordx4 v5, s[8:11], s32 offen offset:3072 lds
  v_mfma_f32_16x16x32_bf16 v[208:211], a[104:107], a[32:35], v[208:211]
  ds_read_b64_tr_b16 a[74:75], v19 offset:17408
  v_mfma_f32_16x16x32_bf16 v[224:227], a[112:115], a[32:35], v[224:227]
  ds_read_b64_tr_b16 a[76:77], v19 offset:24576
  v_mfma_f32_16x16x32_bf16 v[224:227], a[116:119], a[48:51], v[224:227]
  ds_read_b64_tr_b16 a[78:79], v19 offset:25600
  v_mfma_f32_16x16x32_bf16 v[228:231], a[116:119], a[52:55], v[228:231]
  s_add_u32 m0, s28, 4096
  v_mfma_f32_16x16x32_bf16 v[228:231], a[112:115], a[36:39], v[228:231]
  ds_read_b64_tr_b16 a[80:81], v20 offset:16384
  v_mfma_f32_16x16x32_bf16 v[232:235], a[112:115], a[40:43], v[232:235]
  buffer_load_dwordx4 v6, s[8:11], s32 offen offset:0 lds
  v_mfma_f32_16x16x32_bf16 v[232:235], a[116:119], a[56:59], v[232:235]
  ds_read_b64_tr_b16 a[82:83], v20 offset:17408
  ds_read_b64_tr_b16 a[84:85], v20 offset:24576
  v_mfma_f32_16x16x32_bf16 v[236:239], a[116:119], a[60:63], v[236:239]
  ds_read_b64_tr_b16 a[86:87], v20 offset:25600
  v_mfma_f32_16x16x32_bf16 v[236:239], a[112:115], a[44:47], v[236:239]
  ds_read_b64_tr_b16 a[88:89], v21 offset:16384
  v_mfma_f32_16x16x32_bf16 v[252:255], a[120:123], a[44:47], v[252:255]
  buffer_load_dwordx4 v7, s[8:11], s32 offen offset:1024 lds
  v_mfma_f32_16x16x32_bf16 v[252:255], a[124:127], a[60:63], v[252:255]
  ds_read_b64_tr_b16 a[90:91], v21 offset:17408
  v_mfma_f32_16x16x32_bf16 v[248:251], a[124:127], a[56:59], v[248:251]
  ds_read_b64_tr_b16 a[92:93], v21 offset:24576
  v_mfma_f32_16x16x32_bf16 v[248:251], a[120:123], a[40:43], v[248:251]
  ds_read_b64_tr_b16 a[94:95], v21 offset:25600
  v_mfma_f32_16x16x32_bf16 v[244:247], a[120:123], a[36:39], v[244:247]
  v_mfma_f32_16x16x32_bf16 v[244:247], a[124:127], a[52:55], v[244:247]
  v_mfma_f32_16x16x32_bf16 v[240:243], a[124:127], a[48:51], v[240:243]
  v_mfma_f32_16x16x32_bf16 v[240:243], a[120:123], a[32:35], v[240:243]
  s_waitcnt lgkmcnt(0)
  v_mfma_f32_16x16x32_bf16 v[128:131], a[64:67], a[0:3], v[128:131]
  s_add_u32 m0, s28, 4096
  v_mfma_f32_16x16x32_bf16 v[128:131], a[68:71], a[16:19], v[128:131]
  ds_read_b64_tr_b16 a[96:97], v22 offset:16384
  v_mfma_f32_16x16x32_bf16 v[132:135], a[68:71], a[20:23], v[132:135]
  buffer_load_dwordx4 v8, s[8:11], s32 offen offset:2048 lds
  v_mfma_f32_16x16x32_bf16 v[132:135], a[64:67], a[4:7], v[132:135]
  ds_read_b64_tr_b16 a[98:99], v22 offset:17408
  v_mfma_f32_16x16x32_bf16 v[136:139], a[64:67], a[8:11], v[136:139]
  ds_read_b64_tr_b16 a[100:101], v22 offset:24576
  v_mfma_f32_16x16x32_bf16 v[136:139], a[68:71], a[24:27], v[136:139]
  buffer_load_dwordx4 v9, s[8:11], s32 offen offset:3072 lds
  v_mfma_f32_16x16x32_bf16 v[140:143], a[68:71], a[28:31], v[140:143]
  v_mfma_f32_16x16x32_bf16 v[140:143], a[64:67], a[12:15], v[140:143]
  ds_read_b64_tr_b16 a[102:103], v22 offset:25600
  v_mfma_f32_16x16x32_bf16 v[156:159], a[72:75], a[12:15], v[156:159]
  ds_read_b64_tr_b16 a[104:105], v23 offset:16384
  v_mfma_f32_16x16x32_bf16 v[156:159], a[76:79], a[28:31], v[156:159]
  s_add_u32 m0, s29, 0
  v_mfma_f32_16x16x32_bf16 v[152:155], a[76:79], a[24:27], v[152:155]
  ds_read_b64_tr_b16 a[106:107], v23 offset:17408
  v_mfma_f32_16x16x32_bf16 v[152:155], a[72:75], a[8:11], v[152:155]
  buffer_load_dwordx4 v32, s[36:39], s33 offen offset:0 lds
  v_mfma_f32_16x16x32_bf16 v[148:151], a[72:75], a[4:7], v[148:151]
  ds_read_b64_tr_b16 a[108:109], v23 offset:24576
  v_mfma_f32_16x16x32_bf16 v[148:151], a[76:79], a[20:23], v[148:151]
  v_mfma_f32_16x16x32_bf16 v[144:147], a[76:79], a[16:19], v[144:147]
  ds_read_b64_tr_b16 a[110:111], v23 offset:25600
  v_mfma_f32_16x16x32_bf16 v[144:147], a[72:75], a[0:3], v[144:147]
  ds_read_b64_tr_b16 a[112:113], v24 offset:16384
  v_mfma_f32_16x16x32_bf16 v[160:163], a[80:83], a[0:3], v[160:163]
  buffer_load_dwordx4 v33, s[36:39], s33 offen offset:1024 lds
  v_mfma_f32_16x16x32_bf16 v[160:163], a[84:87], a[16:19], v[160:163]
  ds_read_b64_tr_b16 a[114:115], v24 offset:17408
  v_mfma_f32_16x16x32_bf16 v[164:167], a[84:87], a[20:23], v[164:167]
  ds_read_b64_tr_b16 a[116:117], v24 offset:24576
  v_mfma_f32_16x16x32_bf16 v[164:167], a[80:83], a[4:7], v[164:167]
  buffer_load_dwordx4 v34, s[36:39], s33 offen offset:2048 lds
  v_mfma_f32_16x16x32_bf16 v[168:171], a[80:83], a[8:11], v[168:171]
  v_mfma_f32_16x16x32_bf16 v[168:171], a[84:87], a[24:27], v[168:171]
  ds_read_b64_tr_b16 a[118:119], v24 offset:25600
  v_mfma_f32_16x16x32_bf16 v[172:175], a[84:87], a[28:31], v[172:175]
  ds_read_b64_tr_b16 a[120:121], v25 offset:16384
  v_mfma_f32_16x16x32_bf16 v[172:175], a[80:83], a[12:15], v[172:175]
  ds_read_b64_tr_b16 a[122:123], v25 offset:17408
  v_mfma_f32_16x16x32_bf16 v[188:191], a[88:91], a[12:15], v[188:191]
  buffer_load_dwordx4 v35, s[36:39], s33 offen offset:3072 lds
  v_mfma_f32_16x16x32_bf16 v[188:191], a[92:95], a[28:31], v[188:191]
  ds_read_b64_tr_b16 a[124:125], v25 offset:24576
  v_mfma_f32_16x16x32_bf16 v[184:187], a[92:95], a[24:27], v[184:187]
  ds_read_b64_tr_b16 a[126:127], v25 offset:25600
  v_mfma_f32_16x16x32_bf16 v[184:187], a[88:91], a[8:11], v[184:187]
  v_mfma_f32_16x16x32_bf16 v[180:183], a[88:91], a[4:7], v[180:183]
  v_mfma_f32_16x16x32_bf16 v[180:183], a[92:95], a[20:23], v[180:183]
  v_mfma_f32_16x16x32_bf16 v[176:179], a[92:95], a[16:19], v[176:179]
  s_add_u32 s32, s32, 128
  v_mfma_f32_16x16x32_bf16 v[176:179], a[88:91], a[0:3], v[176:179]
  s_add_u32 s33, s33, 524288
  s_waitcnt lgkmcnt(0) vmcnt(12)
  s_barrier
  v_mfma_f32_16x16x32_bf16 v[192:195], a[96:99], a[0:3], v[192:195]
  s_add_u32 m0, s28, 32768
  ds_read_b64_tr_b16 a[64:65], v18 offset:32768
  v_mfma_f32_16x16x32_bf16 v[192:195], a[100:103], a[16:19], v[192:195]
  buffer_load_dwordx4 v2, s[8:11], s32 offen offset:0 lds
  v_mfma_f32_16x16x32_bf16 v[196:199], a[100:103], a[20:23], v[196:199]
  ds_read_b64_tr_b16 a[66:67], v18 offset:33792
  v_mfma_f32_16x16x32_bf16 v[196:199], a[96:99], a[4:7], v[196:199]
  ds_read_b64_tr_b16 a[68:69], v18 offset:40960
  v_mfma_f32_16x16x32_bf16 v[200:203], a[96:99], a[8:11], v[200:203]
  ds_read_b64_tr_b16 a[70:71], v18 offset:41984
  v_mfma_f32_16x16x32_bf16 v[200:203], a[100:103], a[24:27], v[200:203]
  ds_read_b128 a[32:35], v16 offset:0
  v_mfma_f32_16x16x32_bf16 v[204:207], a[100:103], a[28:31], v[204:207]
  buffer_load_dwordx4 v3, s[8:11], s32 offen offset:1024 lds
  v_mfma_f32_16x16x32_bf16 v[204:207], a[96:99], a[12:15], v[204:207]
  ds_read_b128 a[48:51], v17 offset:0
  ds_read_b128 a[36:39], v16 offset:2048
  v_mfma_f32_16x16x32_bf16 v[220:223], a[104:107], a[12:15], v[220:223]
  ds_read_b128 a[52:55], v17 offset:2048
  v_mfma_f32_16x16x32_bf16 v[220:223], a[108:111], a[28:31], v[220:223]
  ds_read_b128 a[40:43], v16 offset:4096
  v_mfma_f32_16x16x32_bf16 v[216:219], a[108:111], a[24:27], v[216:219]
  buffer_load_dwordx4 v4, s[8:11], s32 offen offset:2048 lds
  v_mfma_f32_16x16x32_bf16 v[216:219], a[104:107], a[8:11], v[216:219]
  ds_read_b128 a[56:59], v17 offset:4096
  v_mfma_f32_16x16x32_bf16 v[212:215], a[104:107], a[4:7], v[212:215]
  ds_read_b128 a[44:47], v16 offset:6144
  v_mfma_f32_16x16x32_bf16 v[212:215], a[108:111], a[20:23], v[212:215]
  ds_read_b128 a[60:63], v17 offset:6144
  v_mfma_f32_16x16x32_bf16 v[208:211], a[108:111], a[16:19], v[208:211]
  ds_read_b64_tr_b16 a[72:73], v19 offset:32768
  buffer_load_dwordx4 v5, s[8:11], s32 offen offset:3072 lds
  v_mfma_f32_16x16x32_bf16 v[208:211], a[104:107], a[0:3], v[208:211]
  ds_read_b64_tr_b16 a[74:75], v19 offset:33792
  v_mfma_f32_16x16x32_bf16 v[224:227], a[112:115], a[0:3], v[224:227]
  ds_read_b64_tr_b16 a[76:77], v19 offset:40960
  v_mfma_f32_16x16x32_bf16 v[224:227], a[116:119], a[16:19], v[224:227]
  ds_read_b64_tr_b16 a[78:79], v19 offset:41984
  v_mfma_f32_16x16x32_bf16 v[228:231], a[116:119], a[20:23], v[228:231]
  s_add_u32 m0, s28, 36864
  v_mfma_f32_16x16x32_bf16 v[228:231], a[112:115], a[4:7], v[228:231]
  ds_read_b64_tr_b16 a[80:81], v20 offset:32768
  v_mfma_f32_16x16x32_bf16 v[232:235], a[112:115], a[8:11], v[232:235]
  buffer_load_dwordx4 v6, s[8:11], s32 offen offset:0 lds
  v_mfma_f32_16x16x32_bf16 v[232:235], a[116:119], a[24:27], v[232:235]
  ds_read_b64_tr_b16 a[82:83], v20 offset:33792
  ds_read_b64_tr_b16 a[84:85], v20 offset:40960
  v_mfma_f32_16x16x32_bf16 v[236:239], a[116:119], a[28:31], v[236:239]
  ds_read_b64_tr_b16 a[86:87], v20 offset:41984
  v_mfma_f32_16x16x32_bf16 v[236:239], a[112:115], a[12:15], v[236:239]
  ds_read_b64_tr_b16 a[88:89], v21 offset:32768
  v_mfma_f32_16x16x32_bf16 v[252:255], a[120:123], a[12:15], v[252:255]
  buffer_load_dwordx4 v7, s[8:11], s32 offen offset:1024 lds
  v_mfma_f32_16x16x32_bf16 v[252:255], a[124:127], a[28:31], v[252:255]
  ds_read_b64_tr_b16 a[90:91], v21 offset:33792
  v_mfma_f32_16x16x32_bf16 v[248:251], a[124:127], a[24:27], v[248:251]
  ds_read_b64_tr_b16 a[92:93], v21 offset:40960
  v_mfma_f32_16x16x32_bf16 v[248:251], a[120:123], a[8:11], v[248:251]
  ds_read_b64_tr_b16 a[94:95], v21 offset:41984
  v_mfma_f32_16x16x32_bf16 v[244:247], a[120:123], a[4:7], v[244:247]
  v_mfma_f32_16x16x32_bf16 v[244:247], a[124:127], a[20:23], v[244:247]
  v_mfma_f32_16x16x32_bf16 v[240:243], a[124:127], a[16:19], v[240:243]
  v_mfma_f32_16x16x32_bf16 v[240:243], a[120:123], a[0:3], v[240:243]
  s_waitcnt lgkmcnt(0)
  v_mfma_f32_16x16x32_bf16 v[128:131], a[64:67], a[32:35], v[128:131]
  s_add_u32 m0, s28, 36864
  v_mfma_f32_16x16x32_bf16 v[128:131], a[68:71], a[48:51], v[128:131]
  ds_read_b64_tr_b16 a[96:97], v22 offset:32768
  v_mfma_f32_16x16x32_bf16 v[132:135], a[68:71], a[52:55], v[132:135]
  buffer_load_dwordx4 v8, s[8:11], s32 offen offset:2048 lds
  v_mfma_f32_16x16x32_bf16 v[132:135], a[64:67], a[36:39], v[132:135]
  ds_read_b64_tr_b16 a[98:99], v22 offset:33792
  v_mfma_f32_16x16x32_bf16 v[136:139], a[64:67], a[40:43], v[136:139]
  ds_read_b64_tr_b16 a[100:101], v22 offset:40960
  v_mfma_f32_16x16x32_bf16 v[136:139], a[68:71], a[56:59], v[136:139]
  buffer_load_dwordx4 v9, s[8:11], s32 offen offset:3072 lds
  v_mfma_f32_16x16x32_bf16 v[140:143], a[68:71], a[60:63], v[140:143]
  v_mfma_f32_16x16x32_bf16 v[140:143], a[64:67], a[44:47], v[140:143]
  ds_read_b64_tr_b16 a[102:103], v22 offset:41984
  v_mfma_f32_16x16x32_bf16 v[156:159], a[72:75], a[44:47], v[156:159]
  ds_read_b64_tr_b16 a[104:105], v23 offset:32768
  v_mfma_f32_16x16x32_bf16 v[156:159], a[76:79], a[60:63], v[156:159]
  s_add_u32 m0, s29, 16384
  v_mfma_f32_16x16x32_bf16 v[152:155], a[76:79], a[56:59], v[152:155]
  ds_read_b64_tr_b16 a[106:107], v23 offset:33792
  v_mfma_f32_16x16x32_bf16 v[152:155], a[72:75], a[40:43], v[152:155]
  buffer_load_dwordx4 v32, s[36:39], s33 offen offset:0 lds
  v_mfma_f32_16x16x32_bf16 v[148:151], a[72:75], a[36:39], v[148:151]
  ds_read_b64_tr_b16 a[108:109], v23 offset:40960
  v_mfma_f32_16x16x32_bf16 v[148:151], a[76:79], a[52:55], v[148:151]
  v_mfma_f32_16x16x32_bf16 v[144:147], a[76:79], a[48:51], v[144:147]
  ds_read_b64_tr_b16 a[110:111], v23 offset:41984
  v_mfma_f32_16x16x32_bf16 v[144:147], a[72:75], a[32:35], v[144:147]
  ds_read_b64_tr_b16 a[112:113], v24 offset:32768
  v_mfma_f32_16x16x32_bf16 v[160:163], a[80:83], a[32:35], v[160:163]
  buffer_load_dwordx4 v33, s[36:39], s33 offen offset:1024 lds
  v_mfma_f32_16x16x32_bf16 v[160:163], a[84:87], a[48:51], v[160:163]
  ds_read_b64_tr_b16 a[114:115], v24 offset:33792
  v_mfma_f32_16x16x32_bf16 v[164:167], a[84:87], a[52:55], v[164:167]
  ds_read_b64_tr_b16 a[116:117], v24 offset:40960
  v_mfma_f32_16x16x32_bf16 v[164:167], a[80:83], a[36:39], v[164:167]
  buffer_load_dwordx4 v34, s[36:39], s33 offen offset:2048 lds
  v_mfma_f32_16x16x32_bf16 v[168:171], a[80:83], a[40:43], v[168:171]
  v_mfma_f32_16x16x32_bf16 v[168:171], a[84:87], a[56:59], v[168:171]
  ds_read_b64_tr_b16 a[118:119], v24 offset:41984
  v_mfma_f32_16x16x32_bf16 v[172:175], a[84:87], a[60:63], v[172:175]
  ds_read_b64_tr_b16 a[120:121], v25 offset:32768
  v_mfma_f32_16x16x32_bf16 v[172:175], a[80:83], a[44:47], v[172:175]
  ds_read_b64_tr_b16 a[122:123], v25 offset:33792
  v_mfma_f32_16x16x32_bf16 v[188:191], a[88:91], a[44:47], v[188:191]
  buffer_load_dwordx4 v35, s[36:39], s33 offen offset:3072 lds
  v_mfma_f32_16x16x32_bf16 v[188:191], a[92:95], a[60:63], v[188:191]
  ds_read_b64_tr_b16 a[124:125], v25 offset:40960
  v_mfma_f32_16x16x32_bf16 v[184:187], a[92:95], a[56:59], v[184:187]
  ds_read_b64_tr_b16 a[126:127], v25 offset:41984
  v_mfma_f32_16x16x32_bf16 v[184:187], a[88:91], a[40:43], v[184:187]
  v_mfma_f32_16x16x32_bf16 v[180:183], a[88:91], a[36:39], v[180:183]
  v_mfma_f32_16x16x32_bf16 v[180:183], a[92:95], a[52:55], v[180:183]
  v_mfma_f32_16x16x32_bf16 v[176:179], a[92:95], a[48:51], v[176:179]
  s_add_u32 s32, s32, 128
  v_mfma_f32_16x16x32_bf16 v[176:179], a[88:91], a[32:35], v[176:179]
  s_add_u32 s33, s33, 524288
  s_waitcnt lgkmcnt(0) vmcnt(12)
  s_barrier
  v_mfma_f32_16x16x32_bf16 v[192:195], a[96:99], a[32:35], v[192:195]
  s_add_u32 m0, s28, 65536
  ds_read_b64_tr_b16 a[64:65], v18 offset:0
  v_mfma_f32_16x16x32_bf16 v[192:195], a[100:103], a[48:51], v[192:195]
  buffer_load_dwordx4 v2, s[8:11], s32 offen offset:0 lds
  v_mfma_f32_16x16x32_bf16 v[196:199], a[100:103], a[52:55], v[196:199]
  ds_read_b64_tr_b16 a[66:67], v18 offset:1024
  v_mfma_f32_16x16x32_bf16 v[196:199], a[96:99], a[36:39], v[196:199]
  ds_read_b64_tr_b16 a[68:69], v18 offset:8192
  v_mfma_f32_16x16x32_bf16 v[200:203], a[96:99], a[40:43], v[200:203]
  ds_read_b64_tr_b16 a[70:71], v18 offset:9216
  v_mfma_f32_16x16x32_bf16 v[200:203], a[100:103], a[56:59], v[200:203]
  ds_read_b128 a[0:3], v14 offset:0
  v_mfma_f32_16x16x32_bf16 v[204:207], a[100:103], a[60:63], v[204:207]
  buffer_load_dwordx4 v3, s[8:11], s32 offen offset:1024 lds
  v_mfma_f32_16x16x32_bf16 v[204:207], a[96:99], a[44:47], v[204:207]
  ds_read_b128 a[16:19], v15 offset:0
  ds_read_b128 a[4:7], v14 offset:2048
  v_mfma_f32_16x16x32_bf16 v[220:223], a[104:107], a[44:47], v[220:223]
  ds_read_b128 a[20:23], v15 offset:2048
  v_mfma_f32_16x16x32_bf16 v[220:223], a[108:111], a[60:63], v[220:223]
  ds_read_b128 a[8:11], v14 offset:4096
  v_mfma_f32_16x16x32_bf16 v[216:219], a[108:111], a[56:59], v[216:219]
  buffer_load_dwordx4 v4, s[8:11], s32 offen offset:2048 lds
  v_mfma_f32_16x16x32_bf16 v[216:219], a[104:107], a[40:43], v[216:219]
  ds_read_b128 a[24:27], v15 offset:4096
  v_mfma_f32_16x16x32_bf16 v[212:215], a[104:107], a[36:39], v[212:215]
  ds_read_b128 a[12:15], v14 offset:6144
  v_mfma_f32_16x16x32_bf16 v[212:215], a[108:111], a[52:55], v[212:215]
  ds_read_b128 a[28:31], v15 offset:6144
  v_mfma_f32_16x16x32_bf16 v[208:211], a[108:111], a[48:51], v[208:211]
  ds_read_b64_tr_b16 a[72:73], v19 offset:0
  buffer_load_dwordx4 v5, s[8:11], s32 offen offset:3072 lds
  v_mfma_f32_16x16x32_bf16 v[208:211], a[104:107], a[32:35], v[208:211]
  ds_read_b64_tr_b16 a[74:75], v19 offset:1024
  v_mfma_f32_16x16x32_bf16 v[224:227], a[112:115], a[32:35], v[224:227]
  ds_read_b64_tr_b16 a[76:77], v19 offset:8192
  v_mfma_f32_16x16x32_bf16 v[224:227], a[116:119], a[48:51], v[224:227]
  ds_read_b64_tr_b16 a[78:79], v19 offset:9216
  v_mfma_f32_16x16x32_bf16 v[228:231], a[116:119], a[52:55], v[228:231]
  s_add_u32 m0, s28, 69632
  v_mfma_f32_16x16x32_bf16 v[228:231], a[112:115], a[36:39], v[228:231]
  ds_read_b64_tr_b16 a[80:81], v20 offset:0
  v_mfma_f32_16x16x32_bf16 v[232:235], a[112:115], a[40:43], v[232:235]
  buffer_load_dwordx4 v6, s[8:11], s32 offen offset:0 lds
  v_mfma_f32_16x16x32_bf16 v[232:235], a[116:119], a[56:59], v[232:235]
  ds_read_b64_tr_b16 a[82:83], v20 offset:1024
  ds_read_b64_tr_b16 a[84:85], v20 offset:8192
  v_mfma_f32_16x16x32_bf16 v[236:239], a[116:119], a[60:63], v[236:239]
  ds_read_b64_tr_b16 a[86:87], v20 offset:9216
  v_mfma_f32_16x16x32_bf16 v[236:239], a[112:115], a[44:47], v[236:239]
  ds_read_b64_tr_b16 a[88:89], v21 offset:0
  v_mfma_f32_16x16x32_bf16 v[252:255], a[120:123], a[44:47], v[252:255]
  buffer_load_dwordx4 v7, s[8:11], s32 offen offset:1024 lds
  v_mfma_f32_16x16x32_bf16 v[252:255], a[124:127], a[60:63], v[252:255]
  ds_read_b64_tr_b16 a[90:91], v21 offset:1024
  v_mfma_f32_16x16x32_bf16 v[248:251], a[124:127], a[56:59], v[248:251]
  ds_read_b64_tr_b16 a[92:93], v21 offset:8192
  v_mfma_f32_16x16x32_bf16 v[248:251], a[120:123], a[40:43], v[248:251]
  ds_read_b64_tr_b16 a[94:95], v21 offset:9216
  v_mfma_f32_16x16x32_bf16 v[244:247], a[120:123], a[36:39], v[244:247]
  v_mfma_f32_16x16x32_bf16 v[244:247], a[124:127], a[52:55], v[244:247]
  v_mfma_f32_16x16x32_bf16 v[240:243], a[124:127], a[48:51], v[240:243]
  v_mfma_f32_16x16x32_bf16 v[240:243], a[120:123], a[32:35], v[240:243]
  s_waitcnt lgkmcnt(0)
  v_mfma_f32_16x16x32_bf16 v[128:131], a[64:67], a[0:3], v[128:131]
  s_add_u32 m0, s28, 69632
  v_mfma_f32_16x16x32_bf16 v[128:131], a[68:71], a[16:19], v[128:131]
  ds_read_b64_tr_b16 a[96:97], v22 offset:0
  v_mfma_f32_16x16x32_bf16 v[132:135], a[68:71], a[20:23], v[132:135]
  buffer_load_dwordx4 v8, s[8:11], s32 offen offset:2048 lds
  v_mfma_f32_16x16x32_bf16 v[132:135], a[64:67], a[4:7], v[132:135]
  ds_read_b64_tr_b16 a[98:99], v22 offset:1024
  v_mfma_f32_16x16x32_bf16 v[136:139], a[64:67], a[8:11], v[136:139]
  ds_read_b64_tr_b16 a[100:101], v22 offset:8192
  v_mfma_f32_16x16x32_bf16 v[136:139], a[68:71], a[24:27], v[136:139]
  buffer_load_dwordx4 v9, s[8:11], s32 offen offset:3072 lds
  v_mfma_f32_16x16x32_bf16 v[140:143], a[68:71], a[28:31], v[140:143]
  v_mfma_f32_16x16x32_bf16 v[140:143], a[64:67], a[12:15], v[140:143]
  ds_read_b64_tr_b16 a[102:103], v22 offset:9216
  v_mfma_f32_16x16x32_bf16 v[156:159], a[72:75], a[12:15], v[156:159]
  ds_read_b64_tr_b16 a[104:105], v23 offset:0
  v_mfma_f32_16x16x32_bf16 v[156:159], a[76:79], a[28:31], v[156:159]
  s_add_u32 m0, s29, 32768
  v_mfma_f32_16x16x32_bf16 v[152:155], a[76:79], a[24:27], v[152:155]
  ds_read_b64_tr_b16 a[106:107], v23 offset:1024
  v_mfma_f32_16x16x32_bf16 v[152:155], a[72:75], a[8:11], v[152:155]
  buffer_load_dwordx4 v32, s[36:39], s33 offen offset:0 lds
  v_mfma_f32_16x16x32_bf16 v[148:151], a[72:75], a[4:7], v[148:151]
  ds_read_b64_tr_b16 a[108:109], v23 offset:8192
  v_mfma_f32_16x16x32_bf16 v[148:151], a[76:79], a[20:23], v[148:151]
  v_mfma_f32_16x16x32_bf16 v[144:147], a[76:79], a[16:19], v[144:147]
  ds_read_b64_tr_b16 a[110:111], v23 offset:9216
  v_mfma_f32_16x16x32_bf16 v[144:147], a[72:75], a[0:3], v[144:147]
  ds_read_b64_tr_b16 a[112:113], v24 offset:0
  v_mfma_f32_16x16x32_bf16 v[160:163], a[80:83], a[0:3], v[160:163]
  buffer_load_dwordx4 v33, s[36:39], s33 offen offset:1024 lds
  v_mfma_f32_16x16x32_bf16 v[160:163], a[84:87], a[16:19], v[160:163]
  ds_read_b64_tr_b16 a[114:115], v24 offset:1024
  v_mfma_f32_16x16x32_bf16 v[164:167], a[84:87], a[20:23], v[164:167]
  ds_read_b64_tr_b16 a[116:117], v24 offset:8192
  v_mfma_f32_16x16x32_bf16 v[164:167], a[80:83], a[4:7], v[164:167]
  buffer_load_dwordx4 v34, s[36:39], s33 offen offset:2048 lds
  v_mfma_f32_16x16x32_bf16 v[168:171], a[80:83], a[8:11], v[168:171]
  v_mfma_f32_16x16x32_bf16 v[168:171], a[84:87], a[24:27], v[168:171]
  ds_read_b64_tr_b16 a[118:119], v24 offset:9216
  v_mfma_f32_16x16x32_bf16 v[172:175], a[84:87], a[28:31], v[172:175]
  ds_read_b64_tr_b16 a[120:121], v25 offset:0
  v_mfma_f32_16x16x32_bf16 v[172:175], a[80:83], a[12:15], v[172:175]
  ds_read_b64_tr_b16 a[122:123], v25 offset:1024
  v_mfma_f32_16x16x32_bf16 v[188:191], a[88:91], a[12:15], v[188:191]
  buffer_load_dwordx4 v35, s[36:39], s33 offen offset:3072 lds
  v_mfma_f32_16x16x32_bf16 v[188:191], a[92:95], a[28:31], v[188:191]
  ds_read_b64_tr_b16 a[124:125], v25 offset:8192
  v_mfma_f32_16x16x32_bf16 v[184:187], a[92:95], a[24:27], v[184:187]
  ds_read_b64_tr_b16 a[126:127], v25 offset:9216
  v_mfma_f32_16x16x32_bf16 v[184:187], a[88:91], a[8:11], v[184:187]
  v_mfma_f32_16x16x32_bf16 v[180:183], a[88:91], a[4:7], v[180:183]
  v_mfma_f32_16x16x32_bf16 v[180:183], a[92:95], a[20:23], v[180:183]
  v_mfma_f32_16x16x32_bf16 v[176:179], a[92:95], a[16:19], v[176:179]
  s_add_u32 s32, s32, 128
  v_mfma_f32_16x16x32_bf16 v[176:179], a[88:91], a[0:3], v[176:179]
  s_add_u32 s33, s33, 524288
  s_waitcnt lgkmcnt(0) vmcnt(12)
  s_barrier
  v_mfma_f32_16x16x32_bf16 v[192:195], a[96:99], a[0:3], v[192:195]
  s_add_u32 m0, s28, 0
  ds_read_b64_tr_b16 a[64:65], v18 offset:16384
  v_mfma_f32_16x16x32_bf16 v[192:195], a[100:103], a[16:19], v[192:195]
  buffer_load_dwordx4 v2, s[8:11], s32 offen offset:0 lds
  v_mfma_f32_16x16x32_bf16 v[196:199], a[100:103], a[20:23], v[196:199]
  ds_read_b64_tr_b16 a[66:67], v18 offset:17408
  v_mfma_f32_16x16x32_bf16 v[196:199], a[96:99], a[4:7], v[196:199]
  ds_read_b64_tr_b16 a[68:69], v18 offset:24576
  v_mfma_f32_16x16x32_bf16 v[200:203], a[96:99], a[8:11], v[200:203]
  ds_read_b64_tr_b16 a[70:71], v18 offset:25600
  v_mfma_f32_16x16x32_bf16 v[200:203], a[100:103], a[24:27], v[200:203]
  ds_read_b128 a[32:35], v14 offset:32768
  v_mfma_f32_16x16x32_bf16 v[204:207], a[100:103], a[28:31], v[204:207]
  buffer_load_dwordx4 v3, s[8:11], s32 offen offset:1024 lds
  v_mfma_f32_16x16x32_bf16 v[204:207], a[96:99], a[12:15], v[204:207]
  ds_read_b128 a[48:51], v15 offset:32768
  ds_read_b128 a[36:39], v14 offset:34816
  v_mfma_f32_16x16x32_bf16 v[220:223], a[104:107], a[12:15], v[220:223]
  ds_read_b128 a[52:55], v15 offset:34816
  v_mfma_f32_16x16x32_bf16 v[220:223], a[108:111], a[28:31], v[220:223]
  ds_read_b128 a[40:43], v14 offset:36864
  v_mfma_f32_16x16x32_bf16 v[216:219], a[108:111], a[24:27], v[216:219]
  buffer_load_dwordx4 v4, s[8:11], s32 offen offset:2048 lds
  v_mfma_f32_16x16x32_bf16 v[216:219], a[104:107], a[8:11], v[216:219]
  ds_read_b128 a[56:59], v15 offset:36864
  v_mfma_f32_16x16x32_bf16 v[212:215], a[104:107], a[4:7], v[212:215]
  ds_read_b128 a[44:47], v14 offset:38912
  v_mfma_f32_16x16x32_bf16 v[212:215], a[108:111], a[20:23], v[212:215]
  ds_read_b128 a[60:63], v15 offset:38912
  v_mfma_f32_16x16x32_bf16 v[208:211], a[108:111], a[16:19], v[208:211]
  ds_read_b64_tr_b16 a[72:73], v19 offset:16384
  buffer_load_dwordx4 v5, s[8:11], s32 offen offset:3072 lds
  v_mfma_f32_16x16x32_bf16 v[208:211], a[104:107], a[0:3], v[208:211]
  ds_read_b64_tr_b16 a[74:75], v19 offset:17408
  v_mfma_f32_16x16x32_bf16 v[224:227], a[112:115], a[0:3], v[224:227]
  ds_read_b64_tr_b16 a[76:77], v19 offset:24576
  v_mfma_f32_16x16x32_bf16 v[224:227], a[116:119], a[16:19], v[224:227]
  ds_read_b64_tr_b16 a[78:79], v19 offset:25600
  v_mfma_f32_16x16x32_bf16 v[228:231], a[116:119], a[20:23], v[228:231]
  s_add_u32 m0, s28, 4096
  v_mfma_f32_16x16x32_bf16 v[228:231], a[112:115], a[4:7], v[228:231]
  ds_read_b64_tr_b16 a[80:81], v20 offset:16384
  v_mfma_f32_16x16x32_bf16 v[232:235], a[112:115], a[8:11], v[232:235]
  buffer_load_dwordx4 v6, s[8:11], s32 offen offset:0 lds
  v_mfma_f32_16x16x32_bf16 v[232:235], a[116:119], a[24:27], v[232:235]
  ds_read_b64_tr_b16 a[82:83], v20 offset:17408
  ds_read_b64_tr_b16 a[84:85], v20 offset:24576
  v_mfma_f32_16x16x32_bf16 v[236:239], a[116:119], a[28:31], v[236:239]
  ds_read_b64_tr_b16 a[86:87], v20 offset:25600
  v_mfma_f32_16x16x32_bf16 v[236:239], a[112:115], a[12:15], v[236:239]
  ds_read_b64_tr_b16 a[88:89], v21 offset:16384
  v_mfma_f32_16x16x32_bf16 v[252:255], a[120:123], a[12:15], v[252:255]
  buffer_load_dwordx4 v7, s[8:11], s32 offen offset:1024 lds
  v_mfma_f32_16x16x32_bf16 v[252:255], a[124:127], a[28:31], v[252:255]
  ds_read_b64_tr_b16 a[90:91], v21 offset:17408
  v_mfma_f32_16x16x32_bf16 v[248:251], a[124:127], a[24:27], v[248:251]
  ds_read_b64_tr_b16 a[92:93], v21 offset:24576
  v_mfma_f32_16x16x32_bf16 v[248:251], a[120:123], a[8:11], v[248:251]
  ds_read_b64_tr_b16 a[94:95], v21 offset:25600
  v_mfma_f32_16x16x32_bf16 v[244:247], a[120:123], a[4:7], v[244:247]
  v_mfma_f32_16x16x32_bf16 v[244:247], a[124:127], a[20:23], v[244:247]
  v_mfma_f32_16x16x32_bf16 v[240:243], a[124:127], a[16:19], v[240:243]
  v_mfma_f32_16x16x32_bf16 v[240:243], a[120:123], a[0:3], v[240:243]
  s_waitcnt lgkmcnt(0)
  v_mfma_f32_16x16x32_bf16 v[128:131], a[64:67], a[32:35], v[128:131]
  s_add_u32 m0, s28, 4096
  v_mfma_f32_16x16x32_bf16 v[128:131], a[68:71], a[48:51], v[128:131]
  ds_read_b64_tr_b16 a[96:97], v22 offset:16384
  v_mfma_f32_16x16x32_bf16 v[132:135], a[68:71], a[52:55], v[132:135]
  buffer_load_dwordx4 v8, s[8:11], s32 offen offset:2048 lds
  v_mfma_f32_16x16x32_bf16 v[132:135], a[64:67], a[36:39], v[132:135]
  ds_read_b64_tr_b16 a[98:99], v22 offset:17408
  v_mfma_f32_16x16x32_bf16 v[136:139], a[64:67], a[40:43], v[136:139]
  ds_read_b64_tr_b16 a[100:101], v22 offset:24576
  v_mfma_f32_16x16x32_bf16 v[136:139], a[68:71], a[56:59], v[136:139]
  buffer_load_dwordx4 v9, s[8:11], s32 offen offset:3072 lds
  v_mfma_f32_16x16x32_bf16 v[140:143], a[68:71], a[60:63], v[140:143]
  v_mfma_f32_16x16x32_bf16 v[140:143], a[64:67], a[44:47], v[140:143]
  ds_read_b64_tr_b16 a[102:103], v22 offset:25600
  v_mfma_f32_16x16x32_bf16 v[156:159], a[72:75], a[44:47], v[156:159]
  ds_read_b64_tr_b16 a[104:105], v23 offset:16384
  v_mfma_f32_16x16x32_bf16 v[156:159], a[76:79], a[60:63], v[156:159]
  s_add_u32 m0, s29, 0
  v_mfma_f32_16x16x32_bf16 v[152:155], a[76:79], a[56:59], v[152:155]
  ds_read_b64_tr_b16 a[106:107], v23 offset:17408
  v_mfma_f32_16x16x32_bf16 v[152:155], a[72:75], a[40:43], v[152:155]
  buffer_load_dwordx4 v32, s[36:39], s33 offen offset:0 lds
  v_mfma_f32_16x16x32_bf16 v[148:151], a[72:75], a[36:39], v[148:151]
  ds_read_b64_tr_b16 a[108:109], v23 offset:24576
  v_mfma_f32_16x16x32_bf16 v[148:151], a[76:79], a[52:55], v[148:151]
  v_mfma_f32_16x16x32_bf16 v[144:147], a[76:79], a[48:51], v[144:147]
  ds_read_b64_tr_b16 a[110:111], v23 offset:25600
  v_mfma_f32_16x16x32_bf16 v[144:147], a[72:75], a[32:35], v[144:147]
  ds_read_b64_tr_b16 a[112:113], v24 offset:16384
  v_mfma_f32_16x16x32_bf16 v[160:163], a[80:83], a[32:35], v[160:163]
  buffer_load_dwordx4 v33, s[36:39], s33 offen offset:1024 lds
  v_mfma_f32_16x16x32_bf16 v[160:163], a[84:87], a[48:51], v[160:163]
  ds_read_b64_tr_b16 a[114:115], v24 offset:17408
  v_mfma_f32_16x16x32_bf16 v[164:167], a[84:87], a[52:55], v[164:167]
  ds_read_b64_tr_b16 a[116:117], v24 offset:24576
  v_mfma_f32_16x16x32_bf16 v[164:167], a[80:83], a[36:39], v[164:167]
  buffer_load_dwordx4 v34, s[36:39], s33 offen offset:2048 lds
  v_mfma_f32_16x16x32_bf16 v[168:171], a[80:83], a[40:43], v[168:171]
  v_mfma_f32_16x16x32_bf16 v[168:171], a[84:87], a[56:59], v[168:171]
  ds_read_b64_tr_b16 a[118:119], v24 offset:25600
  v_mfma_f32_16x16x32_bf16 v[172:175], a[84:87], a[60:63], v[172:175]
  ds_read_b64_tr_b16 a[120:121], v25 offset:16384
  v_mfma_f32_16x16x32_bf16 v[172:175], a[80:83], a[44:47], v[172:175]
  ds_read_b64_tr_b16 a[122:123], v25 offset:17408
  v_mfma_f32_16x16x32_bf16 v[188:191], a[88:91], a[44:47], v[188:191]
  buffer_load_dwordx4 v35, s[36:39], s33 offen offset:3072 lds
  v_mfma_f32_16x16x32_bf16 v[188:191], a[92:95], a[60:63], v[188:191]
  ds_read_b64_tr_b16 a[124:125], v25 offset:24576
  v_mfma_f32_16x16x32_bf16 v[184:187], a[92:95], a[56:59], v[184:187]
  ds_read_b64_tr_b16 a[126:127], v25 offset:25600
  v_mfma_f32_16x16x32_bf16 v[184:187], a[88:91], a[40:43], v[184:187]
  v_mfma_f32_16x16x32_bf16 v[180:183], a[88:91], a[36:39], v[180:183]
  v_mfma_f32_16x16x32_bf16 v[180:183], a[92:95], a[52:55], v[180:183]
  v_mfma_f32_16x16x32_bf16 v[176:179], a[92:95], a[48:51], v[176:179]
  s_add_u32 s32, s32, 128
  v_mfma_f32_16x16x32_bf16 v[176:179], a[88:91], a[32:35], v[176:179]
  s_add_u32 s33, s33, 524288
  s_waitcnt lgkmcnt(0) vmcnt(12)
  s_barrier
  v_mfma_f32_16x16x32_bf16 v[192:195], a[96:99], a[32:35], v[192:195]
  s_add_u32 m0, s28, 32768
  ds_read_b64_tr_b16 a[64:65], v18 offset:32768
  v_mfma_f32_16x16x32_bf16 v[192:195], a[100:103], a[48:51], v[192:195]
  buffer_load_dwordx4 v2, s[8:11], s32 offen offset:0 lds
  v_mfma_f32_16x16x32_bf16 v[196:199], a[100:103], a[52:55], v[196:199]
  ds_read_b64_tr_b16 a[66:67], v18 offset:33792
  v_mfma_f32_16x16x32_bf16 v[196:199], a[96:99], a[36:39], v[196:199]
  ds_read_b64_tr_b16 a[68:69], v18 offset:40960
  v_mfma_f32_16x16x32_bf16 v[200:203], a[96:99], a[40:43], v[200:203]
  ds_read_b64_tr_b16 a[70:71], v18 offset:41984
  v_mfma_f32_16x16x32_bf16 v[200:203], a[100:103], a[56:59], v[200:203]
  ds_read_b128 a[0:3], v16 offset:0
  v_mfma_f32_16x16x32_bf16 v[204:207], a[100:103], a[60:63], v[204:207]
  buffer_load_dwordx4 v3, s[8:11], s32 offen offset:1024 lds
  v_mfma_f32_16x16x32_bf16 v[204:207], a[96:99], a[44:47], v[204:207]
  ds_read_b128 a[16:19], v17 offset:0
  ds_read_b128 a[4:7], v16 offset:2048
  v_mfma_f32_16x16x32_bf16 v[220:223], a[104:107], a[44:47], v[220:223]
  ds_read_b128 a[20:23], v17 offset:2048
  v_mfma_f32_16x16x32_bf16 v[220:223], a[108:111], a[60:63], v[220:223]
  ds_read_b128 a[8:11], v16 offset:4096
  v_mfma_f32_16x16x32_bf16 v[216:219], a[108:111], a[56:59], v[216:219]
  buffer_load_dwordx4 v4, s[8:11], s32 offen offset:2048 lds
  v_mfma_f32_16x16x32_bf16 v[216:219], a[104:107], a[40:43], v[216:219]
  ds_read_b128 a[24:27], v17 offset:4096
  v_mfma_f32_16x16x32_bf16 v[212:215], a[104:107], a[36:39], v[212:215]
  ds_read_b128 a[12:15], v16 offset:6144
  v_mfma_f32_16x16x32_bf16 v[212:215], a[108:111], a[52:55], v[212:215]
  ds_read_b128 a[28:31], v17 offset:6144
  v_mfma_f32_16x16x32_bf16 v[208:211], a[108:111], a[48:51], v[208:211]
  ds_read_b64_tr_b16 a[72:73], v19 offset:32768
  buffer_load_dwordx4 v5, s[8:11], s32 offen offset:3072 lds
  v_mfma_f32_16x16x32_bf16 v[208:211], a[104:107], a[32:35], v[208:211]
  ds_read_b64_tr_b16 a[74:75], v19 offset:33792
  v_mfma_f32_16x16x32_bf16 v[224:227], a[112:115], a[32:35], v[224:227]
  ds_read_b64_tr_b16 a[76:77], v19 offset:40960
  v_mfma_f32_16x16x32_bf16 v[224:227], a[116:119], a[48:51], v[224:227]
  ds_read_b64_tr_b16 a[78:79], v19 offset:41984
  v_mfma_f32_16x16x32_bf16 v[228:231], a[116:119], a[52:55], v[228:231]
  s_add_u32 m0, s28, 36864
  v_mfma_f32_16x16x32_bf16 v[228:231], a[112:115], a[36:39], v[228:231]
  ds_read_b64_tr_b16 a[80:81], v20 offset:32768
  v_mfma_f32_16x16x32_bf16 v[232:235], a[112:115], a[40:43], v[232:235]
  buffer_load_dwordx4 v6, s[8:11], s32 offen offset:0 lds
  v_mfma_f32_16x16x32_bf16 v[232:235], a[116:119], a[56:59], v[232:235]
  ds_read_b64_tr_b16 a[82:83], v20 offset:33792
  ds_read_b64_tr_b16 a[84:85], v20 offset:40960
  v_mfma_f32_16x16x32_bf16 v[236:239], a[116:119], a[60:63], v[236:239]
  ds_read_b64_tr_b16 a[86:87], v20 offset:41984
  v_mfma_f32_16x16x32_bf16 v[236:239], a[112:115], a[44:47], v[236:239]
  ds_read_b64_tr_b16 a[88:89], v21 offset:32768
  v_mfma_f32_16x16x32_bf16 v[252:255], a[120:123], a[44:47], v[252:255]
  buffer_load_dwordx4 v7, s[8:11], s32 offen offset:1024 lds
  v_mfma_f32_16x16x32_bf16 v[252:255], a[124:127], a[60:63], v[252:255]
  ds_read_b64_tr_b16 a[90:91], v21 offset:33792
  v_mfma_f32_16x16x32_bf16 v[248:251], a[124:127], a[56:59], v[248:251]
  ds_read_b64_tr_b16 a[92:93], v21 offset:40960
  v_mfma_f32_16x16x32_bf16 v[248:251], a[120:123], a[40:43], v[248:251]
  ds_read_b64_tr_b16 a[94:95], v21 offset:41984
  v_mfma_f32_16x16x32_bf16 v[244:247], a[120:123], a[36:39], v[244:247]
  v_mfma_f32_16x16x32_bf16 v[244:247], a[124:127], a[52:55], v[244:247]
  v_mfma_f32_16x16x32_bf16 v[240:243], a[124:127], a[48:51], v[240:243]
  v_mfma_f32_16x16x32_bf16 v[240:243], a[120:123], a[32:35], v[240:243]
  s_waitcnt lgkmcnt(0)
  v_mfma_f32_16x16x32_bf16 v[128:131], a[64:67], a[0:3], v[128:131]
  s_add_u32 m0, s28, 36864
  v_mfma_f32_16x16x32_bf16 v[128:131], a[68:71], a[16:19], v[128:131]
  ds_read_b64_tr_b16 a[96:97], v22 offset:32768
  v_mfma_f32_16x16x32_bf16 v[132:135], a[68:71], a[20:23], v[132:135]
  buffer_load_dwordx4 v8, s[8:11], s32 offen offset:2048 lds
  v_mfma_f32_16x16x32_bf16 v[132:135], a[64:67], a[4:7], v[132:135]
  ds_read_b64_tr_b16 a[98:99], v22 offset:33792
  v_mfma_f32_16x16x32_bf16 v[136:139], a[64:67], a[8:11], v[136:139]
  ds_read_b64_tr_b16 a[100:101], v22 offset:40960
  v_mfma_f32_16x16x32_bf16 v[136:139], a[68:71], a[24:27], v[136:139]
  buffer_load_dwordx4 v9, s[8:11], s32 offen offset:3072 lds
  v_mfma_f32_16x16x32_bf16 v[140:143], a[68:71], a[28:31], v[140:143]
  v_mfma_f32_16x16x32_bf16 v[140:143], a[64:67], a[12:15], v[140:143]
  ds_read_b64_tr_b16 a[102:103], v22 offset:41984
  v_mfma_f32_16x16x32_bf16 v[156:159], a[72:75], a[12:15], v[156:159]
  ds_read_b64_tr_b16 a[104:105], v23 offset:32768
  v_mfma_f32_16x16x32_bf16 v[156:159], a[76:79], a[28:31], v[156:159]
  s_add_u32 m0, s29, 16384
  v_mfma_f32_16x16x32_bf16 v[152:155], a[76:79], a[24:27], v[152:155]
  ds_read_b64_tr_b16 a[106:107], v23 offset:33792
  v_mfma_f32_16x16x32_bf16 v[152:155], a[72:75], a[8:11], v[152:155]
  buffer_load_dwordx4 v32, s[36:39], s33 offen offset:0 lds
  v_mfma_f32_16x16x32_bf16 v[148:151], a[72:75], a[4:7], v[148:151]
  ds_read_b64_tr_b16 a[108:109], v23 offset:40960
  v_mfma_f32_16x16x32_bf16 v[148:151], a[76:79], a[20:23], v[148:151]
  v_mfma_f32_16x16x32_bf16 v[144:147], a[76:79], a[16:19], v[144:147]
  ds_read_b64_tr_b16 a[110:111], v23 offset:41984
  v_mfma_f32_16x16x32_bf16 v[144:147], a[72:75], a[0:3], v[144:147]
  ds_read_b64_tr_b16 a[112:113], v24 offset:32768
  v_mfma_f32_16x16x32_bf16 v[160:163], a[80:83], a[0:3], v[160:163]
  buffer_load_dwordx4 v33, s[36:39], s33 offen offset:1024 lds
  v_mfma_f32_16x16x32_bf16 v[160:163], a[84:87], a[16:19], v[160:163]
  ds_read_b64_tr_b16 a[114:115], v24 offset:33792
  v_mfma_f32_16x16x32_bf16 v[164:167], a[84:87], a[20:23], v[164:167]
  ds_read_b64_tr_b16 a[116:117], v24 offset:40960
  v_mfma_f32_16x16x32_bf16 v[164:167], a[80:83], a[4:7], v[164:167]
  buffer_load_dwordx4 v34, s[36:39], s33 offen offset:2048 lds
  v_mfma_f32_16x16x32_bf16 v[168:171], a[80:83], a[8:11], v[168:171]
  v_mfma_f32_16x16x32_bf16 v[168:171], a[84:87], a[24:27], v[168:171]
  ds_read_b64_tr_b16 a[118:119], v24 offset:41984
  v_mfma_f32_16x16x32_bf16 v[172:175], a[84:87], a[28:31], v[172:175]
  ds_read_b64_tr_b16 a[120:121], v25 offset:32768
  v_mfma_f32_16x16x32_bf16 v[172:175], a[80:83], a[12:15], v[172:175]
  ds_read_b64_tr_b16 a[122:123], v25 offset:33792
  v_mfma_f32_16x16x32_bf16 v[188:191], a[88:91], a[12:15], v[188:191]
  buffer_load_dwordx4 v35, s[36:39], s33 offen offset:3072 lds
  v_mfma_f32_16x16x32_bf16 v[188:191], a[92:95], a[28:31], v[188:191]
  ds_read_b64_tr_b16 a[124:125], v25 offset:40960
  v_mfma_f32_16x16x32_bf16 v[184:187], a[92:95], a[24:27], v[184:187]
  ds_read_b64_tr_b16 a[126:127], v25 offset:41984
  v_mfma_f32_16x16x32_bf16 v[184:187], a[88:91], a[8:11], v[184:187]
  v_mfma_f32_16x16x32_bf16 v[180:183], a[88:91], a[4:7], v[180:183]
  v_mfma_f32_16x16x32_bf16 v[180:183], a[92:95], a[20:23], v[180:183]
  v_mfma_f32_16x16x32_bf16 v[176:179], a[92:95], a[16:19], v[176:179]
  s_add_u32 s32, s32, 128
  v_mfma_f32_16x16x32_bf16 v[176:179], a[88:91], a[0:3], v[176:179]
  s_add_u32 s33, s33, 524288
  s_waitcnt lgkmcnt(0) vmcnt(12)
  s_barrier
  v_mfma_f32_16x16x32_bf16 v[192:195], a[96:99], a[0:3], v[192:195]
  s_add_u32 m0, s28, 65536
  ds_read_b64_tr_b16 a[64:65], v18 offset:0
  v_mfma_f32_16x16x32_bf16 v[192:195], a[100:103], a[16:19], v[192:195]
  buffer_load_dwordx4 v2, s[8:11], s32 offen offset:0 lds
  v_mfma_f32_16x16x32_bf16 v[196:199], a[100:103], a[20:23], v[196:199]
  ds_read_b64_tr_b16 a[66:67], v18 offset:1024
  v_mfma_f32_16x16x32_bf16 v[196:199], a[96:99], a[4:7], v[196:199]
  ds_read_b64_tr_b16 a[68:69], v18 offset:8192
  v_mfma_f32_16x16x32_bf16 v[200:203], a[96:99], a[8:11], v[200:203]
  ds_read_b64_tr_b16 a[70:71], v18 offset:9216
  v_mfma_f32_16x16x32_bf16 v[200:203], a[100:103], a[24:27], v[200:203]
  ds_read_b128 a[32:35], v14 offset:0
  v_mfma_f32_16x16x32_bf16 v[204:207], a[100:103], a[28:31], v[204:207]
  buffer_load_dwordx4 v3, s[8:11], s32 offen offset:1024 lds
  v_mfma_f32_16x16x32_bf16 v[204:207], a[96:99], a[12:15], v[204:207]
  ds_read_b128 a[48:51], v15 offset:0
  ds_read_b128 a[36:39], v14 offset:2048
  v_mfma_f32_16x16x32_bf16 v[220:223], a[104:107], a[12:15], v[220:223]
  ds_read_b128 a[52:55], v15 offset:2048
  v_mfma_f32_16x16x32_bf16 v[220:223], a[108:111], a[28:31], v[220:223]
  ds_read_b128 a[40:43], v14 offset:4096
  v_mfma_f32_16x16x32_bf16 v[216:219], a[108:111], a[24:27], v[216:219]
  buffer_load_dwordx4 v4, s[8:11], s32 offen offset:2048 lds
  v_mfma_f32_16x16x32_bf16 v[216:219], a[104:107], a[8:11], v[216:219]
  ds_read_b128 a[56:59], v15 offset:4096
  v_mfma_f32_16x16x32_bf16 v[212:215], a[104:107], a[4:7], v[212:215]
  ds_read_b128 a[44:47], v14 offset:6144
  v_mfma_f32_16x16x32_bf16 v[212:215], a[108:111], a[20:23], v[212:215]
  ds_read_b128 a[60:63], v15 offset:6144
  v_mfma_f32_16x16x32_bf16 v[208:211], a[108:111], a[16:19], v[208:211]
  ds_read_b64_tr_b16 a[72:73], v19 offset:0
  buffer_load_dwordx4 v5, s[8:11], s32 offen offset:3072 lds
  v_mfma_f32_16x16x32_bf16 v[208:211], a[104:107], a[0:3], v[208:211]
  ds_read_b64_tr_b16 a[74:75], v19 offset:1024
  v_mfma_f32_16x16x32_bf16 v[224:227], a[112:115], a[0:3], v[224:227]
  ds_read_b64_tr_b16 a[76:77], v19 offset:8192
  v_mfma_f32_16x16x32_bf16 v[224:227], a[116:119], a[16:19], v[224:227]
  ds_read_b64_tr_b16 a[78:79], v19 offset:9216
  v_mfma_f32_16x16x32_bf16 v[228:231], a[116:119], a[20:23], v[228:231]
  s_add_u32 m0, s28, 69632
  v_mfma_f32_16x16x32_bf16 v[228:231], a[112:115], a[4:7], v[228:231]
  ds_read_b64_tr_b16 a[80:81], v20 offset:0
  v_mfma_f32_16x16x32_bf16 v[232:235], a[112:115], a[8:11], v[232:235]
  buffer_load_dwordx4 v6, s[8:11], s32 offen offset:0 lds
  v_mfma_f32_16x16x32_bf16 v[232:235], a[116:119], a[24:27], v[232:235]
  ds_read_b64_tr_b16 a[82:83], v20 offset:1024
  ds_read_b64_tr_b16 a[84:85], v20 offset:8192
  v_mfma_f32_16x16x32_bf16 v[236:239], a[116:119], a[28:31], v[236:239]
  ds_read_b64_tr_b16 a[86:87], v20 offset:9216
  v_mfma_f32_16x16x32_bf16 v[236:239], a[112:115], a[12:15], v[236:239]
  ds_read_b64_tr_b16 a[88:89], v21 offset:0
  v_mfma_f32_16x16x32_bf16 v[252:255], a[120:123], a[12:15], v[252:255]
  buffer_load_dwordx4 v7, s[8:11], s32 offen offset:1024 lds
  v_mfma_f32_16x16x32_bf16 v[252:255], a[124:127], a[28:31], v[252:255]
  ds_read_b64_tr_b16 a[90:91], v21 offset:1024
  v_mfma_f32_16x16x32_bf16 v[248:251], a[124:127], a[24:27], v[248:251]
  ds_read_b64_tr_b16 a[92:93], v21 offset:8192
  v_mfma_f32_16x16x32_bf16 v[248:251], a[120:123], a[8:11], v[248:251]
  ds_read_b64_tr_b16 a[94:95], v21 offset:9216
  v_mfma_f32_16x16x32_bf16 v[244:247], a[120:123], a[4:7], v[244:247]
  v_mfma_f32_16x16x32_bf16 v[244:247], a[124:127], a[20:23], v[244:247]
  v_mfma_f32_16x16x32_bf16 v[240:243], a[124:127], a[16:19], v[240:243]
  v_mfma_f32_16x16x32_bf16 v[240:243], a[120:123], a[0:3], v[240:243]
  s_waitcnt lgkmcnt(0)
  v_mfma_f32_16x16x32_bf16 v[128:131], a[64:67], a[32:35], v[128:131]
  s_add_u32 m0, s28, 69632
  v_mfma_f32_16x16x32_bf16 v[128:131], a[68:71], a[48:51], v[128:131]
  ds_read_b64_tr_b16 a[96:97], v22 offset:0
  v_mfma_f32_16x16x32_bf16 v[132:135], a[68:71], a[52:55], v[132:135]
  buffer_load_dwordx4 v8, s[8:11], s32 offen offset:2048 lds
  v_mfma_f32_16x16x32_bf16 v[132:135], a[64:67], a[36:39], v[132:135]
  ds_read_b64_tr_b16 a[98:99], v22 offset:1024
  v_mfma_f32_16x16x32_bf16 v[136:139], a[64:67], a[40:43], v[136:139]
  ds_read_b64_tr_b16 a[100:101], v22 offset:8192
  v_mfma_f32_16x16x32_bf16 v[136:139], a[68:71], a[56:59], v[136:139]
  buffer_load_dwordx4 v9, s[8:11], s32 offen offset:3072 lds
  v_mfma_f32_16x16x32_bf16 v[140:143], a[68:71], a[60:63], v[140:143]
  v_mfma_f32_16x16x32_bf16 v[140:143], a[64:67], a[44:47], v[140:143]
  ds_read_b64_tr_b16 a[102:103], v22 offset:9216
  v_mfma_f32_16x16x32_bf16 v[156:159], a[72:75], a[44:47], v[156:159]
  ds_read_b64_tr_b16 a[104:105], v23 offset:0
  v_mfma_f32_16x16x32_bf16 v[156:159], a[76:79], a[60:63], v[156:159]
  s_add_u32 m0, s29, 32768
  v_mfma_f32_16x16x32_bf16 v[152:155], a[76:79], a[56:59], v[152:155]
  ds_read_b64_tr_b16 a[106:107], v23 offset:1024
  v_mfma_f32_16x16x32_bf16 v[152:155], a[72:75], a[40:43], v[152:155]
  buffer_load_dwordx4 v32, s[36:39], s33 offen offset:0 lds
  v_mfma_f32_16x16x32_bf16 v[148:151], a[72:75], a[36:39], v[148:151]
  ds_read_b64_tr_b16 a[108:109], v23 offset:8192
  v_mfma_f32_16x16x32_bf16 v[148:151], a[76:79], a[52:55], v[148:151]
  v_mfma_f32_16x16x32_bf16 v[144:147], a[76:79], a[48:51], v[144:147]
  ds_read_b64_tr_b16 a[110:111], v23 offset:9216
  v_mfma_f32_16x16x32_bf16 v[144:147], a[72:75], a[32:35], v[144:147]
  ds_read_b64_tr_b16 a[112:113], v24 offset:0
  v_mfma_f32_16x16x32_bf16 v[160:163], a[80:83], a[32:35], v[160:163]
  buffer_load_dwordx4 v33, s[36:39], s33 offen offset:1024 lds
  v_mfma_f32_16x16x32_bf16 v[160:163], a[84:87], a[48:51], v[160:163]
  ds_read_b64_tr_b16 a[114:115], v24 offset:1024
  v_mfma_f32_16x16x32_bf16 v[164:167], a[84:87], a[52:55], v[164:167]
  ds_read_b64_tr_b16 a[116:117], v24 offset:8192
  v_mfma_f32_16x16x32_bf16 v[164:167], a[80:83], a[36:39], v[164:167]
  buffer_load_dwordx4 v34, s[36:39], s33 offen offset:2048 lds
  v_mfma_f32_16x16x32_bf16 v[168:171], a[80:83], a[40:43], v[168:171]
  v_mfma_f32_16x16x32_bf16 v[168:171], a[84:87], a[56:59], v[168:171]
  ds_read_b64_tr_b16 a[118:119], v24 offset:9216
  v_mfma_f32_16x16x32_bf16 v[172:175], a[84:87], a[60:63], v[172:175]
  ds_read_b64_tr_b16 a[120:121], v25 offset:0
  v_mfma_f32_16x16x32_bf16 v[172:175], a[80:83], a[44:47], v[172:175]
  ds_read_b64_tr_b16 a[122:123], v25 offset:1024
  v_mfma_f32_16x16x32_bf16 v[188:191], a[88:91], a[44:47], v[188:191]
  buffer_load_dwordx4 v35, s[36:39], s33 offen offset:3072 lds
  v_mfma_f32_16x16x32_bf16 v[188:191], a[92:95], a[60:63], v[188:191]
  ds_read_b64_tr_b16 a[124:125], v25 offset:8192
  v_mfma_f32_16x16x32_bf16 v[184:187], a[92:95], a[56:59], v[184:187]
  ds_read_b64_tr_b16 a[126:127], v25 offset:9216
  v_mfma_f32_16x16x32_bf16 v[184:187], a[88:91], a[40:43], v[184:187]
  v_mfma_f32_16x16x32_bf16 v[180:183], a[88:91], a[36:39], v[180:183]
  v_mfma_f32_16x16x32_bf16 v[180:183], a[92:95], a[52:55], v[180:183]
  v_mfma_f32_16x16x32_bf16 v[176:179], a[92:95], a[48:51], v[176:179]
  s_add_u32 s32, s32, 128
  v_mfma_f32_16x16x32_bf16 v[176:179], a[88:91], a[32:35], v[176:179]
  s_add_u32 s33, s33, 524288
  s_waitcnt lgkmcnt(0) vmcnt(12)
  s_barrier
  v_mfma_f32_16x16x32_bf16 v[192:195], a[96:99], a[32:35], v[192:195]
  s_add_u32 m0, s28, 0
  ds_read_b64_tr_b16 a[64:65], v18 offset:16384
  v_mfma_f32_16x16x32_bf16 v[192:195], a[100:103], a[48:51], v[192:195]
  buffer_load_dwordx4 v2, s[8:11], s32 offen offset:0 lds
  v_mfma_f32_16x16x32_bf16 v[196:199], a[100:103], a[52:55], v[196:199]
  ds_read_b64_tr_b16 a[66:67], v18 offset:17408
  v_mfma_f32_16x16x32_bf16 v[196:199], a[96:99], a[36:39], v[196:199]
  ds_read_b64_tr_b16 a[68:69], v18 offset:24576
  v_mfma_f32_16x16x32_bf16 v[200:203], a[96:99], a[40:43], v[200:203]
  ds_read_b64_tr_b16 a[70:71], v18 offset:25600
  v_mfma_f32_16x16x32_bf16 v[200:203], a[100:103], a[56:59], v[200:203]
  ds_read_b128 a[0:3], v14 offset:32768
  v_mfma_f32_16x16x32_bf16 v[204:207], a[100:103], a[60:63], v[204:207]
  buffer_load_dwordx4 v3, s[8:11], s32 offen offset:1024 lds
  v_mfma_f32_16x16x32_bf16 v[204:207], a[96:99], a[44:47], v[204:207]
  ds_read_b128 a[16:19], v15 offset:32768
  ds_read_b128 a[4:7], v14 offset:34816
  v_mfma_f32_16x16x32_bf16 v[220:223], a[104:107], a[44:47], v[220:223]
  ds_read_b128 a[20:23], v15 offset:34816
  v_mfma_f32_16x16x32_bf16 v[220:223], a[108:111], a[60:63], v[220:223]
  ds_read_b128 a[8:11], v14 offset:36864
  v_mfma_f32_16x16x32_bf16 v[216:219], a[108:111], a[56:59], v[216:219]
  buffer_load_dwordx4 v4, s[8:11], s32 offen offset:2048 lds
  v_mfma_f32_16x16x32_bf16 v[216:219], a[104:107], a[40:43], v[216:219]
  ds_read_b128 a[24:27], v15 offset:36864
  v_mfma_f32_16x16x32_bf16 v[212:215], a[104:107], a[36:39], v[212:215]
  ds_read_b128 a[12:15], v14 offset:38912
  v_mfma_f32_16x16x32_bf16 v[212:215], a[108:111], a[52:55], v[212:215]
  ds_read_b128 a[28:31], v15 offset:38912
  v_mfma_f32_16x16x32_bf16 v[208:211], a[108:111], a[48:51], v[208:211]
  ds_read_b64_tr_b16 a[72:73], v19 offset:16384
  buffer_load_dwordx4 v5, s[8:11], s32 offen offset:3072 lds
  v_mfma_f32_16x16x32_bf16 v[208:211], a[104:107], a[32:35], v[208:211]
  ds_read_b64_tr_b16 a[74:75], v19 offset:17408
  v_mfma_f32_16x16x32_bf16 v[224:227], a[112:115], a[32:35], v[224:227]
  ds_read_b64_tr_b16 a[76:77], v19 offset:24576
  v_mfma_f32_16x16x32_bf16 v[224:227], a[116:119], a[48:51], v[224:227]
  ds_read_b64_tr_b16 a[78:79], v19 offset:25600
  v_mfma_f32_16x16x32_bf16 v[228:231], a[116:119], a[52:55], v[228:231]
  s_add_u32 m0, s28, 4096
  v_mfma_f32_16x16x32_bf16 v[228:231], a[112:115], a[36:39], v[228:231]
  ds_read_b64_tr_b16 a[80:81], v20 offset:16384
  v_mfma_f32_16x16x32_bf16 v[232:235], a[112:115], a[40:43], v[232:235]
  buffer_load_dwordx4 v6, s[8:11], s32 offen offset:0 lds
  v_mfma_f32_16x16x32_bf16 v[232:235], a[116:119], a[56:59], v[232:235]
  ds_read_b64_tr_b16 a[82:83], v20 offset:17408
  ds_read_b64_tr_b16 a[84:85], v20 offset:24576
  v_mfma_f32_16x16x32_bf16 v[236:239], a[116:119], a[60:63], v[236:239]
  ds_read_b64_tr_b16 a[86:87], v20 offset:25600
  v_mfma_f32_16x16x32_bf16 v[236:239], a[112:115], a[44:47], v[236:239]
  ds_read_b64_tr_b16 a[88:89], v21 offset:16384
  v_mfma_f32_16x16x32_bf16 v[252:255], a[120:123], a[44:47], v[252:255]
  buffer_load_dwordx4 v7, s[8:11], s32 offen offset:1024 lds
  v_mfma_f32_16x16x32_bf16 v[252:255], a[124:127], a[60:63], v[252:255]
  ds_read_b64_tr_b16 a[90:91], v21 offset:17408
  v_mfma_f32_16x16x32_bf16 v[248:251], a[124:127], a[56:59], v[248:251]
  ds_read_b64_tr_b16 a[92:93], v21 offset:24576
  v_mfma_f32_16x16x32_bf16 v[248:251], a[120:123], a[40:43], v[248:251]
  ds_read_b64_tr_b16 a[94:95], v21 offset:25600
  v_mfma_f32_16x16x32_bf16 v[244:247], a[120:123], a[36:39], v[244:247]
  v_mfma_f32_16x16x32_bf16 v[244:247], a[124:127], a[52:55], v[244:247]
  v_mfma_f32_16x16x32_bf16 v[240:243], a[124:127], a[48:51], v[240:243]
  v_mfma_f32_16x16x32_bf16 v[240:243], a[120:123], a[32:35], v[240:243]
  s_waitcnt lgkmcnt(0)
  v_mfma_f32_16x16x32_bf16 v[128:131], a[64:67], a[0:3], v[128:131]
  s_add_u32 m0, s28, 4096
  v_mfma_f32_16x16x32_bf16 v[128:131], a[68:71], a[16:19], v[128:131]
  ds_read_b64_tr_b16 a[96:97], v22 offset:16384
  v_mfma_f32_16x16x32_bf16 v[132:135], a[68:71], a[20:23], v[132:135]
  buffer_load_dwordx4 v8, s[8:11], s32 offen offset:2048 lds
  v_mfma_f32_16x16x32_bf16 v[132:135], a[64:67], a[4:7], v[132:135]
  ds_read_b64_tr_b16 a[98:99], v22 offset:17408
  v_mfma_f32_16x16x32_bf16 v[136:139], a[64:67], a[8:11], v[136:139]
  ds_read_b64_tr_b16 a[100:101], v22 offset:24576
  v_mfma_f32_16x16x32_bf16 v[136:139], a[68:71], a[24:27], v[136:139]
  buffer_load_dwordx4 v9, s[8:11], s32 offen offset:3072 lds
  v_mfma_f32_16x16x32_bf16 v[140:143], a[68:71], a[28:31], v[140:143]
  v_mfma_f32_16x16x32_bf16 v[140:143], a[64:67], a[12:15], v[140:143]
  ds_read_b64_tr_b16 a[102:103], v22 offset:25600
  v_mfma_f32_16x16x32_bf16 v[156:159], a[72:75], a[12:15], v[156:159]
  ds_read_b64_tr_b16 a[104:105], v23 offset:16384
  v_mfma_f32_16x16x32_bf16 v[156:159], a[76:79], a[28:31], v[156:159]
  s_add_u32 m0, s29, 0
  v_mfma_f32_16x16x32_bf16 v[152:155], a[76:79], a[24:27], v[152:155]
  ds_read_b64_tr_b16 a[106:107], v23 offset:17408
  v_mfma_f32_16x16x32_bf16 v[152:155], a[72:75], a[8:11], v[152:155]
  buffer_load_dwordx4 v32, s[36:39], s33 offen offset:0 lds
  v_mfma_f32_16x16x32_bf16 v[148:151], a[72:75], a[4:7], v[148:151]
  ds_read_b64_tr_b16 a[108:109], v23 offset:24576
  v_mfma_f32_16x16x32_bf16 v[148:151], a[76:79], a[20:23], v[148:151]
  v_mfma_f32_16x16x32_bf16 v[144:147], a[76:79], a[16:19], v[144:147]
  ds_read_b64_tr_b16 a[110:111], v23 offset:25600
  v_mfma_f32_16x16x32_bf16 v[144:147], a[72:75], a[0:3], v[144:147]
  ds_read_b64_tr_b16 a[112:113], v24 offset:16384
  v_mfma_f32_16x16x32_bf16 v[160:163], a[80:83], a[0:3], v[160:163]
  buffer_load_dwordx4 v33, s[36:39], s33 offen offset:1024 lds
  v_mfma_f32_16x16x32_bf16 v[160:163], a[84:87], a[16:19], v[160:163]
  ds_read_b64_tr_b16 a[114:115], v24 offset:17408
  v_mfma_f32_16x16x32_bf16 v[164:167], a[84:87], a[20:23], v[164:167]
  ds_read_b64_tr_b16 a[116:117], v24 offset:24576
  v_mfma_f32_16x16x32_bf16 v[164:167], a[80:83], a[4:7], v[164:167]
  buffer_load_dwordx4 v34, s[36:39], s33 offen offset:2048 lds
  v_mfma_f32_16x16x32_bf16 v[168:171], a[80:83], a[8:11], v[168:171]
  v_mfma_f32_16x16x32_bf16 v[168:171], a[84:87], a[24:27], v[168:171]
  ds_read_b64_tr_b16 a[118:119], v24 offset:25600
  v_mfma_f32_16x16x32_bf16 v[172:175], a[84:87], a[28:31], v[172:175]
  ds_read_b64_tr_b16 a[120:121], v25 offset:16384
  v_mfma_f32_16x16x32_bf16 v[172:175], a[80:83], a[12:15], v[172:175]
  ds_read_b64_tr_b16 a[122:123], v25 offset:17408
  v_mfma_f32_16x16x32_bf16 v[188:191], a[88:91], a[12:15], v[188:191]
  buffer_load_dwordx4 v35, s[36:39], s33 offen offset:3072 lds
  v_mfma_f32_16x16x32_bf16 v[188:191], a[92:95], a[28:31], v[188:191]
  ds_read_b64_tr_b16 a[124:125], v25 offset:24576
  v_mfma_f32_16x16x32_bf16 v[184:187], a[92:95], a[24:27], v[184:187]
  ds_read_b64_tr_b16 a[126:127], v25 offset:25600
  v_mfma_f32_16x16x32_bf16 v[184:187], a[88:91], a[8:11], v[184:187]
  v_mfma_f32_16x16x32_bf16 v[180:183], a[88:91], a[4:7], v[180:183]
  v_mfma_f32_16x16x32_bf16 v[180:183], a[92:95], a[20:23], v[180:183]
  v_mfma_f32_16x16x32_bf16 v[176:179], a[92:95], a[16:19], v[176:179]
  s_add_u32 s32, s32, 128
  v_mfma_f32_16x16x32_bf16 v[176:179], a[88:91], a[0:3], v[176:179]
  s_add_u32 s33, s33, 524288
  s_waitcnt lgkmcnt(0) vmcnt(12)
  s_barrier
  v_mfma_f32_16x16x32_bf16 v[192:195], a[96:99], a[0:3], v[192:195]
  s_add_u32 m0, s28, 32768
  ds_read_b64_tr_b16 a[64:65], v18 offset:32768
  v_mfma_f32_16x16x32_bf16 v[192:195], a[100:103], a[16:19], v[192:195]
  buffer_load_dwordx4 v2, s[8:11], s32 offen offset:0 lds
  v_mfma_f32_16x16x32_bf16 v[196:199], a[100:103], a[20:23], v[196:199]
  ds_read_b64_tr_b16 a[66:67], v18 offset:33792
  v_mfma_f32_16x16x32_bf16 v[196:199], a[96:99], a[4:7], v[196:199]
  ds_read_b64_tr_b16 a[68:69], v18 offset:40960
  v_mfma_f32_16x16x32_bf16 v[200:203], a[96:99], a[8:11], v[200:203]
  ds_read_b64_tr_b16 a[70:71], v18 offset:41984
  v_mfma_f32_16x16x32_bf16 v[200:203], a[100:103], a[24:27], v[200:203]
  ds_read_b128 a[32:35], v16 offset:0
  v_mfma_f32_16x16x32_bf16 v[204:207], a[100:103], a[28:31], v[204:207]
  buffer_load_dwordx4 v3, s[8:11], s32 offen offset:1024 lds
  v_mfma_f32_16x16x32_bf16 v[204:207], a[96:99], a[12:15], v[204:207]
  ds_read_b128 a[48:51], v17 offset:0
  ds_read_b128 a[36:39], v16 offset:2048
  v_mfma_f32_16x16x32_bf16 v[220:223], a[104:107], a[12:15], v[220:223]
  ds_read_b128 a[52:55], v17 offset:2048
  v_mfma_f32_16x16x32_bf16 v[220:223], a[108:111], a[28:31], v[220:223]
  ds_read_b128 a[40:43], v16 offset:4096
  v_mfma_f32_16x16x32_bf16 v[216:219], a[108:111], a[24:27], v[216:219]
  buffer_load_dwordx4 v4, s[8:11], s32 offen offset:2048 lds
  v_mfma_f32_16x16x32_bf16 v[216:219], a[104:107], a[8:11], v[216:219]
  ds_read_b128 a[56:59], v17 offset:4096
  v_mfma_f32_16x16x32_bf16 v[212:215], a[104:107], a[4:7], v[212:215]
  ds_read_b128 a[44:47], v16 offset:6144
  v_mfma_f32_16x16x32_bf16 v[212:215], a[108:111], a[20:23], v[212:215]
  ds_read_b128 a[60:63], v17 offset:6144
  v_mfma_f32_16x16x32_bf16 v[208:211], a[108:111], a[16:19], v[208:211]
  ds_read_b64_tr_b16 a[72:73], v19 offset:32768
  buffer_load_dwordx4 v5, s[8:11], s32 offen offset:3072 lds
  v_mfma_f32_16x16x32_bf16 v[208:211], a[104:107], a[0:3], v[208:211]
  ds_read_b64_tr_b16 a[74:75], v19 offset:33792
  v_mfma_f32_16x16x32_bf16 v[224:227], a[112:115], a[0:3], v[224:227]
  ds_read_b64_tr_b16 a[76:77], v19 offset:40960
  v_mfma_f32_16x16x32_bf16 v[224:227], a[116:119], a[16:19], v[224:227]
  ds_read_b64_tr_b16 a[78:79], v19 offset:41984
  v_mfma_f32_16x16x32_bf16 v[228:231], a[116:119], a[20:23], v[228:231]
  s_add_u32 m0, s28, 36864
  v_mfma_f32_16x16x32_bf16 v[228:231], a[112:115], a[4:7], v[228:231]
  ds_read_b64_tr_b16 a[80:81], v20 offset:32768
  v_mfma_f32_16x16x32_bf16 v[232:235], a[112:115], a[8:11], v[232:235]
  buffer_load_dwordx4 v6, s[8:11], s32 offen offset:0 lds
  v_mfma_f32_16x16x32_bf16 v[232:235], a[116:119], a[24:27], v[232:235]
  ds_read_b64_tr_b16 a[82:83], v20 offset:33792
  ds_read_b64_tr_b16 a[84:85], v20 offset:40960
  v_mfma_f32_16x16x32_bf16 v[236:239], a[116:119], a[28:31], v[236:239]
  ds_read_b64_tr_b16 a[86:87], v20 offset:41984
  v_mfma_f32_16x16x32_bf16 v[236:239], a[112:115], a[12:15], v[236:239]
  ds_read_b64_tr_b16 a[88:89], v21 offset:32768
  v_mfma_f32_16x16x32_bf16 v[252:255], a[120:123], a[12:15], v[252:255]
  buffer_load_dwordx4 v7, s[8:11], s32 offen offset:1024 lds
  v_mfma_f32_16x16x32_bf16 v[252:255], a[124:127], a[28:31], v[252:255]
  ds_read_b64_tr_b16 a[90:91], v21 offset:33792
  v_mfma_f32_16x16x32_bf16 v[248:251], a[124:127], a[24:27], v[248:251]
  ds_read_b64_tr_b16 a[92:93], v21 offset:40960
  v_mfma_f32_16x16x32_bf16 v[248:251], a[120:123], a[8:11], v[248:251]
  ds_read_b64_tr_b16 a[94:95], v21 offset:41984
  v_mfma_f32_16x16x32_bf16 v[244:247], a[120:123], a[4:7], v[244:247]
  v_mfma_f32_16x16x32_bf16 v[244:247], a[124:127], a[20:23], v[244:247]
  v_mfma_f32_16x16x32_bf16 v[240:243], a[124:127], a[16:19], v[240:243]
  v_mfma_f32_16x16x32_bf16 v[240:243], a[120:123], a[0:3], v[240:243]
  s_waitcnt lgkmcnt(0)
  v_mfma_f32_16x16x32_bf16 v[128:131], a[64:67], a[32:35], v[128:131]
  s_add_u32 m0, s28, 36864
  v_mfma_f32_16x16x32_bf16 v[128:131], a[68:71], a[48:51], v[128:131]
  ds_read_b64_tr_b16 a[96:97], v22 offset:32768
  v_mfma_f32_16x16x32_bf16 v[132:135], a[68:71], a[52:55], v[132:135]
  buffer_load_dwordx4 v8, s[8:11], s32 offen offset:2048 lds
  v_mfma_f32_16x16x32_bf16 v[132:135], a[64:67], a[36:39], v[132:135]
  ds_read_b64_tr_b16 a[98:99], v22 offset:33792
  v_mfma_f32_16x16x32_bf16 v[136:139], a[64:67], a[40:43], v[136:139]
  ds_read_b64_tr_b16 a[100:101], v22 offset:40960
  v_mfma_f32_16x16x32_bf16 v[136:139], a[68:71], a[56:59], v[136:139]
  buffer_load_dwordx4 v9, s[8:11], s32 offen offset:3072 lds
  v_mfma_f32_16x16x32_bf16 v[140:143], a[68:71], a[60:63], v[140:143]
  v_mfma_f32_16x16x32_bf16 v[140:143], a[64:67], a[44:47], v[140:143]
  ds_read_b64_tr_b16 a[102:103], v22 offset:41984
  v_mfma_f32_16x16x32_bf16 v[156:159], a[72:75], a[44:47], v[156:159]
  ds_read_b64_tr_b16 a[104:105], v23 offset:32768
  v_mfma_f32_16x16x32_bf16 v[156:159], a[76:79], a[60:63], v[156:159]
  s_add_u32 m0, s29, 16384
  v_mfma_f32_16x16x32_bf16 v[152:155], a[76:79], a[56:59], v[152:155]
  ds_read_b64_tr_b16 a[106:107], v23 offset:33792
  v_mfma_f32_16x16x32_bf16 v[152:155], a[72:75], a[40:43], v[152:155]
  buffer_load_dwordx4 v32, s[36:39], s33 offen offset:0 lds
  v_mfma_f32_16x16x32_bf16 v[148:151], a[72:75], a[36:39], v[148:151]
  ds_read_b64_tr_b16 a[108:109], v23 offset:40960
  v_mfma_f32_16x16x32_bf16 v[148:151], a[76:79], a[52:55], v[148:151]
  v_mfma_f32_16x16x32_bf16 v[144:147], a[76:79], a[48:51], v[144:147]
  ds_read_b64_tr_b16 a[110:111], v23 offset:41984
  v_mfma_f32_16x16x32_bf16 v[144:147], a[72:75], a[32:35], v[144:147]
  ds_read_b64_tr_b16 a[112:113], v24 offset:32768
  v_mfma_f32_16x16x32_bf16 v[160:163], a[80:83], a[32:35], v[160:163]
  buffer_load_dwordx4 v33, s[36:39], s33 offen offset:1024 lds
  v_mfma_f32_16x16x32_bf16 v[160:163], a[84:87], a[48:51], v[160:163]
  ds_read_b64_tr_b16 a[114:115], v24 offset:33792
  v_mfma_f32_16x16x32_bf16 v[164:167], a[84:87], a[52:55], v[164:167]
  ds_read_b64_tr_b16 a[116:117], v24 offset:40960
  v_mfma_f32_16x16x32_bf16 v[164:167], a[80:83], a[36:39], v[164:167]
  buffer_load_dwordx4 v34, s[36:39], s33 offen offset:2048 lds
  v_mfma_f32_16x16x32_bf16 v[168:171], a[80:83], a[40:43], v[168:171]
  v_mfma_f32_16x16x32_bf16 v[168:171], a[84:87], a[56:59], v[168:171]
  ds_read_b64_tr_b16 a[118:119], v24 offset:41984
  v_mfma_f32_16x16x32_bf16 v[172:175], a[84:87], a[60:63], v[172:175]
  ds_read_b64_tr_b16 a[120:121], v25 offset:32768
  v_mfma_f32_16x16x32_bf16 v[172:175], a[80:83], a[44:47], v[172:175]
  ds_read_b64_tr_b16 a[122:123], v25 offset:33792
  v_mfma_f32_16x16x32_bf16 v[188:191], a[88:91], a[44:47], v[188:191]
  buffer_load_dwordx4 v35, s[36:39], s33 offen offset:3072 lds
  v_mfma_f32_16x16x32_bf16 v[188:191], a[92:95], a[60:63], v[188:191]
  ds_read_b64_tr_b16 a[124:125], v25 offset:40960
  v_mfma_f32_16x16x32_bf16 v[184:187], a[92:95], a[56:59], v[184:187]
  ds_read_b64_tr_b16 a[126:127], v25 offset:41984
  v_mfma_f32_16x16x32_bf16 v[184:187], a[88:91], a[40:43], v[184:187]
  v_mfma_f32_16x16x32_bf16 v[180:183], a[88:91], a[36:39], v[180:183]
  v_mfma_f32_16x16x32_bf16 v[180:183], a[92:95], a[52:55], v[180:183]
  v_mfma_f32_16x16x32_bf16 v[176:179], a[92:95], a[48:51], v[176:179]
  s_add_u32 s32, s32, 128
  v_mfma_f32_16x16x32_bf16 v[176:179], a[88:91], a[32:35], v[176:179]
  s_add_u32 s33, s33, 524288
  s_waitcnt lgkmcnt(0) vmcnt(12)
  s_barrier
  v_mfma_f32_16x16x32_bf16 v[192:195], a[96:99], a[32:35], v[192:195]
  s_add_u32 m0, s28, 65536
  ds_read_b64_tr_b16 a[64:65], v18 offset:0
  v_mfma_f32_16x16x32_bf16 v[192:195], a[100:103], a[48:51], v[192:195]
  buffer_load_dwordx4 v2, s[8:11], s32 offen offset:0 lds
  v_mfma_f32_16x16x32_bf16 v[196:199], a[100:103], a[52:55], v[196:199]
  ds_read_b64_tr_b16 a[66:67], v18 offset:1024
  v_mfma_f32_16x16x32_bf16 v[196:199], a[96:99], a[36:39], v[196:199]
  ds_read_b64_tr_b16 a[68:69], v18 offset:8192
  v_mfma_f32_16x16x32_bf16 v[200:203], a[96:99], a[40:43], v[200:203]
  ds_read_b64_tr_b16 a[70:71], v18 offset:9216
  v_mfma_f32_16x16x32_bf16 v[200:203], a[100:103], a[56:59], v[200:203]
  ds_read_b128 a[0:3], v14 offset:0
  v_mfma_f32_16x16x32_bf16 v[204:207], a[100:103], a[60:63], v[204:207]
  buffer_load_dwordx4 v3, s[8:11], s32 offen offset:1024 lds
  v_mfma_f32_16x16x32_bf16 v[204:207], a[96:99], a[44:47], v[204:207]
  ds_read_b128 a[16:19], v15 offset:0
  ds_read_b128 a[4:7], v14 offset:2048
  v_mfma_f32_16x16x32_bf16 v[220:223], a[104:107], a[44:47], v[220:223]
  ds_read_b128 a[20:23], v15 offset:2048
  v_mfma_f32_16x16x32_bf16 v[220:223], a[108:111], a[60:63], v[220:223]
  ds_read_b128 a[8:11], v14 offset:4096
  v_mfma_f32_16x16x32_bf16 v[216:219], a[108:111], a[56:59], v[216:219]
  buffer_load_dwordx4 v4, s[8:11], s32 offen offset:2048 lds
  v_mfma_f32_16x16x32_bf16 v[216:219], a[104:107], a[40:43], v[216:219]
  ds_read_b128 a[24:27], v15 offset:4096
  v_mfma_f32_16x16x32_bf16 v[212:215], a[104:107], a[36:39], v[212:215]
  ds_read_b128 a[12:15], v14 offset:6144
  v_mfma_f32_16x16x32_bf16 v[212:215], a[108:111], a[52:55], v[212:215]
  ds_read_b128 a[28:31], v15 offset:6144
  v_mfma_f32_16x16x32_bf16 v[208:211], a[108:111], a[48:51], v[208:211]
  ds_read_b64_tr_b16 a[72:73], v19 offset:0
  buffer_load_dwordx4 v5, s[8:11], s32 offen offset:3072 lds
  v_mfma_f32_16x16x32_bf16 v[208:211], a[104:107], a[32:35], v[208:211]
  ds_read_b64_tr_b16 a[74:75], v19 offset:1024
  v_mfma_f32_16x16x32_bf16 v[224:227], a[112:115], a[32:35], v[224:227]
  ds_read_b64_tr_b16 a[76:77], v19 offset:8192
  v_mfma_f32_16x16x32_bf16 v[224:227], a[116:119], a[48:51], v[224:227]
  ds_read_b64_tr_b16 a[78:79], v19 offset:9216
  v_mfma_f32_16x16x32_bf16 v[228:231], a[116:119], a[52:55], v[228:231]
  s_add_u32 m0, s28, 69632
  v_mfma_f32_16x16x32_bf16 v[228:231], a[112:115], a[36:39], v[228:231]
  ds_read_b64_tr_b16 a[80:81], v20 offset:0
  v_mfma_f32_16x16x32_bf16 v[232:235], a[112:115], a[40:43], v[232:235]
  buffer_load_dwordx4 v6, s[8:11], s32 offen offset:0 lds
  v_mfma_f32_16x16x32_bf16 v[232:235], a[116:119], a[56:59], v[232:235]
  ds_read_b64_tr_b16 a[82:83], v20 offset:1024
  ds_read_b64_tr_b16 a[84:85], v20 offset:8192
  v_mfma_f32_16x16x32_bf16 v[236:239], a[116:119], a[60:63], v[236:239]
  ds_read_b64_tr_b16 a[86:87], v20 offset:9216
  v_mfma_f32_16x16x32_bf16 v[236:239], a[112:115], a[44:47], v[236:239]
  ds_read_b64_tr_b16 a[88:89], v21 offset:0
  v_mfma_f32_16x16x32_bf16 v[252:255], a[120:123], a[44:47], v[252:255]
  buffer_load_dwordx4 v7, s[8:11], s32 offen offset:1024 lds
  v_mfma_f32_16x16x32_bf16 v[252:255], a[124:127], a[60:63], v[252:255]
  ds_read_b64_tr_b16 a[90:91], v21 offset:1024
  v_mfma_f32_16x16x32_bf16 v[248:251], a[124:127], a[56:59], v[248:251]
  ds_read_b64_tr_b16 a[92:93], v21 offset:8192
  v_mfma_f32_16x16x32_bf16 v[248:251], a[120:123], a[40:43], v[248:251]
  ds_read_b64_tr_b16 a[94:95], v21 offset:9216
  v_mfma_f32_16x16x32_bf16 v[244:247], a[120:123], a[36:39], v[244:247]
  v_mfma_f32_16x16x32_bf16 v[244:247], a[124:127], a[52:55], v[244:247]
  v_mfma_f32_16x16x32_bf16 v[240:243], a[124:127], a[48:51], v[240:243]
  v_mfma_f32_16x16x32_bf16 v[240:243], a[120:123], a[32:35], v[240:243]
  s_waitcnt lgkmcnt(0)
  v_mfma_f32_16x16x32_bf16 v[128:131], a[64:67], a[0:3], v[128:131]
  s_add_u32 m0, s28, 69632
  v_mfma_f32_16x16x32_bf16 v[128:131], a[68:71], a[16:19], v[128:131]
  ds_read_b64_tr_b16 a[96:97], v22 offset:0
  v_mfma_f32_16x16x32_bf16 v[132:135], a[68:71], a[20:23], v[132:135]
  buffer_load_dwordx4 v8, s[8:11], s32 offen offset:2048 lds
  v_mfma_f32_16x16x32_bf16 v[132:135], a[64:67], a[4:7], v[132:135]
  ds_read_b64_tr_b16 a[98:99], v22 offset:1024
  v_mfma_f32_16x16x32_bf16 v[136:139], a[64:67], a[8:11], v[136:139]
  ds_read_b64_tr_b16 a[100:101], v22 offset:8192
  v_mfma_f32_16x16x32_bf16 v[136:139], a[68:71], a[24:27], v[136:139]
  buffer_load_dwordx4 v9, s[8:11], s32 offen offset:3072 lds
  v_mfma_f32_16x16x32_bf16 v[140:143], a[68:71], a[28:31], v[140:143]
  v_mfma_f32_16x16x32_bf16 v[140:143], a[64:67], a[12:15], v[140:143]
  ds_read_b64_tr_b16 a[102:103], v22 offset:9216
  v_mfma_f32_16x16x32_bf16 v[156:159], a[72:75], a[12:15], v[156:159]
  ds_read_b64_tr_b16 a[104:105], v23 offset:0
  v_mfma_f32_16x16x32_bf16 v[156:159], a[76:79], a[28:31], v[156:159]
  s_add_u32 m0, s29, 32768
  v_mfma_f32_16x16x32_bf16 v[152:155], a[76:79], a[24:27], v[152:155]
  ds_read_b64_tr_b16 a[106:107], v23 offset:1024
  v_mfma_f32_16x16x32_bf16 v[152:155], a[72:75], a[8:11], v[152:155]
  buffer_load_dwordx4 v32, s[36:39], s33 offen offset:0 lds
  v_mfma_f32_16x16x32_bf16 v[148:151], a[72:75], a[4:7], v[148:151]
  ds_read_b64_tr_b16 a[108:109], v23 offset:8192
  v_mfma_f32_16x16x32_bf16 v[148:151], a[76:79], a[20:23], v[148:151]
  v_mfma_f32_16x16x32_bf16 v[144:147], a[76:79], a[16:19], v[144:147]
  ds_read_b64_tr_b16 a[110:111], v23 offset:9216
  v_mfma_f32_16x16x32_bf16 v[144:147], a[72:75], a[0:3], v[144:147]
  ds_read_b64_tr_b16 a[112:113], v24 offset:0
  v_mfma_f32_16x16x32_bf16 v[160:163], a[80:83], a[0:3], v[160:163]
  buffer_load_dwordx4 v33, s[36:39], s33 offen offset:1024 lds
  v_mfma_f32_16x16x32_bf16 v[160:163], a[84:87], a[16:19], v[160:163]
  ds_read_b64_tr_b16 a[114:115], v24 offset:1024
  v_mfma_f32_16x16x32_bf16 v[164:167], a[84:87], a[20:23], v[164:167]
  ds_read_b64_tr_b16 a[116:117], v24 offset:8192
  v_mfma_f32_16x16x32_bf16 v[164:167], a[80:83], a[4:7], v[164:167]
  buffer_load_dwordx4 v34, s[36:39], s33 offen offset:2048 lds
  v_mfma_f32_16x16x32_bf16 v[168:171], a[80:83], a[8:11], v[168:171]
  v_mfma_f32_16x16x32_bf16 v[168:171], a[84:87], a[24:27], v[168:171]
  ds_read_b64_tr_b16 a[118:119], v24 offset:9216
  v_mfma_f32_16x16x32_bf16 v[172:175], a[84:87], a[28:31], v[172:175]
  ds_read_b64_tr_b16 a[120:121], v25 offset:0
  v_mfma_f32_16x16x32_bf16 v[172:175], a[80:83], a[12:15], v[172:175]
  ds_read_b64_tr_b16 a[122:123], v25 offset:1024
  v_mfma_f32_16x16x32_bf16 v[188:191], a[88:91], a[12:15], v[188:191]
  buffer_load_dwordx4 v35, s[36:39], s33 offen offset:3072 lds
  v_mfma_f32_16x16x32_bf16 v[188:191], a[92:95], a[28:31], v[188:191]
  ds_read_b64_tr_b16 a[124:125], v25 offset:8192
  v_mfma_f32_16x16x32_bf16 v[184:187], a[92:95], a[24:27], v[184:187]
  ds_read_b64_tr_b16 a[126:127], v25 offset:9216
  v_mfma_f32_16x16x32_bf16 v[184:187], a[88:91], a[8:11], v[184:187]
  v_mfma_f32_16x16x32_bf16 v[180:183], a[88:91], a[4:7], v[180:183]
  v_mfma_f32_16x16x32_bf16 v[180:183], a[92:95], a[20:23], v[180:183]
  v_mfma_f32_16x16x32_bf16 v[176:179], a[92:95], a[16:19], v[176:179]
  s_add_u32 s32, s32, 128
  v_mfma_f32_16x16x32_bf16 v[176:179], a[88:91], a[0:3], v[176:179]
  s_add_u32 s33, s33, 524288
  s_waitcnt lgkmcnt(0) vmcnt(12)
  s_barrier
  v_mfma_f32_16x16x32_bf16 v[192:195], a[96:99], a[0:3], v[192:195]
  s_add_u32 m0, s28, 0
  ds_read_b64_tr_b16 a[64:65], v18 offset:16384
  v_mfma_f32_16x16x32_bf16 v[192:195], a[100:103], a[16:19], v[192:195]
  buffer_load_dwordx4 v2, s[8:11], s32 offen offset:0 lds
  v_mfma_f32_16x16x32_bf16 v[196:199], a[100:103], a[20:23], v[196:199]
  ds_read_b64_tr_b16 a[66:67], v18 offset:17408
  v_mfma_f32_16x16x32_bf16 v[196:199], a[96:99], a[4:7], v[196:199]
  ds_read_b64_tr_b16 a[68:69], v18 offset:24576
  v_mfma_f32_16x16x32_bf16 v[200:203], a[96:99], a[8:11], v[200:203]
  ds_read_b64_tr_b16 a[70:71], v18 offset:25600
  v_mfma_f32_16x16x32_bf16 v[200:203], a[100:103], a[24:27], v[200:203]
  ds_read_b128 a[32:35], v14 offset:32768
  v_mfma_f32_16x16x32_bf16 v[204:207], a[100:103], a[28:31], v[204:207]
  buffer_load_dwordx4 v3, s[8:11], s32 offen offset:1024 lds
  v_mfma_f32_16x16x32_bf16 v[204:207], a[96:99], a[12:15], v[204:207]
  ds_read_b128 a[48:51], v15 offset:32768
  ds_read_b128 a[36:39], v14 offset:34816
  v_mfma_f32_16x16x32_bf16 v[220:223], a[104:107], a[12:15], v[220:223]
  ds_read_b128 a[52:55], v15 offset:34816
  v_mfma_f32_16x16x32_bf16 v[220:223], a[108:111], a[28:31], v[220:223]
  ds_read_b128 a[40:43], v14 offset:36864
  v_mfma_f32_16x16x32_bf16 v[216:219], a[108:111], a[24:27], v[216:219]
  buffer_load_dwordx4 v4, s[8:11], s32 offen offset:2048 lds
  v_mfma_f32_16x16x32_bf16 v[216:219], a[104:107], a[8:11], v[216:219]
  ds_read_b128 a[56:59], v15 offset:36864
  v_mfma_f32_16x16x32_bf16 v[212:215], a[104:107], a[4:7], v[212:215]
  ds_read_b128 a[44:47], v14 offset:38912
  v_mfma_f32_16x16x32_bf16 v[212:215], a[108:111], a[20:23], v[212:215]
  ds_read_b128 a[60:63], v15 offset:38912
  v_mfma_f32_16x16x32_bf16 v[208:211], a[108:111], a[16:19], v[208:211]
  ds_read_b64_tr_b16 a[72:73], v19 offset:16384
  buffer_load_dwordx4 v5, s[8:11], s32 offen offset:3072 lds
  v_mfma_f32_16x16x32_bf16 v[208:211], a[104:107], a[0:3], v[208:211]
  ds_read_b64_tr_b16 a[74:75], v19 offset:17408
  v_mfma_f32_16x16x32_bf16 v[224:227], a[112:115], a[0:3], v[224:227]
  ds_read_b64_tr_b16 a[76:77], v19 offset:24576
  v_mfma_f32_16x16x32_bf16 v[224:227], a[116:119], a[16:19], v[224:227]
  ds_read_b64_tr_b16 a[78:79], v19 offset:25600
  v_mfma_f32_16x16x32_bf16 v[228:231], a[116:119], a[20:23], v[228:231]
  s_add_u32 m0, s28, 4096
  v_mfma_f32_16x16x32_bf16 v[228:231], a[112:115], a[4:7], v[228:231]
  ds_read_b64_tr_b16 a[80:81], v20 offset:16384
  v_mfma_f32_16x16x32_bf16 v[232:235], a[112:115], a[8:11], v[232:235]
  buffer_load_dwordx4 v6, s[8:11], s32 offen offset:0 lds
  v_mfma_f32_16x16x32_bf16 v[232:235], a[116:119], a[24:27], v[232:235]
  ds_read_b64_tr_b16 a[82:83], v20 offset:17408
  ds_read_b64_tr_b16 a[84:85], v20 offset:24576
  v_mfma_f32_16x16x32_bf16 v[236:239], a[116:119], a[28:31], v[236:239]
  ds_read_b64_tr_b16 a[86:87], v20 offset:25600
  v_mfma_f32_16x16x32_bf16 v[236:239], a[112:115], a[12:15], v[236:239]
  ds_read_b64_tr_b16 a[88:89], v21 offset:16384
  v_mfma_f32_16x16x32_bf16 v[252:255], a[120:123], a[12:15], v[252:255]
  buffer_load_dwordx4 v7, s[8:11], s32 offen offset:1024 lds
  v_mfma_f32_16x16x32_bf16 v[252:255], a[124:127], a[28:31], v[252:255]
  ds_read_b64_tr_b16 a[90:91], v21 offset:17408
  v_mfma_f32_16x16x32_bf16 v[248:251], a[124:127], a[24:27], v[248:251]
  ds_read_b64_tr_b16 a[92:93], v21 offset:24576
  v_mfma_f32_16x16x32_bf16 v[248:251], a[120:123], a[8:11], v[248:251]
  ds_read_b64_tr_b16 a[94:95], v21 offset:25600
  v_mfma_f32_16x16x32_bf16 v[244:247], a[120:123], a[4:7], v[244:247]
  v_mfma_f32_16x16x32_bf16 v[244:247], a[124:127], a[20:23], v[244:247]
  v_mfma_f32_16x16x32_bf16 v[240:243], a[124:127], a[16:19], v[240:243]
  v_mfma_f32_16x16x32_bf16 v[240:243], a[120:123], a[0:3], v[240:243]
  s_waitcnt lgkmcnt(0)
  v_mfma_f32_16x16x32_bf16 v[128:131], a[64:67], a[32:35], v[128:131]
  s_add_u32 m0, s28, 4096
  v_mfma_f32_16x16x32_bf16 v[128:131], a[68:71], a[48:51], v[128:131]
  ds_read_b64_tr_b16 a[96:97], v22 offset:16384
  v_mfma_f32_16x16x32_bf16 v[132:135], a[68:71], a[52:55], v[132:135]
  buffer_load_dwordx4 v8, s[8:11], s32 offen offset:2048 lds
  v_mfma_f32_16x16x32_bf16 v[132:135], a[64:67], a[36:39], v[132:135]
  ds_read_b64_tr_b16 a[98:99], v22 offset:17408
  v_mfma_f32_16x16x32_bf16 v[136:139], a[64:67], a[40:43], v[136:139]
  ds_read_b64_tr_b16 a[100:101], v22 offset:24576
  v_mfma_f32_16x16x32_bf16 v[136:139], a[68:71], a[56:59], v[136:139]
  buffer_load_dwordx4 v9, s[8:11], s32 offen offset:3072 lds
  v_mfma_f32_16x16x32_bf16 v[140:143], a[68:71], a[60:63], v[140:143]
  v_mfma_f32_16x16x32_bf16 v[140:143], a[64:67], a[44:47], v[140:143]
  ds_read_b64_tr_b16 a[102:103], v22 offset:25600
  v_mfma_f32_16x16x32_bf16 v[156:159], a[72:75], a[44:47], v[156:159]
  ds_read_b64_tr_b16 a[104:105], v23 offset:16384
  v_mfma_f32_16x16x32_bf16 v[156:159], a[76:79], a[60:63], v[156:159]
  s_add_u32 m0, s29, 0
  v_mfma_f32_16x16x32_bf16 v[152:155], a[76:79], a[56:59], v[152:155]
  ds_read_b64_tr_b16 a[106:107], v23 offset:17408
  v_mfma_f32_16x16x32_bf16 v[152:155], a[72:75], a[40:43], v[152:155]
  buffer_load_dwordx4 v32, s[36:39], s33 offen offset:0 lds
  v_mfma_f32_16x16x32_bf16 v[148:151], a[72:75], a[36:39], v[148:151]
  ds_read_b64_tr_b16 a[108:109], v23 offset:24576
  v_mfma_f32_16x16x32_bf16 v[148:151], a[76:79], a[52:55], v[148:151]
  v_mfma_f32_16x16x32_bf16 v[144:147], a[76:79], a[48:51], v[144:147]
  ds_read_b64_tr_b16 a[110:111], v23 offset:25600
  v_mfma_f32_16x16x32_bf16 v[144:147], a[72:75], a[32:35], v[144:147]
  ds_read_b64_tr_b16 a[112:113], v24 offset:16384
  v_mfma_f32_16x16x32_bf16 v[160:163], a[80:83], a[32:35], v[160:163]
  buffer_load_dwordx4 v33, s[36:39], s33 offen offset:1024 lds
  v_mfma_f32_16x16x32_bf16 v[160:163], a[84:87], a[48:51], v[160:163]
  ds_read_b64_tr_b16 a[114:115], v24 offset:17408
  v_mfma_f32_16x16x32_bf16 v[164:167], a[84:87], a[52:55], v[164:167]
  ds_read_b64_tr_b16 a[116:117], v24 offset:24576
  v_mfma_f32_16x16x32_bf16 v[164:167], a[80:83], a[36:39], v[164:167]
  buffer_load_dwordx4 v34, s[36:39], s33 offen offset:2048 lds
  v_mfma_f32_16x16x32_bf16 v[168:171], a[80:83], a[40:43], v[168:171]
  v_mfma_f32_16x16x32_bf16 v[168:171], a[84:87], a[56:59], v[168:171]
  ds_read_b64_tr_b16 a[118:119], v24 offset:25600
  v_mfma_f32_16x16x32_bf16 v[172:175], a[84:87], a[60:63], v[172:175]
  ds_read_b64_tr_b16 a[120:121], v25 offset:16384
  v_mfma_f32_16x16x32_bf16 v[172:175], a[80:83], a[44:47], v[172:175]
  ds_read_b64_tr_b16 a[122:123], v25 offset:17408
  v_mfma_f32_16x16x32_bf16 v[188:191], a[88:91], a[44:47], v[188:191]
  buffer_load_dwordx4 v35, s[36:39], s33 offen offset:3072 lds
  v_mfma_f32_16x16x32_bf16 v[188:191], a[92:95], a[60:63], v[188:191]
  ds_read_b64_tr_b16 a[124:125], v25 offset:24576
  v_mfma_f32_16x16x32_bf16 v[184:187], a[92:95], a[56:59], v[184:187]
  ds_read_b64_tr_b16 a[126:127], v25 offset:25600
  v_mfma_f32_16x16x32_bf16 v[184:187], a[88:91], a[40:43], v[184:187]
  v_mfma_f32_16x16x32_bf16 v[180:183], a[88:91], a[36:39], v[180:183]
  v_mfma_f32_16x16x32_bf16 v[180:183], a[92:95], a[52:55], v[180:183]
  v_mfma_f32_16x16x32_bf16 v[176:179], a[92:95], a[48:51], v[176:179]
  s_add_u32 s32, s32, 128
  v_mfma_f32_16x16x32_bf16 v[176:179], a[88:91], a[32:35], v[176:179]
  s_add_u32 s33, s33, 524288
  s_waitcnt lgkmcnt(0) vmcnt(12)
  s_barrier
  v_mfma_f32_16x16x32_bf16 v[192:195], a[96:99], a[32:35], v[192:195]
  s_add_u32 m0, s28, 32768
  ds_read_b64_tr_b16 a[64:65], v18 offset:32768
  v_mfma_f32_16x16x32_bf16 v[192:195], a[100:103], a[48:51], v[192:195]
  buffer_load_dwordx4 v2, s[8:11], s32 offen offset:0 lds
  v_mfma_f32_16x16x32_bf16 v[196:199], a[100:103], a[52:55], v[196:199]
  ds_read_b64_tr_b16 a[66:67], v18 offset:33792
  v_mfma_f32_16x16x32_bf16 v[196:199], a[96:99], a[36:39], v[196:199]
  ds_read_b64_tr_b16 a[68:69], v18 offset:40960
  v_mfma_f32_16x16x32_bf16 v[200:203], a[96:99], a[40:43], v[200:203]
  ds_read_b64_tr_b16 a[70:71], v18 offset:41984
  v_mfma_f32_16x16x32_bf16 v[200:203], a[100:103], a[56:59], v[200:203]
  ds_read_b128 a[0:3], v16 offset:0
  v_mfma_f32_16x16x32_bf16 v[204:207], a[100:103], a[60:63], v[204:207]
  buffer_load_dwordx4 v3, s[8:11], s32 offen offset:1024 lds
  v_mfma_f32_16x16x32_bf16 v[204:207], a[96:99], a[44:47], v[204:207]
  ds_read_b128 a[16:19], v17 offset:0
  ds_read_b128 a[4:7], v16 offset:2048
  v_mfma_f32_16x16x32_bf16 v[220:223], a[104:107], a[44:47], v[220:223]
  ds_read_b128 a[20:23], v17 offset:2048
  v_mfma_f32_16x16x32_bf16 v[220:223], a[108:111], a[60:63], v[220:223]
  ds_read_b128 a[8:11], v16 offset:4096
  v_mfma_f32_16x16x32_bf16 v[216:219], a[108:111], a[56:59], v[216:219]
  buffer_load_dwordx4 v4, s[8:11], s32 offen offset:2048 lds
  v_mfma_f32_16x16x32_bf16 v[216:219], a[104:107], a[40:43], v[216:219]
  ds_read_b128 a[24:27], v17 offset:4096
  v_mfma_f32_16x16x32_bf16 v[212:215], a[104:107], a[36:39], v[212:215]
  ds_read_b128 a[12:15], v16 offset:6144
  v_mfma_f32_16x16x32_bf16 v[212:215], a[108:111], a[52:55], v[212:215]
  ds_read_b128 a[28:31], v17 offset:6144
  v_mfma_f32_16x16x32_bf16 v[208:211], a[108:111], a[48:51], v[208:211]
  ds_read_b64_tr_b16 a[72:73], v19 offset:32768
  buffer_load_dwordx4 v5, s[8:11], s32 offen offset:3072 lds
  v_mfma_f32_16x16x32_bf16 v[208:211], a[104:107], a[32:35], v[208:211]
  ds_read_b64_tr_b16 a[74:75], v19 offset:33792
  v_mfma_f32_16x16x32_bf16 v[224:227], a[112:115], a[32:35], v[224:227]
  ds_read_b64_tr_b16 a[76:77], v19 offset:40960
  v_mfma_f32_16x16x32_bf16 v[224:227], a[116:119], a[48:51], v[224:227]
  ds_read_b64_tr_b16 a[78:79], v19 offset:41984
  v_mfma_f32_16x16x32_bf16 v[228:231], a[116:119], a[52:55], v[228:231]
  s_add_u32 m0, s28, 36864
  v_mfma_f32_16x16x32_bf16 v[228:231], a[112:115], a[36:39], v[228:231]
  ds_read_b64_tr_b16 a[80:81], v20 offset:32768
  v_mfma_f32_16x16x32_bf16 v[232:235], a[112:115], a[40:43], v[232:235]
  buffer_load_dwordx4 v6, s[8:11], s32 offen offset:0 lds
  v_mfma_f32_16x16x32_bf16 v[232:235], a[116:119], a[56:59], v[232:235]
  ds_read_b64_tr_b16 a[82:83], v20 offset:33792
  ds_read_b64_tr_b16 a[84:85], v20 offset:40960
  v_mfma_f32_16x16x32_bf16 v[236:239], a[116:119], a[60:63], v[236:239]
  ds_read_b64_tr_b16 a[86:87], v20 offset:41984
  v_mfma_f32_16x16x32_bf16 v[236:239], a[112:115], a[44:47], v[236:239]
  ds_read_b64_tr_b16 a[88:89], v21 offset:32768
  v_mfma_f32_16x16x32_bf16 v[252:255], a[120:123], a[44:47], v[252:255]
  buffer_load_dwordx4 v7, s[8:11], s32 offen offset:1024 lds
  v_mfma_f32_16x16x32_bf16 v[252:255], a[124:127], a[60:63], v[252:255]
  ds_read_b64_tr_b16 a[90:91], v21 offset:33792
  v_mfma_f32_16x16x32_bf16 v[248:251], a[124:127], a[56:59], v[248:251]
  ds_read_b64_tr_b16 a[92:93], v21 offset:40960
  v_mfma_f32_16x16x32_bf16 v[248:251], a[120:123], a[40:43], v[248:251]
  ds_read_b64_tr_b16 a[94:95], v21 offset:41984
  v_mfma_f32_16x16x32_bf16 v[244:247], a[120:123], a[36:39], v[244:247]
  v_mfma_f32_16x16x32_bf16 v[244:247], a[124:127], a[52:55], v[244:247]
  v_mfma_f32_16x16x32_bf16 v[240:243], a[124:127], a[48:51], v[240:243]
  v_mfma_f32_16x16x32_bf16 v[240:243], a[120:123], a[32:35], v[240:243]
  s_waitcnt lgkmcnt(0)
  v_mfma_f32_16x16x32_bf16 v[128:131], a[64:67], a[0:3], v[128:131]
  s_add_u32 m0, s28, 36864
  v_mfma_f32_16x16x32_bf16 v[128:131], a[68:71], a[16:19], v[128:131]
  ds_read_b64_tr_b16 a[96:97], v22 offset:32768
  v_mfma_f32_16x16x32_bf16 v[132:135], a[68:71], a[20:23], v[132:135]
  buffer_load_dwordx4 v8, s[8:11], s32 offen offset:2048 lds
  v_mfma_f32_16x16x32_bf16 v[132:135], a[64:67], a[4:7], v[132:135]
  ds_read_b64_tr_b16 a[98:99], v22 offset:33792
  v_mfma_f32_16x16x32_bf16 v[136:139], a[64:67], a[8:11], v[136:139]
  ds_read_b64_tr_b16 a[100:101], v22 offset:40960
  v_mfma_f32_16x16x32_bf16 v[136:139], a[68:71], a[24:27], v[136:139]
  buffer_load_dwordx4 v9, s[8:11], s32 offen offset:3072 lds
  v_mfma_f32_16x16x32_bf16 v[140:143], a[68:71], a[28:31], v[140:143]
  v_mfma_f32_16x16x32_bf16 v[140:143], a[64:67], a[12:15], v[140:143]
  ds_read_b64_tr_b16 a[102:103], v22 offset:41984
  v_mfma_f32_16x16x32_bf16 v[156:159], a[72:75], a[12:15], v[156:159]
  ds_read_b64_tr_b16 a[104:105], v23 offset:32768
  v_mfma_f32_16x16x32_bf16 v[156:159], a[76:79], a[28:31], v[156:159]
  s_add_u32 m0, s29, 16384
  v_mfma_f32_16x16x32_bf16 v[152:155], a[76:79], a[24:27], v[152:155]
  ds_read_b64_tr_b16 a[106:107], v23 offset:33792
  v_mfma_f32_16x16x32_bf16 v[152:155], a[72:75], a[8:11], v[152:155]
  buffer_load_dwordx4 v32, s[36:39], s33 offen offset:0 lds
  v_mfma_f32_16x16x32_bf16 v[148:151], a[72:75], a[4:7], v[148:151]
  ds_read_b64_tr_b16 a[108:109], v23 offset:40960
  v_mfma_f32_16x16x32_bf16 v[148:151], a[76:79], a[20:23], v[148:151]
  v_mfma_f32_16x16x32_bf16 v[144:147], a[76:79], a[16:19], v[144:147]
  ds_read_b64_tr_b16 a[110:111], v23 offset:41984
  v_mfma_f32_16x16x32_bf16 v[144:147], a[72:75], a[0:3], v[144:147]
  ds_read_b64_tr_b16 a[112:113], v24 offset:32768
  v_mfma_f32_16x16x32_bf16 v[160:163], a[80:83], a[0:3], v[160:163]
  buffer_load_dwordx4 v33, s[36:39], s33 offen offset:1024 lds
  v_mfma_f32_16x16x32_bf16 v[160:163], a[84:87], a[16:19], v[160:163]
  ds_read_b64_tr_b16 a[114:115], v24 offset:33792
  v_mfma_f32_16x16x32_bf16 v[164:167], a[84:87], a[20:23], v[164:167]
  ds_read_b64_tr_b16 a[116:117], v24 offset:40960
  v_mfma_f32_16x16x32_bf16 v[164:167], a[80:83], a[4:7], v[164:167]
  buffer_load_dwordx4 v34, s[36:39], s33 offen offset:2048 lds
  v_mfma_f32_16x16x32_bf16 v[168:171], a[80:83], a[8:11], v[168:171]
  v_mfma_f32_16x16x32_bf16 v[168:171], a[84:87], a[24:27], v[168:171]
  ds_read_b64_tr_b16 a[118:119], v24 offset:41984
  v_mfma_f32_16x16x32_bf16 v[172:175], a[84:87], a[28:31], v[172:175]
  ds_read_b64_tr_b16 a[120:121], v25 offset:32768
  v_mfma_f32_16x16x32_bf16 v[172:175], a[80:83], a[12:15], v[172:175]
  ds_read_b64_tr_b16 a[122:123], v25 offset:33792
  v_mfma_f32_16x16x32_bf16 v[188:191], a[88:91], a[12:15], v[188:191]
  buffer_load_dwordx4 v35, s[36:39], s33 offen offset:3072 lds
  v_mfma_f32_16x16x32_bf16 v[188:191], a[92:95], a[28:31], v[188:191]
  ds_read_b64_tr_b16 a[124:125], v25 offset:40960
  v_mfma_f32_16x16x32_bf16 v[184:187], a[92:95], a[24:27], v[184:187]
  ds_read_b64_tr_b16 a[126:127], v25 offset:41984
  v_mfma_f32_16x16x32_bf16 v[184:187], a[88:91], a[8:11], v[184:187]
  v_mfma_f32_16x16x32_bf16 v[180:183], a[88:91], a[4:7], v[180:183]
  v_mfma_f32_16x16x32_bf16 v[180:183], a[92:95], a[20:23], v[180:183]
  v_mfma_f32_16x16x32_bf16 v[176:179], a[92:95], a[16:19], v[176:179]
  s_add_u32 s32, s32, 128
  v_mfma_f32_16x16x32_bf16 v[176:179], a[88:91], a[0:3], v[176:179]
  s_add_u32 s33, s33, 524288
  s_waitcnt lgkmcnt(0) vmcnt(12)
  s_barrier
  v_mfma_f32_16x16x32_bf16 v[192:195], a[96:99], a[0:3], v[192:195]
  s_add_u32 m0, s28, 65536
  ds_read_b64_tr_b16 a[64:65], v18 offset:0
  v_mfma_f32_16x16x32_bf16 v[192:195], a[100:103], a[16:19], v[192:195]
  buffer_load_dwordx4 v2, s[8:11], s32 offen offset:0 lds
  v_mfma_f32_16x16x32_bf16 v[196:199], a[100:103], a[20:23], v[196:199]
  ds_read_b64_tr_b16 a[66:67], v18 offset:1024
  v_mfma_f32_16x16x32_bf16 v[196:199], a[96:99], a[4:7], v[196:199]
  ds_read_b64_tr_b16 a[68:69], v18 offset:8192
  v_mfma_f32_16x16x32_bf16 v[200:203], a[96:99], a[8:11], v[200:203]
  ds_read_b64_tr_b16 a[70:71], v18 offset:9216
  v_mfma_f32_16x16x32_bf16 v[200:203], a[100:103], a[24:27], v[200:203]
  ds_read_b128 a[32:35], v14 offset:0
  v_mfma_f32_16x16x32_bf16 v[204:207], a[100:103], a[28:31], v[204:207]
  buffer_load_dwordx4 v3, s[8:11], s32 offen offset:1024 lds
  v_mfma_f32_16x16x32_bf16 v[204:207], a[96:99], a[12:15], v[204:207]
  ds_read_b128 a[48:51], v15 offset:0
  ds_read_b128 a[36:39], v14 offset:2048
  v_mfma_f32_16x16x32_bf16 v[220:223], a[104:107], a[12:15], v[220:223]
  ds_read_b128 a[52:55], v15 offset:2048
  v_mfma_f32_16x16x32_bf16 v[220:223], a[108:111], a[28:31], v[220:223]
  ds_read_b128 a[40:43], v14 offset:4096
  v_mfma_f32_16x16x32_bf16 v[216:219], a[108:111], a[24:27], v[216:219]
  buffer_load_dwordx4 v4, s[8:11], s32 offen offset:2048 lds
  v_mfma_f32_16x16x32_bf16 v[216:219], a[104:107], a[8:11], v[216:219]
  ds_read_b128 a[56:59], v15 offset:4096
  v_mfma_f32_16x16x32_bf16 v[212:215], a[104:107], a[4:7], v[212:215]
  ds_read_b128 a[44:47], v14 offset:6144
  v_mfma_f32_16x16x32_bf16 v[212:215], a[108:111], a[20:23], v[212:215]
  ds_read_b128 a[60:63], v15 offset:6144
  v_mfma_f32_16x16x32_bf16 v[208:211], a[108:111], a[16:19], v[208:211]
  ds_read_b64_tr_b16 a[72:73], v19 offset:0
  buffer_load_dwordx4 v5, s[8:11], s32 offen offset:3072 lds
  v_mfma_f32_16x16x32_bf16 v[208:211], a[104:107], a[0:3], v[208:211]
  ds_read_b64_tr_b16 a[74:75], v19 offset:1024
  v_mfma_f32_16x16x32_bf16 v[224:227], a[112:115], a[0:3], v[224:227]
  ds_read_b64_tr_b16 a[76:77], v19 offset:8192
  v_mfma_f32_16x16x32_bf16 v[224:227], a[116:119], a[16:19], v[224:227]
  ds_read_b64_tr_b16 a[78:79], v19 offset:9216
  v_mfma_f32_16x16x32_bf16 v[228:231], a[116:119], a[20:23], v[228:231]
  s_add_u32 m0, s28, 69632
  v_mfma_f32_16x16x32_bf16 v[228:231], a[112:115], a[4:7], v[228:231]
  ds_read_b64_tr_b16 a[80:81], v20 offset:0
  v_mfma_f32_16x16x32_bf16 v[232:235], a[112:115], a[8:11], v[232:235]
  buffer_load_dwordx4 v6, s[8:11], s32 offen offset:0 lds
  v_mfma_f32_16x16x32_bf16 v[232:235], a[116:119], a[24:27], v[232:235]
  ds_read_b64_tr_b16 a[82:83], v20 offset:1024
  ds_read_b64_tr_b16 a[84:85], v20 offset:8192
  v_mfma_f32_16x16x32_bf16 v[236:239], a[116:119], a[28:31], v[236:239]
  ds_read_b64_tr_b16 a[86:87], v20 offset:9216
  v_mfma_f32_16x16x32_bf16 v[236:239], a[112:115], a[12:15], v[236:239]
  ds_read_b64_tr_b16 a[88:89], v21 offset:0
  v_mfma_f32_16x16x32_bf16 v[252:255], a[120:123], a[12:15], v[252:255]
  buffer_load_dwordx4 v7, s[8:11], s32 offen offset:1024 lds
  v_mfma_f32_16x16x32_bf16 v[252:255], a[124:127], a[28:31], v[252:255]
  ds_read_b64_tr_b16 a[90:91], v21 offset:1024
  v_mfma_f32_16x16x32_bf16 v[248:251], a[124:127], a[24:27], v[248:251]
  ds_read_b64_tr_b16 a[92:93], v21 offset:8192
  v_mfma_f32_16x16x32_bf16 v[248:251], a[120:123], a[8:11], v[248:251]
  ds_read_b64_tr_b16 a[94:95], v21 offset:9216
  v_mfma_f32_16x16x32_bf16 v[244:247], a[120:123], a[4:7], v[244:247]
  v_mfma_f32_16x16x32_bf16 v[244:247], a[124:127], a[20:23], v[244:247]
  v_mfma_f32_16x16x32_bf16 v[240:243], a[124:127], a[16:19], v[240:243]
  v_mfma_f32_16x16x32_bf16 v[240:243], a[120:123], a[0:3], v[240:243]
  s_waitcnt lgkmcnt(0)
  v_mfma_f32_16x16x32_bf16 v[128:131], a[64:67], a[32:35], v[128:131]
  s_add_u32 m0, s28, 69632
  v_mfma_f32_16x16x32_bf16 v[128:131], a[68:71], a[48:51], v[128:131]
  ds_read_b64_tr_b16 a[96:97], v22 offset:0
  v_mfma_f32_16x16x32_bf16 v[132:135], a[68:71], a[52:55], v[132:135]
  buffer_load_dwordx4 v8, s[8:11], s32 offen offset:2048 lds
  v_mfma_f32_16x16x32_bf16 v[132:135], a[64:67], a[36:39], v[132:135]
  ds_read_b64_tr_b16 a[98:99], v22 offset:1024
  v_mfma_f32_16x16x32_bf16 v[136:139], a[64:67], a[40:43], v[136:139]
  ds_read_b64_tr_b16 a[100:101], v22 offset:8192
  v_mfma_f32_16x16x32_bf16 v[136:139], a[68:71], a[56:59], v[136:139]
  buffer_load_dwordx4 v9, s[8:11], s32 offen offset:3072 lds
  v_mfma_f32_16x16x32_bf16 v[140:143], a[68:71], a[60:63], v[140:143]
  v_mfma_f32_16x16x32_bf16 v[140:143], a[64:67], a[44:47], v[140:143]
  ds_read_b64_tr_b16 a[102:103], v22 offset:9216
  v_mfma_f32_16x16x32_bf16 v[156:159], a[72:75], a[44:47], v[156:159]
  ds_read_b64_tr_b16 a[104:105], v23 offset:0
  v_mfma_f32_16x16x32_bf16 v[156:159], a[76:79], a[60:63], v[156:159]
  s_add_u32 m0, s29, 32768
  v_mfma_f32_16x16x32_bf16 v[152:155], a[76:79], a[56:59], v[152:155]
  ds_read_b64_tr_b16 a[106:107], v23 offset:1024
  v_mfma_f32_16x16x32_bf16 v[152:155], a[72:75], a[40:43], v[152:155]
  buffer_load_dwordx4 v32, s[36:39], s33 offen offset:0 lds
  v_mfma_f32_16x16x32_bf16 v[148:151], a[72:75], a[36:39], v[148:151]
  ds_read_b64_tr_b16 a[108:109], v23 offset:8192
  v_mfma_f32_16x16x32_bf16 v[148:151], a[76:79], a[52:55], v[148:151]
  v_mfma_f32_16x16x32_bf16 v[144:147], a[76:79], a[48:51], v[144:147]
  ds_read_b64_tr_b16 a[110:111], v23 offset:9216
  v_mfma_f32_16x16x32_bf16 v[144:147], a[72:75], a[32:35], v[144:147]
  ds_read_b64_tr_b16 a[112:113], v24 offset:0
  v_mfma_f32_16x16x32_bf16 v[160:163], a[80:83], a[32:35], v[160:163]
  buffer_load_dwordx4 v33, s[36:39], s33 offen offset:1024 lds
  v_mfma_f32_16x16x32_bf16 v[160:163], a[84:87], a[48:51], v[160:163]
  ds_read_b64_tr_b16 a[114:115], v24 offset:1024
  v_mfma_f32_16x16x32_bf16 v[164:167], a[84:87], a[52:55], v[164:167]
  ds_read_b64_tr_b16 a[116:117], v24 offset:8192
  v_mfma_f32_16x16x32_bf16 v[164:167], a[80:83], a[36:39], v[164:167]
  buffer_load_dwordx4 v34, s[36:39], s33 offen offset:2048 lds
  v_mfma_f32_16x16x32_bf16 v[168:171], a[80:83], a[40:43], v[168:171]
  v_mfma_f32_16x16x32_bf16 v[168:171], a[84:87], a[56:59], v[168:171]
  ds_read_b64_tr_b16 a[118:119], v24 offset:9216
  v_mfma_f32_16x16x32_bf16 v[172:175], a[84:87], a[60:63], v[172:175]
  ds_read_b64_tr_b16 a[120:121], v25 offset:0
  v_mfma_f32_16x16x32_bf16 v[172:175], a[80:83], a[44:47], v[172:175]
  ds_read_b64_tr_b16 a[122:123], v25 offset:1024
  v_mfma_f32_16x16x32_bf16 v[188:191], a[88:91], a[44:47], v[188:191]
  buffer_load_dwordx4 v35, s[36:39], s33 offen offset:3072 lds
  v_mfma_f32_16x16x32_bf16 v[188:191], a[92:95], a[60:63], v[188:191]
  ds_read_b64_tr_b16 a[124:125], v25 offset:8192
  v_mfma_f32_16x16x32_bf16 v[184:187], a[92:95], a[56:59], v[184:187]
  ds_read_b64_tr_b16 a[126:127], v25 offset:9216
  v_mfma_f32_16x16x32_bf16 v[184:187], a[88:91], a[40:43], v[184:187]
  v_mfma_f32_16x16x32_bf16 v[180:183], a[88:91], a[36:39], v[180:183]
  v_mfma_f32_16x16x32_bf16 v[180:183], a[92:95], a[52:55], v[180:183]
  v_mfma_f32_16x16x32_bf16 v[176:179], a[92:95], a[48:51], v[176:179]
  s_add_u32 s32, s32, 128
  v_mfma_f32_16x16x32_bf16 v[176:179], a[88:91], a[32:35], v[176:179]
  s_add_u32 s33, s33, 524288
  s_waitcnt lgkmcnt(0) vmcnt(12)
  s_barrier
  v_mfma_f32_16x16x32_bf16 v[192:195], a[96:99], a[32:35], v[192:195]
  s_add_u32 m0, s60, 0
  ds_read_b64_tr_b16 a[64:65], v18 offset:16384
  v_mfma_f32_16x16x32_bf16 v[192:195], a[100:103], a[48:51], v[192:195]
  buffer_load_dwordx4 v26, s[52:55], s50 offen lds
  v_mfma_f32_16x16x32_bf16 v[196:199], a[100:103], a[52:55], v[196:199]
  ds_read_b64_tr_b16 a[66:67], v18 offset:17408
  v_mfma_f32_16x16x32_bf16 v[196:199], a[96:99], a[36:39], v[196:199]
  ds_read_b64_tr_b16 a[68:69], v18 offset:24576
  v_mfma_f32_16x16x32_bf16 v[200:203], a[96:99], a[40:43], v[200:203]
  ds_read_b64_tr_b16 a[70:71], v18 offset:25600
  v_mfma_f32_16x16x32_bf16 v[200:203], a[100:103], a[56:59], v[200:203]
  ds_read_b128 a[0:3], v14 offset:32768
  v_mfma_f32_16x16x32_bf16 v[204:207], a[100:103], a[60:63], v[204:207]
  buffer_load_dwordx4 v27, s[52:55], s50 offen offset:1024 lds
  v_mfma_f32_16x16x32_bf16 v[204:207], a[96:99], a[44:47], v[204:207]
  ds_read_b128 a[16:19], v15 offset:32768
  v_mfma_f32_16x16x32_bf16 v[220:223], a[104:107], a[44:47], v[220:223]
  ds_read_b128 a[4:7], v14 offset:34816
  v_mfma_f32_16x16x32_bf16 v[220:223], a[108:111], a[60:63], v[220:223]
  ds_read_b128 a[20:23], v15 offset:34816
  v_mfma_f32_16x16x32_bf16 v[216:219], a[108:111], a[56:59], v[216:219]
  ds_read_b128 a[8:11], v14 offset:36864
  v_mfma_f32_16x16x32_bf16 v[216:219], a[104:107], a[40:43], v[216:219]
  ds_read_b128 a[24:27], v15 offset:36864
  v_mfma_f32_16x16x32_bf16 v[212:215], a[104:107], a[36:39], v[212:215]
  buffer_load_dwordx4 v28, s[52:55], s50 offen offset:2048 lds
  v_mfma_f32_16x16x32_bf16 v[212:215], a[108:111], a[52:55], v[212:215]
  ds_read_b128 a[12:15], v14 offset:38912
  v_mfma_f32_16x16x32_bf16 v[208:211], a[108:111], a[48:51], v[208:211]
  ds_read_b128 a[28:31], v15 offset:38912
  ds_read_b64_tr_b16 a[72:73], v19 offset:16384
  v_mfma_f32_16x16x32_bf16 v[208:211], a[104:107], a[32:35], v[208:211]
  ds_read_b64_tr_b16 a[74:75], v19 offset:17408
  v_mfma_f32_16x16x32_bf16 v[224:227], a[112:115], a[32:35], v[224:227]
  ds_read_b64_tr_b16 a[76:77], v19 offset:24576
  v_mfma_f32_16x16x32_bf16 v[224:227], a[116:119], a[48:51], v[224:227]
  buffer_load_dwordx4 v29, s[52:55], s50 offen offset:3072 lds
  v_mfma_f32_16x16x32_bf16 v[228:231], a[116:119], a[52:55], v[228:231]
  ds_read_b64_tr_b16 a[78:79], v19 offset:25600
  v_mfma_f32_16x16x32_bf16 v[228:231], a[112:115], a[36:39], v[228:231]
  ds_read_b64_tr_b16 a[80:81], v20 offset:16384
  v_mfma_f32_16x16x32_bf16 v[232:235], a[112:115], a[40:43], v[232:235]
  ds_read_b64_tr_b16 a[82:83], v20 offset:17408
  v_mfma_f32_16x16x32_bf16 v[232:235], a[116:119], a[56:59], v[232:235]
  ds_read_b64_tr_b16 a[84:85], v20 offset:24576
  v_mfma_f32_16x16x32_bf16 v[236:239], a[116:119], a[60:63], v[236:239]
  ds_read_b64_tr_b16 a[86:87], v20 offset:25600
  v_mfma_f32_16x16x32_bf16 v[236:239], a[112:115], a[44:47], v[236:239]
  s_add_u32 s50, s50, 16384
  v_mfma_f32_16x16x32_bf16 v[252:255], a[120:123], a[44:47], v[252:255]
  ds_read_b64_tr_b16 a[88:89], v21 offset:16384
  v_mfma_f32_16x16x32_bf16 v[252:255], a[124:127], a[60:63], v[252:255]
  ds_read_b64_tr_b16 a[90:91], v21 offset:17408
  v_mfma_f32_16x16x32_bf16 v[248:251], a[124:127], a[56:59], v[248:251]
  ds_read_b64_tr_b16 a[92:93], v21 offset:24576
  v_mfma_f32_16x16x32_bf16 v[248:251], a[120:123], a[40:43], v[248:251]
  ds_read_b64_tr_b16 a[94:95], v21 offset:25600
  v_mfma_f32_16x16x32_bf16 v[244:247], a[120:123], a[36:39], v[244:247]
  v_mfma_f32_16x16x32_bf16 v[244:247], a[124:127], a[52:55], v[244:247]
  v_mfma_f32_16x16x32_bf16 v[240:243], a[124:127], a[48:51], v[240:243]
  v_mfma_f32_16x16x32_bf16 v[240:243], a[120:123], a[32:35], v[240:243]
  s_waitcnt lgkmcnt(0)
  v_mfma_f32_16x16x32_bf16 v[128:131], a[64:67], a[0:3], v[128:131]
  s_add_u32 m0, s60, 16384
  v_mfma_f32_16x16x32_bf16 v[128:131], a[68:71], a[16:19], v[128:131]
  ds_read_b64_tr_b16 a[96:97], v22 offset:16384
  v_and_b32 v104, 63, v0
  v_mfma_f32_16x16x32_bf16 v[132:135], a[68:71], a[20:23], v[132:135]
  buffer_load_dwordx4 v26, s[52:55], s50 offen lds
  v_mfma_f32_16x16x32_bf16 v[132:135], a[64:67], a[4:7], v[132:135]
  ds_read_b64_tr_b16 a[98:99], v22 offset:17408
  v_and_b32 v100, 15, v104
  v_mfma_f32_16x16x32_bf16 v[136:139], a[64:67], a[8:11], v[136:139]
  v_mfma_f32_16x16x32_bf16 v[136:139], a[68:71], a[24:27], v[136:139]
  ds_read_b64_tr_b16 a[100:101], v22 offset:24576
  v_lshrrev_b32 v101, 4, v104
  v_mfma_f32_16x16x32_bf16 v[140:143], a[68:71], a[28:31], v[140:143]
  ds_read_b64_tr_b16 a[102:103], v22 offset:25600
  v_mfma_f32_16x16x32_bf16 v[140:143], a[64:67], a[12:15], v[140:143]
  buffer_load_dwordx4 v27, s[52:55], s50 offen offset:1024 lds
  v_add_u32 v102, 0, v101
  v_mfma_f32_16x16x32_bf16 v[156:159], a[72:75], a[12:15], v[156:159]
  ds_read_b64_tr_b16 a[104:105], v23 offset:16384
  v_mfma_f32_16x16x32_bf16 v[156:159], a[76:79], a[28:31], v[156:159]
  v_mfma_f32_16x16x32_bf16 v[152:155], a[76:79], a[24:27], v[152:155]
  ds_read_b64_tr_b16 a[106:107], v23 offset:17408
  v_xor_b32 v102, v102, v100
  v_mfma_f32_16x16x32_bf16 v[152:155], a[72:75], a[8:11], v[152:155]
  ds_read_b64_tr_b16 a[108:109], v23 offset:24576
  v_mfma_f32_16x16x32_bf16 v[148:151], a[72:75], a[4:7], v[148:151]
  buffer_load_dwordx4 v28, s[52:55], s50 offen offset:2048 lds
  v_lshlrev_b32 v102, 4, v102
  v_mfma_f32_16x16x32_bf16 v[148:151], a[76:79], a[20:23], v[148:151]
  v_mfma_f32_16x16x32_bf16 v[144:147], a[76:79], a[16:19], v[144:147]
  ds_read_b64_tr_b16 a[110:111], v23 offset:25600
  v_lshl_add_u32 v2, v100, 8, v102
  v_mfma_f32_16x16x32_bf16 v[144:147], a[72:75], a[0:3], v[144:147]
  ds_read_b64_tr_b16 a[112:113], v24 offset:16384
  v_mfma_f32_16x16x32_bf16 v[160:163], a[80:83], a[0:3], v[160:163]
  ds_read_b64_tr_b16 a[114:115], v24 offset:17408
  v_mfma_f32_16x16x32_bf16 v[160:163], a[84:87], a[16:19], v[160:163]
  buffer_load_dwordx4 v29, s[52:55], s50 offen offset:3072 lds
  v_add_u32 v102, 4, v101
  v_mfma_f32_16x16x32_bf16 v[164:167], a[84:87], a[20:23], v[164:167]
  v_mfma_f32_16x16x32_bf16 v[164:167], a[80:83], a[4:7], v[164:167]
  ds_read_b64_tr_b16 a[116:117], v24 offset:24576
  v_xor_b32 v102, v102, v100
  v_mfma_f32_16x16x32_bf16 v[168:171], a[80:83], a[8:11], v[168:171]
  ds_read_b64_tr_b16 a[118:119], v24 offset:25600
  v_mfma_f32_16x16x32_bf16 v[168:171], a[84:87], a[24:27], v[168:171]
  ds_read_b64_tr_b16 a[120:121], v25 offset:16384
  v_lshlrev_b32 v102, 4, v102
  v_mfma_f32_16x16x32_bf16 v[172:175], a[84:87], a[28:31], v[172:175]
  s_add_u32 s50, s50, 16384
  v_mfma_f32_16x16x32_bf16 v[172:175], a[80:83], a[12:15], v[172:175]
  v_mfma_f32_16x16x32_bf16 v[188:191], a[88:91], a[12:15], v[188:191]
  ds_read_b64_tr_b16 a[122:123], v25 offset:17408
  v_lshl_add_u32 v3, v100, 8, v102
  v_mfma_f32_16x16x32_bf16 v[188:191], a[92:95], a[28:31], v[188:191]
  ds_read_b64_tr_b16 a[124:125], v25 offset:24576
  v_mfma_f32_16x16x32_bf16 v[184:187], a[92:95], a[24:27], v[184:187]
  ds_read_b64_tr_b16 a[126:127], v25 offset:25600
  v_add_u32 v102, 8, v101
  v_mfma_f32_16x16x32_bf16 v[184:187], a[88:91], a[8:11], v[184:187]
  v_mfma_f32_16x16x32_bf16 v[180:183], a[88:91], a[4:7], v[180:183]
  v_xor_b32 v102, v102, v100
  v_mfma_f32_16x16x32_bf16 v[180:183], a[92:95], a[20:23], v[180:183]
  v_mfma_f32_16x16x32_bf16 v[176:179], a[92:95], a[16:19], v[176:179]
  v_mfma_f32_16x16x32_bf16 v[176:179], a[88:91], a[0:3], v[176:179]
  s_waitcnt lgkmcnt(0) vmcnt(8)
  s_barrier
  v_mfma_f32_16x16x32_bf16 v[192:195], a[96:99], a[0:3], v[192:195]
  s_add_u32 m0, s60, 32768
  ds_read_b64_tr_b16 a[64:65], v18 offset:32768
  v_mfma_f32_16x16x32_bf16 v[192:195], a[100:103], a[16:19], v[192:195]
  buffer_load_dwordx4 v26, s[52:55], s50 offen lds
  v_lshlrev_b32 v102, 4, v102
  v_mfma_f32_16x16x32_bf16 v[196:199], a[100:103], a[20:23], v[196:199]
  ds_read_b64_tr_b16 a[66:67], v18 offset:33792
  v_mfma_f32_16x16x32_bf16 v[196:199], a[96:99], a[4:7], v[196:199]
  ds_read_b64_tr_b16 a[68:69], v18 offset:40960
  v_lshl_add_u32 v4, v100, 8, v102
  v_mfma_f32_16x16x32_bf16 v[200:203], a[96:99], a[8:11], v[200:203]
  ds_read_b64_tr_b16 a[70:71], v18 offset:41984
  v_mfma_f32_16x16x32_bf16 v[200:203], a[100:103], a[24:27], v[200:203]
  ds_read_b128 a[32:35], v16 offset:0
  v_add_u32 v102, 12, v101
  v_mfma_f32_16x16x32_bf16 v[204:207], a[100:103], a[28:31], v[204:207]
  buffer_load_dwordx4 v27, s[52:55], s50 offen offset:1024 lds
  v_mfma_f32_16x16x32_bf16 v[204:207], a[96:99], a[12:15], v[204:207]
  ds_read_b128 a[48:51], v17 offset:0
  v_xor_b32 v102, v102, v100
  v_mfma_f32_16x16x32_bf16 v[220:223], a[104:107], a[12:15], v[220:223]
  ds_read_b128 a[36:39], v16 offset:2048
  v_mfma_f32_16x16x32_bf16 v[220:223], a[108:111], a[28:31], v[220:223]
  ds_read_b128 a[52:55], v17 offset:2048
  v_mfma_f32_16x16x32_bf16 v[216:219], a[108:111], a[24:27], v[216:219]
  ds_read_b128 a[40:43], v16 offset:4096
  v_lshlrev_b32 v102, 4, v102
  v_mfma_f32_16x16x32_bf16 v[216:219], a[104:107], a[8:11], v[216:219]
  ds_read_b128 a[56:59], v17 offset:4096
  v_mfma_f32_16x16x32_bf16 v[212:215], a[104:107], a[4:7], v[212:215]
  buffer_load_dwordx4 v28, s[52:55], s50 offen offset:2048 lds
  v_lshl_add_u32 v5, v100, 8, v102
  v_mfma_f32_16x16x32_bf16 v[212:215], a[108:111], a[20:23], v[212:215]
  ds_read_b128 a[44:47], v16 offset:6144
  v_mfma_f32_16x16x32_bf16 v[208:211], a[108:111], a[16:19], v[208:211]
  ds_read_b128 a[60:63], v17 offset:6144
  ds_read_b64_tr_b16 a[72:73], v19 offset:32768
  v_lshrrev_b32 v102, 2, v100
  v_mfma_f32_16x16x32_bf16 v[208:211], a[104:107], a[0:3], v[208:211]
  ds_read_b64_tr_b16 a[74:75], v19 offset:33792
  v_mfma_f32_16x16x32_bf16 v[224:227], a[112:115], a[0:3], v[224:227]
  ds_read_b64_tr_b16 a[76:77], v19 offset:40960
  v_mfma_f32_16x16x32_bf16 v[224:227], a[116:119], a[16:19], v[224:227]
  buffer_load_dwordx4 v29, s[52:55], s50 offen offset:3072 lds
  v_lshl_add_u32 v102, v101, 2, v102
  v_mfma_f32_16x16x32_bf16 v[228:231], a[116:119], a[20:23], v[228:231]
  ds_read_b64_tr_b16 a[78:79], v19 offset:41984
  v_mfma_f32_16x16x32_bf16 v[228:231], a[112:115], a[4:7], v[228:231]
  ds_read_b64_tr_b16 a[80:81], v20 offset:32768
  v_and_b32 v103, 3, v100
  v_mfma_f32_16x16x32_bf16 v[232:235], a[112:115], a[8:11], v[232:235]
  ds_read_b64_tr_b16 a[82:83], v20 offset:33792
  v_mfma_f32_16x16x32_bf16 v[232:235], a[116:119], a[24:27], v[232:235]
  ds_read_b64_tr_b16 a[84:85], v20 offset:40960
  v_lshlrev_b32 v103, 3, v103
  v_mfma_f32_16x16x32_bf16 v[236:239], a[116:119], a[28:31], v[236:239]
  ds_read_b64_tr_b16 a[86:87], v20 offset:41984
  v_mfma_f32_16x16x32_bf16 v[236:239], a[112:115], a[12:15], v[236:239]
  s_add_u32 s50, s50, 16384
  v_mfma_f32_16x16x32_bf16 v[252:255], a[120:123], a[12:15], v[252:255]
  ds_read_b64_tr_b16 a[88:89], v21 offset:32768
  v_lshl_add_u32 v103, v102, 8, v103
  v_mfma_f32_16x16x32_bf16 v[252:255], a[124:127], a[28:31], v[252:255]
  ds_read_b64_tr_b16 a[90:91], v21 offset:33792
  v_mfma_f32_16x16x32_bf16 v[248:251], a[124:127], a[24:27], v[248:251]
  ds_read_b64_tr_b16 a[92:93], v21 offset:40960
  v_add_u32 v103, 65536, v103
  v_mfma_f32_16x16x32_bf16 v[248:251], a[120:123], a[8:11], v[248:251]
  ds_read_b64_tr_b16 a[94:95], v21 offset:41984
  v_mfma_f32_16x16x32_bf16 v[244:247], a[120:123], a[4:7], v[244:247]
  v_and_b32 v102, 7, v102
  v_mfma_f32_16x16x32_bf16 v[244:247], a[124:127], a[20:23], v[244:247]
  v_mfma_f32_16x16x32_bf16 v[240:243], a[124:127], a[16:19], v[240:243]
  v_mfma_f32_16x16x32_bf16 v[240:243], a[120:123], a[0:3], v[240:243]
  s_waitcnt lgkmcnt(0)
  v_mfma_f32_16x16x32_bf16 v[128:131], a[64:67], a[32:35], v[128:131]
  ds_read_b64_tr_b16 a[96:97], v22 offset:32768
  v_mfma_f32_16x16x32_bf16 v[128:131], a[68:71], a[48:51], v[128:131]
  ds_read_b64_tr_b16 a[98:99], v22 offset:33792
  v_xor_b32 v100, 0, v102
  v_mfma_f32_16x16x32_bf16 v[132:135], a[68:71], a[52:55], v[132:135]
  v_mfma_f32_16x16x32_bf16 v[132:135], a[64:67], a[36:39], v[132:135]
  ds_read_b64_tr_b16 a[100:101], v22 offset:40960
  v_lshl_add_u32 v6, v100, 5, v103
  v_mfma_f32_16x16x32_bf16 v[136:139], a[64:67], a[40:43], v[136:139]
  v_mfma_f32_16x16x32_bf16 v[136:139], a[68:71], a[56:59], v[136:139]
  ds_read_b64_tr_b16 a[102:103], v22 offset:41984
  v_xor_b32 v100, 1, v102
  v_mfma_f32_16x16x32_bf16 v[140:143], a[68:71], a[60:63], v[140:143]
  ds_read_b64_tr_b16 a[104:105], v23 offset:32768
  v_mfma_f32_16x16x32_bf16 v[140:143], a[64:67], a[44:47], v[140:143]
  v_lshl_add_u32 v7, v100, 5, v103
  v_mfma_f32_16x16x32_bf16 v[156:159], a[72:75], a[44:47], v[156:159]
  ds_read_b64_tr_b16 a[106:107], v23 offset:33792
  v_mfma_f32_16x16x32_bf16 v[156:159], a[76:79], a[60:63], v[156:159]
  v_mfma_f32_16x16x32_bf16 v[152:155], a[76:79], a[56:59], v[152:155]
  ds_read_b64_tr_b16 a[108:109], v23 offset:40960
  v_xor_b32 v100, 2, v102
  v_mfma_f32_16x16x32_bf16 v[152:155], a[72:75], a[40:43], v[152:155]
  ds_read_b64_tr_b16 a[110:111], v23 offset:41984
  v_mfma_f32_16x16x32_bf16 v[148:151], a[72:75], a[36:39], v[148:151]
  v_lshl_add_u32 v8, v100, 5, v103
  v_mfma_f32_16x16x32_bf16 v[148:151], a[76:79], a[52:55], v[148:151]
  ds_read_b64_tr_b16 a[112:113], v24 offset:32768
  v_mfma_f32_16x16x32_bf16 v[144:147], a[76:79], a[48:51], v[144:147]
  v_xor_b32 v100, 3, v102
  v_mfma_f32_16x16x32_bf16 v[144:147], a[72:75], a[32:35], v[144:147]
  ds_read_b64_tr_b16 a[114:115], v24 offset:33792
  v_mfma_f32_16x16x32_bf16 v[160:163], a[80:83], a[32:35], v[160:163]
  ds_read_b64_tr_b16 a[116:117], v24 offset:40960
  v_mfma_f32_16x16x32_bf16 v[160:163], a[84:87], a[48:51], v[160:163]
  v_lshl_add_u32 v9, v100, 5, v103
  v_mfma_f32_16x16x32_bf16 v[164:167], a[84:87], a[52:55], v[164:167]
  ds_read_b64_tr_b16 a[118:119], v24 offset:41984
  v_mfma_f32_16x16x32_bf16 v[164:167], a[80:83], a[36:39], v[164:167]
  v_xor_b32 v100, 4, v102
  v_mfma_f32_16x16x32_bf16 v[168:171], a[80:83], a[40:43], v[168:171]
  ds_read_b64_tr_b16 a[120:121], v25 offset:32768
  v_mfma_f32_16x16x32_bf16 v[168:171], a[84:87], a[56:59], v[168:171]
  ds_read_b64_tr_b16 a[122:123], v25 offset:33792
  v_lshl_add_u32 v10, v100, 5, v103
  v_mfma_f32_16x16x32_bf16 v[172:175], a[84:87], a[60:63], v[172:175]
  v_mfma_f32_16x16x32_bf16 v[172:175], a[80:83], a[44:47], v[172:175]
  ds_read_b64_tr_b16 a[124:125], v25 offset:40960
  v_mfma_f32_16x16x32_bf16 v[188:191], a[88:91], a[44:47], v[188:191]
  v_xor_b32 v100, 5, v102
  v_mfma_f32_16x16x32_bf16 v[188:191], a[92:95], a[60:63], v[188:191]
  ds_read_b64_tr_b16 a[126:127], v25 offset:41984
  v_mfma_f32_16x16x32_bf16 v[184:187], a[92:95], a[56:59], v[184:187]
  v_lshl_add_u32 v11, v100, 5, v103
  v_mfma_f32_16x16x32_bf16 v[184:187], a[88:91], a[40:43], v[184:187]
  v_mfma_f32_16x16x32_bf16 v[180:183], a[88:91], a[36:39], v[180:183]
  v_xor_b32 v100, 6, v102
  v_mfma_f32_16x16x32_bf16 v[180:183], a[92:95], a[52:55], v[180:183]
  v_mfma_f32_16x16x32_bf16 v[176:179], a[92:95], a[48:51], v[176:179]
  v_mfma_f32_16x16x32_bf16 v[176:179], a[88:91], a[32:35], v[176:179]
  s_waitcnt lgkmcnt(0)
  s_barrier
  v_mfma_f32_16x16x32_bf16 v[192:195], a[96:99], a[32:35], v[192:195]
  s_add_u32 m0, s61, 0
  v_mfma_f32_16x16x32_bf16 v[192:195], a[100:103], a[48:51], v[192:195]
  v_lshl_add_u32 v12, v100, 5, v103
  v_mfma_f32_16x16x32_bf16 v[196:199], a[100:103], a[52:55], v[196:199]
  buffer_load_dwordx4 v30, s[56:59], s51 offen lds
  v_mfma_f32_16x16x32_bf16 v[196:199], a[96:99], a[36:39], v[196:199]
  v_xor_b32 v100, 7, v102
  v_mfma_f32_16x16x32_bf16 v[200:203], a[96:99], a[40:43], v[200:203]
  buffer_load_dwordx4 v31, s[56:59], s51 offen offset:1024 lds
  v_mfma_f32_16x16x32_bf16 v[200:203], a[100:103], a[56:59], v[200:203]
  v_lshl_add_u32 v13, v100, 5, v103
  v_mfma_f32_16x16x32_bf16 v[204:207], a[100:103], a[60:63], v[204:207]
  v_mfma_f32_16x16x32_bf16 v[204:207], a[96:99], a[44:47], v[204:207]
  buffer_load_dwordx4 v30, s[56:59], s51 offen offset:2048 lds
  v_mov_b32 v96, 0x3e0293ee
  v_mfma_f32_16x16x32_bf16 v[220:223], a[104:107], a[44:47], v[220:223]
  v_mfma_f32_16x16x32_bf16 v[220:223], a[108:111], a[60:63], v[220:223]
  buffer_load_dwordx4 v31, s[56:59], s51 offen offset:3072 lds
  v_mov_b32 v97, 0x3e0293ee
  v_mfma_f32_16x16x32_bf16 v[216:219], a[108:111], a[56:59], v[216:219]
  v_mfma_f32_16x16x32_bf16 v[216:219], a[104:107], a[40:43], v[216:219]
  s_add_u32 s51, s51, 16384
  v_and_b32 v100, 15, v0
  v_mfma_f32_16x16x32_bf16 v[212:215], a[104:107], a[36:39], v[212:215]
  v_mfma_f32_16x16x32_bf16 v[212:215], a[108:111], a[52:55], v[212:215]
  v_bfe_u32 v101, v0, 4, 2
  v_mfma_f32_16x16x32_bf16 v[208:211], a[108:111], a[48:51], v[208:211]
  s_add_u32 m0, s61, 16384
  v_mfma_f32_16x16x32_bf16 v[208:211], a[104:107], a[32:35], v[208:211]
  v_mfma_f32_16x16x32_bf16 v[224:227], a[112:115], a[32:35], v[224:227]
  buffer_load_dwordx4 v30, s[56:59], s51 offen lds
  v_xor_b32 v101, v101, v100
  v_mfma_f32_16x16x32_bf16 v[224:227], a[116:119], a[48:51], v[224:227]
  v_mfma_f32_16x16x32_bf16 v[228:231], a[116:119], a[52:55], v[228:231]
  buffer_load_dwordx4 v31, s[56:59], s51 offen offset:1024 lds
  v_lshlrev_b32 v101, 4, v101
  v_mfma_f32_16x16x32_bf16 v[228:231], a[112:115], a[36:39], v[228:231]
  v_mfma_f32_16x16x32_bf16 v[232:235], a[112:115], a[40:43], v[232:235]
  v_lshl_add_u32 v101, v100, 8, v101
  v_mfma_f32_16x16x32_bf16 v[232:235], a[116:119], a[56:59], v[232:235]
  buffer_load_dwordx4 v30, s[56:59], s51 offen offset:2048 lds
  v_mfma_f32_16x16x32_bf16 v[236:239], a[116:119], a[60:63], v[236:239]
  v_add_u32 v104, s48, v101
  v_mfma_f32_16x16x32_bf16 v[236:239], a[112:115], a[44:47], v[236:239]
  buffer_load_dwordx4 v31, s[56:59], s51 offen offset:3072 lds
  v_mfma_f32_16x16x32_bf16 v[252:255], a[120:123], a[44:47], v[252:255]
  v_xor_b32 v105, 64, v104
  v_mfma_f32_16x16x32_bf16 v[252:255], a[124:127], a[60:63], v[252:255]
  s_add_u32 s51, s51, 16384
  v_mfma_f32_16x16x32_bf16 v[248:251], a[124:127], a[56:59], v[248:251]
  v_xor_b32 v106, 128, v104
  v_mfma_f32_16x16x32_bf16 v[248:251], a[120:123], a[40:43], v[248:251]
  v_mfma_f32_16x16x32_bf16 v[244:247], a[120:123], a[36:39], v[244:247]
  v_xor_b32 v107, 192, v104
  v_mfma_f32_16x16x32_bf16 v[244:247], a[124:127], a[52:55], v[244:247]
  v_mfma_f32_16x16x32_bf16 v[240:243], a[124:127], a[48:51], v[240:243]
  v_mfma_f32_16x16x32_bf16 v[240:243], a[120:123], a[32:35], v[240:243]
  v_pk_mul_f32 v[128:129], v[128:129], v[96:97]
  v_pk_mul_f32 v[130:131], v[130:131], v[96:97]
  v_cvt_pk_bf16_f32 v50, v128, v129
  v_cvt_pk_bf16_f32 v51, v130, v131
  ds_write_b64 v36, v[50:51] offset:0
  v_pk_mul_f32 v[144:145], v[144:145], v[96:97]
  v_pk_mul_f32 v[146:147], v[146:147], v[96:97]
  v_cvt_pk_bf16_f32 v52, v144, v145
  v_cvt_pk_bf16_f32 v53, v146, v147
  ds_write_b64 v37, v[52:53] offset:0
  v_pk_mul_f32 v[160:161], v[160:161], v[96:97]
  v_pk_mul_f32 v[162:163], v[162:163], v[96:97]
  v_cvt_pk_bf16_f32 v54, v160, v161
  v_cvt_pk_bf16_f32 v55, v162, v163
  ds_write_b64 v38, v[54:55] offset:0
  v_pk_mul_f32 v[176:177], v[176:177], v[96:97]
  v_pk_mul_f32 v[178:179], v[178:179], v[96:97]
  v_cvt_pk_bf16_f32 v56, v176, v177
  v_cvt_pk_bf16_f32 v57, v178, v179
  ds_write_b64 v39, v[56:57] offset:0
  v_pk_mul_f32 v[192:193], v[192:193], v[96:97]
  v_pk_mul_f32 v[194:195], v[194:195], v[96:97]
  v_cvt_pk_bf16_f32 v50, v192, v193
  v_cvt_pk_bf16_f32 v51, v194, v195
  ds_write_b64 v40, v[50:51] offset:0
  v_pk_mul_f32 v[208:209], v[208:209], v[96:97]
  v_pk_mul_f32 v[210:211], v[210:211], v[96:97]
  v_cvt_pk_bf16_f32 v52, v208, v209
  v_cvt_pk_bf16_f32 v53, v210, v211
  ds_write_b64 v41, v[52:53] offset:0
  v_pk_mul_f32 v[224:225], v[224:225], v[96:97]
  v_pk_mul_f32 v[226:227], v[226:227], v[96:97]
  v_cvt_pk_bf16_f32 v54, v224, v225
  v_cvt_pk_bf16_f32 v55, v226, v227
  ds_write_b64 v42, v[54:55] offset:0
  v_pk_mul_f32 v[240:241], v[240:241], v[96:97]
  v_pk_mul_f32 v[242:243], v[242:243], v[96:97]
  v_cvt_pk_bf16_f32 v56, v240, v241
  v_cvt_pk_bf16_f32 v57, v242, v243
  ds_write_b64 v43, v[56:57] offset:0
  ds_read_b128 a[128:131], v104
  ds_read_b128 a[132:135], v105
  ds_read_b128 a[136:139], v106
  ds_read_b128 a[140:143], v107
  v_pk_mul_f32 v[132:133], v[132:133], v[96:97]
  v_pk_mul_f32 v[134:135], v[134:135], v[96:97]
  v_cvt_pk_bf16_f32 v50, v132, v133
  v_cvt_pk_bf16_f32 v51, v134, v135
  ds_write_b64 v36, v[50:51] offset:0
  v_pk_mul_f32 v[148:149], v[148:149], v[96:97]
  v_pk_mul_f32 v[150:151], v[150:151], v[96:97]
  v_cvt_pk_bf16_f32 v52, v148, v149
  v_cvt_pk_bf16_f32 v53, v150, v151
  ds_write_b64 v37, v[52:53] offset:0
  v_pk_mul_f32 v[164:165], v[164:165], v[96:97]
  v_pk_mul_f32 v[166:167], v[166:167], v[96:97]
  v_cvt_pk_bf16_f32 v54, v164, v165
  v_cvt_pk_bf16_f32 v55, v166, v167
  ds_write_b64 v38, v[54:55] offset:0
  v_pk_mul_f32 v[180:181], v[180:181], v[96:97]
  v_pk_mul_f32 v[182:183], v[182:183], v[96:97]
  v_cvt_pk_bf16_f32 v56, v180, v181
  v_cvt_pk_bf16_f32 v57, v182, v183
  ds_write_b64 v39, v[56:57] offset:0
  v_pk_mul_f32 v[196:197], v[196:197], v[96:97]
  v_pk_mul_f32 v[198:199], v[198:199], v[96:97]
  v_cvt_pk_bf16_f32 v50, v196, v197
  v_cvt_pk_bf16_f32 v51, v198, v199
  ds_write_b64 v40, v[50:51] offset:0
  v_pk_mul_f32 v[212:213], v[212:213], v[96:97]
  v_pk_mul_f32 v[214:215], v[214:215], v[96:97]
  v_cvt_pk_bf16_f32 v52, v212, v213
  v_cvt_pk_bf16_f32 v53, v214, v215
  ds_write_b64 v41, v[52:53] offset:0
  v_pk_mul_f32 v[228:229], v[228:229], v[96:97]
  v_pk_mul_f32 v[230:231], v[230:231], v[96:97]
  v_cvt_pk_bf16_f32 v54, v228, v229
  v_cvt_pk_bf16_f32 v55, v230, v231
  ds_write_b64 v42, v[54:55] offset:0
  v_pk_mul_f32 v[244:245], v[244:245], v[96:97]
  v_pk_mul_f32 v[246:247], v[246:247], v[96:97]
  v_cvt_pk_bf16_f32 v56, v244, v245
  v_cvt_pk_bf16_f32 v57, v246, v247
  ds_write_b64 v43, v[56:57] offset:0
  ds_read_b128 a[144:147], v104
  ds_read_b128 a[148:151], v105
  ds_read_b128 a[152:155], v106
  ds_read_b128 a[156:159], v107
  v_pk_mul_f32 v[136:137], v[136:137], v[96:97]
  v_pk_mul_f32 v[138:139], v[138:139], v[96:97]
  v_cvt_pk_bf16_f32 v50, v136, v137
  v_cvt_pk_bf16_f32 v51, v138, v139
  ds_write_b64 v36, v[50:51] offset:0
  v_pk_mul_f32 v[152:153], v[152:153], v[96:97]
  v_pk_mul_f32 v[154:155], v[154:155], v[96:97]
  v_cvt_pk_bf16_f32 v52, v152, v153
  v_cvt_pk_bf16_f32 v53, v154, v155
  ds_write_b64 v37, v[52:53] offset:0
  v_pk_mul_f32 v[168:169], v[168:169], v[96:97]
  v_pk_mul_f32 v[170:171], v[170:171], v[96:97]
  v_cvt_pk_bf16_f32 v54, v168, v169
  v_cvt_pk_bf16_f32 v55, v170, v171
  ds_write_b64 v38, v[54:55] offset:0
  v_pk_mul_f32 v[184:185], v[184:185], v[96:97]
  v_pk_mul_f32 v[186:187], v[186:187], v[96:97]
  v_cvt_pk_bf16_f32 v56, v184, v185
  v_cvt_pk_bf16_f32 v57, v186, v187
  ds_write_b64 v39, v[56:57] offset:0
  v_pk_mul_f32 v[200:201], v[200:201], v[96:97]
  v_pk_mul_f32 v[202:203], v[202:203], v[96:97]
  v_cvt_pk_bf16_f32 v50, v200, v201
  v_cvt_pk_bf16_f32 v51, v202, v203
  ds_write_b64 v40, v[50:51] offset:0
  v_pk_mul_f32 v[216:217], v[216:217], v[96:97]
  v_pk_mul_f32 v[218:219], v[218:219], v[96:97]
  v_cvt_pk_bf16_f32 v52, v216, v217
  v_cvt_pk_bf16_f32 v53, v218, v219
  ds_write_b64 v41, v[52:53] offset:0
  v_pk_mul_f32 v[232:233], v[232:233], v[96:97]
  v_pk_mul_f32 v[234:235], v[234:235], v[96:97]
  v_cvt_pk_bf16_f32 v54, v232, v233
  v_cvt_pk_bf16_f32 v55, v234, v235
  ds_write_b64 v42, v[54:55] offset:0
  v_pk_mul_f32 v[248:249], v[248:249], v[96:97]
  v_pk_mul_f32 v[250:251], v[250:251], v[96:97]
  v_cvt_pk_bf16_f32 v56, v248, v249
  v_cvt_pk_bf16_f32 v57, v250, v251
  ds_write_b64 v43, v[56:57] offset:0
  ds_read_b128 a[160:163], v104
  ds_read_b128 a[164:167], v105
  ds_read_b128 a[168:171], v106
  ds_read_b128 a[172:175], v107
  v_pk_mul_f32 v[140:141], v[140:141], v[96:97]
  v_pk_mul_f32 v[142:143], v[142:143], v[96:97]
  v_cvt_pk_bf16_f32 v50, v140, v141
  v_cvt_pk_bf16_f32 v51, v142, v143
  ds_write_b64 v36, v[50:51] offset:0
  v_pk_mul_f32 v[156:157], v[156:157], v[96:97]
  v_pk_mul_f32 v[158:159], v[158:159], v[96:97]
  v_cvt_pk_bf16_f32 v52, v156, v157
  v_cvt_pk_bf16_f32 v53, v158, v159
  ds_write_b64 v37, v[52:53] offset:0
  v_pk_mul_f32 v[172:173], v[172:173], v[96:97]
  v_pk_mul_f32 v[174:175], v[174:175], v[96:97]
  v_cvt_pk_bf16_f32 v54, v172, v173
  v_cvt_pk_bf16_f32 v55, v174, v175
  ds_write_b64 v38, v[54:55] offset:0
  v_pk_mul_f32 v[188:189], v[188:189], v[96:97]
  v_pk_mul_f32 v[190:191], v[190:191], v[96:97]
  v_cvt_pk_bf16_f32 v56, v188, v189
  v_cvt_pk_bf16_f32 v57, v190, v191
  ds_write_b64 v39, v[56:57] offset:0
  v_pk_mul_f32 v[204:205], v[204:205], v[96:97]
  v_pk_mul_f32 v[206:207], v[206:207], v[96:97]
  v_cvt_pk_bf16_f32 v50, v204, v205
  v_cvt_pk_bf16_f32 v51, v206, v207
  ds_write_b64 v40, v[50:51] offset:0
  v_pk_mul_f32 v[220:221], v[220:221], v[96:97]
  v_pk_mul_f32 v[222:223], v[222:223], v[96:97]
  v_cvt_pk_bf16_f32 v52, v220, v221
  v_cvt_pk_bf16_f32 v53, v222, v223
  ds_write_b64 v41, v[52:53] offset:0
  v_pk_mul_f32 v[236:237], v[236:237], v[96:97]
  v_pk_mul_f32 v[238:239], v[238:239], v[96:97]
  v_cvt_pk_bf16_f32 v54, v236, v237
  v_cvt_pk_bf16_f32 v55, v238, v239
  ds_write_b64 v42, v[54:55] offset:0
  v_pk_mul_f32 v[252:253], v[252:253], v[96:97]
  v_pk_mul_f32 v[254:255], v[254:255], v[96:97]
  v_cvt_pk_bf16_f32 v56, v252, v253
  v_cvt_pk_bf16_f32 v57, v254, v255
  ds_write_b64 v43, v[56:57] offset:0
  ds_read_b128 a[176:179], v104
  ds_read_b128 a[180:183], v105
  ds_read_b128 a[184:187], v106
  ds_read_b128 a[188:191], v107
  s_cmp_eq_u32 s34, 2
  s_cbranch_scc1 att_ln
att_ln_ret:
  s_mov_b32 s90, 0
att_rerun:
  s_waitcnt vmcnt(12) lgkmcnt(0)
  s_barrier
  ds_read_b128 a[192:195], v2 offset:0
  ds_read_b128 a[196:199], v3 offset:0
  ds_read_b128 a[200:203], v4 offset:0
  ds_read_b128 a[204:207], v5 offset:0
  ds_read_b128 a[208:211], v2 offset:4096
  ds_read_b128 a[212:215], v3 offset:4096
  ds_read_b128 a[216:219], v4 offset:4096
  ds_read_b128 a[220:223], v5 offset:4096
  s_waitcnt lgkmcnt(0)
  v_mfma_f32_16x16x32_bf16 v[32:35], a[192:195], a[128:131], 0
  s_mov_b32 s8, s46
  s_mov_b32 s9, s47
  s_mov_b32 s10, 8388608
  s_mov_b32 s11, 0x20000
  v_mfma_f32_16x16x32_bf16 v[32:35], a[196:199], a[132:135], v[32:35]
  s_add_u32 s12, s6, 25165824
  s_addc_u32 s13, s7, 0
  s_mov_b32 s14, 7340032
  v_mfma_f32_16x16x32_bf16 v[32:35], a[200:203], a[136:139], v[32:35]
  s_mov_b32 s15, 0x20000
  v_bfe_u32 v100, v0, 3, 3
  s_lshl_b32 s40, s3, 6
  v_add_u32 v100, s40, v100
  v_mfma_f32_16x16x32_bf16 v[32:35], a[204:207], a[140:143], v[32:35]
  v_lshrrev_b32 v101, 1, v100
  v_xor_b32 v101, v0, v101
  v_and_b32 v101, 7, v101
  v_mfma_f32_16x16x32_bf16 v[36:39], a[204:207], a[156:159], 0
  v_lshlrev_b32 v101, 4, v101
  v_mul_u32_u24 v100, 4096, v100
  v_add_u32 v14, v100, v101
  v_xor_b32 v100, 64, v14
  v_mfma_f32_16x16x32_bf16 v[36:39], a[200:203], a[152:155], v[36:39]
  v_add_u32 v15, 31744, v100
  v_add_u32 v16, 63488, v14
  v_add_u32 v17, 95232, v100
  v_mfma_f32_16x16x32_bf16 v[36:39], a[196:199], a[148:151], v[36:39]
  v_add_u32 v18, 131072, v14
  v_add_u32 v19, 162816, v100
  v_add_u32 v20, 194560, v14
  v_add_u32 v21, 226304, v100
  v_mfma_f32_16x16x32_bf16 v[36:39], a[192:195], a[144:147], v[36:39]
  v_and_b32 v100, 15, v0
  v_bfe_u32 v101, v0, 4, 2
  v_lshlrev_b32 v22, 1, v101
  v_mfma_f32_16x16x32_bf16 v[40:43], a[192:195], a[160:163], 0
  v_xor_b32 v100, v100, v22
  v_lshlrev_b32 v100, 4, v100
  s_lshl_b32 s40, s3, 4
  v_add_u32 v101, s40, v101
  v_mfma_f32_16x16x32_bf16 v[40:43], a[196:199], a[164:167], v[40:43]
  v_mul_u32_u24 v101, 3584, v101
  v_add_u32 v22, v101, v100
  v_xor_b32 v100, 128, v22
  v_mfma_f32_16x16x32_bf16 v[40:43], a[200:203], a[168:171], v[40:43]
  v_add_u32 v23, 13312, v22
  v_add_u32 v24, 26624, v100
  v_add_u32 v25, 39936, v100
  v_mfma_f32_16x16x32_bf16 v[40:43], a[204:207], a[172:175], v[40:43]
  s_and_b32 s40, s2, 7
  s_lshr_b32 s41, s2, 3
  s_and_b32 s42, s40, 6
  s_and_b32 s43, s41, 1
  v_mfma_f32_16x16x32_bf16 v[44:47], a[204:207], a[188:191], 0
  s_add_u32 s42, s42, s43
  s_lshr_b32 s41, s41, 1
  s_and_b32 s43, s40, 1
  v_mfma_f32_16x16x32_bf16 v[44:47], a[200:203], a[184:187], v[44:47]
  s_mul_i32 s43, s43, 7
  s_add_u32 s41, s41, s43
  s_lshl_b32 s26, s42, 20
  s_lshl_b32 s27, s41, 8
  v_mfma_f32_16x16x32_bf16 v[44:47], a[196:199], a[180:183], v[44:47]
  s_add_u32 s30, s26, 128
  s_add_u32 s31, s27, 229376
  v_mov_b32 v176, 0x3f803f80
  v_mfma_f32_16x16x32_bf16 v[44:47], a[192:195], a[176:179], v[44:47]
  v_mov_b32 v177, 0x3f803f80
  v_mov_b32 v178, 0x3f803f80
  v_mov_b32 v179, 0x3f803f80
  v_and_b32 v200, 63, v0
  v_mfma_f32_16x16x32_bf16 v[48:51], a[208:211], a[128:131], 0
  v_lshlrev_b32 v200, 4, v200
  v_add_u32 v200, s100, v200
  s_and_b32 s40, s2, 7
  v_mfma_f32_16x16x32_bf16 v[48:51], a[212:215], a[132:135], v[48:51]
  s_lshr_b32 s41, s2, 3
  s_and_b32 s42, s40, 6
  s_and_b32 s43, s41, 1
  s_add_u32 s42, s42, s43
  v_mfma_f32_16x16x32_bf16 v[48:51], a[216:219], a[136:139], v[48:51]
  s_lshr_b32 s41, s41, 1
  s_and_b32 s43, s40, 1
  s_mul_i32 s43, s43, 7
  v_mfma_f32_16x16x32_bf16 v[48:51], a[220:223], a[140:143], v[48:51]
  s_add_u32 s41, s41, s43
  s_lshl_b32 s42, s42, 4
  s_add_u32 s42, s42, s41
  s_lshl_b32 s42, s42, 8
  v_mfma_f32_16x16x32_bf16 v[52:55], a[220:223], a[156:159], 0
  s_add_u32 s42, s42, 2048
  s_lshl_b32 s40, s40, 8
  s_add_u32 s40, s40, 34816
  v_mfma_f32_16x16x32_bf16 v[52:55], a[216:219], a[152:155], v[52:55]
  v_mov_b32 v201, s40
  v_writelane_b32 v201, s42, 1
  v_and_b32 v103, 63, v0
  v_mfma_f32_16x16x32_bf16 v[52:55], a[212:215], a[148:151], v[52:55]
  v_and_b32 v100, 15, v103
  v_lshrrev_b32 v101, 4, v103
  v_lshrrev_b32 v102, 1, v101
  v_xor_b32 v102, v102, v100
  v_mfma_f32_16x16x32_bf16 v[52:55], a[208:211], a[144:147], v[52:55]
  v_lshlrev_b32 v102, 4, v102
  v_and_b32 v101, 1, v101
  v_lshl_add_u32 v102, v101, 3, v102
  v_mfma_f32_16x16x32_bf16 v[56:59], a[208:211], a[160:163], 0
  v_lshl_add_u32 v102, v100, 8, v102
  v_add_u32 v204, s48, v102
  v_xor_b32 v205, 32, v204
  v_xor_b32 v206, 64, v204
  v_mfma_f32_16x16x32_bf16 v[56:59], a[212:215], a[164:167], v[56:59]
  v_xor_b32 v207, 96, v204
  v_xor_b32 v208, 128, v204
  v_xor_b32 v209, 160, v204
  v_mfma_f32_16x16x32_bf16 v[56:59], a[216:219], a[168:171], v[56:59]
  v_xor_b32 v210, 192, v204
  v_xor_b32 v211, 224, v204
  v_lshrrev_b32 v100, 4, v103
  v_and_b32 v101, 15, v103
  v_mfma_f32_16x16x32_bf16 v[56:59], a[220:223], a[172:175], v[56:59]
  v_xor_b32 v102, v101, v100
  v_lshlrev_b32 v102, 4, v102
  v_lshl_add_u32 v102, v100, 8, v102
  v_mfma_f32_16x16x32_bf16 v[60:63], a[220:223], a[188:191], 0
  v_add_u32 v212, s48, v102
  v_xor_b32 v213, 64, v212
  v_xor_b32 v214, 128, v212
  v_xor_b32 v215, 192, v212
  v_mfma_f32_16x16x32_bf16 v[60:63], a[216:219], a[184:187], v[60:63]
  v_and_b32 v100, 63, v0
  v_lshrrev_b32 v101, 4, v100
  v_and_b32 v100, 15, v100
  v_mfma_f32_16x16x32_bf16 v[60:63], a[212:215], a[180:183], v[60:63]
  s_mov_b32 s41, 8448
  v_mul_lo_u32 v216, v101, s41
  v_lshl_add_u32 v216, v100, 4, v216
  v_mfma_f32_16x16x32_bf16 v[60:63], a[208:211], a[176:179], v[60:63]
  ds_read_b128 a[192:195], v2 offset:8192
  ds_read_b128 a[196:199], v3 offset:8192
  ds_read_b128 a[200:203], v4 offset:8192
  ds_read_b128 a[204:207], v5 offset:8192
  ds_read_b128 a[208:211], v2 offset:12288
  ds_read_b128 a[212:215], v3 offset:12288
  ds_read_b128 a[216:219], v4 offset:12288
  ds_read_b128 a[220:223], v5 offset:12288
  s_nop 7
  s_cmp_eq_u32 s90, 1
  s_cbranch_scc1 att_havemax
  v_max3_f32 v180, v32, v33, v34
  v_max3_f32 v180, v180, v35, v48
  v_max3_f32 v180, v180, v49, v50
  v_max_f32 v180, v180, v51
  v_max3_f32 v181, v36, v37, v38
  v_max3_f32 v181, v181, v39, v52
  v_max3_f32 v181, v181, v53, v54
  v_max_f32 v181, v181, v55
  v_max3_f32 v182, v40, v41, v42
  v_max3_f32 v182, v182, v43, v56
  v_max3_f32 v182, v182, v57, v58
  v_max_f32 v182, v182, v59
  v_max3_f32 v183, v44, v45, v46
  v_max3_f32 v183, v183, v47, v60
  v_max3_f32 v183, v183, v61, v62
  v_max_f32 v183, v183, v63
  v_mov_b32 v184, v180
  v_mov_b32 v185, v181
  v_mov_b32 v186, v182
  v_mov_b32 v187, v183
  s_nop 1
  v_permlane16_swap_b32 v180, v184
  v_permlane16_swap_b32 v181, v185
  v_permlane16_swap_b32 v182, v186
  v_permlane16_swap_b32 v183, v187
  s_nop 1
  v_max_f32 v180, v180, v184
  v_max_f32 v181, v181, v185
  v_max_f32 v182, v182, v186
  v_max_f32 v183, v183, v187
  v_mov_b32 v184, v180
  v_mov_b32 v185, v181
  v_mov_b32 v186, v182
  v_mov_b32 v187, v183
  s_nop 1
  v_permlane32_swap_b32 v180, v184
  v_permlane32_swap_b32 v181, v185
  v_permlane32_swap_b32 v182, v186
  v_permlane32_swap_b32 v183, v187
  s_nop 1
  v_max_f32 v180, v180, v184
  v_max_f32 v181, v181, v185
  v_max_f32 v182, v182, v186
  v_max_f32 v183, v183, v187
att_havemax:
  v_sub_f32 v144, 0xc0a00000, v180
  v_sub_f32 v145, 0xc0a00000, v180
  v_sub_f32 v146, 0xc0a00000, v180
  v_sub_f32 v147, 0xc0a00000, v180
  v_sub_f32 v148, 0xc0a00000, v181
  v_sub_f32 v149, 0xc0a00000, v181
  v_sub_f32 v150, 0xc0a00000, v181
  v_sub_f32 v151, 0xc0a00000, v181
  v_sub_f32 v152, 0xc0a00000, v182
  v_sub_f32 v153, 0xc0a00000, v182
  v_sub_f32 v154, 0xc0a00000, v182
  v_sub_f32 v155, 0xc0a00000, v182
  v_sub_f32 v156, 0xc0a00000, v183
  v_sub_f32 v157, 0xc0a00000, v183
  v_sub_f32 v158, 0xc0a00000, v183
  v_sub_f32 v159, 0xc0a00000, v183
  v_pk_add_f32 v[32:33], v[32:33], v[144:145]
  v_pk_add_f32 v[34:35], v[34:35], v[144:145]
  v_pk_add_f32 v[36:37], v[36:37], v[148:149]
  v_pk_add_f32 v[38:39], v[38:39], v[148:149]
  v_pk_add_f32 v[40:41], v[40:41], v[152:153]
  v_pk_add_f32 v[42:43], v[42:43], v[152:153]
  v_pk_add_f32 v[44:45], v[44:45], v[156:157]
  v_pk_add_f32 v[46:47], v[46:47], v[156:157]
  v_pk_add_f32 v[48:49], v[48:49], v[144:145]
  v_pk_add_f32 v[50:51], v[50:51], v[144:145]
  v_pk_add_f32 v[52:53], v[52:53], v[148:149]
  v_pk_add_f32 v[54:55], v[54:55], v[148:149]
  v_pk_add_f32 v[56:57], v[56:57], v[152:153]
  v_pk_add_f32 v[58:59], v[58:59], v[152:153]
  v_pk_add_f32 v[60:61], v[60:61], v[156:157]
  v_pk_add_f32 v[62:63], v[62:63], v[156:157]
  s_waitcnt lgkmcnt(0)
  v_mfma_f32_16x16x32_bf16 v[64:67], a[192:195], a[128:131], v[144:147]
  v_mfma_f32_16x16x32_bf16 v[64:67], a[196:199], a[132:135], v[64:67]
  v_mfma_f32_16x16x32_bf16 v[64:67], a[200:203], a[136:139], v[64:67]
  v_mfma_f32_16x16x32_bf16 v[64:67], a[204:207], a[140:143], v[64:67]
  v_mfma_f32_16x16x32_bf16 v[68:71], a[204:207], a[156:159], v[148:151]
  v_mfma_f32_16x16x32_bf16 v[68:71], a[200:203], a[152:155], v[68:71]
  v_mfma_f32_16x16x32_bf16 v[68:71], a[196:199], a[148:151], v[68:71]
  v_mfma_f32_16x16x32_bf16 v[68:71], a[192:195], a[144:147], v[68:71]
  v_mfma_f32_16x16x32_bf16 v[72:75], a[192:195], a[160:163], v[152:155]
  v_mfma_f32_16x16x32_bf16 v[72:75], a[196:199], a[164:167], v[72:75]
  v_mfma_f32_16x16x32_bf16 v[72:75], a[200:203], a[168:171], v[72:75]
  v_mfma_f32_16x16x32_bf16 v[72:75], a[204:207], a[172:175], v[72:75]
  v_mfma_f32_16x16x32_bf16 v[76:79], a[204:207], a[188:191], v[156:159]
  v_mfma_f32_16x16x32_bf16 v[76:79], a[200:203], a[184:187], v[76:79]
  v_mfma_f32_16x16x32_bf16 v[76:79], a[196:199], a[180:183], v[76:79]
  v_mfma_f32_16x16x32_bf16 v[76:79], a[192:195], a[176:179], v[76:79]
  v_mfma_f32_16x16x32_bf16 v[80:83], a[208:211], a[128:131], v[144:147]
  v_exp_f32 v96, v32
  v_mfma_f32_16x16x32_bf16 v[80:83], a[212:215], a[132:135], v[80:83]
  v_exp_f32 v97, v33
  v_mfma_f32_16x16x32_bf16 v[80:83], a[216:219], a[136:139], v[80:83]
  v_exp_f32 v98, v34
  v_mfma_f32_16x16x32_bf16 v[80:83], a[220:223], a[140:143], v[80:83]
  v_exp_f32 v99, v35
  v_mfma_f32_16x16x32_bf16 v[84:87], a[220:223], a[156:159], v[148:151]
  v_exp_f32 v100, v36
  v_mfma_f32_16x16x32_bf16 v[84:87], a[216:219], a[152:155], v[84:87]
  v_exp_f32 v101, v37
  v_mfma_f32_16x16x32_bf16 v[84:87], a[212:215], a[148:151], v[84:87]
  v_exp_f32 v102, v38
  v_mfma_f32_16x16x32_bf16 v[84:87], a[208:211], a[144:147], v[84:87]
  v_exp_f32 v103, v39
  v_mfma_f32_16x16x32_bf16 v[88:91], a[208:211], a[160:163], v[152:155]
  v_exp_f32 v104, v40
  v_mfma_f32_16x16x32_bf16 v[88:91], a[212:215], a[164:167], v[88:91]
  v_exp_f32 v105, v41
  v_mfma_f32_16x16x32_bf16 v[88:91], a[216:219], a[168:171], v[88:91]
  v_exp_f32 v106, v42
  v_mfma_f32_16x16x32_bf16 v[88:91], a[220:223], a[172:175], v[88:91]
  v_exp_f32 v107, v43
  v_mfma_f32_16x16x32_bf16 v[92:95], a[220:223], a[188:191], v[156:159]
  v_exp_f32 v108, v44
  v_mfma_f32_16x16x32_bf16 v[92:95], a[216:219], a[184:187], v[92:95]
  s_waitcnt lgkmcnt(0) vmcnt(4)
  v_exp_f32 v109, v45
  v_mfma_f32_16x16x32_bf16 v[92:95], a[212:215], a[180:183], v[92:95]
  s_barrier
  v_exp_f32 v110, v46
  v_mfma_f32_16x16x32_bf16 v[92:95], a[208:211], a[176:179], v[92:95]
  v_exp_f32 v111, v47
  ds_read_b128 a[192:195], v2 offset:16384
  ds_read_b128 a[196:199], v3 offset:16384
  ds_read_b128 a[200:203], v4 offset:16384
  ds_read_b128 a[204:207], v5 offset:16384
  ds_read_b128 a[208:211], v2 offset:20480
  ds_read_b128 a[212:215], v3 offset:20480
  ds_read_b128 a[216:219], v4 offset:20480
  ds_read_b128 a[220:223], v5 offset:20480
  s_add_u32 m0, s60, 49152
  s_nop 0
  buffer_load_dwordx4 v26, s[52:55], s50 offen lds
  buffer_load_dwordx4 v27, s[52:55], s50 offen offset:1024 lds
  buffer_load_dwordx4 v28, s[52:55], s50 offen offset:2048 lds
  buffer_load_dwordx4 v29, s[52:55], s50 offen offset:3072 lds
  v_exp_f32 v112, v48
  v_exp_f32 v113, v49
  v_exp_f32 v114, v50
  v_exp_f32 v115, v51
  v_exp_f32 v116, v52
  v_exp_f32 v117, v53
  v_exp_f32 v118, v54
  v_exp_f32 v119, v55
  v_exp_f32 v120, v56
  v_exp_f32 v121, v57
  v_exp_f32 v122, v58
  v_exp_f32 v123, v59
  v_exp_f32 v124, v60
  v_exp_f32 v125, v61
  v_exp_f32 v126, v62
  v_exp_f32 v127, v63
  s_waitcnt lgkmcnt(0)
  s_add_u32 s50, s50, 16384
  v_mfma_f32_16x16x32_bf16 v[32:35], a[192:195], a[128:131], v[144:147]
  ds_read_b64_tr_b16 a[224:225], v6 offset:0
  v_cvt_pk_bf16_f32 v128, v96, v97
  v_mfma_f32_16x16x32_bf16 v[32:35], a[196:199], a[132:135], v[32:35]
  ds_read_b64_tr_b16 a[226:227], v6 offset:4096
  v_cvt_pk_bf16_f32 v129, v98, v99
  v_mfma_f32_16x16x32_bf16 v[32:35], a[200:203], a[136:139], v[32:35]
  ds_read_b64_tr_b16 a[228:229], v7 offset:0
  v_cvt_pk_bf16_f32 v130, v112, v113
  v_mfma_f32_16x16x32_bf16 v[32:35], a[204:207], a[140:143], v[32:35]
  ds_read_b64_tr_b16 a[230:231], v7 offset:4096
  v_cvt_pk_bf16_f32 v131, v114, v115
  v_mfma_f32_16x16x32_bf16 v[36:39], a[204:207], a[156:159], v[148:151]
  ds_read_b64_tr_b16 a[232:233], v8 offset:0
  v_cvt_pk_bf16_f32 v132, v100, v101
  v_mfma_f32_16x16x32_bf16 v[36:39], a[200:203], a[152:155], v[36:39]
  ds_read_b64_tr_b16 a[234:235], v8 offset:4096
  v_cvt_pk_bf16_f32 v133, v102, v103
  v_mfma_f32_16x16x32_bf16 v[36:39], a[196:199], a[148:151], v[36:39]
  ds_read_b64_tr_b16 a[236:237], v9 offset:0
  v_cvt_pk_bf16_f32 v134, v116, v117
  v_mfma_f32_16x16x32_bf16 v[36:39], a[192:195], a[144:147], v[36:39]
  ds_read_b64_tr_b16 a[238:239], v9 offset:4096
  v_cvt_pk_bf16_f32 v135, v118, v119
  v_mfma_f32_16x16x32_bf16 v[40:43], a[192:195], a[160:163], v[152:155]
  ds_read_b64_tr_b16 a[240:241], v10 offset:0
  v_cvt_pk_bf16_f32 v136, v104, v105
  v_mfma_f32_16x16x32_bf16 v[40:43], a[196:199], a[164:167], v[40:43]
  ds_read_b64_tr_b16 a[242:243], v10 offset:4096
  v_cvt_pk_bf16_f32 v137, v106, v107
  v_mfma_f32_16x16x32_bf16 v[40:43], a[200:203], a[168:171], v[40:43]
  ds_read_b64_tr_b16 a[244:245], v11 offset:0
  v_cvt_pk_bf16_f32 v138, v120, v121
  v_mfma_f32_16x16x32_bf16 v[40:43], a[204:207], a[172:175], v[40:43]
  ds_read_b64_tr_b16 a[246:247], v11 offset:4096
  v_cvt_pk_bf16_f32 v139, v122, v123
  v_mfma_f32_16x16x32_bf16 v[44:47], a[204:207], a[188:191], v[156:159]
  ds_read_b64_tr_b16 a[248:249], v12 offset:0
  v_cvt_pk_bf16_f32 v140, v108, v109
  v_mfma_f32_16x16x32_bf16 v[44:47], a[200:203], a[184:187], v[44:47]
  ds_read_b64_tr_b16 a[250:251], v12 offset:4096
  v_cvt_pk_bf16_f32 v141, v110, v111
  v_mfma_f32_16x16x32_bf16 v[44:47], a[196:199], a[180:183], v[44:47]
  ds_read_b64_tr_b16 a[252:253], v13 offset:0
  v_cvt_pk_bf16_f32 v142, v124, v125
  v_mfma_f32_16x16x32_bf16 v[44:47], a[192:195], a[176:179], v[44:47]
  ds_read_b64_tr_b16 a[254:255], v13 offset:4096
  v_cvt_pk_bf16_f32 v143, v126, v127
  v_mfma_f32_16x16x32_bf16 v[48:51], a[208:211], a[128:131], v[144:147]
  v_exp_f32 v96, v64
  v_mfma_f32_16x16x32_bf16 v[48:51], a[212:215], a[132:135], v[48:51]
  v_exp_f32 v97, v65
  v_mfma_f32_16x16x32_bf16 v[48:51], a[216:219], a[136:139], v[48:51]
  v_exp_f32 v98, v66
  v_mfma_f32_16x16x32_bf16 v[48:51], a[220:223], a[140:143], v[48:51]
  v_exp_f32 v99, v67
  v_mfma_f32_16x16x32_bf16 v[52:55], a[220:223], a[156:159], v[148:151]
  v_exp_f32 v100, v68
  v_mfma_f32_16x16x32_bf16 v[52:55], a[216:219], a[152:155], v[52:55]
  v_exp_f32 v101, v69
  v_mfma_f32_16x16x32_bf16 v[52:55], a[212:215], a[148:151], v[52:55]
  v_exp_f32 v102, v70
  v_mfma_f32_16x16x32_bf16 v[52:55], a[208:211], a[144:147], v[52:55]
  v_exp_f32 v103, v71
  v_mfma_f32_16x16x32_bf16 v[56:59], a[208:211], a[160:163], v[152:155]
  v_exp_f32 v104, v72
  v_mfma_f32_16x16x32_bf16 v[56:59], a[212:215], a[164:167], v[56:59]
  v_exp_f32 v105, v73
  v_mfma_f32_16x16x32_bf16 v[56:59], a[216:219], a[168:171], v[56:59]
  v_exp_f32 v106, v74
  v_mfma_f32_16x16x32_bf16 v[56:59], a[220:223], a[172:175], v[56:59]
  v_exp_f32 v107, v75
  v_mfma_f32_16x16x32_bf16 v[60:63], a[220:223], a[188:191], v[156:159]
  v_exp_f32 v108, v76
  v_mfma_f32_16x16x32_bf16 v[60:63], a[216:219], a[184:187], v[60:63]
  s_waitcnt lgkmcnt(0)
  v_exp_f32 v109, v77
  v_mfma_f32_16x16x32_bf16 v[60:63], a[212:215], a[180:183], v[60:63]
  v_exp_f32 v110, v78
  v_mfma_f32_16x16x32_bf16 v[60:63], a[208:211], a[176:179], v[60:63]
  v_exp_f32 v111, v79
  v_mfma_f32_16x16x32_bf16 a[0:3], a[224:227], v[128:131], 0
  ds_read_b128 a[192:195], v2 offset:24576
  v_mfma_f32_16x16x32_bf16 a[4:7], a[224:227], v[132:135], 0
  v_exp_f32 v112, v80
  v_mfma_f32_16x16x32_bf16 a[8:11], a[224:227], v[136:139], 0
  ds_read_b128 a[196:199], v3 offset:24576
  v_mfma_f32_16x16x32_bf16 a[12:15], a[224:227], v[140:143], 0
  v_exp_f32 v113, v81
  v_mfma_f32_16x16x32_bf16 a[28:31], a[228:231], v[140:143], 0
  ds_read_b128 a[200:203], v4 offset:24576
  v_mfma_f32_16x16x32_bf16 a[24:27], a[228:231], v[136:139], 0
  v_exp_f32 v114, v82
  v_mfma_f32_16x16x32_bf16 a[20:23], a[228:231], v[132:135], 0
  ds_read_b128 a[204:207], v5 offset:24576
  v_mfma_f32_16x16x32_bf16 a[16:19], a[228:231], v[128:131], 0
  v_exp_f32 v115, v83
  v_mfma_f32_16x16x32_bf16 v[160:163], v[176:179], v[128:131], 0
  ds_read_b128 a[208:211], v2 offset:28672
  v_mfma_f32_16x16x32_bf16 a[32:35], a[232:235], v[128:131], 0
  v_exp_f32 v116, v84
  v_mfma_f32_16x16x32_bf16 a[36:39], a[232:235], v[132:135], 0
  ds_read_b128 a[212:215], v3 offset:28672
  v_mfma_f32_16x16x32_bf16 a[40:43], a[232:235], v[136:139], 0
  v_exp_f32 v117, v85
  v_mfma_f32_16x16x32_bf16 a[44:47], a[232:235], v[140:143], 0
  ds_read_b128 a[216:219], v4 offset:28672
  v_mfma_f32_16x16x32_bf16 a[60:63], a[236:239], v[140:143], 0
  v_exp_f32 v118, v86
  v_mfma_f32_16x16x32_bf16 a[56:59], a[236:239], v[136:139], 0
  ds_read_b128 a[220:223], v5 offset:28672
  v_mfma_f32_16x16x32_bf16 a[52:55], a[236:239], v[132:135], 0
  v_exp_f32 v119, v87
  v_mfma_f32_16x16x32_bf16 a[48:51], a[236:239], v[128:131], 0
  s_add_u32 m0, s61, 32768
  v_exp_f32 v120, v88
  v_mfma_f32_16x16x32_bf16 v[164:167], v[176:179], v[132:135], 0
  buffer_load_dwordx4 v30, s[56:59], s51 offen lds
  v_mfma_f32_16x16x32_bf16 a[64:67], a[240:243], v[128:131], 0
  v_exp_f32 v121, v89
  v_mfma_f32_16x16x32_bf16 a[68:71], a[240:243], v[132:135], 0
  buffer_load_dwordx4 v31, s[56:59], s51 offen offset:1024 lds
  v_mfma_f32_16x16x32_bf16 a[72:75], a[240:243], v[136:139], 0
  v_exp_f32 v122, v90
  v_mfma_f32_16x16x32_bf16 a[76:79], a[240:243], v[140:143], 0
  buffer_load_dwordx4 v30, s[56:59], s51 offen offset:2048 lds
  v_mfma_f32_16x16x32_bf16 a[92:95], a[244:247], v[140:143], 0
  v_exp_f32 v123, v91
  v_mfma_f32_16x16x32_bf16 a[88:91], a[244:247], v[136:139], 0
  buffer_load_dwordx4 v31, s[56:59], s51 offen offset:3072 lds
  v_mfma_f32_16x16x32_bf16 a[84:87], a[244:247], v[132:135], 0
  v_exp_f32 v124, v92
  v_mfma_f32_16x16x32_bf16 a[80:83], a[244:247], v[128:131], 0
  v_mfma_f32_16x16x32_bf16 v[168:171], v[176:179], v[136:139], 0
  v_exp_f32 v125, v93
  v_mfma_f32_16x16x32_bf16 a[96:99], a[248:251], v[128:131], 0
  v_mfma_f32_16x16x32_bf16 a[100:103], a[248:251], v[132:135], 0
  v_exp_f32 v126, v94
  v_mfma_f32_16x16x32_bf16 a[104:107], a[248:251], v[136:139], 0
  v_mfma_f32_16x16x32_bf16 a[108:111], a[248:251], v[140:143], 0
  v_exp_f32 v127, v95
  v_mfma_f32_16x16x32_bf16 a[124:127], a[252:255], v[140:143], 0
  v_mfma_f32_16x16x32_bf16 a[120:123], a[252:255], v[136:139], 0
  v_mfma_f32_16x16x32_bf16 a[116:119], a[252:255], v[132:135], 0
  s_waitcnt lgkmcnt(0)
  v_mfma_f32_16x16x32_bf16 a[112:115], a[252:255], v[128:131], 0
  v_mfma_f32_16x16x32_bf16 v[172:175], v[176:179], v[140:143], 0
  s_add_u32 s51, s51, 16384
  s_mov_b32 s62, 7
  .p2align 6
att_loop_2:
  v_mfma_f32_16x16x32_bf16 v[64:67], a[192:195], a[128:131], v[144:147]
  ds_read_b64_tr_b16 a[224:225], v6 offset:8192
  v_cvt_pk_bf16_f32 v128, v96, v97
  v_mfma_f32_16x16x32_bf16 v[64:67], a[196:199], a[132:135], v[64:67]
  ds_read_b64_tr_b16 a[226:227], v6 offset:12288
  v_cvt_pk_bf16_f32 v129, v98, v99
  v_mfma_f32_16x16x32_bf16 v[64:67], a[200:203], a[136:139], v[64:67]
  ds_read_b64_tr_b16 a[228:229], v7 offset:8192
  v_cvt_pk_bf16_f32 v130, v112, v113
  v_mfma_f32_16x16x32_bf16 v[64:67], a[204:207], a[140:143], v[64:67]
  ds_read_b64_tr_b16 a[230:231], v7 offset:12288
  v_cvt_pk_bf16_f32 v131, v114, v115
  v_mfma_f32_16x16x32_bf16 v[68:71], a[204:207], a[156:159], v[148:151]
  ds_read_b64_tr_b16 a[232:233], v8 offset:8192
  v_cvt_pk_bf16_f32 v132, v100, v101
  v_mfma_f32_16x16x32_bf16 v[68:71], a[200:203], a[152:155], v[68:71]
  ds_read_b64_tr_b16 a[234:235], v8 offset:12288
  v_cvt_pk_bf16_f32 v133, v102, v103
  v_mfma_f32_16x16x32_bf16 v[68:71], a[196:199], a[148:151], v[68:71]
  ds_read_b64_tr_b16 a[236:237], v9 offset:8192
  v_cvt_pk_bf16_f32 v134, v116, v117
  v_mfma_f32_16x16x32_bf16 v[68:71], a[192:195], a[144:147], v[68:71]
  ds_read_b64_tr_b16 a[238:239], v9 offset:12288
  v_cvt_pk_bf16_f32 v135, v118, v119
  v_mfma_f32_16x16x32_bf16 v[72:75], a[192:195], a[160:163], v[152:155]
  ds_read_b64_tr_b16 a[240:241], v10 offset:8192
  v_cvt_pk_bf16_f32 v136, v104, v105
  v_mfma_f32_16x16x32_bf16 v[72:75], a[196:199], a[164:167], v[72:75]
  ds_read_b64_tr_b16 a[242:243], v10 offset:12288
  v_cvt_pk_bf16_f32 v137, v106, v107
  v_mfma_f32_16x16x32_bf16 v[72:75], a[200:203], a[168:171], v[72:75]
  ds_read_b64_tr_b16 a[244:245], v11 offset:8192
  v_cvt_pk_bf16_f32 v138, v120, v121
  v_mfma_f32_16x16x32_bf16 v[72:75], a[204:207], a[172:175], v[72:75]
  ds_read_b64_tr_b16 a[246:247], v11 offset:12288
  v_cvt_pk_bf16_f32 v139, v122, v123
  v_mfma_f32_16x16x32_bf16 v[76:79], a[204:207], a[188:191], v[156:159]
  ds_read_b64_tr_b16 a[248:249], v12 offset:8192
  v_cvt_pk_bf16_f32 v140, v108, v109
  v_mfma_f32_16x16x32_bf16 v[76:79], a[200:203], a[184:187], v[76:79]
  ds_read_b64_tr_b16 a[250:251], v12 offset:12288
  v_cvt_pk_bf16_f32 v141, v110, v111
  v_mfma_f32_16x16x32_bf16 v[76:79], a[196:199], a[180:183], v[76:79]
  ds_read_b64_tr_b16 a[252:253], v13 offset:8192
  v_cvt_pk_bf16_f32 v142, v124, v125
  v_mfma_f32_16x16x32_bf16 v[76:79], a[192:195], a[176:179], v[76:79]
  ds_read_b64_tr_b16 a[254:255], v13 offset:12288
  v_cvt_pk_bf16_f32 v143, v126, v127
  v_mfma_f32_16x16x32_bf16 v[80:83], a[208:211], a[128:131], v[144:147]
  v_exp_f32 v96, v32
  v_mfma_f32_16x16x32_bf16 v[80:83], a[212:215], a[132:135], v[80:83]
  v_exp_f32 v97, v33
  v_mfma_f32_16x16x32_bf16 v[80:83], a[216:219], a[136:139], v[80:83]
  v_exp_f32 v98, v34
  v_mfma_f32_16x16x32_bf16 v[80:83], a[220:223], a[140:143], v[80:83]
  v_exp_f32 v99, v35
  v_mfma_f32_16x16x32_bf16 v[84:87], a[220:223], a[156:159], v[148:151]
  v_exp_f32 v100, v36
  v_mfma_f32_16x16x32_bf16 v[84:87], a[216:219], a[152:155], v[84:87]
  v_exp_f32 v101, v37
  v_mfma_f32_16x16x32_bf16 v[84:87], a[212:215], a[148:151], v[84:87]
  v_exp_f32 v102, v38
  v_mfma_f32_16x16x32_bf16 v[84:87], a[208:211], a[144:147], v[84:87]
  v_exp_f32 v103, v39
  v_mfma_f32_16x16x32_bf16 v[88:91], a[208:211], a[160:163], v[152:155]
  v_exp_f32 v104, v40
  v_mfma_f32_16x16x32_bf16 v[88:91], a[212:215], a[164:167], v[88:91]
  v_exp_f32 v105, v41
  v_mfma_f32_16x16x32_bf16 v[88:91], a[216:219], a[168:171], v[88:91]
  v_exp_f32 v106, v42
  v_mfma_f32_16x16x32_bf16 v[88:91], a[220:223], a[172:175], v[88:91]
  v_exp_f32 v107, v43
  v_mfma_f32_16x16x32_bf16 v[92:95], a[220:223], a[188:191], v[156:159]
  v_exp_f32 v108, v44
  v_mfma_f32_16x16x32_bf16 v[92:95], a[216:219], a[184:187], v[92:95]
  s_waitcnt lgkmcnt(0) vmcnt(8)
  v_exp_f32 v109, v45
  v_mfma_f32_16x16x32_bf16 v[92:95], a[212:215], a[180:183], v[92:95]
  s_barrier
  v_exp_f32 v110, v46
  v_mfma_f32_16x16x32_bf16 v[92:95], a[208:211], a[176:179], v[92:95]
  v_exp_f32 v111, v47
  v_mfma_f32_16x16x32_bf16 a[0:3], a[224:227], v[128:131], a[0:3]
  ds_read_b128 a[192:195], v2 offset:32768
  v_mfma_f32_16x16x32_bf16 a[4:7], a[224:227], v[132:135], a[4:7]
  v_exp_f32 v112, v48
  v_mfma_f32_16x16x32_bf16 a[8:11], a[224:227], v[136:139], a[8:11]
  ds_read_b128 a[196:199], v3 offset:32768
  v_mfma_f32_16x16x32_bf16 a[12:15], a[224:227], v[140:143], a[12:15]
  v_exp_f32 v113, v49
  v_mfma_f32_16x16x32_bf16 a[28:31], a[228:231], v[140:143], a[28:31]
  ds_read_b128 a[200:203], v4 offset:32768
  v_mfma_f32_16x16x32_bf16 a[24:27], a[228:231], v[136:139], a[24:27]
  v_exp_f32 v114, v50
  v_mfma_f32_16x16x32_bf16 a[20:23], a[228:231], v[132:135], a[20:23]
  ds_read_b128 a[204:207], v5 offset:32768
  v_mfma_f32_16x16x32_bf16 a[16:19], a[228:231], v[128:131], a[16:19]
  v_exp_f32 v115, v51
  v_mfma_f32_16x16x32_bf16 v[160:163], v[176:179], v[128:131], v[160:163]
  ds_read_b128 a[208:211], v2 offset:36864
  v_mfma_f32_16x16x32_bf16 a[32:35], a[232:235], v[128:131], a[32:35]
  v_exp_f32 v116, v52
  v_mfma_f32_16x16x32_bf16 a[36:39], a[232:235], v[132:135], a[36:39]
  ds_read_b128 a[212:215], v3 offset:36864
  v_mfma_f32_16x16x32_bf16 a[40:43], a[232:235], v[136:139], a[40:43]
  v_exp_f32 v117, v53
  v_mfma_f32_16x16x32_bf16 a[44:47], a[232:235], v[140:143], a[44:47]
  ds_read_b128 a[216:219], v4 offset:36864
  v_mfma_f32_16x16x32_bf16 a[60:63], a[236:239], v[140:143], a[60:63]
  v_exp_f32 v118, v54
  v_mfma_f32_16x16x32_bf16 a[56:59], a[236:239], v[136:139], a[56:59]
  ds_read_b128 a[220:223], v5 offset:36864
  v_mfma_f32_16x16x32_bf16 a[52:55], a[236:239], v[132:135], a[52:55]
  v_exp_f32 v119, v55
  v_mfma_f32_16x16x32_bf16 a[48:51], a[236:239], v[128:131], a[48:51]
  s_add_u32 m0, s60, 0
  v_exp_f32 v120, v56
  v_mfma_f32_16x16x32_bf16 v[164:167], v[176:179], v[132:135], v[164:167]
  buffer_load_dwordx4 v26, s[52:55], s50 offen lds
  v_mfma_f32_16x16x32_bf16 a[64:67], a[240:243], v[128:131], a[64:67]
  v_exp_f32 v121, v57
  v_mfma_f32_16x16x32_bf16 a[68:71], a[240:243], v[132:135], a[68:71]
  buffer_load_dwordx4 v27, s[52:55], s50 offen offset:1024 lds
  v_mfma_f32_16x16x32_bf16 a[72:75], a[240:243], v[136:139], a[72:75]
  v_exp_f32 v122, v58
  v_mfma_f32_16x16x32_bf16 a[76:79], a[240:243], v[140:143], a[76:79]
  buffer_load_dwordx4 v28, s[52:55], s50 offen offset:2048 lds
  v_mfma_f32_16x16x32_bf16 a[92:95], a[244:247], v[140:143], a[92:95]
  v_exp_f32 v123, v59
  v_mfma_f32_16x16x32_bf16 a[88:91], a[244:247], v[136:139], a[88:91]
  buffer_load_dwordx4 v29, s[52:55], s50 offen offset:3072 lds
  v_mfma_f32_16x16x32_bf16 a[84:87], a[244:247], v[132:135], a[84:87]
  v_exp_f32 v124, v60
  v_mfma_f32_16x16x32_bf16 a[80:83], a[244:247], v[128:131], a[80:83]
  v_mfma_f32_16x16x32_bf16 v[168:171], v[176:179], v[136:139], v[168:171]
  v_exp_f32 v125, v61
  v_mfma_f32_16x16x32_bf16 a[96:99], a[248:251], v[128:131], a[96:99]
  v_mfma_f32_16x16x32_bf16 a[100:103], a[248:251], v[132:135], a[100:103]
  v_exp_f32 v126, v62
  v_mfma_f32_16x16x32_bf16 a[104:107], a[248:251], v[136:139], a[104:107]
  v_mfma_f32_16x16x32_bf16 a[108:111], a[248:251], v[140:143], a[108:111]
  v_exp_f32 v127, v63
  v_mfma_f32_16x16x32_bf16 a[124:127], a[252:255], v[140:143], a[124:127]
  v_mfma_f32_16x16x32_bf16 a[120:123], a[252:255], v[136:139], a[120:123]
  v_mfma_f32_16x16x32_bf16 a[116:119], a[252:255], v[132:135], a[116:119]
  s_waitcnt lgkmcnt(0)
  v_mfma_f32_16x16x32_bf16 a[112:115], a[252:255], v[128:131], a[112:115]
  v_mfma_f32_16x16x32_bf16 v[172:175], v[176:179], v[140:143], v[172:175]
  s_add_u32 s50, s50, 16384
  v_mfma_f32_16x16x32_bf16 v[32:35], a[192:195], a[128:131], v[144:147]
  ds_read_b64_tr_b16 a[224:225], v6 offset:16384
  v_cvt_pk_bf16_f32 v128, v96, v97
  v_mfma_f32_16x16x32_bf16 v[32:35], a[196:199], a[132:135], v[32:35]
  ds_read_b64_tr_b16 a[226:227], v6 offset:20480
  v_cvt_pk_bf16_f32 v129, v98, v99
  v_mfma_f32_16x16x32_bf16 v[32:35], a[200:203], a[136:139], v[32:35]
  ds_read_b64_tr_b16 a[228:229], v7 offset:16384
  v_cvt_pk_bf16_f32 v130, v112, v113
  v_mfma_f32_16x16x32_bf16 v[32:35], a[204:207], a[140:143], v[32:35]
  ds_read_b64_tr_b16 a[230:231], v7 offset:20480
  v_cvt_pk_bf16_f32 v131, v114, v115
  v_mfma_f32_16x16x32_bf16 v[36:39], a[204:207], a[156:159], v[148:151]
  ds_read_b64_tr_b16 a[232:233], v8 offset:16384
  v_cvt_pk_bf16_f32 v132, v100, v101
  v_mfma_f32_16x16x32_bf16 v[36:39], a[200:203], a[152:155], v[36:39]
  ds_read_b64_tr_b16 a[234:235], v8 offset:20480
  v_cvt_pk_bf16_f32 v133, v102, v103
  v_mfma_f32_16x16x32_bf16 v[36:39], a[196:199], a[148:151], v[36:39]
  ds_read_b64_tr_b16 a[236:237], v9 offset:16384
  v_cvt_pk_bf16_f32 v134, v116, v117
  v_mfma_f32_16x16x32_bf16 v[36:39], a[192:195], a[144:147], v[36:39]
  ds_read_b64_tr_b16 a[238:239], v9 offset:20480
  v_cvt_pk_bf16_f32 v135, v118, v119
  v_mfma_f32_16x16x32_bf16 v[40:43], a[192:195], a[160:163], v[152:155]
  ds_read_b64_tr_b16 a[240:241], v10 offset:16384
  v_cvt_pk_bf16_f32 v136, v104, v105
  v_mfma_f32_16x16x32_bf16 v[40:43], a[196:199], a[164:167], v[40:43]
  ds_read_b64_tr_b16 a[242:243], v10 offset:20480
  v_cvt_pk_bf16_f32 v137, v106, v107
  v_mfma_f32_16x16x32_bf16 v[40:43], a[200:203], a[168:171], v[40:43]
  ds_read_b64_tr_b16 a[244:245], v11 offset:16384
  v_cvt_pk_bf16_f32 v138, v120, v121
  v_mfma_f32_16x16x32_bf16 v[40:43], a[204:207], a[172:175], v[40:43]
  ds_read_b64_tr_b16 a[246:247], v11 offset:20480
  v_cvt_pk_bf16_f32 v139, v122, v123
  v_mfma_f32_16x16x32_bf16 v[44:47], a[204:207], a[188:191], v[156:159]
  ds_read_b64_tr_b16 a[248:249], v12 offset:16384
  v_cvt_pk_bf16_f32 v140, v108, v109
  v_mfma_f32_16x16x32_bf16 v[44:47], a[200:203], a[184:187], v[44:47]
  ds_read_b64_tr_b16 a[250:251], v12 offset:20480
  v_cvt_pk_bf16_f32 v141, v110, v111
  v_mfma_f32_16x16x32_bf16 v[44:47], a[196:199], a[180:183], v[44:47]
  ds_read_b64_tr_b16 a[252:253], v13 offset:16384
  v_cvt_pk_bf16_f32 v142, v124, v125
  v_mfma_f32_16x16x32_bf16 v[44:47], a[192:195], a[176:179], v[44:47]
  ds_read_b64_tr_b16 a[254:255], v13 offset:20480
  v_cvt_pk_bf16_f32 v143, v126, v127
  v_mfma_f32_16x16x32_bf16 v[48:51], a[208:211], a[128:131], v[144:147]
  v_exp_f32 v96, v64
  v_mfma_f32_16x16x32_bf16 v[48:51], a[212:215], a[132:135], v[48:51]
  v_exp_f32 v97, v65
  v_mfma_f32_16x16x32_bf16 v[48:51], a[216:219], a[136:139], v[48:51]
  v_exp_f32 v98, v66
  v_mfma_f32_16x16x32_bf16 v[48:51], a[220:223], a[140:143], v[48:51]
  v_exp_f32 v99, v67
  v_mfma_f32_16x16x32_bf16 v[52:55], a[220:223], a[156:159], v[148:151]
  v_exp_f32 v100, v68
  v_mfma_f32_16x16x32_bf16 v[52:55], a[216:219], a[152:155], v[52:55]
  v_exp_f32 v101, v69
  v_mfma_f32_16x16x32_bf16 v[52:55], a[212:215], a[148:151], v[52:55]
  v_exp_f32 v102, v70
  v_mfma_f32_16x16x32_bf16 v[52:55], a[208:211], a[144:147], v[52:55]
  v_exp_f32 v103, v71
  v_mfma_f32_16x16x32_bf16 v[56:59], a[208:211], a[160:163], v[152:155]
  v_exp_f32 v104, v72
  v_mfma_f32_16x16x32_bf16 v[56:59], a[212:215], a[164:167], v[56:59]
  v_exp_f32 v105, v73
  v_mfma_f32_16x16x32_bf16 v[56:59], a[216:219], a[168:171], v[56:59]
  v_exp_f32 v106, v74
  v_mfma_f32_16x16x32_bf16 v[56:59], a[220:223], a[172:175], v[56:59]
  v_exp_f32 v107, v75
  v_mfma_f32_16x16x32_bf16 v[60:63], a[220:223], a[188:191], v[156:159]
  v_exp_f32 v108, v76
  v_mfma_f32_16x16x32_bf16 v[60:63], a[216:219], a[184:187], v[60:63]
  s_waitcnt lgkmcnt(0)
  v_exp_f32 v109, v77
  v_mfma_f32_16x16x32_bf16 v[60:63], a[212:215], a[180:183], v[60:63]
  v_exp_f32 v110, v78
  v_mfma_f32_16x16x32_bf16 v[60:63], a[208:211], a[176:179], v[60:63]
  v_exp_f32 v111, v79
  v_mfma_f32_16x16x32_bf16 a[0:3], a[224:227], v[128:131], a[0:3]
  ds_read_b128 a[192:195], v2 offset:40960
  v_mfma_f32_16x16x32_bf16 a[4:7], a[224:227], v[132:135], a[4:7]
  v_exp_f32 v112, v80
  v_mfma_f32_16x16x32_bf16 a[8:11], a[224:227], v[136:139], a[8:11]
  ds_read_b128 a[196:199], v3 offset:40960
  v_mfma_f32_16x16x32_bf16 a[12:15], a[224:227], v[140:143], a[12:15]
  v_exp_f32 v113, v81
  v_mfma_f32_16x16x32_bf16 a[28:31], a[228:231], v[140:143], a[28:31]
  ds_read_b128 a[200:203], v4 offset:40960
  v_mfma_f32_16x16x32_bf16 a[24:27], a[228:231], v[136:139], a[24:27]
  v_exp_f32 v114, v82
  v_mfma_f32_16x16x32_bf16 a[20:23], a[228:231], v[132:135], a[20:23]
  ds_read_b128 a[204:207], v5 offset:40960
  v_mfma_f32_16x16x32_bf16 a[16:19], a[228:231], v[128:131], a[16:19]
  v_exp_f32 v115, v83
  v_mfma_f32_16x16x32_bf16 v[160:163], v[176:179], v[128:131], v[160:163]
  ds_read_b128 a[208:211], v2 offset:45056
  v_mfma_f32_16x16x32_bf16 a[32:35], a[232:235], v[128:131], a[32:35]
  v_exp_f32 v116, v84
  v_mfma_f32_16x16x32_bf16 a[36:39], a[232:235], v[132:135], a[36:39]
  ds_read_b128 a[212:215], v3 offset:45056
  v_mfma_f32_16x16x32_bf16 a[40:43], a[232:235], v[136:139], a[40:43]
  v_exp_f32 v117, v85
  v_mfma_f32_16x16x32_bf16 a[44:47], a[232:235], v[140:143], a[44:47]
  ds_read_b128 a[216:219], v4 offset:45056
  v_mfma_f32_16x16x32_bf16 a[60:63], a[236:239], v[140:143], a[60:63]
  v_exp_f32 v118, v86
  v_mfma_f32_16x16x32_bf16 a[56:59], a[236:239], v[136:139], a[56:59]
  ds_read_b128 a[220:223], v5 offset:45056
  v_mfma_f32_16x16x32_bf16 a[52:55], a[236:239], v[132:135], a[52:55]
  v_exp_f32 v119, v87
  v_mfma_f32_16x16x32_bf16 a[48:51], a[236:239], v[128:131], a[48:51]
  s_add_u32 m0, s61, 49152
  v_exp_f32 v120, v88
  v_mfma_f32_16x16x32_bf16 v[164:167], v[176:179], v[132:135], v[164:167]
  buffer_load_dwordx4 v30, s[56:59], s51 offen lds
  v_mfma_f32_16x16x32_bf16 a[64:67], a[240:243], v[128:131], a[64:67]
  v_exp_f32 v121, v89
  v_mfma_f32_16x16x32_bf16 a[68:71], a[240:243], v[132:135], a[68:71]
  buffer_load_dwordx4 v31, s[56:59], s51 offen offset:1024 lds
  v_mfma_f32_16x16x32_bf16 a[72:75], a[240:243], v[136:139], a[72:75]
  v_exp_f32 v122, v90
  v_mfma_f32_16x16x32_bf16 a[76:79], a[240:243], v[140:143], a[76:79]
  buffer_load_dwordx4 v30, s[56:59], s51 offen offset:2048 lds
  v_mfma_f32_16x16x32_bf16 a[92:95], a[244:247], v[140:143], a[92:95]
  v_exp_f32 v123, v91
  v_mfma_f32_16x16x32_bf16 a[88:91], a[244:247], v[136:139], a[88:91]
  buffer_load_dwordx4 v31, s[56:59], s51 offen offset:3072 lds
  v_mfma_f32_16x16x32_bf16 a[84:87], a[244:247], v[132:135], a[84:87]
  v_exp_f32 v124, v92
  v_mfma_f32_16x16x32_bf16 a[80:83], a[244:247], v[128:131], a[80:83]
  v_mfma_f32_16x16x32_bf16 v[168:171], v[176:179], v[136:139], v[168:171]
  v_exp_f32 v125, v93
  v_mfma_f32_16x16x32_bf16 a[96:99], a[248:251], v[128:131], a[96:99]
  v_mfma_f32_16x16x32_bf16 a[100:103], a[248:251], v[132:135], a[100:103]
  v_exp_f32 v126, v94
  v_mfma_f32_16x16x32_bf16 a[104:107], a[248:251], v[136:139], a[104:107]
  v_mfma_f32_16x16x32_bf16 a[108:111], a[248:251], v[140:143], a[108:111]
  v_exp_f32 v127, v95
  v_mfma_f32_16x16x32_bf16 a[124:127], a[252:255], v[140:143], a[124:127]
  v_mfma_f32_16x16x32_bf16 a[120:123], a[252:255], v[136:139], a[120:123]
  v_mfma_f32_16x16x32_bf16 a[116:119], a[252:255], v[132:135], a[116:119]
  s_waitcnt lgkmcnt(0)
  v_mfma_f32_16x16x32_bf16 a[112:115], a[252:255], v[128:131], a[112:115]
  v_mfma_f32_16x16x32_bf16 v[172:175], v[176:179], v[140:143], v[172:175]
  s_add_u32 s51, s51, 16384
  buffer_load_dwordx4 v[196:199], v200, s[92:95], 0 offen
  v_add_u32 v200, 1024, v200
  v_mfma_f32_16x16x32_bf16 v[64:67], a[192:195], a[128:131], v[144:147]
  ds_read_b64_tr_b16 a[224:225], v6 offset:24576
  v_cvt_pk_bf16_f32 v128, v96, v97
  v_mfma_f32_16x16x32_bf16 v[64:67], a[196:199], a[132:135], v[64:67]
  ds_read_b64_tr_b16 a[226:227], v6 offset:28672
  v_cvt_pk_bf16_f32 v129, v98, v99
  v_mfma_f32_16x16x32_bf16 v[64:67], a[200:203], a[136:139], v[64:67]
  ds_read_b64_tr_b16 a[228:229], v7 offset:24576
  v_cvt_pk_bf16_f32 v130, v112, v113
  v_mfma_f32_16x16x32_bf16 v[64:67], a[204:207], a[140:143], v[64:67]
  ds_read_b64_tr_b16 a[230:231], v7 offset:28672
  v_cvt_pk_bf16_f32 v131, v114, v115
  v_mfma_f32_16x16x32_bf16 v[68:71], a[204:207], a[156:159], v[148:151]
  ds_read_b64_tr_b16 a[232:233], v8 offset:24576
  v_cvt_pk_bf16_f32 v132, v100, v101
  v_mfma_f32_16x16x32_bf16 v[68:71], a[200:203], a[152:155], v[68:71]
  ds_read_b64_tr_b16 a[234:235], v8 offset:28672
  v_cvt_pk_bf16_f32 v133, v102, v103
  v_mfma_f32_16x16x32_bf16 v[68:71], a[196:199], a[148:151], v[68:71]
  ds_read_b64_tr_b16 a[236:237], v9 offset:24576
  v_cvt_pk_bf16_f32 v134, v116, v117
  v_mfma_f32_16x16x32_bf16 v[68:71], a[192:195], a[144:147], v[68:71]
  ds_read_b64_tr_b16 a[238:239], v9 offset:28672
  v_cvt_pk_bf16_f32 v135, v118, v119
  v_mfma_f32_16x16x32_bf16 v[72:75], a[192:195], a[160:163], v[152:155]
  ds_read_b64_tr_b16 a[240:241], v10 offset:24576
  v_cvt_pk_bf16_f32 v136, v104, v105
  v_mfma_f32_16x16x32_bf16 v[72:75], a[196:199], a[164:167], v[72:75]
  ds_read_b64_tr_b16 a[242:243], v10 offset:28672
  v_cvt_pk_bf16_f32 v137, v106, v107
  v_mfma_f32_16x16x32_bf16 v[72:75], a[200:203], a[168:171], v[72:75]
  ds_read_b64_tr_b16 a[244:245], v11 offset:24576
  v_cvt_pk_bf16_f32 v138, v120, v121
  v_mfma_f32_16x16x32_bf16 v[72:75], a[204:207], a[172:175], v[72:75]
  ds_read_b64_tr_b16 a[246:247], v11 offset:28672
  v_cvt_pk_bf16_f32 v139, v122, v123
  v_mfma_f32_16x16x32_bf16 v[76:79], a[204:207], a[188:191], v[156:159]
  ds_read_b64_tr_b16 a[248:249], v12 offset:24576
  v_cvt_pk_bf16_f32 v140, v108, v109
  v_mfma_f32_16x16x32_bf16 v[76:79], a[200:203], a[184:187], v[76:79]
  ds_read_b64_tr_b16 a[250:251], v12 offset:28672
  v_cvt_pk_bf16_f32 v141, v110, v111
  v_mfma_f32_16x16x32_bf16 v[76:79], a[196:199], a[180:183], v[76:79]
  ds_read_b64_tr_b16 a[252:253], v13 offset:24576
  v_cvt_pk_bf16_f32 v142, v124, v125
  v_mfma_f32_16x16x32_bf16 v[76:79], a[192:195], a[176:179], v[76:79]
  ds_read_b64_tr_b16 a[254:255], v13 offset:28672
  v_cvt_pk_bf16_f32 v143, v126, v127
  v_mfma_f32_16x16x32_bf16 v[80:83], a[208:211], a[128:131], v[144:147]
  v_exp_f32 v96, v32
  v_mfma_f32_16x16x32_bf16 v[80:83], a[212:215], a[132:135], v[80:83]
  v_exp_f32 v97, v33
  v_mfma_f32_16x16x32_bf16 v[80:83], a[216:219], a[136:139], v[80:83]
  v_exp_f32 v98, v34
  v_mfma_f32_16x16x32_bf16 v[80:83], a[220:223], a[140:143], v[80:83]
  v_exp_f32 v99, v35
  v_mfma_f32_16x16x32_bf16 v[84:87], a[220:223], a[156:159], v[148:151]
  v_exp_f32 v100, v36
  v_mfma_f32_16x16x32_bf16 v[84:87], a[216:219], a[152:155], v[84:87]
  v_exp_f32 v101, v37
  v_mfma_f32_16x16x32_bf16 v[84:87], a[212:215], a[148:151], v[84:87]
  v_exp_f32 v102, v38
  v_mfma_f32_16x16x32_bf16 v[84:87], a[208:211], a[144:147], v[84:87]
  v_exp_f32 v103, v39
  v_mfma_f32_16x16x32_bf16 v[88:91], a[208:211], a[160:163], v[152:155]
  v_exp_f32 v104, v40
  v_mfma_f32_16x16x32_bf16 v[88:91], a[212:215], a[164:167], v[88:91]
  v_exp_f32 v105, v41
  v_mfma_f32_16x16x32_bf16 v[88:91], a[216:219], a[168:171], v[88:91]
  v_exp_f32 v106, v42
  v_mfma_f32_16x16x32_bf16 v[88:91], a[220:223], a[172:175], v[88:91]
  v_exp_f32 v107, v43
  v_mfma_f32_16x16x32_bf16 v[92:95], a[220:223], a[188:191], v[156:159]
  v_exp_f32 v108, v44
  v_mfma_f32_16x16x32_bf16 v[92:95], a[216:219], a[184:187], v[92:95]
  s_waitcnt lgkmcnt(0) vmcnt(8)
  v_exp_f32 v109, v45
  v_mfma_f32_16x16x32_bf16 v[92:95], a[212:215], a[180:183], v[92:95]
  s_barrier
  v_exp_f32 v110, v46
  v_mfma_f32_16x16x32_bf16 v[92:95], a[208:211], a[176:179], v[92:95]
  v_exp_f32 v111, v47
  v_mfma_f32_16x16x32_bf16 a[0:3], a[224:227], v[128:131], a[0:3]
  ds_read_b128 a[192:195], v2 offset:49152
  v_mfma_f32_16x16x32_bf16 a[4:7], a[224:227], v[132:135], a[4:7]
  v_exp_f32 v112, v48
  v_mfma_f32_16x16x32_bf16 a[8:11], a[224:227], v[136:139], a[8:11]
  ds_read_b128 a[196:199], v3 offset:49152
  v_mfma_f32_16x16x32_bf16 a[12:15], a[224:227], v[140:143], a[12:15]
  v_exp_f32 v113, v49
  v_mfma_f32_16x16x32_bf16 a[28:31], a[228:231], v[140:143], a[28:31]
  ds_read_b128 a[200:203], v4 offset:49152
  v_mfma_f32_16x16x32_bf16 a[24:27], a[228:231], v[136:139], a[24:27]
  v_exp_f32 v114, v50
  v_mfma_f32_16x16x32_bf16 a[20:23], a[228:231], v[132:135], a[20:23]
  ds_read_b128 a[204:207], v5 offset:49152
  v_mfma_f32_16x16x32_bf16 a[16:19], a[228:231], v[128:131], a[16:19]
  v_exp_f32 v115, v51
  v_mfma_f32_16x16x32_bf16 v[160:163], v[176:179], v[128:131], v[160:163]
  ds_read_b128 a[208:211], v2 offset:53248
  v_mfma_f32_16x16x32_bf16 a[32:35], a[232:235], v[128:131], a[32:35]
  v_exp_f32 v116, v52
  v_mfma_f32_16x16x32_bf16 a[36:39], a[232:235], v[132:135], a[36:39]
  ds_read_b128 a[212:215], v3 offset:53248
  v_mfma_f32_16x16x32_bf16 a[40:43], a[232:235], v[136:139], a[40:43]
  v_exp_f32 v117, v53
  v_mfma_f32_16x16x32_bf16 a[44:47], a[232:235], v[140:143], a[44:47]
  ds_read_b128 a[216:219], v4 offset:53248
  v_mfma_f32_16x16x32_bf16 a[60:63], a[236:239], v[140:143], a[60:63]
  v_exp_f32 v118, v54
  v_mfma_f32_16x16x32_bf16 a[56:59], a[236:239], v[136:139], a[56:59]
  ds_read_b128 a[220:223], v5 offset:53248
  v_mfma_f32_16x16x32_bf16 a[52:55], a[236:239], v[132:135], a[52:55]
  v_exp_f32 v119, v55
  v_mfma_f32_16x16x32_bf16 a[48:51], a[236:239], v[128:131], a[48:51]
  s_add_u32 m0, s60, 16384
  v_exp_f32 v120, v56
  v_mfma_f32_16x16x32_bf16 v[164:167], v[176:179], v[132:135], v[164:167]
  buffer_load_dwordx4 v26, s[52:55], s50 offen lds
  v_mfma_f32_16x16x32_bf16 a[64:67], a[240:243], v[128:131], a[64:67]
  v_exp_f32 v121, v57
  v_mfma_f32_16x16x32_bf16 a[68:71], a[240:243], v[132:135], a[68:71]
  buffer_load_dwordx4 v27, s[52:55], s50 offen offset:1024 lds
  v_mfma_f32_16x16x32_bf16 a[72:75], a[240:243], v[136:139], a[72:75]
  v_exp_f32 v122, v58
  v_mfma_f32_16x16x32_bf16 a[76:79], a[240:243], v[140:143], a[76:79]
  buffer_load_dwordx4 v28, s[52:55], s50 offen offset:2048 lds
  v_mfma_f32_16x16x32_bf16 a[92:95], a[244:247], v[140:143], a[92:95]
  v_exp_f32 v123, v59
  v_mfma_f32_16x16x32_bf16 a[88:91], a[244:247], v[136:139], a[88:91]
  buffer_load_dwordx4 v29, s[52:55], s50 offen offset:3072 lds
  v_mfma_f32_16x16x32_bf16 a[84:87], a[244:247], v[132:135], a[84:87]
  v_exp_f32 v124, v60
  v_mfma_f32_16x16x32_bf16 a[80:83], a[244:247], v[128:131], a[80:83]
  v_mfma_f32_16x16x32_bf16 v[168:171], v[176:179], v[136:139], v[168:171]
  v_exp_f32 v125, v61
  v_mfma_f32_16x16x32_bf16 a[96:99], a[248:251], v[128:131], a[96:99]
  v_mfma_f32_16x16x32_bf16 a[100:103], a[248:251], v[132:135], a[100:103]
  v_exp_f32 v126, v62
  v_mfma_f32_16x16x32_bf16 a[104:107], a[248:251], v[136:139], a[104:107]
  v_mfma_f32_16x16x32_bf16 a[108:111], a[248:251], v[140:143], a[108:111]
  v_exp_f32 v127, v63
  v_mfma_f32_16x16x32_bf16 a[124:127], a[252:255], v[140:143], a[124:127]
  v_mfma_f32_16x16x32_bf16 a[120:123], a[252:255], v[136:139], a[120:123]
  v_mfma_f32_16x16x32_bf16 a[116:119], a[252:255], v[132:135], a[116:119]
  s_waitcnt lgkmcnt(0)
  v_mfma_f32_16x16x32_bf16 a[112:115], a[252:255], v[128:131], a[112:115]
  v_mfma_f32_16x16x32_bf16 v[172:175], v[176:179], v[140:143], v[172:175]
  s_add_u32 s50, s50, 16384
  v_mfma_f32_16x16x32_bf16 v[32:35], a[192:195], a[128:131], v[144:147]
  ds_read_b64_tr_b16 a[224:225], v6 offset:32768
  v_cvt_pk_bf16_f32 v128, v96, v97
  v_mfma_f32_16x16x32_bf16 v[32:35], a[196:199], a[132:135], v[32:35]
  ds_read_b64_tr_b16 a[226:227], v6 offset:36864
  v_cvt_pk_bf16_f32 v129, v98, v99
  v_mfma_f32_16x16x32_bf16 v[32:35], a[200:203], a[136:139], v[32:35]
  ds_read_b64_tr_b16 a[228:229], v7 offset:32768
  v_cvt_pk_bf16_f32 v130, v112, v113
  v_mfma_f32_16x16x32_bf16 v[32:35], a[204:207], a[140:143], v[32:35]
  ds_read_b64_tr_b16 a[230:231], v7 offset:36864
  v_cvt_pk_bf16_f32 v131, v114, v115
  v_mfma_f32_16x16x32_bf16 v[36:39], a[204:207], a[156:159], v[148:151]
  ds_read_b64_tr_b16 a[232:233], v8 offset:32768
  v_cvt_pk_bf16_f32 v132, v100, v101
  v_mfma_f32_16x16x32_bf16 v[36:39], a[200:203], a[152:155], v[36:39]
  ds_read_b64_tr_b16 a[234:235], v8 offset:36864
  v_cvt_pk_bf16_f32 v133, v102, v103
  v_mfma_f32_16x16x32_bf16 v[36:39], a[196:199], a[148:151], v[36:39]
  ds_read_b64_tr_b16 a[236:237], v9 offset:32768
  v_cvt_pk_bf16_f32 v134, v116, v117
  v_mfma_f32_16x16x32_bf16 v[36:39], a[192:195], a[144:147], v[36:39]
  ds_read_b64_tr_b16 a[238:239], v9 offset:36864
  v_cvt_pk_bf16_f32 v135, v118, v119
  v_mfma_f32_16x16x32_bf16 v[40:43], a[192:195], a[160:163], v[152:155]
  ds_read_b64_tr_b16 a[240:241], v10 offset:32768
  v_cvt_pk_bf16_f32 v136, v104, v105
  v_mfma_f32_16x16x32_bf16 v[40:43], a[196:199], a[164:167], v[40:43]
  ds_read_b64_tr_b16 a[242:243], v10 offset:36864
  v_cvt_pk_bf16_f32 v137, v106, v107
  v_mfma_f32_16x16x32_bf16 v[40:43], a[200:203], a[168:171], v[40:43]
  ds_read_b64_tr_b16 a[244:245], v11 offset:32768
  v_cvt_pk_bf16_f32 v138, v120, v121
  v_mfma_f32_16x16x32_bf16 v[40:43], a[204:207], a[172:175], v[40:43]
  ds_read_b64_tr_b16 a[246:247], v11 offset:36864
  v_cvt_pk_bf16_f32 v139, v122, v123
  v_mfma_f32_16x16x32_bf16 v[44:47], a[204:207], a[188:191], v[156:159]
  ds_read_b64_tr_b16 a[248:249], v12 offset:32768
  v_cvt_pk_bf16_f32 v140, v108, v109
  v_mfma_f32_16x16x32_bf16 v[44:47], a[200:203], a[184:187], v[44:47]
  ds_read_b64_tr_b16 a[250:251], v12 offset:36864
  v_cvt_pk_bf16_f32 v141, v110, v111
  v_mfma_f32_16x16x32_bf16 v[44:47], a[196:199], a[180:183], v[44:47]
  ds_read_b64_tr_b16 a[252:253], v13 offset:32768
  v_cvt_pk_bf16_f32 v142, v124, v125
  v_mfma_f32_16x16x32_bf16 v[44:47], a[192:195], a[176:179], v[44:47]
  ds_read_b64_tr_b16 a[254:255], v13 offset:36864
  v_cvt_pk_bf16_f32 v143, v126, v127
  v_mfma_f32_16x16x32_bf16 v[48:51], a[208:211], a[128:131], v[144:147]
  v_exp_f32 v96, v64
  v_mfma_f32_16x16x32_bf16 v[48:51], a[212:215], a[132:135], v[48:51]
  v_exp_f32 v97, v65
  v_mfma_f32_16x16x32_bf16 v[48:51], a[216:219], a[136:139], v[48:51]
  v_exp_f32 v98, v66
  v_mfma_f32_16x16x32_bf16 v[48:51], a[220:223], a[140:143], v[48:51]
  v_exp_f32 v99, v67
  v_mfma_f32_16x16x32_bf16 v[52:55], a[220:223], a[156:159], v[148:151]
  v_exp_f32 v100, v68
  v_mfma_f32_16x16x32_bf16 v[52:55], a[216:219], a[152:155], v[52:55]
  v_exp_f32 v101, v69
  v_mfma_f32_16x16x32_bf16 v[52:55], a[212:215], a[148:151], v[52:55]
  v_exp_f32 v102, v70
  v_mfma_f32_16x16x32_bf16 v[52:55], a[208:211], a[144:147], v[52:55]
  v_exp_f32 v103, v71
  v_mfma_f32_16x16x32_bf16 v[56:59], a[208:211], a[160:163], v[152:155]
  v_exp_f32 v104, v72
  v_mfma_f32_16x16x32_bf16 v[56:59], a[212:215], a[164:167], v[56:59]
  v_exp_f32 v105, v73
  v_mfma_f32_16x16x32_bf16 v[56:59], a[216:219], a[168:171], v[56:59]
  v_exp_f32 v106, v74
  v_mfma_f32_16x16x32_bf16 v[56:59], a[220:223], a[172:175], v[56:59]
  v_exp_f32 v107, v75
  v_mfma_f32_16x16x32_bf16 v[60:63], a[220:223], a[188:191], v[156:159]
  v_exp_f32 v108, v76
  v_mfma_f32_16x16x32_bf16 v[60:63], a[216:219], a[184:187], v[60:63]
  s_waitcnt lgkmcnt(0)
  v_exp_f32 v109, v77
  v_mfma_f32_16x16x32_bf16 v[60:63], a[212:215], a[180:183], v[60:63]
  v_exp_f32 v110, v78
  v_mfma_f32_16x16x32_bf16 v[60:63], a[208:211], a[176:179], v[60:63]
  v_exp_f32 v111, v79
  v_mfma_f32_16x16x32_bf16 a[0:3], a[224:227], v[128:131], a[0:3]
  ds_read_b128 a[192:195], v2 offset:57344
  v_mfma_f32_16x16x32_bf16 a[4:7], a[224:227], v[132:135], a[4:7]
  v_exp_f32 v112, v80
  v_mfma_f32_16x16x32_bf16 a[8:11], a[224:227], v[136:139], a[8:11]
  ds_read_b128 a[196:199], v3 offset:57344
  v_mfma_f32_16x16x32_bf16 a[12:15], a[224:227], v[140:143], a[12:15]
  v_exp_f32 v113, v81
  v_mfma_f32_16x16x32_bf16 a[28:31], a[228:231], v[140:143], a[28:31]
  ds_read_b128 a[200:203], v4 offset:57344
  v_mfma_f32_16x16x32_bf16 a[24:27], a[228:231], v[136:139], a[24:27]
  v_exp_f32 v114, v82
  v_mfma_f32_16x16x32_bf16 a[20:23], a[228:231], v[132:135], a[20:23]
  ds_read_b128 a[204:207], v5 offset:57344
  v_mfma_f32_16x16x32_bf16 a[16:19], a[228:231], v[128:131], a[16:19]
  v_exp_f32 v115, v83
  v_mfma_f32_16x16x32_bf16 v[160:163], v[176:179], v[128:131], v[160:163]
  ds_read_b128 a[208:211], v2 offset:61440
  v_mfma_f32_16x16x32_bf16 a[32:35], a[232:235], v[128:131], a[32:35]
  v_exp_f32 v116, v84
  v_mfma_f32_16x16x32_bf16 a[36:39], a[232:235], v[132:135], a[36:39]
  ds_read_b128 a[212:215], v3 offset:61440
  v_mfma_f32_16x16x32_bf16 a[40:43], a[232:235], v[136:139], a[40:43]
  v_exp_f32 v117, v85
  v_mfma_f32_16x16x32_bf16 a[44:47], a[232:235], v[140:143], a[44:47]
  ds_read_b128 a[216:219], v4 offset:61440
  v_mfma_f32_16x16x32_bf16 a[60:63], a[236:239], v[140:143], a[60:63]
  v_exp_f32 v118, v86
  v_mfma_f32_16x16x32_bf16 a[56:59], a[236:239], v[136:139], a[56:59]
  ds_read_b128 a[220:223], v5 offset:61440
  v_mfma_f32_16x16x32_bf16 a[52:55], a[236:239], v[132:135], a[52:55]
  v_exp_f32 v119, v87
  v_mfma_f32_16x16x32_bf16 a[48:51], a[236:239], v[128:131], a[48:51]
  s_add_u32 m0, s61, 0
  v_exp_f32 v120, v88
  v_mfma_f32_16x16x32_bf16 v[164:167], v[176:179], v[132:135], v[164:167]
  buffer_load_dwordx4 v30, s[56:59], s51 offen lds
  v_mfma_f32_16x16x32_bf16 a[64:67], a[240:243], v[128:131], a[64:67]
  v_exp_f32 v121, v89
  v_mfma_f32_16x16x32_bf16 a[68:71], a[240:243], v[132:135], a[68:71]
  buffer_load_dwordx4 v31, s[56:59], s51 offen offset:1024 lds
  v_mfma_f32_16x16x32_bf16 a[72:75], a[240:243], v[136:139], a[72:75]
  v_exp_f32 v122, v90
  v_mfma_f32_16x16x32_bf16 a[76:79], a[240:243], v[140:143], a[76:79]
  buffer_load_dwordx4 v30, s[56:59], s51 offen offset:2048 lds
  v_mfma_f32_16x16x32_bf16 a[92:95], a[244:247], v[140:143], a[92:95]
  v_exp_f32 v123, v91
  v_mfma_f32_16x16x32_bf16 a[88:91], a[244:247], v[136:139], a[88:91]
  buffer_load_dwordx4 v31, s[56:59], s51 offen offset:3072 lds
  v_mfma_f32_16x16x32_bf16 a[84:87], a[244:247], v[132:135], a[84:87]
  v_exp_f32 v124, v92
  v_mfma_f32_16x16x32_bf16 a[80:83], a[244:247], v[128:131], a[80:83]
  v_mfma_f32_16x16x32_bf16 v[168:171], v[176:179], v[136:139], v[168:171]
  v_exp_f32 v125, v93
  v_mfma_f32_16x16x32_bf16 a[96:99], a[248:251], v[128:131], a[96:99]
  v_mfma_f32_16x16x32_bf16 a[100:103], a[248:251], v[132:135], a[100:103]
  v_exp_f32 v126, v94
  v_mfma_f32_16x16x32_bf16 a[104:107], a[248:251], v[136:139], a[104:107]
  v_mfma_f32_16x16x32_bf16 a[108:111], a[248:251], v[140:143], a[108:111]
  v_exp_f32 v127, v95
  v_mfma_f32_16x16x32_bf16 a[124:127], a[252:255], v[140:143], a[124:127]
  v_mfma_f32_16x16x32_bf16 a[120:123], a[252:255], v[136:139], a[120:123]
  v_mfma_f32_16x16x32_bf16 a[116:119], a[252:255], v[132:135], a[116:119]
  s_waitcnt lgkmcnt(0)
  v_mfma_f32_16x16x32_bf16 a[112:115], a[252:255], v[128:131], a[112:115]
  v_mfma_f32_16x16x32_bf16 v[172:175], v[176:179], v[140:143], v[172:175]
  s_add_u32 s51, s51, 16384
  buffer_load_dwordx4 v[196:199], v200, s[92:95], 0 offen
  v_add_u32 v200, 1024, v200
  v_mfma_f32_16x16x32_bf16 v[64:67], a[192:195], a[128:131], v[144:147]
  ds_read_b64_tr_b16 a[224:225], v6 offset:40960
  v_cvt_pk_bf16_f32 v128, v96, v97
  v_mfma_f32_16x16x32_bf16 v[64:67], a[196:199], a[132:135], v[64:67]
  ds_read_b64_tr_b16 a[226:227], v6 offset:45056
  v_cvt_pk_bf16_f32 v129, v98, v99
  v_mfma_f32_16x16x32_bf16 v[64:67], a[200:203], a[136:139], v[64:67]
  ds_read_b64_tr_b16 a[228:229], v7 offset:40960
  v_cvt_pk_bf16_f32 v130, v112, v113
  v_mfma_f32_16x16x32_bf16 v[64:67], a[204:207], a[140:143], v[64:67]
  ds_read_b64_tr_b16 a[230:231], v7 offset:45056
  v_cvt_pk_bf16_f32 v131, v114, v115
  v_mfma_f32_16x16x32_bf16 v[68:71], a[204:207], a[156:159], v[148:151]
  ds_read_b64_tr_b16 a[232:233], v8 offset:40960
  v_cvt_pk_bf16_f32 v132, v100, v101
  v_mfma_f32_16x16x32_bf16 v[68:71], a[200:203], a[152:155], v[68:71]
  ds_read_b64_tr_b16 a[234:235], v8 offset:45056
  v_cvt_pk_bf16_f32 v133, v102, v103
  v_mfma_f32_16x16x32_bf16 v[68:71], a[196:199], a[148:151], v[68:71]
  ds_read_b64_tr_b16 a[236:237], v9 offset:40960
  v_cvt_pk_bf16_f32 v134, v116, v117
  v_mfma_f32_16x16x32_bf16 v[68:71], a[192:195], a[144:147], v[68:71]
  ds_read_b64_tr_b16 a[238:239], v9 offset:45056
  v_cvt_pk_bf16_f32 v135, v118, v119
  v_mfma_f32_16x16x32_bf16 v[72:75], a[192:195], a[160:163], v[152:155]
  ds_read_b64_tr_b16 a[240:241], v10 offset:40960
  v_cvt_pk_bf16_f32 v136, v104, v105
  v_mfma_f32_16x16x32_bf16 v[72:75], a[196:199], a[164:167], v[72:75]
  ds_read_b64_tr_b16 a[242:243], v10 offset:45056
  v_cvt_pk_bf16_f32 v137, v106, v107
  v_mfma_f32_16x16x32_bf16 v[72:75], a[200:203], a[168:171], v[72:75]
  ds_read_b64_tr_b16 a[244:245], v11 offset:40960
  v_cvt_pk_bf16_f32 v138, v120, v121
  v_mfma_f32_16x16x32_bf16 v[72:75], a[204:207], a[172:175], v[72:75]
  ds_read_b64_tr_b16 a[246:247], v11 offset:45056
  v_cvt_pk_bf16_f32 v139, v122, v123
  v_mfma_f32_16x16x32_bf16 v[76:79], a[204:207], a[188:191], v[156:159]
  ds_read_b64_tr_b16 a[248:249], v12 offset:40960
  v_cvt_pk_bf16_f32 v140, v108, v109
  v_mfma_f32_16x16x32_bf16 v[76:79], a[200:203], a[184:187], v[76:79]
  ds_read_b64_tr_b16 a[250:251], v12 offset:45056
  v_cvt_pk_bf16_f32 v141, v110, v111
  v_mfma_f32_16x16x32_bf16 v[76:79], a[196:199], a[180:183], v[76:79]
  ds_read_b64_tr_b16 a[252:253], v13 offset:40960
  v_cvt_pk_bf16_f32 v142, v124, v125
  v_mfma_f32_16x16x32_bf16 v[76:79], a[192:195], a[176:179], v[76:79]
  ds_read_b64_tr_b16 a[254:255], v13 offset:45056
  v_cvt_pk_bf16_f32 v143, v126, v127
  v_mfma_f32_16x16x32_bf16 v[80:83], a[208:211], a[128:131], v[144:147]
  v_exp_f32 v96, v32
  v_mfma_f32_16x16x32_bf16 v[80:83], a[212:215], a[132:135], v[80:83]
  v_exp_f32 v97, v33
  v_mfma_f32_16x16x32_bf16 v[80:83], a[216:219], a[136:139], v[80:83]
  v_exp_f32 v98, v34
  v_mfma_f32_16x16x32_bf16 v[80:83], a[220:223], a[140:143], v[80:83]
  v_exp_f32 v99, v35
  v_mfma_f32_16x16x32_bf16 v[84:87], a[220:223], a[156:159], v[148:151]
  v_exp_f32 v100, v36
  v_mfma_f32_16x16x32_bf16 v[84:87], a[216:219], a[152:155], v[84:87]
  v_exp_f32 v101, v37
  v_mfma_f32_16x16x32_bf16 v[84:87], a[212:215], a[148:151], v[84:87]
  v_exp_f32 v102, v38
  v_mfma_f32_16x16x32_bf16 v[84:87], a[208:211], a[144:147], v[84:87]
  v_exp_f32 v103, v39
  v_mfma_f32_16x16x32_bf16 v[88:91], a[208:211], a[160:163], v[152:155]
  v_exp_f32 v104, v40
  v_mfma_f32_16x16x32_bf16 v[88:91], a[212:215], a[164:167], v[88:91]
  v_exp_f32 v105, v41
  v_mfma_f32_16x16x32_bf16 v[88:91], a[216:219], a[168:171], v[88:91]
  v_exp_f32 v106, v42
  v_mfma_f32_16x16x32_bf16 v[88:91], a[220:223], a[172:175], v[88:91]
  v_exp_f32 v107, v43
  v_mfma_f32_16x16x32_bf16 v[92:95], a[220:223], a[188:191], v[156:159]
  v_exp_f32 v108, v44
  v_mfma_f32_16x16x32_bf16 v[92:95], a[216:219], a[184:187], v[92:95]
  s_waitcnt lgkmcnt(0) vmcnt(8)
  v_exp_f32 v109, v45
  v_mfma_f32_16x16x32_bf16 v[92:95], a[212:215], a[180:183], v[92:95]
  s_barrier
  v_exp_f32 v110, v46
  v_mfma_f32_16x16x32_bf16 v[92:95], a[208:211], a[176:179], v[92:95]
  v_exp_f32 v111, v47
  v_mfma_f32_16x16x32_bf16 a[0:3], a[224:227], v[128:131], a[0:3]
  ds_read_b128 a[192:195], v2 offset:0
  v_mfma_f32_16x16x32_bf16 a[4:7], a[224:227], v[132:135], a[4:7]
  v_exp_f32 v112, v48
  v_mfma_f32_16x16x32_bf16 a[8:11], a[224:227], v[136:139], a[8:11]
  ds_read_b128 a[196:199], v3 offset:0
  v_mfma_f32_16x16x32_bf16 a[12:15], a[224:227], v[140:143], a[12:15]
  v_exp_f32 v113, v49
  v_mfma_f32_16x16x32_bf16 a[28:31], a[228:231], v[140:143], a[28:31]
  ds_read_b128 a[200:203], v4 offset:0
  v_mfma_f32_16x16x32_bf16 a[24:27], a[228:231], v[136:139], a[24:27]
  v_exp_f32 v114, v50
  v_mfma_f32_16x16x32_bf16 a[20:23], a[228:231], v[132:135], a[20:23]
  ds_read_b128 a[204:207], v5 offset:0
  v_mfma_f32_16x16x32_bf16 a[16:19], a[228:231], v[128:131], a[16:19]
  v_exp_f32 v115, v51
  v_mfma_f32_16x16x32_bf16 v[160:163], v[176:179], v[128:131], v[160:163]
  ds_read_b128 a[208:211], v2 offset:4096
  v_mfma_f32_16x16x32_bf16 a[32:35], a[232:235], v[128:131], a[32:35]
  v_exp_f32 v116, v52
  v_mfma_f32_16x16x32_bf16 a[36:39], a[232:235], v[132:135], a[36:39]
  ds_read_b128 a[212:215], v3 offset:4096
  v_mfma_f32_16x16x32_bf16 a[40:43], a[232:235], v[136:139], a[40:43]
  v_exp_f32 v117, v53
  v_mfma_f32_16x16x32_bf16 a[44:47], a[232:235], v[140:143], a[44:47]
  ds_read_b128 a[216:219], v4 offset:4096
  v_mfma_f32_16x16x32_bf16 a[60:63], a[236:239], v[140:143], a[60:63]
  v_exp_f32 v118, v54
  v_mfma_f32_16x16x32_bf16 a[56:59], a[236:239], v[136:139], a[56:59]
  ds_read_b128 a[220:223], v5 offset:4096
  v_mfma_f32_16x16x32_bf16 a[52:55], a[236:239], v[132:135], a[52:55]
  v_exp_f32 v119, v55
  v_mfma_f32_16x16x32_bf16 a[48:51], a[236:239], v[128:131], a[48:51]
  s_add_u32 m0, s60, 32768
  v_exp_f32 v120, v56
  v_mfma_f32_16x16x32_bf16 v[164:167], v[176:179], v[132:135], v[164:167]
  buffer_load_dwordx4 v26, s[52:55], s50 offen lds
  v_mfma_f32_16x16x32_bf16 a[64:67], a[240:243], v[128:131], a[64:67]
  v_exp_f32 v121, v57
  v_mfma_f32_16x16x32_bf16 a[68:71], a[240:243], v[132:135], a[68:71]
  buffer_load_dwordx4 v27, s[52:55], s50 offen offset:1024 lds
  v_mfma_f32_16x16x32_bf16 a[72:75], a[240:243], v[136:139], a[72:75]
  v_exp_f32 v122, v58
  v_mfma_f32_16x16x32_bf16 a[76:79], a[240:243], v[140:143], a[76:79]
  buffer_load_dwordx4 v28, s[52:55], s50 offen offset:2048 lds
  v_mfma_f32_16x16x32_bf16 a[92:95], a[244:247], v[140:143], a[92:95]
  v_exp_f32 v123, v59
  v_mfma_f32_16x16x32_bf16 a[88:91], a[244:247], v[136:139], a[88:91]
  buffer_load_dwordx4 v29, s[52:55], s50 offen offset:3072 lds
  v_mfma_f32_16x16x32_bf16 a[84:87], a[244:247], v[132:135], a[84:87]
  v_exp_f32 v124, v60
  v_mfma_f32_16x16x32_bf16 a[80:83], a[244:247], v[128:131], a[80:83]
  v_mfma_f32_16x16x32_bf16 v[168:171], v[176:179], v[136:139], v[168:171]
  v_exp_f32 v125, v61
  v_mfma_f32_16x16x32_bf16 a[96:99], a[248:251], v[128:131], a[96:99]
  v_mfma_f32_16x16x32_bf16 a[100:103], a[248:251], v[132:135], a[100:103]
  v_exp_f32 v126, v62
  v_mfma_f32_16x16x32_bf16 a[104:107], a[248:251], v[136:139], a[104:107]
  v_mfma_f32_16x16x32_bf16 a[108:111], a[248:251], v[140:143], a[108:111]
  v_exp_f32 v127, v63
  v_mfma_f32_16x16x32_bf16 a[124:127], a[252:255], v[140:143], a[124:127]
  v_mfma_f32_16x16x32_bf16 a[120:123], a[252:255], v[136:139], a[120:123]
  v_mfma_f32_16x16x32_bf16 a[116:119], a[252:255], v[132:135], a[116:119]
  s_waitcnt lgkmcnt(0)
  v_mfma_f32_16x16x32_bf16 a[112:115], a[252:255], v[128:131], a[112:115]
  v_mfma_f32_16x16x32_bf16 v[172:175], v[176:179], v[140:143], v[172:175]
  s_add_u32 s50, s50, 16384
  v_mfma_f32_16x16x32_bf16 v[32:35], a[192:195], a[128:131], v[144:147]
  ds_read_b64_tr_b16 a[224:225], v6 offset:49152
  v_cvt_pk_bf16_f32 v128, v96, v97
  v_mfma_f32_16x16x32_bf16 v[32:35], a[196:199], a[132:135], v[32:35]
  ds_read_b64_tr_b16 a[226:227], v6 offset:53248
  v_cvt_pk_bf16_f32 v129, v98, v99
  v_mfma_f32_16x16x32_bf16 v[32:35], a[200:203], a[136:139], v[32:35]
  ds_read_b64_tr_b16 a[228:229], v7 offset:49152
  v_cvt_pk_bf16_f32 v130, v112, v113
  v_mfma_f32_16x16x32_bf16 v[32:35], a[204:207], a[140:143], v[32:35]
  ds_read_b64_tr_b16 a[230:231], v7 offset:53248
  v_cvt_pk_bf16_f32 v131, v114, v115
  v_mfma_f32_16x16x32_bf16 v[36:39], a[204:207], a[156:159], v[148:151]
  ds_read_b64_tr_b16 a[232:233], v8 offset:49152
  v_cvt_pk_bf16_f32 v132, v100, v101
  v_mfma_f32_16x16x32_bf16 v[36:39], a[200:203], a[152:155], v[36:39]
  ds_read_b64_tr_b16 a[234:235], v8 offset:53248
  v_cvt_pk_bf16_f32 v133, v102, v103
  v_mfma_f32_16x16x32_bf16 v[36:39], a[196:199], a[148:151], v[36:39]
  ds_read_b64_tr_b16 a[236:237], v9 offset:49152
  v_cvt_pk_bf16_f32 v134, v116, v117
  v_mfma_f32_16x16x32_bf16 v[36:39], a[192:195], a[144:147], v[36:39]
  ds_read_b64_tr_b16 a[238:239], v9 offset:53248
  v_cvt_pk_bf16_f32 v135, v118, v119
  v_mfma_f32_16x16x32_bf16 v[40:43], a[192:195], a[160:163], v[152:155]
  ds_read_b64_tr_b16 a[240:241], v10 offset:49152
  v_cvt_pk_bf16_f32 v136, v104, v105
  v_mfma_f32_16x16x32_bf16 v[40:43], a[196:199], a[164:167], v[40:43]
  ds_read_b64_tr_b16 a[242:243], v10 offset:53248
  v_cvt_pk_bf16_f32 v137, v106, v107
  v_mfma_f32_16x16x32_bf16 v[40:43], a[200:203], a[168:171], v[40:43]
  ds_read_b64_tr_b16 a[244:245], v11 offset:49152
  v_cvt_pk_bf16_f32 v138, v120, v121
  v_mfma_f32_16x16x32_bf16 v[40:43], a[204:207], a[172:175], v[40:43]
  ds_read_b64_tr_b16 a[246:247], v11 offset:53248
  v_cvt_pk_bf16_f32 v139, v122, v123
  v_mfma_f32_16x16x32_bf16 v[44:47], a[204:207], a[188:191], v[156:159]
  ds_read_b64_tr_b16 a[248:249], v12 offset:49152
  v_cvt_pk_bf16_f32 v140, v108, v109
  v_mfma_f32_16x16x32_bf16 v[44:47], a[200:203], a[184:187], v[44:47]
  ds_read_b64_tr_b16 a[250:251], v12 offset:53248
  v_cvt_pk_bf16_f32 v141, v110, v111
  v_mfma_f32_16x16x32_bf16 v[44:47], a[196:199], a[180:183], v[44:47]
  ds_read_b64_tr_b16 a[252:253], v13 offset:49152
  v_cvt_pk_bf16_f32 v142, v124, v125
  v_mfma_f32_16x16x32_bf16 v[44:47], a[192:195], a[176:179], v[44:47]
  ds_read_b64_tr_b16 a[254:255], v13 offset:53248
  v_cvt_pk_bf16_f32 v143, v126, v127
  v_mfma_f32_16x16x32_bf16 v[48:51], a[208:211], a[128:131], v[144:147]
  v_exp_f32 v96, v64
  v_mfma_f32_16x16x32_bf16 v[48:51], a[212:215], a[132:135], v[48:51]
  v_exp_f32 v97, v65
  v_mfma_f32_16x16x32_bf16 v[48:51], a[216:219], a[136:139], v[48:51]
  v_exp_f32 v98, v66
  v_mfma_f32_16x16x32_bf16 v[48:51], a[220:223], a[140:143], v[48:51]
  v_exp_f32 v99, v67
  v_mfma_f32_16x16x32_bf16 v[52:55], a[220:223], a[156:159], v[148:151]
  v_exp_f32 v100, v68
  v_mfma_f32_16x16x32_bf16 v[52:55], a[216:219], a[152:155], v[52:55]
  v_exp_f32 v101, v69
  v_mfma_f32_16x16x32_bf16 v[52:55], a[212:215], a[148:151], v[52:55]
  v_exp_f32 v102, v70
  v_mfma_f32_16x16x32_bf16 v[52:55], a[208:211], a[144:147], v[52:55]
  v_exp_f32 v103, v71
  v_mfma_f32_16x16x32_bf16 v[56:59], a[208:211], a[160:163], v[152:155]
  v_exp_f32 v104, v72
  v_mfma_f32_16x16x32_bf16 v[56:59], a[212:215], a[164:167], v[56:59]
  v_exp_f32 v105, v73
  v_mfma_f32_16x16x32_bf16 v[56:59], a[216:219], a[168:171], v[56:59]
  v_exp_f32 v106, v74
  v_mfma_f32_16x16x32_bf16 v[56:59], a[220:223], a[172:175], v[56:59]
  v_exp_f32 v107, v75
  v_mfma_f32_16x16x32_bf16 v[60:63], a[220:223], a[188:191], v[156:159]
  v_exp_f32 v108, v76
  v_mfma_f32_16x16x32_bf16 v[60:63], a[216:219], a[184:187], v[60:63]
  s_waitcnt lgkmcnt(0)
  v_exp_f32 v109, v77
  v_mfma_f32_16x16x32_bf16 v[60:63], a[212:215], a[180:183], v[60:63]
  v_exp_f32 v110, v78
  v_mfma_f32_16x16x32_bf16 v[60:63], a[208:211], a[176:179], v[60:63]
  v_exp_f32 v111, v79
  v_mfma_f32_16x16x32_bf16 a[0:3], a[224:227], v[128:131], a[0:3]
  ds_read_b128 a[192:195], v2 offset:8192
  v_mfma_f32_16x16x32_bf16 a[4:7], a[224:227], v[132:135], a[4:7]
  v_exp_f32 v112, v80
  v_mfma_f32_16x16x32_bf16 a[8:11], a[224:227], v[136:139], a[8:11]
  ds_read_b128 a[196:199], v3 offset:8192
  v_mfma_f32_16x16x32_bf16 a[12:15], a[224:227], v[140:143], a[12:15]
  v_exp_f32 v113, v81
  v_mfma_f32_16x16x32_bf16 a[28:31], a[228:231], v[140:143], a[28:31]
  ds_read_b128 a[200:203], v4 offset:8192
  v_mfma_f32_16x16x32_bf16 a[24:27], a[228:231], v[136:139], a[24:27]
  v_exp_f32 v114, v82
  v_mfma_f32_16x16x32_bf16 a[20:23], a[228:231], v[132:135], a[20:23]
  ds_read_b128 a[204:207], v5 offset:8192
  v_mfma_f32_16x16x32_bf16 a[16:19], a[228:231], v[128:131], a[16:19]
  v_exp_f32 v115, v83
  v_mfma_f32_16x16x32_bf16 v[160:163], v[176:179], v[128:131], v[160:163]
  ds_read_b128 a[208:211], v2 offset:12288
  v_mfma_f32_16x16x32_bf16 a[32:35], a[232:235], v[128:131], a[32:35]
  v_exp_f32 v116, v84
  v_mfma_f32_16x16x32_bf16 a[36:39], a[232:235], v[132:135], a[36:39]
  ds_read_b128 a[212:215], v3 offset:12288
  v_mfma_f32_16x16x32_bf16 a[40:43], a[232:235], v[136:139], a[40:43]
  v_exp_f32 v117, v85
  v_mfma_f32_16x16x32_bf16 a[44:47], a[232:235], v[140:143], a[44:47]
  ds_read_b128 a[216:219], v4 offset:12288
  v_mfma_f32_16x16x32_bf16 a[60:63], a[236:239], v[140:143], a[60:63]
  v_exp_f32 v118, v86
  v_mfma_f32_16x16x32_bf16 a[56:59], a[236:239], v[136:139], a[56:59]
  ds_read_b128 a[220:223], v5 offset:12288
  v_mfma_f32_16x16x32_bf16 a[52:55], a[236:239], v[132:135], a[52:55]
  v_exp_f32 v119, v87
  v_mfma_f32_16x16x32_bf16 a[48:51], a[236:239], v[128:131], a[48:51]
  s_add_u32 m0, s61, 16384
  v_exp_f32 v120, v88
  v_mfma_f32_16x16x32_bf16 v[164:167], v[176:179], v[132:135], v[164:167]
  buffer_load_dwordx4 v30, s[56:59], s51 offen lds
  v_mfma_f32_16x16x32_bf16 a[64:67], a[240:243], v[128:131], a[64:67]
  v_exp_f32 v121, v89
  v_mfma_f32_16x16x32_bf16 a[68:71], a[240:243], v[132:135], a[68:71]
  buffer_load_dwordx4 v31, s[56:59], s51 offen offset:1024 lds
  v_mfma_f32_16x16x32_bf16 a[72:75], a[240:243], v[136:139], a[72:75]
  v_exp_f32 v122, v90
  v_mfma_f32_16x16x32_bf16 a[76:79], a[240:243], v[140:143], a[76:79]
  buffer_load_dwordx4 v30, s[56:59], s51 offen offset:2048 lds
  v_mfma_f32_16x16x32_bf16 a[92:95], a[244:247], v[140:143], a[92:95]
  v_exp_f32 v123, v91
  v_mfma_f32_16x16x32_bf16 a[88:91], a[244:247], v[136:139], a[88:91]
  buffer_load_dwordx4 v31, s[56:59], s51 offen offset:3072 lds
  v_mfma_f32_16x16x32_bf16 a[84:87], a[244:247], v[132:135], a[84:87]
  v_exp_f32 v124, v92
  v_mfma_f32_16x16x32_bf16 a[80:83], a[244:247], v[128:131], a[80:83]
  v_mfma_f32_16x16x32_bf16 v[168:171], v[176:179], v[136:139], v[168:171]
  v_exp_f32 v125, v93
  v_mfma_f32_16x16x32_bf16 a[96:99], a[248:251], v[128:131], a[96:99]
  v_mfma_f32_16x16x32_bf16 a[100:103], a[248:251], v[132:135], a[100:103]
  v_exp_f32 v126, v94
  v_mfma_f32_16x16x32_bf16 a[104:107], a[248:251], v[136:139], a[104:107]
  v_mfma_f32_16x16x32_bf16 a[108:111], a[248:251], v[140:143], a[108:111]
  v_exp_f32 v127, v95
  v_mfma_f32_16x16x32_bf16 a[124:127], a[252:255], v[140:143], a[124:127]
  v_mfma_f32_16x16x32_bf16 a[120:123], a[252:255], v[136:139], a[120:123]
  v_mfma_f32_16x16x32_bf16 a[116:119], a[252:255], v[132:135], a[116:119]
  s_waitcnt lgkmcnt(0)
  v_mfma_f32_16x16x32_bf16 a[112:115], a[252:255], v[128:131], a[112:115]
  v_mfma_f32_16x16x32_bf16 v[172:175], v[176:179], v[140:143], v[172:175]
  s_add_u32 s51, s51, 16384
  buffer_load_dwordx4 v[196:199], v200, s[92:95], 0 offen
  v_add_u32 v200, 1024, v200
  v_mfma_f32_16x16x32_bf16 v[64:67], a[192:195], a[128:131], v[144:147]
  ds_read_b64_tr_b16 a[224:225], v6 offset:57344
  v_cvt_pk_bf16_f32 v128, v96, v97
  v_mfma_f32_16x16x32_bf16 v[64:67], a[196:199], a[132:135], v[64:67]
  ds_read_b64_tr_b16 a[226:227], v6 offset:61440
  v_cvt_pk_bf16_f32 v129, v98, v99
  v_mfma_f32_16x16x32_bf16 v[64:67], a[200:203], a[136:139], v[64:67]
  ds_read_b64_tr_b16 a[228:229], v7 offset:57344
  v_cvt_pk_bf16_f32 v130, v112, v113
  v_mfma_f32_16x16x32_bf16 v[64:67], a[204:207], a[140:143], v[64:67]
  ds_read_b64_tr_b16 a[230:231], v7 offset:61440
  v_cvt_pk_bf16_f32 v131, v114, v115
  v_mfma_f32_16x16x32_bf16 v[68:71], a[204:207], a[156:159], v[148:151]
  ds_read_b64_tr_b16 a[232:233], v8 offset:57344
  v_cvt_pk_bf16_f32 v132, v100, v101
  v_mfma_f32_16x16x32_bf16 v[68:71], a[200:203], a[152:155], v[68:71]
  ds_read_b64_tr_b16 a[234:235], v8 offset:61440
  v_cvt_pk_bf16_f32 v133, v102, v103
  v_mfma_f32_16x16x32_bf16 v[68:71], a[196:199], a[148:151], v[68:71]
  ds_read_b64_tr_b16 a[236:237], v9 offset:57344
  v_cvt_pk_bf16_f32 v134, v116, v117
  v_mfma_f32_16x16x32_bf16 v[68:71], a[192:195], a[144:147], v[68:71]
  ds_read_b64_tr_b16 a[238:239], v9 offset:61440
  v_cvt_pk_bf16_f32 v135, v118, v119
  v_mfma_f32_16x16x32_bf16 v[72:75], a[192:195], a[160:163], v[152:155]
  ds_read_b64_tr_b16 a[240:241], v10 offset:57344
  v_cvt_pk_bf16_f32 v136, v104, v105
  v_mfma_f32_16x16x32_bf16 v[72:75], a[196:199], a[164:167], v[72:75]
  ds_read_b64_tr_b16 a[242:243], v10 offset:61440
  v_cvt_pk_bf16_f32 v137, v106, v107
  v_mfma_f32_16x16x32_bf16 v[72:75], a[200:203], a[168:171], v[72:75]
  ds_read_b64_tr_b16 a[244:245], v11 offset:57344
  v_cvt_pk_bf16_f32 v138, v120, v121
  v_mfma_f32_16x16x32_bf16 v[72:75], a[204:207], a[172:175], v[72:75]
  ds_read_b64_tr_b16 a[246:247], v11 offset:61440
  v_cvt_pk_bf16_f32 v139, v122, v123
  v_mfma_f32_16x16x32_bf16 v[76:79], a[204:207], a[188:191], v[156:159]
  ds_read_b64_tr_b16 a[248:249], v12 offset:57344
  v_cvt_pk_bf16_f32 v140, v108, v109
  v_mfma_f32_16x16x32_bf16 v[76:79], a[200:203], a[184:187], v[76:79]
  ds_read_b64_tr_b16 a[250:251], v12 offset:61440
  v_cvt_pk_bf16_f32 v141, v110, v111
  v_mfma_f32_16x16x32_bf16 v[76:79], a[196:199], a[180:183], v[76:79]
  ds_read_b64_tr_b16 a[252:253], v13 offset:57344
  v_cvt_pk_bf16_f32 v142, v124, v125
  v_mfma_f32_16x16x32_bf16 v[76:79], a[192:195], a[176:179], v[76:79]
  ds_read_b64_tr_b16 a[254:255], v13 offset:61440
  v_cvt_pk_bf16_f32 v143, v126, v127
  v_mfma_f32_16x16x32_bf16 v[80:83], a[208:211], a[128:131], v[144:147]
  v_exp_f32 v96, v32
  v_mfma_f32_16x16x32_bf16 v[80:83], a[212:215], a[132:135], v[80:83]
  v_exp_f32 v97, v33
  v_mfma_f32_16x16x32_bf16 v[80:83], a[216:219], a[136:139], v[80:83]
  v_exp_f32 v98, v34
  v_mfma_f32_16x16x32_bf16 v[80:83], a[220:223], a[140:143], v[80:83]
  v_exp_f32 v99, v35
  v_mfma_f32_16x16x32_bf16 v[84:87], a[220:223], a[156:159], v[148:151]
  v_exp_f32 v100, v36
  v_mfma_f32_16x16x32_bf16 v[84:87], a[216:219], a[152:155], v[84:87]
  v_exp_f32 v101, v37
  v_mfma_f32_16x16x32_bf16 v[84:87], a[212:215], a[148:151], v[84:87]
  v_exp_f32 v102, v38
  v_mfma_f32_16x16x32_bf16 v[84:87], a[208:211], a[144:147], v[84:87]
  v_exp_f32 v103, v39
  v_mfma_f32_16x16x32_bf16 v[88:91], a[208:211], a[160:163], v[152:155]
  v_exp_f32 v104, v40
  v_mfma_f32_16x16x32_bf16 v[88:91], a[212:215], a[164:167], v[88:91]
  v_exp_f32 v105, v41
  v_mfma_f32_16x16x32_bf16 v[88:91], a[216:219], a[168:171], v[88:91]
  v_exp_f32 v106, v42
  v_mfma_f32_16x16x32_bf16 v[88:91], a[220:223], a[172:175], v[88:91]
  v_exp_f32 v107, v43
  v_mfma_f32_16x16x32_bf16 v[92:95], a[220:223], a[188:191], v[156:159]
  v_exp_f32 v108, v44
  v_mfma_f32_16x16x32_bf16 v[92:95], a[216:219], a[184:187], v[92:95]
  s_waitcnt lgkmcnt(0) vmcnt(8)
  v_exp_f32 v109, v45
  v_mfma_f32_16x16x32_bf16 v[92:95], a[212:215], a[180:183], v[92:95]
  s_barrier
  v_exp_f32 v110, v46
  v_mfma_f32_16x16x32_bf16 v[92:95], a[208:211], a[176:179], v[92:95]
  v_exp_f32 v111, v47
  v_mfma_f32_16x16x32_bf16 a[0:3], a[224:227], v[128:131], a[0:3]
  ds_read_b128 a[192:195], v2 offset:16384
  v_mfma_f32_16x16x32_bf16 a[4:7], a[224:227], v[132:135], a[4:7]
  v_exp_f32 v112, v48
  v_mfma_f32_16x16x32_bf16 a[8:11], a[224:227], v[136:139], a[8:11]
  ds_read_b128 a[196:199], v3 offset:16384
  v_mfma_f32_16x16x32_bf16 a[12:15], a[224:227], v[140:143], a[12:15]
  v_exp_f32 v113, v49
  v_mfma_f32_16x16x32_bf16 a[28:31], a[228:231], v[140:143], a[28:31]
  ds_read_b128 a[200:203], v4 offset:16384
  v_mfma_f32_16x16x32_bf16 a[24:27], a[228:231], v[136:139], a[24:27]
  v_exp_f32 v114, v50
  v_mfma_f32_16x16x32_bf16 a[20:23], a[228:231], v[132:135], a[20:23]
  ds_read_b128 a[204:207], v5 offset:16384
  v_mfma_f32_16x16x32_bf16 a[16:19], a[228:231], v[128:131], a[16:19]
  v_exp_f32 v115, v51
  v_mfma_f32_16x16x32_bf16 v[160:163], v[176:179], v[128:131], v[160:163]
  ds_read_b128 a[208:211], v2 offset:20480
  v_mfma_f32_16x16x32_bf16 a[32:35], a[232:235], v[128:131], a[32:35]
  v_exp_f32 v116, v52
  v_mfma_f32_16x16x32_bf16 a[36:39], a[232:235], v[132:135], a[36:39]
  ds_read_b128 a[212:215], v3 offset:20480
  v_mfma_f32_16x16x32_bf16 a[40:43], a[232:235], v[136:139], a[40:43]
  v_exp_f32 v117, v53
  v_mfma_f32_16x16x32_bf16 a[44:47], a[232:235], v[140:143], a[44:47]
  ds_read_b128 a[216:219], v4 offset:20480
  v_mfma_f32_16x16x32_bf16 a[60:63], a[236:239], v[140:143], a[60:63]
  v_exp_f32 v118, v54
  v_mfma_f32_16x16x32_bf16 a[56:59], a[236:239], v[136:139], a[56:59]
  ds_read_b128 a[220:223], v5 offset:20480
  v_mfma_f32_16x16x32_bf16 a[52:55], a[236:239], v[132:135], a[52:55]
  v_exp_f32 v119, v55
  v_mfma_f32_16x16x32_bf16 a[48:51], a[236:239], v[128:131], a[48:51]
  s_add_u32 m0, s60, 49152
  v_exp_f32 v120, v56
  v_mfma_f32_16x16x32_bf16 v[164:167], v[176:179], v[132:135], v[164:167]
  buffer_load_dwordx4 v26, s[52:55], s50 offen lds
  v_mfma_f32_16x16x32_bf16 a[64:67], a[240:243], v[128:131], a[64:67]
  v_exp_f32 v121, v57
  v_mfma_f32_16x16x32_bf16 a[68:71], a[240:243], v[132:135], a[68:71]
  buffer_load_dwordx4 v27, s[52:55], s50 offen offset:1024 lds
  v_mfma_f32_16x16x32_bf16 a[72:75], a[240:243], v[136:139], a[72:75]
  v_exp_f32 v122, v58
  v_mfma_f32_16x16x32_bf16 a[76:79], a[240:243], v[140:143], a[76:79]
  buffer_load_dwordx4 v28, s[52:55], s50 offen offset:2048 lds
  v_mfma_f32_16x16x32_bf16 a[92:95], a[244:247], v[140:143], a[92:95]
  v_exp_f32 v123, v59
  v_mfma_f32_16x16x32_bf16 a[88:91], a[244:247], v[136:139], a[88:91]
  buffer_load_dwordx4 v29, s[52:55], s50 offen offset:3072 lds
  v_mfma_f32_16x16x32_bf16 a[84:87], a[244:247], v[132:135], a[84:87]
  v_exp_f32 v124, v60
  v_mfma_f32_16x16x32_bf16 a[80:83], a[244:247], v[128:131], a[80:83]
  v_mfma_f32_16x16x32_bf16 v[168:171], v[176:179], v[136:139], v[168:171]
  v_exp_f32 v125, v61
  v_mfma_f32_16x16x32_bf16 a[96:99], a[248:251], v[128:131], a[96:99]
  v_mfma_f32_16x16x32_bf16 a[100:103], a[248:251], v[132:135], a[100:103]
  v_exp_f32 v126, v62
  v_mfma_f32_16x16x32_bf16 a[104:107], a[248:251], v[136:139], a[104:107]
  v_mfma_f32_16x16x32_bf16 a[108:111], a[248:251], v[140:143], a[108:111]
  v_exp_f32 v127, v63
  v_mfma_f32_16x16x32_bf16 a[124:127], a[252:255], v[140:143], a[124:127]
  v_mfma_f32_16x16x32_bf16 a[120:123], a[252:255], v[136:139], a[120:123]
  v_mfma_f32_16x16x32_bf16 a[116:119], a[252:255], v[132:135], a[116:119]
  s_waitcnt lgkmcnt(0)
  v_mfma_f32_16x16x32_bf16 a[112:115], a[252:255], v[128:131], a[112:115]
  v_mfma_f32_16x16x32_bf16 v[172:175], v[176:179], v[140:143], v[172:175]
  s_add_u32 s50, s50, 16384
  v_mfma_f32_16x16x32_bf16 v[32:35], a[192:195], a[128:131], v[144:147]
  ds_read_b64_tr_b16 a[224:225], v6 offset:0
  v_cvt_pk_bf16_f32 v128, v96, v97
  v_mfma_f32_16x16x32_bf16 v[32:35], a[196:199], a[132:135], v[32:35]
  ds_read_b64_tr_b16 a[226:227], v6 offset:4096
  v_cvt_pk_bf16_f32 v129, v98, v99
  v_mfma_f32_16x16x32_bf16 v[32:35], a[200:203], a[136:139], v[32:35]
  ds_read_b64_tr_b16 a[228:229], v7 offset:0
  v_cvt_pk_bf16_f32 v130, v112, v113
  v_mfma_f32_16x16x32_bf16 v[32:35], a[204:207], a[140:143], v[32:35]
  ds_read_b64_tr_b16 a[230:231], v7 offset:4096
  v_cvt_pk_bf16_f32 v131, v114, v115
  v_mfma_f32_16x16x32_bf16 v[36:39], a[204:207], a[156:159], v[148:151]
  ds_read_b64_tr_b16 a[232:233], v8 offset:0
  v_cvt_pk_bf16_f32 v132, v100, v101
  v_mfma_f32_16x16x32_bf16 v[36:39], a[200:203], a[152:155], v[36:39]
  ds_read_b64_tr_b16 a[234:235], v8 offset:4096
  v_cvt_pk_bf16_f32 v133, v102, v103
  v_mfma_f32_16x16x32_bf16 v[36:39], a[196:199], a[148:151], v[36:39]
  ds_read_b64_tr_b16 a[236:237], v9 offset:0
  v_cvt_pk_bf16_f32 v134, v116, v117
  v_mfma_f32_16x16x32_bf16 v[36:39], a[192:195], a[144:147], v[36:39]
  ds_read_b64_tr_b16 a[238:239], v9 offset:4096
  v_cvt_pk_bf16_f32 v135, v118, v119
  v_mfma_f32_16x16x32_bf16 v[40:43], a[192:195], a[160:163], v[152:155]
  ds_read_b64_tr_b16 a[240:241], v10 offset:0
  v_cvt_pk_bf16_f32 v136, v104, v105
  v_mfma_f32_16x16x32_bf16 v[40:43], a[196:199], a[164:167], v[40:43]
  ds_read_b64_tr_b16 a[242:243], v10 offset:4096
  v_cvt_pk_bf16_f32 v137, v106, v107
  v_mfma_f32_16x16x32_bf16 v[40:43], a[200:203], a[168:171], v[40:43]
  ds_read_b64_tr_b16 a[244:245], v11 offset:0
  v_cvt_pk_bf16_f32 v138, v120, v121
  v_mfma_f32_16x16x32_bf16 v[40:43], a[204:207], a[172:175], v[40:43]
  ds_read_b64_tr_b16 a[246:247], v11 offset:4096
  v_cvt_pk_bf16_f32 v139, v122, v123
  v_mfma_f32_16x16x32_bf16 v[44:47], a[204:207], a[188:191], v[156:159]
  ds_read_b64_tr_b16 a[248:249], v12 offset:0
  v_cvt_pk_bf16_f32 v140, v108, v109
  v_mfma_f32_16x16x32_bf16 v[44:47], a[200:203], a[184:187], v[44:47]
  ds_read_b64_tr_b16 a[250:251], v12 offset:4096
  v_cvt_pk_bf16_f32 v141, v110, v111
  v_mfma_f32_16x16x32_bf16 v[44:47], a[196:199], a[180:183], v[44:47]
  ds_read_b64_tr_b16 a[252:253], v13 offset:0
  v_cvt_pk_bf16_f32 v142, v124, v125
  v_mfma_f32_16x16x32_bf16 v[44:47], a[192:195], a[176:179], v[44:47]
  ds_read_b64_tr_b16 a[254:255], v13 offset:4096
  v_cvt_pk_bf16_f32 v143, v126, v127
  v_mfma_f32_16x16x32_bf16 v[48:51], a[208:211], a[128:131], v[144:147]
  v_exp_f32 v96, v64
  v_mfma_f32_16x16x32_bf16 v[48:51], a[212:215], a[132:135], v[48:51]
  v_exp_f32 v97, v65
  v_mfma_f32_16x16x32_bf16 v[48:51], a[216:219], a[136:139], v[48:51]
  v_exp_f32 v98, v66
  v_mfma_f32_16x16x32_bf16 v[48:51], a[220:223], a[140:143], v[48:51]
  v_exp_f32 v99, v67
  v_mfma_f32_16x16x32_bf16 v[52:55], a[220:223], a[156:159], v[148:151]
  v_exp_f32 v100, v68
  v_mfma_f32_16x16x32_bf16 v[52:55], a[216:219], a[152:155], v[52:55]
  v_exp_f32 v101, v69
  v_mfma_f32_16x16x32_bf16 v[52:55], a[212:215], a[148:151], v[52:55]
  v_exp_f32 v102, v70
  v_mfma_f32_16x16x32_bf16 v[52:55], a[208:211], a[144:147], v[52:55]
  v_exp_f32 v103, v71
  v_mfma_f32_16x16x32_bf16 v[56:59], a[208:211], a[160:163], v[152:155]
  v_exp_f32 v104, v72
  v_mfma_f32_16x16x32_bf16 v[56:59], a[212:215], a[164:167], v[56:59]
  v_exp_f32 v105, v73
  v_mfma_f32_16x16x32_bf16 v[56:59], a[216:219], a[168:171], v[56:59]
  v_exp_f32 v106, v74
  v_mfma_f32_16x16x32_bf16 v[56:59], a[220:223], a[172:175], v[56:59]
  v_exp_f32 v107, v75
  v_mfma_f32_16x16x32_bf16 v[60:63], a[220:223], a[188:191], v[156:159]
  v_exp_f32 v108, v76
  v_mfma_f32_16x16x32_bf16 v[60:63], a[216:219], a[184:187], v[60:63]
  s_waitcnt lgkmcnt(0)
  v_exp_f32 v109, v77
  v_mfma_f32_16x16x32_bf16 v[60:63], a[212:215], a[180:183], v[60:63]
  v_exp_f32 v110, v78
  v_mfma_f32_16x16x32_bf16 v[60:63], a[208:211], a[176:179], v[60:63]
  v_exp_f32 v111, v79
  v_mfma_f32_16x16x32_bf16 a[0:3], a[224:227], v[128:131], a[0:3]
  ds_read_b128 a[192:195], v2 offset:24576
  v_mfma_f32_16x16x32_bf16 a[4:7], a[224:227], v[132:135], a[4:7]
  v_exp_f32 v112, v80
  v_mfma_f32_16x16x32_bf16 a[8:11], a[224:227], v[136:139], a[8:11]
  ds_read_b128 a[196:199], v3 offset:24576
  v_mfma_f32_16x16x32_bf16 a[12:15], a[224:227], v[140:143], a[12:15]
  v_exp_f32 v113, v81
  v_mfma_f32_16x16x32_bf16 a[28:31], a[228:231], v[140:143], a[28:31]
  ds_read_b128 a[200:203], v4 offset:24576
  v_mfma_f32_16x16x32_bf16 a[24:27], a[228:231], v[136:139], a[24:27]
  v_exp_f32 v114, v82
  v_mfma_f32_16x16x32_bf16 a[20:23], a[228:231], v[132:135], a[20:23]
  ds_read_b128 a[204:207], v5 offset:24576
  v_mfma_f32_16x16x32_bf16 a[16:19], a[228:231], v[128:131], a[16:19]
  v_exp_f32 v115, v83
  v_mfma_f32_16x16x32_bf16 v[160:163], v[176:179], v[128:131], v[160:163]
  ds_read_b128 a[208:211], v2 offset:28672
  v_mfma_f32_16x16x32_bf16 a[32:35], a[232:235], v[128:131], a[32:35]
  v_exp_f32 v116, v84
  v_mfma_f32_16x16x32_bf16 a[36:39], a[232:235], v[132:135], a[36:39]
  ds_read_b128 a[212:215], v3 offset:28672
  v_mfma_f32_16x16x32_bf16 a[40:43], a[232:235], v[136:139], a[40:43]
  v_exp_f32 v117, v85
  v_mfma_f32_16x16x32_bf16 a[44:47], a[232:235], v[140:143], a[44:47]
  ds_read_b128 a[216:219], v4 offset:28672
  v_mfma_f32_16x16x32_bf16 a[60:63], a[236:239], v[140:143], a[60:63]
  v_exp_f32 v118, v86
  v_mfma_f32_16x16x32_bf16 a[56:59], a[236:239], v[136:139], a[56:59]
  ds_read_b128 a[220:223], v5 offset:28672
  v_mfma_f32_16x16x32_bf16 a[52:55], a[236:239], v[132:135], a[52:55]
  v_exp_f32 v119, v87
  v_mfma_f32_16x16x32_bf16 a[48:51], a[236:239], v[128:131], a[48:51]
  s_add_u32 m0, s61, 32768
  v_exp_f32 v120, v88
  v_mfma_f32_16x16x32_bf16 v[164:167], v[176:179], v[132:135], v[164:167]
  buffer_load_dwordx4 v30, s[56:59], s51 offen lds
  v_mfma_f32_16x16x32_bf16 a[64:67], a[240:243], v[128:131], a[64:67]
  v_exp_f32 v121, v89
  v_mfma_f32_16x16x32_bf16 a[68:71], a[240:243], v[132:135], a[68:71]
  buffer_load_dwordx4 v31, s[56:59], s51 offen offset:1024 lds
  v_mfma_f32_16x16x32_bf16 a[72:75], a[240:243], v[136:139], a[72:75]
  v_exp_f32 v122, v90
  v_mfma_f32_16x16x32_bf16 a[76:79], a[240:243], v[140:143], a[76:79]
  buffer_load_dwordx4 v30, s[56:59], s51 offen offset:2048 lds
  v_mfma_f32_16x16x32_bf16 a[92:95], a[244:247], v[140:143], a[92:95]
  v_exp_f32 v123, v91
  v_mfma_f32_16x16x32_bf16 a[88:91], a[244:247], v[136:139], a[88:91]
  buffer_load_dwordx4 v31, s[56:59], s51 offen offset:3072 lds
  v_mfma_f32_16x16x32_bf16 a[84:87], a[244:247], v[132:135], a[84:87]
  v_exp_f32 v124, v92
  v_mfma_f32_16x16x32_bf16 a[80:83], a[244:247], v[128:131], a[80:83]
  v_mfma_f32_16x16x32_bf16 v[168:171], v[176:179], v[136:139], v[168:171]
  v_exp_f32 v125, v93
  v_mfma_f32_16x16x32_bf16 a[96:99], a[248:251], v[128:131], a[96:99]
  v_mfma_f32_16x16x32_bf16 a[100:103], a[248:251], v[132:135], a[100:103]
  v_exp_f32 v126, v94
  v_mfma_f32_16x16x32_bf16 a[104:107], a[248:251], v[136:139], a[104:107]
  v_mfma_f32_16x16x32_bf16 a[108:111], a[248:251], v[140:143], a[108:111]
  v_exp_f32 v127, v95
  v_mfma_f32_16x16x32_bf16 a[124:127], a[252:255], v[140:143], a[124:127]
  v_mfma_f32_16x16x32_bf16 a[120:123], a[252:255], v[136:139], a[120:123]
  v_mfma_f32_16x16x32_bf16 a[116:119], a[252:255], v[132:135], a[116:119]
  s_waitcnt lgkmcnt(0)
  v_mfma_f32_16x16x32_bf16 a[112:115], a[252:255], v[128:131], a[112:115]
  v_mfma_f32_16x16x32_bf16 v[172:175], v[176:179], v[140:143], v[172:175]
  s_add_u32 s51, s51, 16384
  buffer_load_dwordx4 v[196:199], v200, s[92:95], 0 offen
  v_add_u32 v200, 1024, v200
  s_sub_u32 s62, s62, 1
  s_cmp_lg_u32 s62, 0
  s_cbranch_scc1 att_loop_2
  v_mfma_f32_16x16x32_bf16 v[64:67], a[192:195], a[128:131], v[144:147]
  ds_read_b64_tr_b16 a[224:225], v6 offset:8192
  v_cvt_pk_bf16_f32 v128, v96, v97
  v_mfma_f32_16x16x32_bf16 v[64:67], a[196:199], a[132:135], v[64:67]
  ds_read_b64_tr_b16 a[226:227], v6 offset:12288
  v_cvt_pk_bf16_f32 v129, v98, v99
  v_mfma_f32_16x16x32_bf16 v[64:67], a[200:203], a[136:139], v[64:67]
  ds_read_b64_tr_b16 a[228:229], v7 offset:8192
  v_cvt_pk_bf16_f32 v130, v112, v113
  v_mfma_f32_16x16x32_bf16 v[64:67], a[204:207], a[140:143], v[64:67]
  ds_read_b64_tr_b16 a[230:231], v7 offset:12288
  v_cvt_pk_bf16_f32 v131, v114, v115
  v_mfma_f32_16x16x32_bf16 v[68:71], a[204:207], a[156:159], v[148:151]
  ds_read_b64_tr_b16 a[232:233], v8 offset:8192
  v_cvt_pk_bf16_f32 v132, v100, v101
  v_mfma_f32_16x16x32_bf16 v[68:71], a[200:203], a[152:155], v[68:71]
  ds_read_b64_tr_b16 a[234:235], v8 offset:12288
  v_cvt_pk_bf16_f32 v133, v102, v103
  v_mfma_f32_16x16x32_bf16 v[68:71], a[196:199], a[148:151], v[68:71]
  ds_read_b64_tr_b16 a[236:237], v9 offset:8192
  v_cvt_pk_bf16_f32 v134, v116, v117
  v_mfma_f32_16x16x32_bf16 v[68:71], a[192:195], a[144:147], v[68:71]
  ds_read_b64_tr_b16 a[238:239], v9 offset:12288
  v_cvt_pk_bf16_f32 v135, v118, v119
  v_mfma_f32_16x16x32_bf16 v[72:75], a[192:195], a[160:163], v[152:155]
  ds_read_b64_tr_b16 a[240:241], v10 offset:8192
  v_cvt_pk_bf16_f32 v136, v104, v105
  v_mfma_f32_16x16x32_bf16 v[72:75], a[196:199], a[164:167], v[72:75]
  ds_read_b64_tr_b16 a[242:243], v10 offset:12288
  v_cvt_pk_bf16_f32 v137, v106, v107
  v_mfma_f32_16x16x32_bf16 v[72:75], a[200:203], a[168:171], v[72:75]
  ds_read_b64_tr_b16 a[244:245], v11 offset:8192
  v_cvt_pk_bf16_f32 v138, v120, v121
  v_mfma_f32_16x16x32_bf16 v[72:75], a[204:207], a[172:175], v[72:75]
  ds_read_b64_tr_b16 a[246:247], v11 offset:12288
  v_cvt_pk_bf16_f32 v139, v122, v123
  v_mfma_f32_16x16x32_bf16 v[76:79], a[204:207], a[188:191], v[156:159]
  ds_read_b64_tr_b16 a[248:249], v12 offset:8192
  v_cvt_pk_bf16_f32 v140, v108, v109
  v_mfma_f32_16x16x32_bf16 v[76:79], a[200:203], a[184:187], v[76:79]
  ds_read_b64_tr_b16 a[250:251], v12 offset:12288
  v_cvt_pk_bf16_f32 v141, v110, v111
  v_mfma_f32_16x16x32_bf16 v[76:79], a[196:199], a[180:183], v[76:79]
  ds_read_b64_tr_b16 a[252:253], v13 offset:8192
  v_cvt_pk_bf16_f32 v142, v124, v125
  v_mfma_f32_16x16x32_bf16 v[76:79], a[192:195], a[176:179], v[76:79]
  ds_read_b64_tr_b16 a[254:255], v13 offset:12288
  v_cvt_pk_bf16_f32 v143, v126, v127
  v_mfma_f32_16x16x32_bf16 v[80:83], a[208:211], a[128:131], v[144:147]
  v_exp_f32 v96, v32
  v_mfma_f32_16x16x32_bf16 v[80:83], a[212:215], a[132:135], v[80:83]
  v_exp_f32 v97, v33
  v_mfma_f32_16x16x32_bf16 v[80:83], a[216:219], a[136:139], v[80:83]
  v_exp_f32 v98, v34
  v_mfma_f32_16x16x32_bf16 v[80:83], a[220:223], a[140:143], v[80:83]
  v_exp_f32 v99, v35
  v_mfma_f32_16x16x32_bf16 v[84:87], a[220:223], a[156:159], v[148:151]
  v_exp_f32 v100, v36
  v_mfma_f32_16x16x32_bf16 v[84:87], a[216:219], a[152:155], v[84:87]
  v_exp_f32 v101, v37
  v_mfma_f32_16x16x32_bf16 v[84:87], a[212:215], a[148:151], v[84:87]
  v_exp_f32 v102, v38
  v_mfma_f32_16x16x32_bf16 v[84:87], a[208:211], a[144:147], v[84:87]
  v_exp_f32 v103, v39
  v_mfma_f32_16x16x32_bf16 v[88:91], a[208:211], a[160:163], v[152:155]
  v_exp_f32 v104, v40
  v_mfma_f32_16x16x32_bf16 v[88:91], a[212:215], a[164:167], v[88:91]
  v_exp_f32 v105, v41
  v_mfma_f32_16x16x32_bf16 v[88:91], a[216:219], a[168:171], v[88:91]
  v_exp_f32 v106, v42
  v_mfma_f32_16x16x32_bf16 v[88:91], a[220:223], a[172:175], v[88:91]
  v_exp_f32 v107, v43
  v_mfma_f32_16x16x32_bf16 v[92:95], a[220:223], a[188:191], v[156:159]
  v_exp_f32 v108, v44
  v_mfma_f32_16x16x32_bf16 v[92:95], a[216:219], a[184:187], v[92:95]
  s_waitcnt lgkmcnt(0) vmcnt(8)
  v_exp_f32 v109, v45
  v_mfma_f32_16x16x32_bf16 v[92:95], a[212:215], a[180:183], v[92:95]
  s_barrier
  v_exp_f32 v110, v46
  v_mfma_f32_16x16x32_bf16 v[92:95], a[208:211], a[176:179], v[92:95]
  v_exp_f32 v111, v47
  v_mfma_f32_16x16x32_bf16 a[0:3], a[224:227], v[128:131], a[0:3]
  ds_read_b128 a[192:195], v2 offset:32768
  v_mfma_f32_16x16x32_bf16 a[4:7], a[224:227], v[132:135], a[4:7]
  v_exp_f32 v112, v48
  v_mfma_f32_16x16x32_bf16 a[8:11], a[224:227], v[136:139], a[8:11]
  ds_read_b128 a[196:199], v3 offset:32768
  v_mfma_f32_16x16x32_bf16 a[12:15], a[224:227], v[140:143], a[12:15]
  v_exp_f32 v113, v49
  v_mfma_f32_16x16x32_bf16 a[28:31], a[228:231], v[140:143], a[28:31]
  ds_read_b128 a[200:203], v4 offset:32768
  v_mfma_f32_16x16x32_bf16 a[24:27], a[228:231], v[136:139], a[24:27]
  v_exp_f32 v114, v50
  v_mfma_f32_16x16x32_bf16 a[20:23], a[228:231], v[132:135], a[20:23]
  ds_read_b128 a[204:207], v5 offset:32768
  v_mfma_f32_16x16x32_bf16 a[16:19], a[228:231], v[128:131], a[16:19]
  v_exp_f32 v115, v51
  v_mfma_f32_16x16x32_bf16 v[160:163], v[176:179], v[128:131], v[160:163]
  ds_read_b128 a[208:211], v2 offset:36864
  v_mfma_f32_16x16x32_bf16 a[32:35], a[232:235], v[128:131], a[32:35]
  v_exp_f32 v116, v52
  v_mfma_f32_16x16x32_bf16 a[36:39], a[232:235], v[132:135], a[36:39]
  ds_read_b128 a[212:215], v3 offset:36864
  v_mfma_f32_16x16x32_bf16 a[40:43], a[232:235], v[136:139], a[40:43]
  v_exp_f32 v117, v53
  v_mfma_f32_16x16x32_bf16 a[44:47], a[232:235], v[140:143], a[44:47]
  ds_read_b128 a[216:219], v4 offset:36864
  v_mfma_f32_16x16x32_bf16 a[60:63], a[236:239], v[140:143], a[60:63]
  v_exp_f32 v118, v54
  v_mfma_f32_16x16x32_bf16 a[56:59], a[236:239], v[136:139], a[56:59]
  ds_read_b128 a[220:223], v5 offset:36864
  v_mfma_f32_16x16x32_bf16 a[52:55], a[236:239], v[132:135], a[52:55]
  v_exp_f32 v119, v55
  v_mfma_f32_16x16x32_bf16 a[48:51], a[236:239], v[128:131], a[48:51]
  v_exp_f32 v120, v56
  v_mfma_f32_16x16x32_bf16 v[164:167], v[176:179], v[132:135], v[164:167]
  v_mfma_f32_16x16x32_bf16 a[64:67], a[240:243], v[128:131], a[64:67]
  v_exp_f32 v121, v57
  v_mfma_f32_16x16x32_bf16 a[68:71], a[240:243], v[132:135], a[68:71]
  v_mfma_f32_16x16x32_bf16 a[72:75], a[240:243], v[136:139], a[72:75]
  v_exp_f32 v122, v58
  v_mfma_f32_16x16x32_bf16 a[76:79], a[240:243], v[140:143], a[76:79]
  v_mfma_f32_16x16x32_bf16 a[92:95], a[244:247], v[140:143], a[92:95]
  v_exp_f32 v123, v59
  v_mfma_f32_16x16x32_bf16 a[88:91], a[244:247], v[136:139], a[88:91]
  v_mfma_f32_16x16x32_bf16 a[84:87], a[244:247], v[132:135], a[84:87]
  v_exp_f32 v124, v60
  v_mfma_f32_16x16x32_bf16 a[80:83], a[244:247], v[128:131], a[80:83]
  v_mfma_f32_16x16x32_bf16 v[168:171], v[176:179], v[136:139], v[168:171]
  v_exp_f32 v125, v61
  v_mfma_f32_16x16x32_bf16 a[96:99], a[248:251], v[128:131], a[96:99]
  v_mfma_f32_16x16x32_bf16 a[100:103], a[248:251], v[132:135], a[100:103]
  v_exp_f32 v126, v62
  v_mfma_f32_16x16x32_bf16 a[104:107], a[248:251], v[136:139], a[104:107]
  v_mfma_f32_16x16x32_bf16 a[108:111], a[248:251], v[140:143], a[108:111]
  v_exp_f32 v127, v63
  v_mfma_f32_16x16x32_bf16 a[124:127], a[252:255], v[140:143], a[124:127]
  v_mfma_f32_16x16x32_bf16 a[120:123], a[252:255], v[136:139], a[120:123]
  v_mfma_f32_16x16x32_bf16 a[116:119], a[252:255], v[132:135], a[116:119]
  s_waitcnt lgkmcnt(0)
  v_mfma_f32_16x16x32_bf16 a[112:115], a[252:255], v[128:131], a[112:115]
  v_mfma_f32_16x16x32_bf16 v[172:175], v[176:179], v[140:143], v[172:175]
  v_mfma_f32_16x16x32_bf16 v[32:35], a[192:195], a[128:131], v[144:147]
  ds_read_b64_tr_b16 a[224:225], v6 offset:16384
  v_cvt_pk_bf16_f32 v128, v96, v97
  v_mfma_f32_16x16x32_bf16 v[32:35], a[196:199], a[132:135], v[32:35]
  ds_read_b64_tr_b16 a[226:227], v6 offset:20480
  v_cvt_pk_bf16_f32 v129, v98, v99
  v_mfma_f32_16x16x32_bf16 v[32:35], a[200:203], a[136:139], v[32:35]
  ds_read_b64_tr_b16 a[228:229], v7 offset:16384
  v_cvt_pk_bf16_f32 v130, v112, v113
  v_mfma_f32_16x16x32_bf16 v[32:35], a[204:207], a[140:143], v[32:35]
  ds_read_b64_tr_b16 a[230:231], v7 offset:20480
  v_cvt_pk_bf16_f32 v131, v114, v115
  v_mfma_f32_16x16x32_bf16 v[36:39], a[204:207], a[156:159], v[148:151]
  ds_read_b64_tr_b16 a[232:233], v8 offset:16384
  v_cvt_pk_bf16_f32 v132, v100, v101
  v_mfma_f32_16x16x32_bf16 v[36:39], a[200:203], a[152:155], v[36:39]
  ds_read_b64_tr_b16 a[234:235], v8 offset:20480
  v_cvt_pk_bf16_f32 v133, v102, v103
  v_mfma_f32_16x16x32_bf16 v[36:39], a[196:199], a[148:151], v[36:39]
  ds_read_b64_tr_b16 a[236:237], v9 offset:16384
  v_cvt_pk_bf16_f32 v134, v116, v117
  v_mfma_f32_16x16x32_bf16 v[36:39], a[192:195], a[144:147], v[36:39]
  ds_read_b64_tr_b16 a[238:239], v9 offset:20480
  v_cvt_pk_bf16_f32 v135, v118, v119
  v_mfma_f32_16x16x32_bf16 v[40:43], a[192:195], a[160:163], v[152:155]
  ds_read_b64_tr_b16 a[240:241], v10 offset:16384
  v_cvt_pk_bf16_f32 v136, v104, v105
  v_mfma_f32_16x16x32_bf16 v[40:43], a[196:199], a[164:167], v[40:43]
  ds_read_b64_tr_b16 a[242:243], v10 offset:20480
  v_cvt_pk_bf16_f32 v137, v106, v107
  v_mfma_f32_16x16x32_bf16 v[40:43], a[200:203], a[168:171], v[40:43]
  ds_read_b64_tr_b16 a[244:245], v11 offset:16384
  v_cvt_pk_bf16_f32 v138, v120, v121
  v_mfma_f32_16x16x32_bf16 v[40:43], a[204:207], a[172:175], v[40:43]
  ds_read_b64_tr_b16 a[246:247], v11 offset:20480
  v_cvt_pk_bf16_f32 v139, v122, v123
  v_mfma_f32_16x16x32_bf16 v[44:47], a[204:207], a[188:191], v[156:159]
  ds_read_b64_tr_b16 a[248:249], v12 offset:16384
  v_cvt_pk_bf16_f32 v140, v108, v109
  v_mfma_f32_16x16x32_bf16 v[44:47], a[200:203], a[184:187], v[44:47]
  ds_read_b64_tr_b16 a[250:251], v12 offset:20480
  v_cvt_pk_bf16_f32 v141, v110, v111
  v_mfma_f32_16x16x32_bf16 v[44:47], a[196:199], a[180:183], v[44:47]
  ds_read_b64_tr_b16 a[252:253], v13 offset:16384
  v_cvt_pk_bf16_f32 v142, v124, v125
  v_mfma_f32_16x16x32_bf16 v[44:47], a[192:195], a[176:179], v[44:47]
  ds_read_b64_tr_b16 a[254:255], v13 offset:20480
  v_cvt_pk_bf16_f32 v143, v126, v127
  v_mfma_f32_16x16x32_bf16 v[48:51], a[208:211], a[128:131], v[144:147]
  v_exp_f32 v96, v64
  v_mfma_f32_16x16x32_bf16 v[48:51], a[212:215], a[132:135], v[48:51]
  v_exp_f32 v97, v65
  v_mfma_f32_16x16x32_bf16 v[48:51], a[216:219], a[136:139], v[48:51]
  v_exp_f32 v98, v66
  v_mfma_f32_16x16x32_bf16 v[48:51], a[220:223], a[140:143], v[48:51]
  v_exp_f32 v99, v67
  v_mfma_f32_16x16x32_bf16 v[52:55], a[220:223], a[156:159], v[148:151]
  v_exp_f32 v100, v68
  v_mfma_f32_16x16x32_bf16 v[52:55], a[216:219], a[152:155], v[52:55]
  v_exp_f32 v101, v69
  v_mfma_f32_16x16x32_bf16 v[52:55], a[212:215], a[148:151], v[52:55]
  v_exp_f32 v102, v70
  v_mfma_f32_16x16x32_bf16 v[52:55], a[208:211], a[144:147], v[52:55]
  v_exp_f32 v103, v71
  v_mfma_f32_16x16x32_bf16 v[56:59], a[208:211], a[160:163], v[152:155]
  v_exp_f32 v104, v72
  v_mfma_f32_16x16x32_bf16 v[56:59], a[212:215], a[164:167], v[56:59]
  v_exp_f32 v105, v73
  v_mfma_f32_16x16x32_bf16 v[56:59], a[216:219], a[168:171], v[56:59]
  v_exp_f32 v106, v74
  v_mfma_f32_16x16x32_bf16 v[56:59], a[220:223], a[172:175], v[56:59]
  v_exp_f32 v107, v75
  v_mfma_f32_16x16x32_bf16 v[60:63], a[220:223], a[188:191], v[156:159]
  v_exp_f32 v108, v76
  v_mfma_f32_16x16x32_bf16 v[60:63], a[216:219], a[184:187], v[60:63]
  s_waitcnt lgkmcnt(0)
  v_exp_f32 v109, v77
  v_mfma_f32_16x16x32_bf16 v[60:63], a[212:215], a[180:183], v[60:63]
  v_exp_f32 v110, v78
  v_mfma_f32_16x16x32_bf16 v[60:63], a[208:211], a[176:179], v[60:63]
  v_exp_f32 v111, v79
  v_mfma_f32_16x16x32_bf16 a[0:3], a[224:227], v[128:131], a[0:3]
  ds_read_b128 a[192:195], v2 offset:40960
  v_mfma_f32_16x16x32_bf16 a[4:7], a[224:227], v[132:135], a[4:7]
  v_exp_f32 v112, v80
  v_mfma_f32_16x16x32_bf16 a[8:11], a[224:227], v[136:139], a[8:11]
  ds_read_b128 a[196:199], v3 offset:40960
  v_mfma_f32_16x16x32_bf16 a[12:15], a[224:227], v[140:143], a[12:15]
  v_exp_f32 v113, v81
  v_mfma_f32_16x16x32_bf16 a[28:31], a[228:231], v[140:143], a[28:31]
  ds_read_b128 a[200:203], v4 offset:40960
  v_mfma_f32_16x16x32_bf16 a[24:27], a[228:231], v[136:139], a[24:27]
  v_exp_f32 v114, v82
  v_mfma_f32_16x16x32_bf16 a[20:23], a[228:231], v[132:135], a[20:23]
  ds_read_b128 a[204:207], v5 offset:40960
  v_mfma_f32_16x16x32_bf16 a[16:19], a[228:231], v[128:131], a[16:19]
  v_exp_f32 v115, v83
  v_mfma_f32_16x16x32_bf16 v[160:163], v[176:179], v[128:131], v[160:163]
  ds_read_b128 a[208:211], v2 offset:45056
  v_mfma_f32_16x16x32_bf16 a[32:35], a[232:235], v[128:131], a[32:35]
  v_exp_f32 v116, v84
  v_mfma_f32_16x16x32_bf16 a[36:39], a[232:235], v[132:135], a[36:39]
  ds_read_b128 a[212:215], v3 offset:45056
  v_mfma_f32_16x16x32_bf16 a[40:43], a[232:235], v[136:139], a[40:43]
  v_exp_f32 v117, v85
  v_mfma_f32_16x16x32_bf16 a[44:47], a[232:235], v[140:143], a[44:47]
  ds_read_b128 a[216:219], v4 offset:45056
  v_mfma_f32_16x16x32_bf16 a[60:63], a[236:239], v[140:143], a[60:63]
  v_exp_f32 v118, v86
  v_mfma_f32_16x16x32_bf16 a[56:59], a[236:239], v[136:139], a[56:59]
  ds_read_b128 a[220:223], v5 offset:45056
  v_mfma_f32_16x16x32_bf16 a[52:55], a[236:239], v[132:135], a[52:55]
  v_exp_f32 v119, v87
  v_mfma_f32_16x16x32_bf16 a[48:51], a[236:239], v[128:131], a[48:51]
  s_add_u32 m0, s61, 49152
  v_exp_f32 v120, v88
  v_mfma_f32_16x16x32_bf16 v[164:167], v[176:179], v[132:135], v[164:167]
  buffer_load_dwordx4 v30, s[56:59], s51 offen lds
  v_mfma_f32_16x16x32_bf16 a[64:67], a[240:243], v[128:131], a[64:67]
  v_exp_f32 v121, v89
  v_mfma_f32_16x16x32_bf16 a[68:71], a[240:243], v[132:135], a[68:71]
  buffer_load_dwordx4 v31, s[56:59], s51 offen offset:1024 lds
  v_mfma_f32_16x16x32_bf16 a[72:75], a[240:243], v[136:139], a[72:75]
  v_exp_f32 v122, v90
  v_mfma_f32_16x16x32_bf16 a[76:79], a[240:243], v[140:143], a[76:79]
  buffer_load_dwordx4 v30, s[56:59], s51 offen offset:2048 lds
  v_mfma_f32_16x16x32_bf16 a[92:95], a[244:247], v[140:143], a[92:95]
  v_exp_f32 v123, v91
  v_mfma_f32_16x16x32_bf16 a[88:91], a[244:247], v[136:139], a[88:91]
  buffer_load_dwordx4 v31, s[56:59], s51 offen offset:3072 lds
  v_mfma_f32_16x16x32_bf16 a[84:87], a[244:247], v[132:135], a[84:87]
  v_exp_f32 v124, v92
  v_mfma_f32_16x16x32_bf16 a[80:83], a[244:247], v[128:131], a[80:83]
  v_mfma_f32_16x16x32_bf16 v[168:171], v[176:179], v[136:139], v[168:171]
  v_exp_f32 v125, v93
  v_mfma_f32_16x16x32_bf16 a[96:99], a[248:251], v[128:131], a[96:99]
  v_mfma_f32_16x16x32_bf16 a[100:103], a[248:251], v[132:135], a[100:103]
  v_exp_f32 v126, v94
  v_mfma_f32_16x16x32_bf16 a[104:107], a[248:251], v[136:139], a[104:107]
  v_mfma_f32_16x16x32_bf16 a[108:111], a[248:251], v[140:143], a[108:111]
  v_exp_f32 v127, v95
  v_mfma_f32_16x16x32_bf16 a[124:127], a[252:255], v[140:143], a[124:127]
  v_mfma_f32_16x16x32_bf16 a[120:123], a[252:255], v[136:139], a[120:123]
  v_mfma_f32_16x16x32_bf16 a[116:119], a[252:255], v[132:135], a[116:119]
  s_waitcnt lgkmcnt(0)
  v_mfma_f32_16x16x32_bf16 a[112:115], a[252:255], v[128:131], a[112:115]
  v_mfma_f32_16x16x32_bf16 v[172:175], v[176:179], v[140:143], v[172:175]
  s_add_u32 s51, s51, 16384
  s_mov_b64 exec, 3
  global_load_dword v202, v201, s[70:71] sc1
  s_mov_b64 exec, -1
  v_mfma_f32_16x16x32_bf16 v[64:67], a[192:195], a[128:131], v[144:147]
  ds_read_b64_tr_b16 a[224:225], v6 offset:24576
  v_cvt_pk_bf16_f32 v128, v96, v97
  v_mfma_f32_16x16x32_bf16 v[64:67], a[196:199], a[132:135], v[64:67]
  ds_read_b64_tr_b16 a[226:227], v6 offset:28672
  v_cvt_pk_bf16_f32 v129, v98, v99
  v_mfma_f32_16x16x32_bf16 v[64:67], a[200:203], a[136:139], v[64:67]
  ds_read_b64_tr_b16 a[228:229], v7 offset:24576
  v_cvt_pk_bf16_f32 v130, v112, v113
  v_mfma_f32_16x16x32_bf16 v[64:67], a[204:207], a[140:143], v[64:67]
  ds_read_b64_tr_b16 a[230:231], v7 offset:28672
  v_cvt_pk_bf16_f32 v131, v114, v115
  v_mfma_f32_16x16x32_bf16 v[68:71], a[204:207], a[156:159], v[148:151]
  ds_read_b64_tr_b16 a[232:233], v8 offset:24576
  v_cvt_pk_bf16_f32 v132, v100, v101
  v_mfma_f32_16x16x32_bf16 v[68:71], a[200:203], a[152:155], v[68:71]
  ds_read_b64_tr_b16 a[234:235], v8 offset:28672
  v_cvt_pk_bf16_f32 v133, v102, v103
  v_mfma_f32_16x16x32_bf16 v[68:71], a[196:199], a[148:151], v[68:71]
  ds_read_b64_tr_b16 a[236:237], v9 offset:24576
  v_cvt_pk_bf16_f32 v134, v116, v117
  v_mfma_f32_16x16x32_bf16 v[68:71], a[192:195], a[144:147], v[68:71]
  ds_read_b64_tr_b16 a[238:239], v9 offset:28672
  v_cvt_pk_bf16_f32 v135, v118, v119
  v_mfma_f32_16x16x32_bf16 v[72:75], a[192:195], a[160:163], v[152:155]
  ds_read_b64_tr_b16 a[240:241], v10 offset:24576
  v_cvt_pk_bf16_f32 v136, v104, v105
  v_mfma_f32_16x16x32_bf16 v[72:75], a[196:199], a[164:167], v[72:75]
  ds_read_b64_tr_b16 a[242:243], v10 offset:28672
  v_cvt_pk_bf16_f32 v137, v106, v107
  v_mfma_f32_16x16x32_bf16 v[72:75], a[200:203], a[168:171], v[72:75]
  ds_read_b64_tr_b16 a[244:245], v11 offset:24576
  v_cvt_pk_bf16_f32 v138, v120, v121
  v_mfma_f32_16x16x32_bf16 v[72:75], a[204:207], a[172:175], v[72:75]
  ds_read_b64_tr_b16 a[246:247], v11 offset:28672
  v_cvt_pk_bf16_f32 v139, v122, v123
  v_mfma_f32_16x16x32_bf16 v[76:79], a[204:207], a[188:191], v[156:159]
  ds_read_b64_tr_b16 a[248:249], v12 offset:24576
  v_cvt_pk_bf16_f32 v140, v108, v109
  v_mfma_f32_16x16x32_bf16 v[76:79], a[200:203], a[184:187], v[76:79]
  ds_read_b64_tr_b16 a[250:251], v12 offset:28672
  v_cvt_pk_bf16_f32 v141, v110, v111
  v_mfma_f32_16x16x32_bf16 v[76:79], a[196:199], a[180:183], v[76:79]
  ds_read_b64_tr_b16 a[252:253], v13 offset:24576
  v_cvt_pk_bf16_f32 v142, v124, v125
  v_mfma_f32_16x16x32_bf16 v[76:79], a[192:195], a[176:179], v[76:79]
  ds_read_b64_tr_b16 a[254:255], v13 offset:28672
  v_cvt_pk_bf16_f32 v143, v126, v127
  v_mfma_f32_16x16x32_bf16 v[80:83], a[208:211], a[128:131], v[144:147]
  v_exp_f32 v96, v32
  v_mfma_f32_16x16x32_bf16 v[80:83], a[212:215], a[132:135], v[80:83]
  v_exp_f32 v97, v33
  v_mfma_f32_16x16x32_bf16 v[80:83], a[216:219], a[136:139], v[80:83]
  v_exp_f32 v98, v34
  v_mfma_f32_16x16x32_bf16 v[80:83], a[220:223], a[140:143], v[80:83]
  v_exp_f32 v99, v35
  v_mfma_f32_16x16x32_bf16 v[84:87], a[220:223], a[156:159], v[148:151]
  v_exp_f32 v100, v36
  v_mfma_f32_16x16x32_bf16 v[84:87], a[216:219], a[152:155], v[84:87]
  v_exp_f32 v101, v37
  v_mfma_f32_16x16x32_bf16 v[84:87], a[212:215], a[148:151], v[84:87]
  v_exp_f32 v102, v38
  v_mfma_f32_16x16x32_bf16 v[84:87], a[208:211], a[144:147], v[84:87]
  v_exp_f32 v103, v39
  v_mfma_f32_16x16x32_bf16 v[88:91], a[208:211], a[160:163], v[152:155]
  v_exp_f32 v104, v40
  v_mfma_f32_16x16x32_bf16 v[88:91], a[212:215], a[164:167], v[88:91]
  v_exp_f32 v105, v41
  v_mfma_f32_16x16x32_bf16 v[88:91], a[216:219], a[168:171], v[88:91]
  v_exp_f32 v106, v42
  v_mfma_f32_16x16x32_bf16 v[88:91], a[220:223], a[172:175], v[88:91]
  v_exp_f32 v107, v43
  v_mfma_f32_16x16x32_bf16 v[92:95], a[220:223], a[188:191], v[156:159]
  v_exp_f32 v108, v44
  v_mfma_f32_16x16x32_bf16 v[92:95], a[216:219], a[184:187], v[92:95]
  s_waitcnt lgkmcnt(0) vmcnt(5)
  v_exp_f32 v109, v45
  v_mfma_f32_16x16x32_bf16 v[92:95], a[212:215], a[180:183], v[92:95]
  s_barrier
  v_exp_f32 v110, v46
  v_mfma_f32_16x16x32_bf16 v[92:95], a[208:211], a[176:179], v[92:95]
  v_exp_f32 v111, v47
  v_mfma_f32_16x16x32_bf16 a[0:3], a[224:227], v[128:131], a[0:3]
  ds_read_b128 a[192:195], v2 offset:49152
  v_mfma_f32_16x16x32_bf16 a[4:7], a[224:227], v[132:135], a[4:7]
  v_exp_f32 v112, v48
  v_mfma_f32_16x16x32_bf16 a[8:11], a[224:227], v[136:139], a[8:11]
  ds_read_b128 a[196:199], v3 offset:49152
  v_mfma_f32_16x16x32_bf16 a[12:15], a[224:227], v[140:143], a[12:15]
  v_exp_f32 v113, v49
  v_mfma_f32_16x16x32_bf16 a[28:31], a[228:231], v[140:143], a[28:31]
  ds_read_b128 a[200:203], v4 offset:49152
  v_mfma_f32_16x16x32_bf16 a[24:27], a[228:231], v[136:139], a[24:27]
  v_exp_f32 v114, v50
  v_mfma_f32_16x16x32_bf16 a[20:23], a[228:231], v[132:135], a[20:23]
  ds_read_b128 a[204:207], v5 offset:49152
  v_mfma_f32_16x16x32_bf16 a[16:19], a[228:231], v[128:131], a[16:19]
  v_exp_f32 v115, v51
  v_mfma_f32_16x16x32_bf16 v[160:163], v[176:179], v[128:131], v[160:163]
  ds_read_b128 a[208:211], v2 offset:53248
  v_mfma_f32_16x16x32_bf16 a[32:35], a[232:235], v[128:131], a[32:35]
  v_exp_f32 v116, v52
  v_mfma_f32_16x16x32_bf16 a[36:39], a[232:235], v[132:135], a[36:39]
  ds_read_b128 a[212:215], v3 offset:53248
  v_mfma_f32_16x16x32_bf16 a[40:43], a[232:235], v[136:139], a[40:43]
  v_exp_f32 v117, v53
  v_mfma_f32_16x16x32_bf16 a[44:47], a[232:235], v[140:143], a[44:47]
  ds_read_b128 a[216:219], v4 offset:53248
  v_mfma_f32_16x16x32_bf16 a[60:63], a[236:239], v[140:143], a[60:63]
  v_exp_f32 v118, v54
  v_mfma_f32_16x16x32_bf16 a[56:59], a[236:239], v[136:139], a[56:59]
  ds_read_b128 a[220:223], v5 offset:53248
  v_mfma_f32_16x16x32_bf16 a[52:55], a[236:239], v[132:135], a[52:55]
  v_exp_f32 v119, v55
  v_mfma_f32_16x16x32_bf16 a[48:51], a[236:239], v[128:131], a[48:51]
  v_exp_f32 v120, v56
  v_mfma_f32_16x16x32_bf16 v[164:167], v[176:179], v[132:135], v[164:167]
  v_mfma_f32_16x16x32_bf16 a[64:67], a[240:243], v[128:131], a[64:67]
  v_exp_f32 v121, v57
  v_mfma_f32_16x16x32_bf16 a[68:71], a[240:243], v[132:135], a[68:71]
  v_mfma_f32_16x16x32_bf16 a[72:75], a[240:243], v[136:139], a[72:75]
  v_exp_f32 v122, v58
  v_mfma_f32_16x16x32_bf16 a[76:79], a[240:243], v[140:143], a[76:79]
  v_mfma_f32_16x16x32_bf16 a[92:95], a[244:247], v[140:143], a[92:95]
  v_exp_f32 v123, v59
  v_mfma_f32_16x16x32_bf16 a[88:91], a[244:247], v[136:139], a[88:91]
  v_mfma_f32_16x16x32_bf16 a[84:87], a[244:247], v[132:135], a[84:87]
  v_exp_f32 v124, v60
  v_mfma_f32_16x16x32_bf16 a[80:83], a[244:247], v[128:131], a[80:83]
  v_mfma_f32_16x16x32_bf16 v[168:171], v[176:179], v[136:139], v[168:171]
  v_exp_f32 v125, v61
  v_mfma_f32_16x16x32_bf16 a[96:99], a[248:251], v[128:131], a[96:99]
  v_mfma_f32_16x16x32_bf16 a[100:103], a[248:251], v[132:135], a[100:103]
  v_exp_f32 v126, v62
  v_mfma_f32_16x16x32_bf16 a[104:107], a[248:251], v[136:139], a[104:107]
  v_mfma_f32_16x16x32_bf16 a[108:111], a[248:251], v[140:143], a[108:111]
  v_exp_f32 v127, v63
  v_mfma_f32_16x16x32_bf16 a[124:127], a[252:255], v[140:143], a[124:127]
  v_mfma_f32_16x16x32_bf16 a[120:123], a[252:255], v[136:139], a[120:123]
  v_mfma_f32_16x16x32_bf16 a[116:119], a[252:255], v[132:135], a[116:119]
  s_waitcnt lgkmcnt(0)
  v_mfma_f32_16x16x32_bf16 a[112:115], a[252:255], v[128:131], a[112:115]
  v_mfma_f32_16x16x32_bf16 v[172:175], v[176:179], v[140:143], v[172:175]
  v_mfma_f32_16x16x32_bf16 v[32:35], a[192:195], a[128:131], v[144:147]
  ds_read_b64_tr_b16 a[224:225], v6 offset:32768
  v_cvt_pk_bf16_f32 v128, v96, v97
  v_mfma_f32_16x16x32_bf16 v[32:35], a[196:199], a[132:135], v[32:35]
  ds_read_b64_tr_b16 a[226:227], v6 offset:36864
  v_cvt_pk_bf16_f32 v129, v98, v99
  v_mfma_f32_16x16x32_bf16 v[32:35], a[200:203], a[136:139], v[32:35]
  ds_read_b64_tr_b16 a[228:229], v7 offset:32768
  v_cvt_pk_bf16_f32 v130, v112, v113
  v_mfma_f32_16x16x32_bf16 v[32:35], a[204:207], a[140:143], v[32:35]
  ds_read_b64_tr_b16 a[230:231], v7 offset:36864
  v_cvt_pk_bf16_f32 v131, v114, v115
  v_mfma_f32_16x16x32_bf16 v[36:39], a[204:207], a[156:159], v[148:151]
  ds_read_b64_tr_b16 a[232:233], v8 offset:32768
  v_cvt_pk_bf16_f32 v132, v100, v101
  v_mfma_f32_16x16x32_bf16 v[36:39], a[200:203], a[152:155], v[36:39]
  ds_read_b64_tr_b16 a[234:235], v8 offset:36864
  v_cvt_pk_bf16_f32 v133, v102, v103
  v_mfma_f32_16x16x32_bf16 v[36:39], a[196:199], a[148:151], v[36:39]
  ds_read_b64_tr_b16 a[236:237], v9 offset:32768
  v_cvt_pk_bf16_f32 v134, v116, v117
  v_mfma_f32_16x16x32_bf16 v[36:39], a[192:195], a[144:147], v[36:39]
  ds_read_b64_tr_b16 a[238:239], v9 offset:36864
  v_cvt_pk_bf16_f32 v135, v118, v119
  v_mfma_f32_16x16x32_bf16 v[40:43], a[192:195], a[160:163], v[152:155]
  ds_read_b64_tr_b16 a[240:241], v10 offset:32768
  v_cvt_pk_bf16_f32 v136, v104, v105
  v_mfma_f32_16x16x32_bf16 v[40:43], a[196:199], a[164:167], v[40:43]
  ds_read_b64_tr_b16 a[242:243], v10 offset:36864
  v_cvt_pk_bf16_f32 v137, v106, v107
  v_mfma_f32_16x16x32_bf16 v[40:43], a[200:203], a[168:171], v[40:43]
  ds_read_b64_tr_b16 a[244:245], v11 offset:32768
  v_cvt_pk_bf16_f32 v138, v120, v121
  v_mfma_f32_16x16x32_bf16 v[40:43], a[204:207], a[172:175], v[40:43]
  ds_read_b64_tr_b16 a[246:247], v11 offset:36864
  v_cvt_pk_bf16_f32 v139, v122, v123
  v_mfma_f32_16x16x32_bf16 v[44:47], a[204:207], a[188:191], v[156:159]
  ds_read_b64_tr_b16 a[248:249], v12 offset:32768
  v_cvt_pk_bf16_f32 v140, v108, v109
  v_mfma_f32_16x16x32_bf16 v[44:47], a[200:203], a[184:187], v[44:47]
  ds_read_b64_tr_b16 a[250:251], v12 offset:36864
  v_cvt_pk_bf16_f32 v141, v110, v111
  v_mfma_f32_16x16x32_bf16 v[44:47], a[196:199], a[180:183], v[44:47]
  ds_read_b64_tr_b16 a[252:253], v13 offset:32768
  v_cvt_pk_bf16_f32 v142, v124, v125
  v_mfma_f32_16x16x32_bf16 v[44:47], a[192:195], a[176:179], v[44:47]
  ds_read_b64_tr_b16 a[254:255], v13 offset:36864
  v_cvt_pk_bf16_f32 v143, v126, v127
  v_mfma_f32_16x16x32_bf16 v[48:51], a[208:211], a[128:131], v[144:147]
  v_exp_f32 v96, v64
  v_mfma_f32_16x16x32_bf16 v[48:51], a[212:215], a[132:135], v[48:51]
  v_exp_f32 v97, v65
  v_mfma_f32_16x16x32_bf16 v[48:51], a[216:219], a[136:139], v[48:51]
  v_exp_f32 v98, v66
  v_mfma_f32_16x16x32_bf16 v[48:51], a[220:223], a[140:143], v[48:51]
  v_exp_f32 v99, v67
  v_mfma_f32_16x16x32_bf16 v[52:55], a[220:223], a[156:159], v[148:151]
  v_exp_f32 v100, v68
  v_mfma_f32_16x16x32_bf16 v[52:55], a[216:219], a[152:155], v[52:55]
  v_exp_f32 v101, v69
  v_mfma_f32_16x16x32_bf16 v[52:55], a[212:215], a[148:151], v[52:55]
  v_exp_f32 v102, v70
  v_mfma_f32_16x16x32_bf16 v[52:55], a[208:211], a[144:147], v[52:55]
  v_exp_f32 v103, v71
  v_mfma_f32_16x16x32_bf16 v[56:59], a[208:211], a[160:163], v[152:155]
  v_exp_f32 v104, v72
  v_mfma_f32_16x16x32_bf16 v[56:59], a[212:215], a[164:167], v[56:59]
  v_exp_f32 v105, v73
  v_mfma_f32_16x16x32_bf16 v[56:59], a[216:219], a[168:171], v[56:59]
  v_exp_f32 v106, v74
  v_mfma_f32_16x16x32_bf16 v[56:59], a[220:223], a[172:175], v[56:59]
  v_exp_f32 v107, v75
  v_mfma_f32_16x16x32_bf16 v[60:63], a[220:223], a[188:191], v[156:159]
  v_exp_f32 v108, v76
  v_mfma_f32_16x16x32_bf16 v[60:63], a[216:219], a[184:187], v[60:63]
  s_waitcnt lgkmcnt(0)
  v_exp_f32 v109, v77
  v_mfma_f32_16x16x32_bf16 v[60:63], a[212:215], a[180:183], v[60:63]
  v_exp_f32 v110, v78
  v_mfma_f32_16x16x32_bf16 v[60:63], a[208:211], a[176:179], v[60:63]
  v_exp_f32 v111, v79
  v_mfma_f32_16x16x32_bf16 a[0:3], a[224:227], v[128:131], a[0:3]
  ds_read_b128 a[192:195], v2 offset:57344
  v_mfma_f32_16x16x32_bf16 a[4:7], a[224:227], v[132:135], a[4:7]
  v_exp_f32 v112, v80
  v_mfma_f32_16x16x32_bf16 a[8:11], a[224:227], v[136:139], a[8:11]
  ds_read_b128 a[196:199], v3 offset:57344
  v_mfma_f32_16x16x32_bf16 a[12:15], a[224:227], v[140:143], a[12:15]
  v_exp_f32 v113, v81
  v_mfma_f32_16x16x32_bf16 a[28:31], a[228:231], v[140:143], a[28:31]
  ds_read_b128 a[200:203], v4 offset:57344
  v_mfma_f32_16x16x32_bf16 a[24:27], a[228:231], v[136:139], a[24:27]
  v_exp_f32 v114, v82
  v_mfma_f32_16x16x32_bf16 a[20:23], a[228:231], v[132:135], a[20:23]
  ds_read_b128 a[204:207], v5 offset:57344
  v_mfma_f32_16x16x32_bf16 a[16:19], a[228:231], v[128:131], a[16:19]
  v_exp_f32 v115, v83
  v_mfma_f32_16x16x32_bf16 v[160:163], v[176:179], v[128:131], v[160:163]
  ds_read_b128 a[208:211], v2 offset:61440
  v_mfma_f32_16x16x32_bf16 a[32:35], a[232:235], v[128:131], a[32:35]
  v_exp_f32 v116, v84
  v_mfma_f32_16x16x32_bf16 a[36:39], a[232:235], v[132:135], a[36:39]
  ds_read_b128 a[212:215], v3 offset:61440
  v_mfma_f32_16x16x32_bf16 a[40:43], a[232:235], v[136:139], a[40:43]
  v_exp_f32 v117, v85
  v_mfma_f32_16x16x32_bf16 a[44:47], a[232:235], v[140:143], a[44:47]
  ds_read_b128 a[216:219], v4 offset:61440
  v_mfma_f32_16x16x32_bf16 a[60:63], a[236:239], v[140:143], a[60:63]
  v_exp_f32 v118, v86
  v_mfma_f32_16x16x32_bf16 a[56:59], a[236:239], v[136:139], a[56:59]
  ds_read_b128 a[220:223], v5 offset:61440
  v_mfma_f32_16x16x32_bf16 a[52:55], a[236:239], v[132:135], a[52:55]
  v_exp_f32 v119, v87
  v_mfma_f32_16x16x32_bf16 a[48:51], a[236:239], v[128:131], a[48:51]
  v_exp_f32 v120, v88
  v_mfma_f32_16x16x32_bf16 v[164:167], v[176:179], v[132:135], v[164:167]
  v_mfma_f32_16x16x32_bf16 a[64:67], a[240:243], v[128:131], a[64:67]
  v_exp_f32 v121, v89
  v_mfma_f32_16x16x32_bf16 a[68:71], a[240:243], v[132:135], a[68:71]
  v_mfma_f32_16x16x32_bf16 a[72:75], a[240:243], v[136:139], a[72:75]
  v_exp_f32 v122, v90
  v_mfma_f32_16x16x32_bf16 a[76:79], a[240:243], v[140:143], a[76:79]
  v_mfma_f32_16x16x32_bf16 a[92:95], a[244:247], v[140:143], a[92:95]
  v_exp_f32 v123, v91
  v_mfma_f32_16x16x32_bf16 a[88:91], a[244:247], v[136:139], a[88:91]
  v_mfma_f32_16x16x32_bf16 a[84:87], a[244:247], v[132:135], a[84:87]
  v_exp_f32 v124, v92
  v_mfma_f32_16x16x32_bf16 a[80:83], a[244:247], v[128:131], a[80:83]
  v_mfma_f32_16x16x32_bf16 v[168:171], v[176:179], v[136:139], v[168:171]
  v_exp_f32 v125, v93
  v_mfma_f32_16x16x32_bf16 a[96:99], a[248:251], v[128:131], a[96:99]
  v_mfma_f32_16x16x32_bf16 a[100:103], a[248:251], v[132:135], a[100:103]
  v_exp_f32 v126, v94
  v_mfma_f32_16x16x32_bf16 a[104:107], a[248:251], v[136:139], a[104:107]
  v_mfma_f32_16x16x32_bf16 a[108:111], a[248:251], v[140:143], a[108:111]
  v_exp_f32 v127, v95
  v_mfma_f32_16x16x32_bf16 a[124:127], a[252:255], v[140:143], a[124:127]
  v_mfma_f32_16x16x32_bf16 a[120:123], a[252:255], v[136:139], a[120:123]
  v_mfma_f32_16x16x32_bf16 a[116:119], a[252:255], v[132:135], a[116:119]
  s_waitcnt lgkmcnt(0)
  v_mfma_f32_16x16x32_bf16 a[112:115], a[252:255], v[128:131], a[112:115]
  v_mfma_f32_16x16x32_bf16 v[172:175], v[176:179], v[140:143], v[172:175]
  v_mfma_f32_16x16x32_bf16 v[64:67], a[192:195], a[128:131], v[144:147]
  ds_read_b64_tr_b16 a[224:225], v6 offset:40960
  v_cvt_pk_bf16_f32 v128, v96, v97
  v_mfma_f32_16x16x32_bf16 v[64:67], a[196:199], a[132:135], v[64:67]
  ds_read_b64_tr_b16 a[226:227], v6 offset:45056
  v_cvt_pk_bf16_f32 v129, v98, v99
  v_mfma_f32_16x16x32_bf16 v[64:67], a[200:203], a[136:139], v[64:67]
  ds_read_b64_tr_b16 a[228:229], v7 offset:40960
  v_cvt_pk_bf16_f32 v130, v112, v113
  v_mfma_f32_16x16x32_bf16 v[64:67], a[204:207], a[140:143], v[64:67]
  ds_read_b64_tr_b16 a[230:231], v7 offset:45056
  v_cvt_pk_bf16_f32 v131, v114, v115
  v_mfma_f32_16x16x32_bf16 v[68:71], a[204:207], a[156:159], v[148:151]
  ds_read_b64_tr_b16 a[232:233], v8 offset:40960
  v_cvt_pk_bf16_f32 v132, v100, v101
  v_mfma_f32_16x16x32_bf16 v[68:71], a[200:203], a[152:155], v[68:71]
  ds_read_b64_tr_b16 a[234:235], v8 offset:45056
  v_cvt_pk_bf16_f32 v133, v102, v103
  v_mfma_f32_16x16x32_bf16 v[68:71], a[196:199], a[148:151], v[68:71]
  ds_read_b64_tr_b16 a[236:237], v9 offset:40960
  v_cvt_pk_bf16_f32 v134, v116, v117
  v_mfma_f32_16x16x32_bf16 v[68:71], a[192:195], a[144:147], v[68:71]
  ds_read_b64_tr_b16 a[238:239], v9 offset:45056
  v_cvt_pk_bf16_f32 v135, v118, v119
  v_mfma_f32_16x16x32_bf16 v[72:75], a[192:195], a[160:163], v[152:155]
  ds_read_b64_tr_b16 a[240:241], v10 offset:40960
  v_cvt_pk_bf16_f32 v136, v104, v105
  v_mfma_f32_16x16x32_bf16 v[72:75], a[196:199], a[164:167], v[72:75]
  ds_read_b64_tr_b16 a[242:243], v10 offset:45056
  v_cvt_pk_bf16_f32 v137, v106, v107
  v_mfma_f32_16x16x32_bf16 v[72:75], a[200:203], a[168:171], v[72:75]
  ds_read_b64_tr_b16 a[244:245], v11 offset:40960
  v_cvt_pk_bf16_f32 v138, v120, v121
  v_mfma_f32_16x16x32_bf16 v[72:75], a[204:207], a[172:175], v[72:75]
  ds_read_b64_tr_b16 a[246:247], v11 offset:45056
  v_cvt_pk_bf16_f32 v139, v122, v123
  v_mfma_f32_16x16x32_bf16 v[76:79], a[204:207], a[188:191], v[156:159]
  ds_read_b64_tr_b16 a[248:249], v12 offset:40960
  v_cvt_pk_bf16_f32 v140, v108, v109
  v_mfma_f32_16x16x32_bf16 v[76:79], a[200:203], a[184:187], v[76:79]
  ds_read_b64_tr_b16 a[250:251], v12 offset:45056
  v_cvt_pk_bf16_f32 v141, v110, v111
  v_mfma_f32_16x16x32_bf16 v[76:79], a[196:199], a[180:183], v[76:79]
  ds_read_b64_tr_b16 a[252:253], v13 offset:40960
  v_cvt_pk_bf16_f32 v142, v124, v125
  v_mfma_f32_16x16x32_bf16 v[76:79], a[192:195], a[176:179], v[76:79]
  ds_read_b64_tr_b16 a[254:255], v13 offset:45056
  v_cvt_pk_bf16_f32 v143, v126, v127
  v_mfma_f32_16x16x32_bf16 v[80:83], a[208:211], a[128:131], v[144:147]
  v_exp_f32 v96, v32
  v_mfma_f32_16x16x32_bf16 v[80:83], a[212:215], a[132:135], v[80:83]
  v_exp_f32 v97, v33
  v_mfma_f32_16x16x32_bf16 v[80:83], a[216:219], a[136:139], v[80:83]
  v_exp_f32 v98, v34
  v_mfma_f32_16x16x32_bf16 v[80:83], a[220:223], a[140:143], v[80:83]
  v_exp_f32 v99, v35
  v_mfma_f32_16x16x32_bf16 v[84:87], a[220:223], a[156:159], v[148:151]
  v_exp_f32 v100, v36
  v_mfma_f32_16x16x32_bf16 v[84:87], a[216:219], a[152:155], v[84:87]
  v_exp_f32 v101, v37
  v_mfma_f32_16x16x32_bf16 v[84:87], a[212:215], a[148:151], v[84:87]
  v_exp_f32 v102, v38
  v_mfma_f32_16x16x32_bf16 v[84:87], a[208:211], a[144:147], v[84:87]
  v_exp_f32 v103, v39
  v_mfma_f32_16x16x32_bf16 v[88:91], a[208:211], a[160:163], v[152:155]
  v_exp_f32 v104, v40
  v_mfma_f32_16x16x32_bf16 v[88:91], a[212:215], a[164:167], v[88:91]
  v_exp_f32 v105, v41
  v_mfma_f32_16x16x32_bf16 v[88:91], a[216:219], a[168:171], v[88:91]
  v_exp_f32 v106, v42
  v_mfma_f32_16x16x32_bf16 v[88:91], a[220:223], a[172:175], v[88:91]
  v_exp_f32 v107, v43
  v_mfma_f32_16x16x32_bf16 v[92:95], a[220:223], a[188:191], v[156:159]
  v_exp_f32 v108, v44
  v_mfma_f32_16x16x32_bf16 v[92:95], a[216:219], a[184:187], v[92:95]
  s_waitcnt lgkmcnt(0) vmcnt(0)
  v_exp_f32 v109, v45
  v_mfma_f32_16x16x32_bf16 v[92:95], a[212:215], a[180:183], v[92:95]
  s_barrier
  v_exp_f32 v110, v46
  v_mfma_f32_16x16x32_bf16 v[92:95], a[208:211], a[176:179], v[92:95]
  v_exp_f32 v111, v47
  v_readlane_b32 s40, v202, 0
  v_readlane_b32 s41, v202, 1
  s_nop 3
  s_cmp_ge_u32 s40, 32
  s_cselect_b32 s68, 1, 0
  s_cmp_ge_u32 s41, 1
  s_cselect_b32 s68, s68, 0
  s_cmp_lt_u32 s2, 112
  s_cselect_b32 s68, s68, 0
  s_cmp_eq_u32 s68, 1
  s_cselect_b32 s10, 8388608, 0
  s_cselect_b32 s14, 7340032, 0
  v_mfma_f32_16x16x32_bf16 a[0:3], a[224:227], v[128:131], a[0:3]
  v_mfma_f32_16x16x32_bf16 a[4:7], a[224:227], v[132:135], a[4:7]
  v_exp_f32 v112, v48
  v_mfma_f32_16x16x32_bf16 a[8:11], a[224:227], v[136:139], a[8:11]
  v_mfma_f32_16x16x32_bf16 a[12:15], a[224:227], v[140:143], a[12:15]
  v_exp_f32 v113, v49
  v_mfma_f32_16x16x32_bf16 a[28:31], a[228:231], v[140:143], a[28:31]
  v_mfma_f32_16x16x32_bf16 a[24:27], a[228:231], v[136:139], a[24:27]
  v_exp_f32 v114, v50
  v_mfma_f32_16x16x32_bf16 a[20:23], a[228:231], v[132:135], a[20:23]
  v_mfma_f32_16x16x32_bf16 a[16:19], a[228:231], v[128:131], a[16:19]
  v_exp_f32 v115, v51
  v_mfma_f32_16x16x32_bf16 v[160:163], v[176:179], v[128:131], v[160:163]
  v_mfma_f32_16x16x32_bf16 a[32:35], a[232:235], v[128:131], a[32:35]
  v_exp_f32 v116, v52
  v_mfma_f32_16x16x32_bf16 a[36:39], a[232:235], v[132:135], a[36:39]
  v_mfma_f32_16x16x32_bf16 a[40:43], a[232:235], v[136:139], a[40:43]
  v_exp_f32 v117, v53
  v_mfma_f32_16x16x32_bf16 a[44:47], a[232:235], v[140:143], a[44:47]
  v_mfma_f32_16x16x32_bf16 a[60:63], a[236:239], v[140:143], a[60:63]
  v_exp_f32 v118, v54
  v_mfma_f32_16x16x32_bf16 a[56:59], a[236:239], v[136:139], a[56:59]
  v_mfma_f32_16x16x32_bf16 a[52:55], a[236:239], v[132:135], a[52:55]
  v_exp_f32 v119, v55
  v_mfma_f32_16x16x32_bf16 a[48:51], a[236:239], v[128:131], a[48:51]
  s_add_u32 m0, s28, 65536
  v_exp_f32 v120, v56
  v_mfma_f32_16x16x32_bf16 v[164:167], v[176:179], v[132:135], v[164:167]
  buffer_load_dwordx4 v14, s[8:11], s26 offen offset:0 sc1 lds
  v_mfma_f32_16x16x32_bf16 a[64:67], a[240:243], v[128:131], a[64:67]
  v_exp_f32 v121, v57
  v_mfma_f32_16x16x32_bf16 a[68:71], a[240:243], v[132:135], a[68:71]
  v_mfma_f32_16x16x32_bf16 a[72:75], a[240:243], v[136:139], a[72:75]
  v_exp_f32 v122, v58
  v_mfma_f32_16x16x32_bf16 a[76:79], a[240:243], v[140:143], a[76:79]
  buffer_load_dwordx4 v15, s[8:11], s26 offen offset:1024 sc1 lds
  v_mfma_f32_16x16x32_bf16 a[92:95], a[244:247], v[140:143], a[92:95]
  v_exp_f32 v123, v59
  v_mfma_f32_16x16x32_bf16 a[88:91], a[244:247], v[136:139], a[88:91]
  v_mfma_f32_16x16x32_bf16 a[84:87], a[244:247], v[132:135], a[84:87]
  v_exp_f32 v124, v60
  v_mfma_f32_16x16x32_bf16 a[80:83], a[244:247], v[128:131], a[80:83]
  v_mfma_f32_16x16x32_bf16 v[168:171], v[176:179], v[136:139], v[168:171]
  v_exp_f32 v125, v61
  v_mfma_f32_16x16x32_bf16 a[96:99], a[248:251], v[128:131], a[96:99]
  buffer_load_dwordx4 v16, s[8:11], s26 offen offset:2048 sc1 lds
  v_mfma_f32_16x16x32_bf16 a[100:103], a[248:251], v[132:135], a[100:103]
  v_exp_f32 v126, v62
  v_mfma_f32_16x16x32_bf16 a[104:107], a[248:251], v[136:139], a[104:107]
  v_mfma_f32_16x16x32_bf16 a[108:111], a[248:251], v[140:143], a[108:111]
  v_exp_f32 v127, v63
  v_mfma_f32_16x16x32_bf16 a[124:127], a[252:255], v[140:143], a[124:127]
  buffer_load_dwordx4 v17, s[8:11], s26 offen offset:3072 sc1 lds
  v_mfma_f32_16x16x32_bf16 a[120:123], a[252:255], v[136:139], a[120:123]
  v_mfma_f32_16x16x32_bf16 a[116:119], a[252:255], v[132:135], a[116:119]
  s_waitcnt lgkmcnt(0)
  v_mfma_f32_16x16x32_bf16 a[112:115], a[252:255], v[128:131], a[112:115]
  v_mfma_f32_16x16x32_bf16 v[172:175], v[176:179], v[140:143], v[172:175]
  ds_read_b64_tr_b16 a[224:225], v6 offset:49152
  v_cvt_pk_bf16_f32 v128, v96, v97
  ds_read_b64_tr_b16 a[226:227], v6 offset:53248
  v_cvt_pk_bf16_f32 v129, v98, v99
  ds_read_b64_tr_b16 a[228:229], v7 offset:49152
  v_cvt_pk_bf16_f32 v130, v112, v113
  ds_read_b64_tr_b16 a[230:231], v7 offset:53248
  v_cvt_pk_bf16_f32 v131, v114, v115
  ds_read_b64_tr_b16 a[232:233], v8 offset:49152
  v_cvt_pk_bf16_f32 v132, v100, v101
  ds_read_b64_tr_b16 a[234:235], v8 offset:53248
  v_cvt_pk_bf16_f32 v133, v102, v103
  ds_read_b64_tr_b16 a[236:237], v9 offset:49152
  v_cvt_pk_bf16_f32 v134, v116, v117
  ds_read_b64_tr_b16 a[238:239], v9 offset:53248
  v_cvt_pk_bf16_f32 v135, v118, v119
  ds_read_b64_tr_b16 a[240:241], v10 offset:49152
  v_cvt_pk_bf16_f32 v136, v104, v105
  ds_read_b64_tr_b16 a[242:243], v10 offset:53248
  v_cvt_pk_bf16_f32 v137, v106, v107
  ds_read_b64_tr_b16 a[244:245], v11 offset:49152
  v_cvt_pk_bf16_f32 v138, v120, v121
  ds_read_b64_tr_b16 a[246:247], v11 offset:53248
  v_cvt_pk_bf16_f32 v139, v122, v123
  ds_read_b64_tr_b16 a[248:249], v12 offset:49152
  v_cvt_pk_bf16_f32 v140, v108, v109
  ds_read_b64_tr_b16 a[250:251], v12 offset:53248
  v_cvt_pk_bf16_f32 v141, v110, v111
  ds_read_b64_tr_b16 a[252:253], v13 offset:49152
  v_cvt_pk_bf16_f32 v142, v124, v125
  ds_read_b64_tr_b16 a[254:255], v13 offset:53248
  v_cvt_pk_bf16_f32 v143, v126, v127
  v_exp_f32 v96, v64
  v_exp_f32 v97, v65
  v_exp_f32 v98, v66
  v_exp_f32 v99, v67
  v_exp_f32 v100, v68
  v_exp_f32 v101, v69
  v_exp_f32 v102, v70
  v_exp_f32 v103, v71
  v_exp_f32 v104, v72
  v_exp_f32 v105, v73
  v_exp_f32 v106, v74
  v_exp_f32 v107, v75
  v_exp_f32 v108, v76
  v_exp_f32 v109, v77
  v_exp_f32 v110, v78
  v_exp_f32 v111, v79
  s_waitcnt lgkmcnt(0)
  v_mfma_f32_16x16x32_bf16 a[0:3], a[224:227], v[128:131], a[0:3]
  v_mfma_f32_16x16x32_bf16 a[4:7], a[224:227], v[132:135], a[4:7]
  v_exp_f32 v112, v80
  v_mfma_f32_16x16x32_bf16 a[8:11], a[224:227], v[136:139], a[8:11]
  v_mfma_f32_16x16x32_bf16 a[12:15], a[224:227], v[140:143], a[12:15]
  v_exp_f32 v113, v81
  v_mfma_f32_16x16x32_bf16 a[28:31], a[228:231], v[140:143], a[28:31]
  v_mfma_f32_16x16x32_bf16 a[24:27], a[228:231], v[136:139], a[24:27]
  v_exp_f32 v114, v82
  v_mfma_f32_16x16x32_bf16 a[20:23], a[228:231], v[132:135], a[20:23]
  v_mfma_f32_16x16x32_bf16 a[16:19], a[228:231], v[128:131], a[16:19]
  v_exp_f32 v115, v83
  v_mfma_f32_16x16x32_bf16 v[160:163], v[176:179], v[128:131], v[160:163]
  v_mfma_f32_16x16x32_bf16 a[32:35], a[232:235], v[128:131], a[32:35]
  v_exp_f32 v116, v84
  v_mfma_f32_16x16x32_bf16 a[36:39], a[232:235], v[132:135], a[36:39]
  v_mfma_f32_16x16x32_bf16 a[40:43], a[232:235], v[136:139], a[40:43]
  v_exp_f32 v117, v85
  v_mfma_f32_16x16x32_bf16 a[44:47], a[232:235], v[140:143], a[44:47]
  v_mfma_f32_16x16x32_bf16 a[60:63], a[236:239], v[140:143], a[60:63]
  v_exp_f32 v118, v86
  v_mfma_f32_16x16x32_bf16 a[56:59], a[236:239], v[136:139], a[56:59]
  v_mfma_f32_16x16x32_bf16 a[52:55], a[236:239], v[132:135], a[52:55]
  v_exp_f32 v119, v87
  v_mfma_f32_16x16x32_bf16 a[48:51], a[236:239], v[128:131], a[48:51]
  s_add_u32 m0, s28, 69632
  v_exp_f32 v120, v88
  v_mfma_f32_16x16x32_bf16 v[164:167], v[176:179], v[132:135], v[164:167]
  buffer_load_dwordx4 v18, s[8:11], s26 offen offset:0 sc1 lds
  v_mfma_f32_16x16x32_bf16 a[64:67], a[240:243], v[128:131], a[64:67]
  v_exp_f32 v121, v89
  v_mfma_f32_16x16x32_bf16 a[68:71], a[240:243], v[132:135], a[68:71]
  v_mfma_f32_16x16x32_bf16 a[72:75], a[240:243], v[136:139], a[72:75]
  v_exp_f32 v122, v90
  v_mfma_f32_16x16x32_bf16 a[76:79], a[240:243], v[140:143], a[76:79]
  buffer_load_dwordx4 v19, s[8:11], s26 offen offset:1024 sc1 lds
  v_mfma_f32_16x16x32_bf16 a[92:95], a[244:247], v[140:143], a[92:95]
  v_exp_f32 v123, v91
  v_mfma_f32_16x16x32_bf16 a[88:91], a[244:247], v[136:139], a[88:91]
  v_mfma_f32_16x16x32_bf16 a[84:87], a[244:247], v[132:135], a[84:87]
  v_exp_f32 v124, v92
  v_mfma_f32_16x16x32_bf16 a[80:83], a[244:247], v[128:131], a[80:83]
  v_mfma_f32_16x16x32_bf16 v[168:171], v[176:179], v[136:139], v[168:171]
  v_exp_f32 v125, v93
  v_mfma_f32_16x16x32_bf16 a[96:99], a[248:251], v[128:131], a[96:99]
  buffer_load_dwordx4 v20, s[8:11], s26 offen offset:2048 sc1 lds
  v_mfma_f32_16x16x32_bf16 a[100:103], a[248:251], v[132:135], a[100:103]
  v_exp_f32 v126, v94
  v_mfma_f32_16x16x32_bf16 a[104:107], a[248:251], v[136:139], a[104:107]
  v_mfma_f32_16x16x32_bf16 a[108:111], a[248:251], v[140:143], a[108:111]
  v_exp_f32 v127, v95
  v_mfma_f32_16x16x32_bf16 a[124:127], a[252:255], v[140:143], a[124:127]
  buffer_load_dwordx4 v21, s[8:11], s26 offen offset:3072 sc1 lds
  v_mfma_f32_16x16x32_bf16 a[120:123], a[252:255], v[136:139], a[120:123]
  v_mfma_f32_16x16x32_bf16 a[116:119], a[252:255], v[132:135], a[116:119]
  s_waitcnt lgkmcnt(0)
  v_mfma_f32_16x16x32_bf16 a[112:115], a[252:255], v[128:131], a[112:115]
  v_mfma_f32_16x16x32_bf16 v[172:175], v[176:179], v[140:143], v[172:175]
  ds_read_b64_tr_b16 a[224:225], v6 offset:57344
  v_cvt_pk_bf16_f32 v128, v96, v97
  ds_read_b64_tr_b16 a[226:227], v6 offset:61440
  v_cvt_pk_bf16_f32 v129, v98, v99
  ds_read_b64_tr_b16 a[228:229], v7 offset:57344
  v_cvt_pk_bf16_f32 v130, v112, v113
  ds_read_b64_tr_b16 a[230:231], v7 offset:61440
  v_cvt_pk_bf16_f32 v131, v114, v115
  ds_read_b64_tr_b16 a[232:233], v8 offset:57344
  v_cvt_pk_bf16_f32 v132, v100, v101
  ds_read_b64_tr_b16 a[234:235], v8 offset:61440
  v_cvt_pk_bf16_f32 v133, v102, v103
  ds_read_b64_tr_b16 a[236:237], v9 offset:57344
  v_cvt_pk_bf16_f32 v134, v116, v117
  ds_read_b64_tr_b16 a[238:239], v9 offset:61440
  v_cvt_pk_bf16_f32 v135, v118, v119
  ds_read_b64_tr_b16 a[240:241], v10 offset:57344
  v_cvt_pk_bf16_f32 v136, v104, v105
  ds_read_b64_tr_b16 a[242:243], v10 offset:61440
  v_cvt_pk_bf16_f32 v137, v106, v107
  ds_read_b64_tr_b16 a[244:245], v11 offset:57344
  v_cvt_pk_bf16_f32 v138, v120, v121
  ds_read_b64_tr_b16 a[246:247], v11 offset:61440
  v_cvt_pk_bf16_f32 v139, v122, v123
  ds_read_b64_tr_b16 a[248:249], v12 offset:57344
  v_cvt_pk_bf16_f32 v140, v108, v109
  ds_read_b64_tr_b16 a[250:251], v12 offset:61440
  v_cvt_pk_bf16_f32 v141, v110, v111
  ds_read_b64_tr_b16 a[252:253], v13 offset:57344
  v_cvt_pk_bf16_f32 v142, v124, v125
  ds_read_b64_tr_b16 a[254:255], v13 offset:61440
  v_cvt_pk_bf16_f32 v143, v126, v127
  s_waitcnt lgkmcnt(0)
  v_mfma_f32_16x16x32_bf16 a[0:3], a[224:227], v[128:131], a[0:3]
  s_add_u32 m0, s29, 32768
  v_mfma_f32_16x16x32_bf16 a[4:7], a[224:227], v[132:135], a[4:7]
  buffer_load_dwordx4 v22, s[12:15], s27 offen offset:0 sc1 lds
  v_mfma_f32_16x16x32_bf16 a[8:11], a[224:227], v[136:139], a[8:11]
  v_mfma_f32_16x16x32_bf16 a[12:15], a[224:227], v[140:143], a[12:15]
  v_mfma_f32_16x16x32_bf16 a[28:31], a[228:231], v[140:143], a[28:31]
  v_mfma_f32_16x16x32_bf16 a[24:27], a[228:231], v[136:139], a[24:27]
  v_mfma_f32_16x16x32_bf16 a[20:23], a[228:231], v[132:135], a[20:23]
  v_mfma_f32_16x16x32_bf16 a[16:19], a[228:231], v[128:131], a[16:19]
  v_mfma_f32_16x16x32_bf16 v[160:163], v[176:179], v[128:131], v[160:163]
  v_mfma_f32_16x16x32_bf16 a[32:35], a[232:235], v[128:131], a[32:35]
  buffer_load_dwordx4 v23, s[12:15], s27 offen offset:1024 sc1 lds
  v_mfma_f32_16x16x32_bf16 a[36:39], a[232:235], v[132:135], a[36:39]
  v_mfma_f32_16x16x32_bf16 a[40:43], a[232:235], v[136:139], a[40:43]
  v_mfma_f32_16x16x32_bf16 a[44:47], a[232:235], v[140:143], a[44:47]
  v_mfma_f32_16x16x32_bf16 a[60:63], a[236:239], v[140:143], a[60:63]
  v_mfma_f32_16x16x32_bf16 a[56:59], a[236:239], v[136:139], a[56:59]
  v_mfma_f32_16x16x32_bf16 a[52:55], a[236:239], v[132:135], a[52:55]
  v_mfma_f32_16x16x32_bf16 a[48:51], a[236:239], v[128:131], a[48:51]
  v_mfma_f32_16x16x32_bf16 v[164:167], v[176:179], v[132:135], v[164:167]
  v_mfma_f32_16x16x32_bf16 a[64:67], a[240:243], v[128:131], a[64:67]
  v_mfma_f32_16x16x32_bf16 a[68:71], a[240:243], v[132:135], a[68:71]
  buffer_load_dwordx4 v24, s[12:15], s27 offen offset:2048 sc1 lds
  v_mfma_f32_16x16x32_bf16 a[72:75], a[240:243], v[136:139], a[72:75]
  v_mfma_f32_16x16x32_bf16 a[76:79], a[240:243], v[140:143], a[76:79]
  v_mfma_f32_16x16x32_bf16 a[92:95], a[244:247], v[140:143], a[92:95]
  v_mfma_f32_16x16x32_bf16 a[88:91], a[244:247], v[136:139], a[88:91]
  v_mfma_f32_16x16x32_bf16 a[84:87], a[244:247], v[132:135], a[84:87]
  v_mfma_f32_16x16x32_bf16 a[80:83], a[244:247], v[128:131], a[80:83]
  v_mfma_f32_16x16x32_bf16 v[168:171], v[176:179], v[136:139], v[168:171]
  v_mfma_f32_16x16x32_bf16 a[96:99], a[248:251], v[128:131], a[96:99]
  buffer_load_dwordx4 v25, s[12:15], s27 offen offset:3072 sc1 lds
  v_mfma_f32_16x16x32_bf16 a[100:103], a[248:251], v[132:135], a[100:103]
  v_mfma_f32_16x16x32_bf16 a[104:107], a[248:251], v[136:139], a[104:107]
  v_mfma_f32_16x16x32_bf16 a[108:111], a[248:251], v[140:143], a[108:111]
  v_mfma_f32_16x16x32_bf16 a[124:127], a[252:255], v[140:143], a[124:127]
  v_mfma_f32_16x16x32_bf16 a[120:123], a[252:255], v[136:139], a[120:123]
  v_mfma_f32_16x16x32_bf16 a[116:119], a[252:255], v[132:135], a[116:119]
  s_waitcnt lgkmcnt(0)
  v_mfma_f32_16x16x32_bf16 a[112:115], a[252:255], v[128:131], a[112:115]
  v_mfma_f32_16x16x32_bf16 v[172:175], v[176:179], v[140:143], v[172:175]
  s_nop 7
  s_nop 7
  v_cmp_nge_f32 vcc, 0x45000000, v160
  s_mov_b64 s[40:41], vcc
  v_cmp_nge_f32 vcc, 0x45000000, v164
  s_or_b64 s[40:41], s[40:41], vcc
  v_cmp_nge_f32 vcc, 0x45000000, v168
  s_or_b64 s[40:41], s[40:41], vcc
  v_cmp_nge_f32 vcc, 0x45000000, v172
  s_or_b64 s[40:41], s[40:41], vcc
  s_cmp_lg_u64 s[40:41], 0
  s_cselect_b32 s63, 1, 0
  v_rcp_f32 v180, v160
  v_rcp_f32 v182, v164
  v_rcp_f32 v184, v168
  v_rcp_f32 v186, v172
  s_nop 0
  v_mov_b32 v181, v180
  v_mov_b32 v183, v182
  v_mov_b32 v185, v184
  v_mov_b32 v187, v186
  v_accvgpr_read_b32 v96, a0
  v_accvgpr_read_b32 v97, a1
  v_accvgpr_read_b32 v98, a2
  v_accvgpr_read_b32 v99, a3
  v_pk_mul_f32 v[96:97], v[96:97], v[180:181]
  v_pk_mul_f32 v[98:99], v[98:99], v[180:181]
  v_cvt_pk_bf16_f32 v50, v96, v97
  v_cvt_pk_bf16_f32 v51, v98, v99
  ds_write_b64 v204, v[50:51] offset:0
  s_add_u32 m0, s28, 0
  v_accvgpr_read_b32 v100, a16
  v_accvgpr_read_b32 v101, a17
  buffer_load_dwordx4 v14, s[8:11], s30 offen offset:0 sc1 lds
  v_accvgpr_read_b32 v102, a18
  v_accvgpr_read_b32 v103, a19
  v_pk_mul_f32 v[100:101], v[100:101], v[180:181]
  v_pk_mul_f32 v[102:103], v[102:103], v[180:181]
  v_cvt_pk_bf16_f32 v52, v100, v101
  v_cvt_pk_bf16_f32 v53, v102, v103
  ds_write_b64 v205, v[52:53] offset:0
  v_accvgpr_read_b32 v96, a32
  v_accvgpr_read_b32 v97, a33
  buffer_load_dwordx4 v15, s[8:11], s30 offen offset:1024 sc1 lds
  v_accvgpr_read_b32 v98, a34
  v_accvgpr_read_b32 v99, a35
  v_pk_mul_f32 v[96:97], v[96:97], v[180:181]
  v_pk_mul_f32 v[98:99], v[98:99], v[180:181]
  v_cvt_pk_bf16_f32 v54, v96, v97
  v_cvt_pk_bf16_f32 v55, v98, v99
  ds_write_b64 v206, v[54:55] offset:0
  v_accvgpr_read_b32 v100, a48
  v_accvgpr_read_b32 v101, a49
  buffer_load_dwordx4 v16, s[8:11], s30 offen offset:2048 sc1 lds
  v_accvgpr_read_b32 v102, a50
  v_accvgpr_read_b32 v103, a51
  v_pk_mul_f32 v[100:101], v[100:101], v[180:181]
  v_pk_mul_f32 v[102:103], v[102:103], v[180:181]
  v_cvt_pk_bf16_f32 v56, v100, v101
  v_cvt_pk_bf16_f32 v57, v102, v103
  ds_write_b64 v207, v[56:57] offset:0
  v_accvgpr_read_b32 v96, a64
  v_accvgpr_read_b32 v97, a65
  v_accvgpr_read_b32 v98, a66
  v_accvgpr_read_b32 v99, a67
  v_pk_mul_f32 v[96:97], v[96:97], v[180:181]
  v_pk_mul_f32 v[98:99], v[98:99], v[180:181]
  v_cvt_pk_bf16_f32 v50, v96, v97
  v_cvt_pk_bf16_f32 v51, v98, v99
  ds_write_b64 v208, v[50:51] offset:0
  v_accvgpr_read_b32 v100, a80
  v_accvgpr_read_b32 v101, a81
  buffer_load_dwordx4 v17, s[8:11], s30 offen offset:3072 sc1 lds
  v_accvgpr_read_b32 v102, a82
  v_accvgpr_read_b32 v103, a83
  v_pk_mul_f32 v[100:101], v[100:101], v[180:181]
  v_pk_mul_f32 v[102:103], v[102:103], v[180:181]
  v_cvt_pk_bf16_f32 v52, v100, v101
  v_cvt_pk_bf16_f32 v53, v102, v103
  ds_write_b64 v209, v[52:53] offset:0
  s_add_u32 m0, s28, 4096
  v_accvgpr_read_b32 v96, a96
  v_accvgpr_read_b32 v97, a97
  buffer_load_dwordx4 v18, s[8:11], s30 offen offset:0 sc1 lds
  v_accvgpr_read_b32 v98, a98
  v_accvgpr_read_b32 v99, a99
  v_pk_mul_f32 v[96:97], v[96:97], v[180:181]
  v_pk_mul_f32 v[98:99], v[98:99], v[180:181]
  v_cvt_pk_bf16_f32 v54, v96, v97
  v_cvt_pk_bf16_f32 v55, v98, v99
  ds_write_b64 v210, v[54:55] offset:0
  v_accvgpr_read_b32 v100, a112
  v_accvgpr_read_b32 v101, a113
  buffer_load_dwordx4 v19, s[8:11], s30 offen offset:1024 sc1 lds
  v_accvgpr_read_b32 v102, a114
  v_accvgpr_read_b32 v103, a115
  v_pk_mul_f32 v[100:101], v[100:101], v[180:181]
  v_pk_mul_f32 v[102:103], v[102:103], v[180:181]
  v_cvt_pk_bf16_f32 v56, v100, v101
  v_cvt_pk_bf16_f32 v57, v102, v103
  ds_write_b64 v211, v[56:57] offset:0
  ds_read_b128 v[64:67], v212 offset:0
  ds_read_b128 v[68:71], v213 offset:1024
  ds_read_b128 v[72:75], v214 offset:2048
  ds_read_b128 v[76:79], v215 offset:3072
  v_accvgpr_read_b32 v96, a4
  v_accvgpr_read_b32 v97, a5
  v_accvgpr_read_b32 v98, a6
  v_accvgpr_read_b32 v99, a7
  v_pk_mul_f32 v[96:97], v[96:97], v[182:183]
  v_pk_mul_f32 v[98:99], v[98:99], v[182:183]
  v_cvt_pk_bf16_f32 v50, v96, v97
  v_cvt_pk_bf16_f32 v51, v98, v99
  ds_write_b64 v204, v[50:51] offset:0
  v_accvgpr_read_b32 v100, a20
  v_accvgpr_read_b32 v101, a21
  buffer_load_dwordx4 v20, s[8:11], s30 offen offset:2048 sc1 lds
  v_accvgpr_read_b32 v102, a22
  v_accvgpr_read_b32 v103, a23
  v_pk_mul_f32 v[100:101], v[100:101], v[182:183]
  v_pk_mul_f32 v[102:103], v[102:103], v[182:183]
  v_cvt_pk_bf16_f32 v52, v100, v101
  v_cvt_pk_bf16_f32 v53, v102, v103
  ds_write_b64 v205, v[52:53] offset:0
  v_accvgpr_read_b32 v96, a36
  v_accvgpr_read_b32 v97, a37
  buffer_load_dwordx4 v21, s[8:11], s30 offen offset:3072 sc1 lds
  v_accvgpr_read_b32 v98, a38
  v_accvgpr_read_b32 v99, a39
  v_pk_mul_f32 v[96:97], v[96:97], v[182:183]
  v_pk_mul_f32 v[98:99], v[98:99], v[182:183]
  v_cvt_pk_bf16_f32 v54, v96, v97
  v_cvt_pk_bf16_f32 v55, v98, v99
  ds_write_b64 v206, v[54:55] offset:0
  s_add_u32 m0, s29, 0
  v_accvgpr_read_b32 v100, a52
  v_accvgpr_read_b32 v101, a53
  buffer_load_dwordx4 v22, s[12:15], s31 offen offset:0 sc1 lds
  v_accvgpr_read_b32 v102, a54
  v_accvgpr_read_b32 v103, a55
  v_pk_mul_f32 v[100:101], v[100:101], v[182:183]
  v_pk_mul_f32 v[102:103], v[102:103], v[182:183]
  v_cvt_pk_bf16_f32 v56, v100, v101
  v_cvt_pk_bf16_f32 v57, v102, v103
  ds_write_b64 v207, v[56:57] offset:0
  v_accvgpr_read_b32 v96, a68
  v_accvgpr_read_b32 v97, a69
  v_accvgpr_read_b32 v98, a70
  v_accvgpr_read_b32 v99, a71
  v_pk_mul_f32 v[96:97], v[96:97], v[182:183]
  v_pk_mul_f32 v[98:99], v[98:99], v[182:183]
  v_cvt_pk_bf16_f32 v50, v96, v97
  v_cvt_pk_bf16_f32 v51, v98, v99
  ds_write_b64 v208, v[50:51] offset:0
  v_accvgpr_read_b32 v100, a84
  v_accvgpr_read_b32 v101, a85
  buffer_load_dwordx4 v23, s[12:15], s31 offen offset:1024 sc1 lds
  v_accvgpr_read_b32 v102, a86
  v_accvgpr_read_b32 v103, a87
  v_pk_mul_f32 v[100:101], v[100:101], v[182:183]
  v_pk_mul_f32 v[102:103], v[102:103], v[182:183]
  v_cvt_pk_bf16_f32 v52, v100, v101
  v_cvt_pk_bf16_f32 v53, v102, v103
  ds_write_b64 v209, v[52:53] offset:0
  v_accvgpr_read_b32 v96, a100
  v_accvgpr_read_b32 v97, a101
  buffer_load_dwordx4 v24, s[12:15], s31 offen offset:2048 sc1 lds
  v_accvgpr_read_b32 v98, a102
  v_accvgpr_read_b32 v99, a103
  v_pk_mul_f32 v[96:97], v[96:97], v[182:183]
  v_pk_mul_f32 v[98:99], v[98:99], v[182:183]
  v_cvt_pk_bf16_f32 v54, v96, v97
  v_cvt_pk_bf16_f32 v55, v98, v99
  ds_write_b64 v210, v[54:55] offset:0
  v_accvgpr_read_b32 v100, a116
  v_accvgpr_read_b32 v101, a117
  buffer_load_dwordx4 v25, s[12:15], s31 offen offset:3072 sc1 lds
  v_accvgpr_read_b32 v102, a118
  v_accvgpr_read_b32 v103, a119
  v_pk_mul_f32 v[100:101], v[100:101], v[182:183]
  v_pk_mul_f32 v[102:103], v[102:103], v[182:183]
  v_cvt_pk_bf16_f32 v56, v100, v101
  v_cvt_pk_bf16_f32 v57, v102, v103
  ds_write_b64 v211, v[56:57] offset:0
  s_waitcnt lgkmcnt(8)
  buffer_store_dwordx4 v[64:67], v216, s[64:67], s35 offen sc1
  s_add_u32 s35, s35, 33792
  buffer_store_dwordx4 v[68:71], v216, s[64:67], s35 offen sc1
  s_add_u32 s35, s35, 33792
  buffer_store_dwordx4 v[72:75], v216, s[64:67], s35 offen sc1
  s_add_u32 s35, s35, 33792
  buffer_store_dwordx4 v[76:79], v216, s[64:67], s35 offen sc1
  s_add_u32 s35, s35, 33792
  ds_read_b128 v[80:83], v212 offset:0
  ds_read_b128 v[84:87], v213 offset:1024
  ds_read_b128 v[88:91], v214 offset:2048
  ds_read_b128 v[92:95], v215 offset:3072
  v_accvgpr_read_b32 v96, a8
  v_accvgpr_read_b32 v97, a9
  v_accvgpr_read_b32 v98, a10
  v_accvgpr_read_b32 v99, a11
  v_pk_mul_f32 v[96:97], v[96:97], v[184:185]
  v_pk_mul_f32 v[98:99], v[98:99], v[184:185]
  v_cvt_pk_bf16_f32 v50, v96, v97
  v_cvt_pk_bf16_f32 v51, v98, v99
  ds_write_b64 v204, v[50:51] offset:0
  v_accvgpr_read_b32 v100, a24
  v_accvgpr_read_b32 v101, a25
  v_accvgpr_read_b32 v102, a26
  v_accvgpr_read_b32 v103, a27
  v_pk_mul_f32 v[100:101], v[100:101], v[184:185]
  v_pk_mul_f32 v[102:103], v[102:103], v[184:185]
  v_cvt_pk_bf16_f32 v52, v100, v101
  v_cvt_pk_bf16_f32 v53, v102, v103
  ds_write_b64 v205, v[52:53] offset:0
  v_accvgpr_read_b32 v96, a40
  v_accvgpr_read_b32 v97, a41
  v_accvgpr_read_b32 v98, a42
  v_accvgpr_read_b32 v99, a43
  v_pk_mul_f32 v[96:97], v[96:97], v[184:185]
  v_pk_mul_f32 v[98:99], v[98:99], v[184:185]
  v_cvt_pk_bf16_f32 v54, v96, v97
  v_cvt_pk_bf16_f32 v55, v98, v99
  ds_write_b64 v206, v[54:55] offset:0
  v_accvgpr_read_b32 v100, a56
  v_accvgpr_read_b32 v101, a57
  v_accvgpr_read_b32 v102, a58
  v_accvgpr_read_b32 v103, a59
  v_pk_mul_f32 v[100:101], v[100:101], v[184:185]
  v_pk_mul_f32 v[102:103], v[102:103], v[184:185]
  v_cvt_pk_bf16_f32 v56, v100, v101
  v_cvt_pk_bf16_f32 v57, v102, v103
  ds_write_b64 v207, v[56:57] offset:0
  v_accvgpr_read_b32 v96, a72
  v_accvgpr_read_b32 v97, a73
  v_accvgpr_read_b32 v98, a74
  v_accvgpr_read_b32 v99, a75
  v_pk_mul_f32 v[96:97], v[96:97], v[184:185]
  v_pk_mul_f32 v[98:99], v[98:99], v[184:185]
  v_cvt_pk_bf16_f32 v50, v96, v97
  v_cvt_pk_bf16_f32 v51, v98, v99
  ds_write_b64 v208, v[50:51] offset:0
  v_accvgpr_read_b32 v100, a88
  v_accvgpr_read_b32 v101, a89
  v_accvgpr_read_b32 v102, a90
  v_accvgpr_read_b32 v103, a91
  v_pk_mul_f32 v[100:101], v[100:101], v[184:185]
  v_pk_mul_f32 v[102:103], v[102:103], v[184:185]
  v_cvt_pk_bf16_f32 v52, v100, v101
  v_cvt_pk_bf16_f32 v53, v102, v103
  ds_write_b64 v209, v[52:53] offset:0
  v_accvgpr_read_b32 v96, a104
  v_accvgpr_read_b32 v97, a105
  v_accvgpr_read_b32 v98, a106
  v_accvgpr_read_b32 v99, a107
  v_pk_mul_f32 v[96:97], v[96:97], v[184:185]
  v_pk_mul_f32 v[98:99], v[98:99], v[184:185]
  v_cvt_pk_bf16_f32 v54, v96, v97
  v_cvt_pk_bf16_f32 v55, v98, v99
  ds_write_b64 v210, v[54:55] offset:0
  v_accvgpr_read_b32 v100, a120
  v_accvgpr_read_b32 v101, a121
  v_accvgpr_read_b32 v102, a122
  v_accvgpr_read_b32 v103, a123
  v_pk_mul_f32 v[100:101], v[100:101], v[184:185]
  v_pk_mul_f32 v[102:103], v[102:103], v[184:185]
  v_cvt_pk_bf16_f32 v56, v100, v101
  v_cvt_pk_bf16_f32 v57, v102, v103
  ds_write_b64 v211, v[56:57] offset:0
  s_waitcnt lgkmcnt(8)
  buffer_store_dwordx4 v[80:83], v216, s[64:67], s35 offen sc1
  s_add_u32 s35, s35, 33792
  buffer_store_dwordx4 v[84:87], v216, s[64:67], s35 offen sc1
  s_add_u32 s35, s35, 33792
  buffer_store_dwordx4 v[88:91], v216, s[64:67], s35 offen sc1
  s_add_u32 s35, s35, 33792
  buffer_store_dwordx4 v[92:95], v216, s[64:67], s35 offen sc1
  s_add_u32 s35, s35, 33792
  ds_read_b128 v[64:67], v212 offset:0
  ds_read_b128 v[68:71], v213 offset:1024
  ds_read_b128 v[72:75], v214 offset:2048
  ds_read_b128 v[76:79], v215 offset:3072
  v_accvgpr_read_b32 v96, a12
  v_accvgpr_read_b32 v97, a13
  v_accvgpr_read_b32 v98, a14
  v_accvgpr_read_b32 v99, a15
  v_pk_mul_f32 v[96:97], v[96:97], v[186:187]
  v_pk_mul_f32 v[98:99], v[98:99], v[186:187]
  v_cvt_pk_bf16_f32 v50, v96, v97
  v_cvt_pk_bf16_f32 v51, v98, v99
  ds_write_b64 v204, v[50:51] offset:0
  v_accvgpr_read_b32 v100, a28
  v_accvgpr_read_b32 v101, a29
  v_accvgpr_read_b32 v102, a30
  v_accvgpr_read_b32 v103, a31
  v_pk_mul_f32 v[100:101], v[100:101], v[186:187]
  v_pk_mul_f32 v[102:103], v[102:103], v[186:187]
  v_cvt_pk_bf16_f32 v52, v100, v101
  v_cvt_pk_bf16_f32 v53, v102, v103
  ds_write_b64 v205, v[52:53] offset:0
  v_accvgpr_read_b32 v96, a44
  v_accvgpr_read_b32 v97, a45
  v_accvgpr_read_b32 v98, a46
  v_accvgpr_read_b32 v99, a47
  v_pk_mul_f32 v[96:97], v[96:97], v[186:187]
  v_pk_mul_f32 v[98:99], v[98:99], v[186:187]
  v_cvt_pk_bf16_f32 v54, v96, v97
  v_cvt_pk_bf16_f32 v55, v98, v99
  ds_write_b64 v206, v[54:55] offset:0
  v_accvgpr_read_b32 v100, a60
  v_accvgpr_read_b32 v101, a61
  v_accvgpr_read_b32 v102, a62
  v_accvgpr_read_b32 v103, a63
  v_pk_mul_f32 v[100:101], v[100:101], v[186:187]
  v_pk_mul_f32 v[102:103], v[102:103], v[186:187]
  v_cvt_pk_bf16_f32 v56, v100, v101
  v_cvt_pk_bf16_f32 v57, v102, v103
  ds_write_b64 v207, v[56:57] offset:0
  v_accvgpr_read_b32 v96, a76
  v_accvgpr_read_b32 v97, a77
  v_accvgpr_read_b32 v98, a78
  v_accvgpr_read_b32 v99, a79
  v_pk_mul_f32 v[96:97], v[96:97], v[186:187]
  v_pk_mul_f32 v[98:99], v[98:99], v[186:187]
  v_cvt_pk_bf16_f32 v50, v96, v97
  v_cvt_pk_bf16_f32 v51, v98, v99
  ds_write_b64 v208, v[50:51] offset:0
  v_accvgpr_read_b32 v100, a92
  v_accvgpr_read_b32 v101, a93
  v_accvgpr_read_b32 v102, a94
  v_accvgpr_read_b32 v103, a95
  v_pk_mul_f32 v[100:101], v[100:101], v[186:187]
  v_pk_mul_f32 v[102:103], v[102:103], v[186:187]
  v_cvt_pk_bf16_f32 v52, v100, v101
  v_cvt_pk_bf16_f32 v53, v102, v103
  ds_write_b64 v209, v[52:53] offset:0
  v_accvgpr_read_b32 v96, a108
  v_accvgpr_read_b32 v97, a109
  v_accvgpr_read_b32 v98, a110
  v_accvgpr_read_b32 v99, a111
  v_pk_mul_f32 v[96:97], v[96:97], v[186:187]
  v_pk_mul_f32 v[98:99], v[98:99], v[186:187]
  v_cvt_pk_bf16_f32 v54, v96, v97
  v_cvt_pk_bf16_f32 v55, v98, v99
  ds_write_b64 v210, v[54:55] offset:0
  v_accvgpr_read_b32 v100, a124
  v_accvgpr_read_b32 v101, a125
  v_accvgpr_read_b32 v102, a126
  v_accvgpr_read_b32 v103, a127
  v_pk_mul_f32 v[100:101], v[100:101], v[186:187]
  v_pk_mul_f32 v[102:103], v[102:103], v[186:187]
  v_cvt_pk_bf16_f32 v56, v100, v101
  v_cvt_pk_bf16_f32 v57, v102, v103
  ds_write_b64 v211, v[56:57] offset:0
  s_waitcnt lgkmcnt(8)
  buffer_store_dwordx4 v[64:67], v216, s[64:67], s35 offen sc1
  s_add_u32 s35, s35, 33792
  buffer_store_dwordx4 v[68:71], v216, s[64:67], s35 offen sc1
  s_add_u32 s35, s35, 33792
  buffer_store_dwordx4 v[72:75], v216, s[64:67], s35 offen sc1
  s_add_u32 s35, s35, 33792
  buffer_store_dwordx4 v[76:79], v216, s[64:67], s35 offen sc1
  s_add_u32 s35, s35, 33792
  ds_read_b128 v[80:83], v212 offset:0
  ds_read_b128 v[84:87], v213 offset:1024
  ds_read_b128 v[88:91], v214 offset:2048
  ds_read_b128 v[92:95], v215 offset:3072
  s_waitcnt lgkmcnt(0)
  buffer_store_dwordx4 v[80:83], v216, s[64:67], s35 offen sc1
  s_add_u32 s35, s35, 33792
  buffer_store_dwordx4 v[84:87], v216, s[64:67], s35 offen sc1
  s_add_u32 s35, s35, 33792
  buffer_store_dwordx4 v[88:91], v216, s[64:67], s35 offen sc1
  s_add_u32 s35, s35, 33792
  buffer_store_dwordx4 v[92:95], v216, s[64:67], s35 offen sc1
  s_add_u32 s35, s35, 33792
  s_xor_b32 s42, s68, 1
  s_lshl_b32 s42, s42, 1
  s_or_b32 s63, s63, s42
  v_mov_b32 v100, s48
  v_mov_b32 v101, s63
  ds_write_b32 v100, v101
  v_mov_b32 v100, 147456
  s_waitcnt lgkmcnt(0)
  s_barrier
  ds_read_b32 v104, v100 offset:0
  ds_read_b32 v105, v100 offset:4096
  ds_read_b32 v106, v100 offset:8192
  ds_read_b32 v107, v100 offset:12288
  s_waitcnt lgkmcnt(0)
  v_or3_b32 v104, v104, v105, v106
  v_or_b32 v104, v104, v107
  s_nop 1
  v_readfirstlane_b32 s42, v104
  s_nop 3
  s_bitcmp1_b32 s42, 1
  s_cselect_b32 s68, 0, s68
  s_cmp_eq_u32 s90, 1
  s_cbranch_scc1 att_checked
  s_bitcmp1_b32 s42, 0
  s_cbranch_scc1 att_fb
att_checked:
  s_lshr_b32 s42, s24, 4
  s_lshl_b32 s43, s25, 1
  s_add_u32 s42, s42, s43
  s_lshl_b32 s42, s42, 11
  s_add_u32 s91, s42, 36864
  s_mov_b32 s69, 0
  s_and_b32 s42, s24, 1
  s_lshl_b32 s42, s42, 7
  s_add_u32 s91, s91, s42
mid_entry:
  s_cmp_ge_u32 s2, 240
  s_cbranch_scc1 mid_idle
  s_load_dwordx2 s[50:51], s[0:1], 64
  s_mov_b32 s4, s46
  s_mov_b32 s5, s47
  s_and_b32 s36, s2, 7
  s_lshr_b32 s37, s2, 3
  s_and_b32 s38, s36, 6
  s_and_b32 s39, s36, 1
  s_cmp_lt_u32 s37, 14
  s_cbranch_scc0 mid_wo
  s_and_b32 s24, s37, 1
  s_add_u32 s24, s24, s38
  s_lshr_b32 s25, s37, 1
  s_mul_i32 s39, s39, 7
  s_add_u32 s25, s25, s39
  s_mov_b32 s8, s4
  s_mov_b32 s9, s5
  s_mov_b32 s10, 8388608
  s_mov_b32 s11, 0x20000
  s_add_u32 s12, s6, 25165824
  s_addc_u32 s13, s7, 0
  s_mov_b32 s14, 7340032
  s_mov_b32 s15, 0x20000
  s_add_u32 s16, s6, 58720256
  s_addc_u32 s17, s7, 0
  s_mov_b32 s18, 7340032
  s_mov_b32 s19, 0x20000
  s_add_u32 s52, s6, 8388608
  s_addc_u32 s53, s7, 0
  s_mov_b32 s54, 7340032
  s_mov_b32 s55, 0x20000
  s_mov_b32 s32, 4096
  s_mov_b32 s33, 3584
  s_mov_b32 s35, 3584
  s_lshl_b32 s26, s24, 20
  s_lshl_b32 s27, s25, 8
  s_mul_i32 s30, s24, 917504
  s_add_u32 s30, s30, s27
  s_mov_b32 s36, 0
  s_mov_b32 s62, 0xff
  s_mov_b32 s92, 0
  s_mov_b32 s93, 0
  s_branch mid_go
mid_wo:
  s_sub_u32 s37, s37, 14
  s_and_b32 s24, s37, 1
  s_add_u32 s24, s24, s38
  s_lshr_b32 s25, s37, 1
  s_add_u32 s8, s6, 33554432
  s_addc_u32 s9, s7, 0
  s_mov_b32 s10, 17301504
  s_mov_b32 s11, 0x20000
  s_mov_b32 s12, s96
  s_mov_b32 s13, s97
  s_mov_b32 s14, 8388608
  s_mov_b32 s15, 0x20000
  s_lshl_b32 s43, s39, 22
  s_add_u32 s16, s6, s43
  s_addc_u32 s17, s7, 0
  s_add_u32 s16, s16, 67108864
  s_addc_u32 s17, s17, 0
  s_mov_b32 s18, 4194304
  s_mov_b32 s19, 0x20000
  s_mov_b32 s52, s6
  s_mov_b32 s53, s7
  s_mov_b32 s54, 0
  s_mov_b32 s55, 0x20000
  s_mov_b32 s32, 8448
  s_mov_b32 s33, 2048
  s_mov_b32 s35, 2048
  s_mul_i32 s26, s24, 2162688
  s_lshl_b32 s42, s39, 12
  s_add_u32 s26, s26, s42
  s_lshl_b32 s27, s25, 8
  s_add_u32 s27, s27, s43
  s_lshl_b32 s30, s24, 19
  s_lshl_b32 s42, s25, 8
  s_add_u32 s30, s30, s42
  s_lshl_b32 s61, s24, 1
  s_add_u32 s61, s61, s39
  s_lshl_b32 s61, s61, 3
  s_add_u32 s61, s61, s25
  s_lshl_b32 s61, s61, 8
  s_add_u32 s61, s61, 36864
  s_mov_b32 s36, 1
  s_lshl_b32 s62, 1, s25
  s_mov_b32 s92, 0x40000
  s_mov_b32 s93, 4291035136
mid_go:
  s_lshl_b32 s34, s33, 6
  s_cmp_eq_u32 s68, 1
  s_cbranch_scc1 mid_fast
  s_waitcnt vmcnt(16)
  s_mul_i32 s28, s3, 8192
  s_mul_i32 s29, s3, 4096
  s_add_u32 s29, s29, 98304
  v_and_b32 v103, 63, v0
  v_lshrrev_b32 v100, 3, v103
  s_mul_i32 s40, s3, 64
  v_add_u32 v100, s40, v100
  v_lshrrev_b32 v102, 1, v100
  v_xor_b32 v102, v102, v103
  v_and_b32 v102, 7, v102
  v_lshlrev_b32 v102, 4, v102
  v_mul_lo_u32 v101, v100, s32
  s_lshl_b32 s42, s32, 3
  v_add_u32 v14, v101, v102
  v_add_u32 v101, s42, v101
  v_xor_b32 v15, 64, v102
  v_add_u32 v15, v15, v101
  v_subrev_u32 v15, 1024, v15
  v_add_u32 v101, s42, v101
  v_add_u32 v16, v101, v102
  v_subrev_u32 v16, 2048, v16
  v_add_u32 v101, s42, v101
  v_xor_b32 v17, 64, v102
  v_add_u32 v17, v17, v101
  v_subrev_u32 v17, 3072, v17
  v_add_u32 v101, s42, v101
  v_add_u32 v18, v101, v102
  v_add_u32 v101, s42, v101
  v_xor_b32 v19, 64, v102
  v_add_u32 v19, v19, v101
  v_subrev_u32 v19, 1024, v19
  v_add_u32 v101, s42, v101
  v_add_u32 v20, v101, v102
  v_subrev_u32 v20, 2048, v20
  v_add_u32 v101, s42, v101
  v_xor_b32 v21, 64, v102
  v_add_u32 v21, v21, v101
  v_subrev_u32 v21, 3072, v21
  v_and_b32 v105, 63, v0
  v_lshrrev_b32 v100, 4, v105
  s_lshl_b32 s40, s3, 4
  v_add_u32 v100, s40, v100
  v_and_b32 v103, 15, v105
  v_add_u32 v101, 0, v100
  v_and_b32 v102, 3, v101
  v_lshrrev_b32 v104, 1, v101
  v_and_b32 v104, 4, v104
  v_or_b32 v102, v102, v104
  v_lshlrev_b32 v102, 1, v102
  v_xor_b32 v102, v102, v103
  v_lshlrev_b32 v102, 4, v102
  v_mul_lo_u32 v101, v101, s33
  v_add_u32 v101, v101, v102
  v_mov_b32 v22, v101
  v_add_u32 v101, 4, v100
  v_and_b32 v102, 3, v101
  v_lshrrev_b32 v104, 1, v101
  v_and_b32 v104, 4, v104
  v_or_b32 v102, v102, v104
  v_lshlrev_b32 v102, 1, v102
  v_xor_b32 v102, v102, v103
  v_lshlrev_b32 v102, 4, v102
  v_mul_lo_u32 v101, v101, s33
  v_add_u32 v101, v101, v102
  v_subrev_u32 v23, 1024, v101
  v_add_u32 v101, 8, v100
  v_and_b32 v102, 3, v101
  v_lshrrev_b32 v104, 1, v101
  v_and_b32 v104, 4, v104
  v_or_b32 v102, v102, v104
  v_lshlrev_b32 v102, 1, v102
  v_xor_b32 v102, v102, v103
  v_lshlrev_b32 v102, 4, v102
  v_mul_lo_u32 v101, v101, s33
  v_add_u32 v101, v101, v102
  v_subrev_u32 v24, 2048, v101
  v_add_u32 v101, 12, v100
  v_and_b32 v102, 3, v101
  v_lshrrev_b32 v104, 1, v101
  v_and_b32 v104, 4, v104
  v_or_b32 v102, v102, v104
  v_lshlrev_b32 v102, 1, v102
  v_xor_b32 v102, v102, v103
  v_lshlrev_b32 v102, 4, v102
  v_mul_lo_u32 v101, v101, s33
  v_add_u32 v101, v101, v102
  v_subrev_u32 v25, 3072, v101
  s_cmp_eq_u32 s36, 1
  s_cbranch_scc1 mid_pro_wo
  s_branch mid_pro_slow
mid_fast:
  s_add_u32 s26, s26, 256
  s_lshl_b32 s42, s34, 1
  s_add_u32 s27, s27, s42
  v_and_b32 v105, 63, v0
  s_and_b32 s40, s3, 3
  s_lshr_b32 s41, s3, 2
  v_and_b32 v100, 15, v105
  v_lshrrev_b32 v101, 4, v105
  v_lshrrev_b32 v102, 1, v100
  v_xor_b32 v102, v102, v101
  v_lshlrev_b32 v102, 4, v102
  s_mul_i32 s42, s40, 8192
  v_lshlrev_b32 v103, 7, v100
  v_add3_u32 v102, v102, v103, s42
  v_add_u32 v2, 0, v102
  v_xor_b32 v3, 64, v2
  v_add_u32 v4, 65536, v102
  v_xor_b32 v5, 64, v4
  v_lshrrev_b32 v102, 2, v100
  v_lshl_add_u32 v103, v101, 3, v102
  v_mul_u32_u24 v103, 256, v103
  v_and_b32 v104, 3, v100
  v_lshl_add_u32 v103, v104, 3, v103
  v_and_b32 v104, 1, v101
  v_lshl_or_b32 v102, v104, 2, v102
  s_mul_i32 s42, s41, 8
  s_add_u32 s43, s42, 0
  v_xor_b32 v104, s43, v102
  v_lshl_add_u32 v104, v104, 5, v103
  v_add_u32 v6, 98304, v104
  s_add_u32 s43, s42, 1
  v_xor_b32 v104, s43, v102
  v_lshl_add_u32 v104, v104, 5, v103
  v_add_u32 v7, 98304, v104
  s_add_u32 s43, s42, 2
  v_xor_b32 v104, s43, v102
  v_lshl_add_u32 v104, v104, 5, v103
  v_add_u32 v8, 98304, v104
  s_add_u32 s43, s42, 3
  v_xor_b32 v104, s43, v102
  v_lshl_add_u32 v104, v104, 5, v103
  v_add_u32 v9, 98304, v104
  s_add_u32 s43, s42, 4
  v_xor_b32 v104, s43, v102
  v_lshl_add_u32 v104, v104, 5, v103
  v_add_u32 v10, 98304, v104
  s_add_u32 s43, s42, 5
  v_xor_b32 v104, s43, v102
  v_lshl_add_u32 v104, v104, 5, v103
  v_add_u32 v11, 98304, v104
  s_add_u32 s43, s42, 6
  v_xor_b32 v104, s43, v102
  v_lshl_add_u32 v104, v104, 5, v103
  v_add_u32 v12, 98304, v104
  s_add_u32 s43, s42, 7
  v_xor_b32 v104, s43, v102
  v_lshl_add_u32 v104, v104, 5, v103
  v_add_u32 v13, 98304, v104
  s_lshl_b32 s48, s3, 13
  s_add_u32 s48, s48, 32768
  v_and_b32 v103, 63, v0
  v_and_b32 v100, 15, v103
  v_lshrrev_b32 v101, 4, v103
  v_lshrrev_b32 v102, 1, v101
  v_xor_b32 v102, v102, v100
  v_lshlrev_b32 v102, 4, v102
  v_and_b32 v101, 1, v101
  v_lshl_add_u32 v102, v101, 3, v102
  v_lshl_add_u32 v102, v100, 8, v102
  v_add_u32 v30, s48, v102
  v_xor_b32 v31, 32, v30
  v_xor_b32 v32, 64, v30
  v_xor_b32 v33, 96, v30
  v_xor_b32 v34, 128, v30
  v_xor_b32 v35, 160, v30
  v_xor_b32 v36, 192, v30
  v_xor_b32 v37, 224, v30
  v_lshrrev_b32 v100, 4, v103
  v_and_b32 v101, 15, v103
  v_xor_b32 v102, v101, v100
  v_lshlrev_b32 v102, 4, v102
  v_lshl_add_u32 v102, v100, 8, v102
  v_add_u32 v38, s48, v102
  v_xor_b32 v39, 64, v38
  v_xor_b32 v40, 128, v38
  v_xor_b32 v41, 192, v38
  v_and_b32 v100, 63, v0
  v_lshrrev_b32 v101, 4, v100
  v_and_b32 v100, 15, v100
  v_mul_lo_u32 v42, v101, s35
  v_lshl_add_u32 v42, v100, 4, v42
  v_and_b32 v100, 15, v0
  v_lshlrev_b32 v43, 1, v100
  v_bfe_u32 v101, v0, 4, 2
  v_add_u32 v102, 0, v101
  v_xor_b32 v103, v102, v100
  v_lshlrev_b32 v103, 4, v103
  v_mul_lo_u32 v102, v102, s35
  v_add_u32 v102, v102, v103
  v_subrev_u32 v26, 0, v102
  v_add_u32 v102, 4, v101
  v_xor_b32 v103, v102, v100
  v_lshlrev_b32 v103, 4, v103
  v_mul_lo_u32 v102, v102, s35
  v_add_u32 v102, v102, v103
  v_subrev_u32 v27, 1024, v102
  v_add_u32 v102, 8, v101
  v_xor_b32 v103, v102, v100
  v_lshlrev_b32 v103, 4, v103
  v_mul_lo_u32 v102, v102, s35
  v_add_u32 v102, v102, v103
  v_subrev_u32 v28, 2048, v102
  v_add_u32 v102, 12, v101
  v_xor_b32 v103, v102, v100
  v_lshlrev_b32 v103, 4, v103
  v_mul_lo_u32 v102, v102, s35
  v_add_u32 v102, v102, v103
  v_subrev_u32 v29, 3072, v102
  s_lshl_b32 s42, s35, 6
  s_mul_i32 s42, s42, s3
  s_add_u32 s30, s30, s42
  s_lshl_b32 s37, s35, 4
  s_mov_b32 s44, s30
  s_add_u32 s45, s44, s37
  s_add_u32 s46, s45, s37
  s_add_u32 s47, s46, s37
  s_lshl_b32 s37, s35, 2
  s_lshl_b32 s43, s24, 8
  s_lshl_b32 s42, s3, 6
  s_add_u32 s43, s43, s42
  s_lshl_b32 s49, s43, 1
  s_lshl_b32 s60, s24, 2
  s_add_u32 s60, s60, s3
  s_lshl_b32 s60, s60, 11
  s_add_u32 s60, s60, 69632
  s_lshl_b32 s42, s36, 7
  s_add_u32 s60, s60, s42
  s_cmp_ge_u32 s25, 7
  s_cselect_b32 s42, 64, 0
  s_cmp_eq_u32 s36, 1
  s_cselect_b32 s42, 0, s42
  s_add_u32 s60, s60, s42
  s_cmp_eq_u32 s36, 1
  s_cselect_b32 s63, s61, 0
  s_cselect_b32 s89, 8, 0
  s_add_u32 s63, s63, 128
  v_mov_b32 v126, s63
  s_waitcnt lgkmcnt(0)
  s_mov_b32 s56, s50
  s_mov_b32 s57, s51
  s_cmp_eq_u32 s36, 0
  s_cselect_b32 s58, 4096, 0
  s_mov_b32 s59, 0x20000
  s_waitcnt vmcnt(28)
  s_branch mid_pro_done
mid_pro_slow:
  s_add_u32 m0, s28, 65536
  s_nop 0
  buffer_load_dwordx4 v14, s[8:11], s26 offen offset:0 sc1 lds
  buffer_load_dwordx4 v15, s[8:11], s26 offen offset:1024 sc1 lds
  buffer_load_dwordx4 v16, s[8:11], s26 offen offset:2048 sc1 lds
  buffer_load_dwordx4 v17, s[8:11], s26 offen offset:3072 sc1 lds
  s_add_u32 m0, s28, 69632
  s_nop 0
  buffer_load_dwordx4 v18, s[8:11], s26 offen offset:0 sc1 lds
  buffer_load_dwordx4 v19, s[8:11], s26 offen offset:1024 sc1 lds
  buffer_load_dwordx4 v20, s[8:11], s26 offen offset:2048 sc1 lds
  buffer_load_dwordx4 v21, s[8:11], s26 offen offset:3072 sc1 lds
  s_add_u32 s26, s26, 128
  s_add_u32 m0, s28, 0
  s_nop 0
  buffer_load_dwordx4 v14, s[8:11], s26 offen offset:0 sc1 lds
  buffer_load_dwordx4 v15, s[8:11], s26 offen offset:1024 sc1 lds
  buffer_load_dwordx4 v16, s[8:11], s26 offen offset:2048 sc1 lds
  buffer_load_dwordx4 v17, s[8:11], s26 offen offset:3072 sc1 lds
  s_add_u32 m0, s28, 4096
  s_nop 0
  buffer_load_dwordx4 v18, s[8:11], s26 offen offset:0 sc1 lds
  buffer_load_dwordx4 v19, s[8:11], s26 offen offset:1024 sc1 lds
  buffer_load_dwordx4 v20, s[8:11], s26 offen offset:2048 sc1 lds
  buffer_load_dwordx4 v21, s[8:11], s26 offen offset:3072 sc1 lds
  s_add_u32 s26, s26, 128
  s_waitcnt vmcnt(16)
  s_barrier
  s_cmp_eq_u32 s69, 0
  s_cbranch_scc0 mid_pubb
  s_cmp_eq_u32 s3, 0
  s_cbranch_scc0 mid_pubb
  v_and_b32 v104, 7, v0
  v_lshlrev_b32 v104, 8, v104
  v_add_u32 v104, s91, v104
  v_mov_b32 v105, 1
  s_mov_b64 exec, 0xff
  global_atomic_add v104, v105, s[70:71] sc1
  s_mov_b64 exec, -1
mid_pubb:
  s_mov_b32 s69, 1
  v_and_b32 v105, 63, v0
  s_and_b32 s40, s3, 3
  s_lshr_b32 s41, s3, 2
  v_and_b32 v100, 15, v105
  v_lshrrev_b32 v101, 4, v105
  v_lshrrev_b32 v102, 1, v100
  v_xor_b32 v102, v102, v101
  v_lshlrev_b32 v102, 4, v102
  s_mul_i32 s42, s40, 8192
  v_lshlrev_b32 v103, 7, v100
  v_add3_u32 v102, v102, v103, s42
  v_add_u32 v2, 0, v102
  v_xor_b32 v3, 64, v2
  v_add_u32 v4, 65536, v102
  v_xor_b32 v5, 64, v4
  v_lshrrev_b32 v102, 2, v100
  v_lshl_add_u32 v103, v101, 3, v102
  v_mul_u32_u24 v103, 256, v103
  v_and_b32 v104, 3, v100
  v_lshl_add_u32 v103, v104, 3, v103
  v_and_b32 v104, 1, v101
  v_lshl_or_b32 v102, v104, 2, v102
  s_mul_i32 s42, s41, 8
  s_add_u32 s43, s42, 0
  v_xor_b32 v104, s43, v102
  v_lshl_add_u32 v104, v104, 5, v103
  v_add_u32 v6, 98304, v104
  s_add_u32 s43, s42, 1
  v_xor_b32 v104, s43, v102
  v_lshl_add_u32 v104, v104, 5, v103
  v_add_u32 v7, 98304, v104
  s_add_u32 s43, s42, 2
  v_xor_b32 v104, s43, v102
  v_lshl_add_u32 v104, v104, 5, v103
  v_add_u32 v8, 98304, v104
  s_add_u32 s43, s42, 3
  v_xor_b32 v104, s43, v102
  v_lshl_add_u32 v104, v104, 5, v103
  v_add_u32 v9, 98304, v104
  s_add_u32 s43, s42, 4
  v_xor_b32 v104, s43, v102
  v_lshl_add_u32 v104, v104, 5, v103
  v_add_u32 v10, 98304, v104
  s_add_u32 s43, s42, 5
  v_xor_b32 v104, s43, v102
  v_lshl_add_u32 v104, v104, 5, v103
  v_add_u32 v11, 98304, v104
  s_add_u32 s43, s42, 6
  v_xor_b32 v104, s43, v102
  v_lshl_add_u32 v104, v104, 5, v103
  v_add_u32 v12, 98304, v104
  s_add_u32 s43, s42, 7
  v_xor_b32 v104, s43, v102
  v_lshl_add_u32 v104, v104, 5, v103
  v_add_u32 v13, 98304, v104
  s_lshl_b32 s48, s3, 13
  s_add_u32 s48, s48, 32768
  v_and_b32 v103, 63, v0
  v_and_b32 v100, 15, v103
  v_lshrrev_b32 v101, 4, v103
  v_lshrrev_b32 v102, 1, v101
  v_xor_b32 v102, v102, v100
  v_lshlrev_b32 v102, 4, v102
  v_and_b32 v101, 1, v101
  v_lshl_add_u32 v102, v101, 3, v102
  v_lshl_add_u32 v102, v100, 8, v102
  v_add_u32 v30, s48, v102
  v_xor_b32 v31, 32, v30
  v_xor_b32 v32, 64, v30
  v_xor_b32 v33, 96, v30
  v_xor_b32 v34, 128, v30
  v_xor_b32 v35, 160, v30
  v_xor_b32 v36, 192, v30
  v_xor_b32 v37, 224, v30
  v_lshrrev_b32 v100, 4, v103
  v_and_b32 v101, 15, v103
  v_xor_b32 v102, v101, v100
  v_lshlrev_b32 v102, 4, v102
  v_lshl_add_u32 v102, v100, 8, v102
  v_add_u32 v38, s48, v102
  v_xor_b32 v39, 64, v38
  v_xor_b32 v40, 128, v38
  v_xor_b32 v41, 192, v38
  v_and_b32 v100, 63, v0
  v_lshrrev_b32 v101, 4, v100
  v_and_b32 v100, 15, v100
  v_mul_lo_u32 v42, v101, s35
  v_lshl_add_u32 v42, v100, 4, v42
  v_and_b32 v100, 15, v0
  v_lshlrev_b32 v43, 1, v100
  v_bfe_u32 v101, v0, 4, 2
  v_add_u32 v102, 0, v101
  v_xor_b32 v103, v102, v100
  v_lshlrev_b32 v103, 4, v103
  v_mul_lo_u32 v102, v102, s35
  v_add_u32 v102, v102, v103
  v_subrev_u32 v26, 0, v102
  v_add_u32 v102, 4, v101
  v_xor_b32 v103, v102, v100
  v_lshlrev_b32 v103, 4, v103
  v_mul_lo_u32 v102, v102, s35
  v_add_u32 v102, v102, v103
  v_subrev_u32 v27, 1024, v102
  v_add_u32 v102, 8, v101
  v_xor_b32 v103, v102, v100
  v_lshlrev_b32 v103, 4, v103
  v_mul_lo_u32 v102, v102, s35
  v_add_u32 v102, v102, v103
  v_subrev_u32 v28, 2048, v102
  v_add_u32 v102, 12, v101
  v_xor_b32 v103, v102, v100
  v_lshlrev_b32 v103, 4, v103
  v_mul_lo_u32 v102, v102, s35
  v_add_u32 v102, v102, v103
  v_subrev_u32 v29, 3072, v102
  s_lshl_b32 s42, s35, 6
  s_mul_i32 s42, s42, s3
  s_add_u32 s30, s30, s42
  s_lshl_b32 s37, s35, 4
  s_mov_b32 s44, s30
  s_add_u32 s45, s44, s37
  s_add_u32 s46, s45, s37
  s_add_u32 s47, s46, s37
  s_lshl_b32 s37, s35, 2
  s_lshl_b32 s43, s24, 8
  s_lshl_b32 s42, s3, 6
  s_add_u32 s43, s43, s42
  s_lshl_b32 s49, s43, 1
  s_lshl_b32 s60, s24, 2
  s_add_u32 s60, s60, s3
  s_lshl_b32 s60, s60, 11
  s_add_u32 s60, s60, 69632
  s_lshl_b32 s42, s36, 7
  s_add_u32 s60, s60, s42
  s_cmp_ge_u32 s25, 7
  s_cselect_b32 s42, 64, 0
  s_cmp_eq_u32 s36, 1
  s_cselect_b32 s42, 0, s42
  s_add_u32 s60, s60, s42
  s_cmp_eq_u32 s36, 1
  s_cselect_b32 s63, s61, 0
  s_cselect_b32 s89, 8, 0
  s_add_u32 s63, s63, 128
  v_mov_b32 v126, s63
  s_waitcnt lgkmcnt(0)
  s_mov_b32 s56, s50
  s_mov_b32 s57, s51
  s_cmp_eq_u32 s36, 0
  s_cselect_b32 s58, 4096, 0
  s_mov_b32 s59, 0x20000
  s_and_b32 s42, s2, 7
  s_lshl_b32 s42, s42, 8
  s_add_u32 s42, s42, 34816
  v_mov_b32 v104, s42
  s_mov_b64 exec, 1
  s_mov_b32 s42, 0x20000
mid_pollzn:
  global_load_dword v105, v104, s[70:71] sc1
  s_waitcnt vmcnt(0)
  v_readfirstlane_b32 s43, v105
  s_sub_u32 s42, s42, 1
  s_cbranch_scc1 mid_pollzn_ok
  s_nop 1
  s_cmp_ge_u32 s43, 32
  s_cbranch_scc1 mid_pollzn_ok
  s_sleep 2
  s_branch mid_pollzn
mid_pollzn_ok:
  s_mov_b64 exec, -1
  s_lshl_b32 s42, s24, 4
  s_add_u32 s42, s42, s25
  s_lshl_b32 s42, s42, 8
  s_add_u32 s42, s42, 2048
  v_mov_b32 v104, s42
  s_mov_b64 exec, 1
  s_mov_b32 s42, 0x20000
mid_pollz1:
  global_load_dword v105, v104, s[70:71] sc1
  s_waitcnt vmcnt(0)
  v_readfirstlane_b32 s43, v105
  s_sub_u32 s42, s42, 1
  s_cbranch_scc1 mid_pollz1_ok
  s_nop 1
  s_cmp_ge_u32 s43, 1
  s_cbranch_scc1 mid_pollz1_ok
  s_sleep 2
  s_branch mid_pollz1
mid_pollz1_ok:
  s_mov_b64 exec, -1
  s_add_u32 m0, s29, 32768
  s_nop 0
  buffer_load_dwordx4 v22, s[12:15], s27 offen offset:0 sc1 lds
  buffer_load_dwordx4 v23, s[12:15], s27 offen offset:1024 sc1 lds
  buffer_load_dwordx4 v24, s[12:15], s27 offen offset:2048 sc1 lds
  buffer_load_dwordx4 v25, s[12:15], s27 offen offset:3072 sc1 lds
  s_add_u32 s27, s27, s34
  s_xor_b32 s34, s34, s92
  s_add_u32 m0, s29, 0
  s_nop 0
  buffer_load_dwordx4 v22, s[12:15], s27 offen offset:0 sc1 lds
  buffer_load_dwordx4 v23, s[12:15], s27 offen offset:1024 sc1 lds
  buffer_load_dwordx4 v24, s[12:15], s27 offen offset:2048 sc1 lds
  buffer_load_dwordx4 v25, s[12:15], s27 offen offset:3072 sc1 lds
  s_add_u32 s27, s27, s34
  s_xor_b32 s34, s34, s92
  s_waitcnt vmcnt(4)
  s_branch mid_pro_done
mid_pro_wo:
  s_add_u32 m0, s29, 32768
  s_nop 0
  buffer_load_dwordx4 v22, s[12:15], s27 offen offset:0 sc1 lds
  buffer_load_dwordx4 v23, s[12:15], s27 offen offset:1024 sc1 lds
  buffer_load_dwordx4 v24, s[12:15], s27 offen offset:2048 sc1 lds
  buffer_load_dwordx4 v25, s[12:15], s27 offen offset:3072 sc1 lds
  s_add_u32 s27, s27, s34
  s_xor_b32 s34, s34, s92
  s_add_u32 m0, s29, 0
  s_nop 0
  buffer_load_dwordx4 v22, s[12:15], s27 offen offset:0 sc1 lds
  buffer_load_dwordx4 v23, s[12:15], s27 offen offset:1024 sc1 lds
  buffer_load_dwordx4 v24, s[12:15], s27 offen offset:2048 sc1 lds
  buffer_load_dwordx4 v25, s[12:15], s27 offen offset:3072 sc1 lds
  s_add_u32 s27, s27, s34
  s_xor_b32 s34, s34, s92
  s_waitcnt vmcnt(8)
  s_barrier
  s_cmp_eq_u32 s69, 0
  s_cbranch_scc0 mid_pubc
  s_cmp_eq_u32 s3, 0
  s_cbranch_scc0 mid_pubc
  v_and_b32 v104, 7, v0
  v_lshlrev_b32 v104, 8, v104
  v_add_u32 v104, s91, v104
  v_mov_b32 v105, 1
  s_mov_b64 exec, 0xff
  global_atomic_add v104, v105, s[70:71] sc1
  s_mov_b64 exec, -1
mid_pubc:
  s_mov_b32 s69, 1
  v_and_b32 v105, 63, v0
  s_and_b32 s40, s3, 3
  s_lshr_b32 s41, s3, 2
  v_and_b32 v100, 15, v105
  v_lshrrev_b32 v101, 4, v105
  v_lshrrev_b32 v102, 1, v100
  v_xor_b32 v102, v102, v101
  v_lshlrev_b32 v102, 4, v102
  s_mul_i32 s42, s40, 8192
  v_lshlrev_b32 v103, 7, v100
  v_add3_u32 v102, v102, v103, s42
  v_add_u32 v2, 0, v102
  v_xor_b32 v3, 64, v2
  v_add_u32 v4, 65536, v102
  v_xor_b32 v5, 64, v4
  v_lshrrev_b32 v102, 2, v100
  v_lshl_add_u32 v103, v101, 3, v102
  v_mul_u32_u24 v103, 256, v103
  v_and_b32 v104, 3, v100
  v_lshl_add_u32 v103, v104, 3, v103
  v_and_b32 v104, 1, v101
  v_lshl_or_b32 v102, v104, 2, v102
  s_mul_i32 s42, s41, 8
  s_add_u32 s43, s42, 0
  v_xor_b32 v104, s43, v102
  v_lshl_add_u32 v104, v104, 5, v103
  v_add_u32 v6, 98304, v104
  s_add_u32 s43, s42, 1
  v_xor_b32 v104, s43, v102
  v_lshl_add_u32 v104, v104, 5, v103
  v_add_u32 v7, 98304, v104
  s_add_u32 s43, s42, 2
  v_xor_b32 v104, s43, v102
  v_lshl_add_u32 v104, v104, 5, v103
  v_add_u32 v8, 98304, v104
  s_add_u32 s43, s42, 3
  v_xor_b32 v104, s43, v102
  v_lshl_add_u32 v104, v104, 5, v103
  v_add_u32 v9, 98304, v104
  s_add_u32 s43, s42, 4
  v_xor_b32 v104, s43, v102
  v_lshl_add_u32 v104, v104, 5, v103
  v_add_u32 v10, 98304, v104
  s_add_u32 s43, s42, 5
  v_xor_b32 v104, s43, v102
  v_lshl_add_u32 v104, v104, 5, v103
  v_add_u32 v11, 98304, v104
  s_add_u32 s43, s42, 6
  v_xor_b32 v104, s43, v102
  v_lshl_add_u32 v104, v104, 5, v103
  v_add_u32 v12, 98304, v104
  s_add_u32 s43, s42, 7
  v_xor_b32 v104, s43, v102
  v_lshl_add_u32 v104, v104, 5, v103
  v_add_u32 v13, 98304, v104
  s_lshl_b32 s48, s3, 13
  s_add_u32 s48, s48, 32768
  v_and_b32 v103, 63, v0
  v_and_b32 v100, 15, v103
  v_lshrrev_b32 v101, 4, v103
  v_lshrrev_b32 v102, 1, v101
  v_xor_b32 v102, v102, v100
  v_lshlrev_b32 v102, 4, v102
  v_and_b32 v101, 1, v101
  v_lshl_add_u32 v102, v101, 3, v102
  v_lshl_add_u32 v102, v100, 8, v102
  v_add_u32 v30, s48, v102
  v_xor_b32 v31, 32, v30
  v_xor_b32 v32, 64, v30
  v_xor_b32 v33, 96, v30
  v_xor_b32 v34, 128, v30
  v_xor_b32 v35, 160, v30
  v_xor_b32 v36, 192, v30
  v_xor_b32 v37, 224, v30
  v_lshrrev_b32 v100, 4, v103
  v_and_b32 v101, 15, v103
  v_xor_b32 v102, v101, v100
  v_lshlrev_b32 v102, 4, v102
  v_lshl_add_u32 v102, v100, 8, v102
  v_add_u32 v38, s48, v102
  v_xor_b32 v39, 64, v38
  v_xor_b32 v40, 128, v38
  v_xor_b32 v41, 192, v38
  v_and_b32 v100, 63, v0
  v_lshrrev_b32 v101, 4, v100
  v_and_b32 v100, 15, v100
  v_mul_lo_u32 v42, v101, s35
  v_lshl_add_u32 v42, v100, 4, v42
  v_and_b32 v100, 15, v0
  v_lshlrev_b32 v43, 1, v100
  v_bfe_u32 v101, v0, 4, 2
  v_add_u32 v102, 0, v101
  v_xor_b32 v103, v102, v100
  v_lshlrev_b32 v103, 4, v103
  v_mul_lo_u32 v102, v102, s35
  v_add_u32 v102, v102, v103
  v_subrev_u32 v26, 0, v102
  v_add_u32 v102, 4, v101
  v_xor_b32 v103, v102, v100
  v_lshlrev_b32 v103, 4, v103
  v_mul_lo_u32 v102, v102, s35
  v_add_u32 v102, v102, v103
  v_subrev_u32 v27, 1024, v102
  v_add_u32 v102, 8, v101
  v_xor_b32 v103, v102, v100
  v_lshlrev_b32 v103, 4, v103
  v_mul_lo_u32 v102, v102, s35
  v_add_u32 v102, v102, v103
  v_subrev_u32 v28, 2048, v102
  v_add_u32 v102, 12, v101
  v_xor_b32 v103, v102, v100
  v_lshlrev_b32 v103, 4, v103
  v_mul_lo_u32 v102, v102, s35
  v_add_u32 v102, v102, v103
  v_subrev_u32 v29, 3072, v102
  s_lshl_b32 s42, s35, 6
  s_mul_i32 s42, s42, s3
  s_add_u32 s30, s30, s42
  s_lshl_b32 s37, s35, 4
  s_mov_b32 s44, s30
  s_add_u32 s45, s44, s37
  s_add_u32 s46, s45, s37
  s_add_u32 s47, s46, s37
  s_lshl_b32 s37, s35, 2
  s_lshl_b32 s43, s24, 8
  s_lshl_b32 s42, s3, 6
  s_add_u32 s43, s43, s42
  s_lshl_b32 s49, s43, 1
  s_lshl_b32 s60, s24, 2
  s_add_u32 s60, s60, s3
  s_lshl_b32 s60, s60, 11
  s_add_u32 s60, s60, 69632
  s_lshl_b32 s42, s36, 7
  s_add_u32 s60, s60, s42
  s_cmp_ge_u32 s25, 7
  s_cselect_b32 s42, 64, 0
  s_cmp_eq_u32 s36, 1
  s_cselect_b32 s42, 0, s42
  s_add_u32 s60, s60, s42
  s_cmp_eq_u32 s36, 1
  s_cselect_b32 s63, s61, 0
  s_cselect_b32 s89, 8, 0
  s_add_u32 s63, s63, 128
  v_mov_b32 v126, s63
  s_waitcnt lgkmcnt(0)
  s_mov_b32 s56, s50
  s_mov_b32 s57, s51
  s_cmp_eq_u32 s36, 0
  s_cselect_b32 s58, 4096, 0
  s_mov_b32 s59, 0x20000
  v_mov_b32 v104, s61
  s_mov_b64 exec, 1
  s_mov_b32 s42, 0x40000
  global_load_dword v105, v104, s[70:71] sc1
  s_sleep 4
  global_load_dword v106, v104, s[70:71] sc1
  s_sleep 4
  global_load_dword v107, v104, s[70:71] sc1
  s_sleep 4
  global_load_dword v108, v104, s[70:71] sc1
mid_pollo:
  s_waitcnt vmcnt(3)
  v_readfirstlane_b32 s43, v105
  s_sub_u32 s42, s42, 1
  s_cbranch_scc1 mid_pollo_ok
  s_nop 1
  s_cmp_ge_u32 s43, 8
  s_cbranch_scc1 mid_pollo_ok
  global_load_dword v105, v104, s[70:71] sc1
  s_sleep 4
  s_waitcnt vmcnt(3)
  v_readfirstlane_b32 s43, v106
  s_sub_u32 s42, s42, 1
  s_cbranch_scc1 mid_pollo_ok
  s_nop 1
  s_cmp_ge_u32 s43, 8
  s_cbranch_scc1 mid_pollo_ok
  global_load_dword v106, v104, s[70:71] sc1
  s_sleep 4
  s_waitcnt vmcnt(3)
  v_readfirstlane_b32 s43, v107
  s_sub_u32 s42, s42, 1
  s_cbranch_scc1 mid_pollo_ok
  s_nop 1
  s_cmp_ge_u32 s43, 8
  s_cbranch_scc1 mid_pollo_ok
  global_load_dword v107, v104, s[70:71] sc1
  s_sleep 4
  s_waitcnt vmcnt(3)
  v_readfirstlane_b32 s43, v108
  s_sub_u32 s42, s42, 1
  s_cbranch_scc1 mid_pollo_ok
  s_nop 1
  s_cmp_ge_u32 s43, 8
  s_cbranch_scc1 mid_pollo_ok
  global_load_dword v108, v104, s[70:71] sc1
  s_sleep 4
  s_branch mid_pollo
mid_pollo_ok:
  s_mov_b64 exec, -1
  s_add_u32 m0, s28, 65536
  s_nop 0
  buffer_load_dwordx4 v14, s[8:11], s26 offen offset:0 sc1 lds
  buffer_load_dwordx4 v15, s[8:11], s26 offen offset:1024 sc1 lds
  buffer_load_dwordx4 v16, s[8:11], s26 offen offset:2048 sc1 lds
  buffer_load_dwordx4 v17, s[8:11], s26 offen offset:3072 sc1 lds
  s_add_u32 m0, s28, 69632
  s_nop 0
  buffer_load_dwordx4 v18, s[8:11], s26 offen offset:0 sc1 lds
  buffer_load_dwordx4 v19, s[8:11], s26 offen offset:1024 sc1 lds
  buffer_load_dwordx4 v20, s[8:11], s26 offen offset:2048 sc1 lds
  buffer_load_dwordx4 v21, s[8:11], s26 offen offset:3072 sc1 lds
  s_add_u32 s26, s26, 128
  s_add_u32 m0, s28, 0
  s_nop 0
  buffer_load_dwordx4 v14, s[8:11], s26 offen offset:0 sc1 lds
  buffer_load_dwordx4 v15, s[8:11], s26 offen offset:1024 sc1 lds
  buffer_load_dwordx4 v16, s[8:11], s26 offen offset:2048 sc1 lds
  buffer_load_dwordx4 v17, s[8:11], s26 offen offset:3072 sc1 lds
  s_add_u32 m0, s28, 4096
  s_nop 0
  buffer_load_dwordx4 v18, s[8:11], s26 offen offset:0 sc1 lds
  buffer_load_dwordx4 v19, s[8:11], s26 offen offset:1024 sc1 lds
  buffer_load_dwordx4 v20, s[8:11], s26 offen offset:2048 sc1 lds
  buffer_load_dwordx4 v21, s[8:11], s26 offen offset:3072 sc1 lds
  s_add_u32 s26, s26, 128
  s_waitcnt vmcnt(8)
mid_pro_done:
  s_barrier
  ds_read_b64_tr_b16 a[64:65], v6 offset:32768
  ds_read_b64_tr_b16 a[66:67], v6 offset:33792
  ds_read_b64_tr_b16 a[68:69], v6 offset:40960
  ds_read_b64_tr_b16 a[70:71], v6 offset:41984
  ds_read_b128 a[0:3], v4 offset:0
  ds_read_b128 a[16:19], v5 offset:0
  ds_read_b128 a[4:7], v4 offset:2048
  ds_read_b128 a[20:23], v5 offset:2048
  ds_read_b128 a[8:11], v4 offset:4096
  ds_read_b128 a[24:27], v5 offset:4096
  ds_read_b128 a[12:15], v4 offset:6144
  ds_read_b128 a[28:31], v5 offset:6144
  ds_read_b64_tr_b16 a[72:73], v7 offset:32768
  ds_read_b64_tr_b16 a[74:75], v7 offset:33792
  ds_read_b64_tr_b16 a[76:77], v7 offset:40960
  ds_read_b64_tr_b16 a[78:79], v7 offset:41984
  ds_read_b64_tr_b16 a[80:81], v8 offset:32768
  ds_read_b64_tr_b16 a[82:83], v8 offset:33792
  ds_read_b64_tr_b16 a[84:85], v8 offset:40960
  ds_read_b64_tr_b16 a[86:87], v8 offset:41984
  ds_read_b64_tr_b16 a[88:89], v9 offset:32768
  ds_read_b64_tr_b16 a[90:91], v9 offset:33792
  ds_read_b64_tr_b16 a[92:93], v9 offset:40960
  ds_read_b64_tr_b16 a[94:95], v9 offset:41984
  s_waitcnt lgkmcnt(0)
  v_mfma_f32_16x16x32_bf16 v[128:131], a[64:67], a[0:3], 0
  s_add_u32 m0, s28, 32768
  ds_read_b64_tr_b16 a[96:97], v10 offset:32768
  v_mfma_f32_16x16x32_bf16 v[128:131], a[68:71], a[16:19], v[128:131]
  buffer_load_dwordx4 v14, s[8:11], s26 offen offset:0 sc1 lds
  v_mfma_f32_16x16x32_bf16 v[132:135], a[68:71], a[20:23], 0
  ds_read_b64_tr_b16 a[98:99], v10 offset:33792
  v_mfma_f32_16x16x32_bf16 v[132:135], a[64:67], a[4:7], v[132:135]
  buffer_load_dwordx4 v15, s[8:11], s26 offen offset:1024 sc1 lds
  v_mfma_f32_16x16x32_bf16 v[136:139], a[64:67], a[8:11], 0
  ds_read_b64_tr_b16 a[100:101], v10 offset:40960
  buffer_load_dwordx4 v16, s[8:11], s26 offen offset:2048 sc1 lds
  v_mfma_f32_16x16x32_bf16 v[136:139], a[68:71], a[24:27], v[136:139]
  ds_read_b64_tr_b16 a[102:103], v10 offset:41984
  v_mfma_f32_16x16x32_bf16 v[140:143], a[68:71], a[28:31], 0
  buffer_load_dwordx4 v17, s[8:11], s26 offen offset:3072 sc1 lds
  v_mfma_f32_16x16x32_bf16 v[140:143], a[64:67], a[12:15], v[140:143]
  s_add_u32 m0, s28, 36864
  v_mfma_f32_16x16x32_bf16 v[156:159], a[72:75], a[12:15], 0
  ds_read_b64_tr_b16 a[104:105], v11 offset:32768
  buffer_load_dwordx4 v18, s[8:11], s26 offen offset:0 sc1 lds
  v_mfma_f32_16x16x32_bf16 v[156:159], a[76:79], a[28:31], v[156:159]
  ds_read_b64_tr_b16 a[106:107], v11 offset:33792
  v_mfma_f32_16x16x32_bf16 v[152:155], a[76:79], a[24:27], 0
  buffer_load_dwordx4 v19, s[8:11], s26 offen offset:1024 sc1 lds
  v_mfma_f32_16x16x32_bf16 v[152:155], a[72:75], a[8:11], v[152:155]
  ds_read_b64_tr_b16 a[108:109], v11 offset:40960
  v_mfma_f32_16x16x32_bf16 v[148:151], a[72:75], a[4:7], 0
  buffer_load_dwordx4 v20, s[8:11], s26 offen offset:2048 sc1 lds
  ds_read_b64_tr_b16 a[110:111], v11 offset:41984
  v_mfma_f32_16x16x32_bf16 v[148:151], a[76:79], a[20:23], v[148:151]
  buffer_load_dwordx4 v21, s[8:11], s26 offen offset:3072 sc1 lds
  v_mfma_f32_16x16x32_bf16 v[144:147], a[76:79], a[16:19], 0
  s_add_u32 m0, s29, 16384
  v_mfma_f32_16x16x32_bf16 v[144:147], a[72:75], a[0:3], v[144:147]
  ds_read_b64_tr_b16 a[112:113], v12 offset:32768
  v_mfma_f32_16x16x32_bf16 v[160:163], a[80:83], a[0:3], 0
  buffer_load_dwordx4 v22, s[12:15], s27 offen offset:0 sc1 lds
  ds_read_b64_tr_b16 a[114:115], v12 offset:33792
  v_mfma_f32_16x16x32_bf16 v[160:163], a[84:87], a[16:19], v[160:163]
  buffer_load_dwordx4 v23, s[12:15], s27 offen offset:1024 sc1 lds
  v_mfma_f32_16x16x32_bf16 v[164:167], a[84:87], a[20:23], 0
  ds_read_b64_tr_b16 a[116:117], v12 offset:40960
  v_mfma_f32_16x16x32_bf16 v[164:167], a[80:83], a[4:7], v[164:167]
  buffer_load_dwordx4 v24, s[12:15], s27 offen offset:2048 sc1 lds
  v_mfma_f32_16x16x32_bf16 v[168:171], a[80:83], a[8:11], 0
  ds_read_b64_tr_b16 a[118:119], v12 offset:41984
  buffer_load_dwordx4 v25, s[12:15], s27 offen offset:3072 sc1 lds
  v_mfma_f32_16x16x32_bf16 v[168:171], a[84:87], a[24:27], v[168:171]
  ds_read_b64_tr_b16 a[120:121], v13 offset:32768
  v_mfma_f32_16x16x32_bf16 v[172:175], a[84:87], a[28:31], 0
  s_add_u32 s26, s26, 128
  v_mfma_f32_16x16x32_bf16 v[172:175], a[80:83], a[12:15], v[172:175]
  ds_read_b64_tr_b16 a[122:123], v13 offset:33792
  v_mfma_f32_16x16x32_bf16 v[188:191], a[88:91], a[12:15], 0
  s_add_u32 s27, s27, s34
  ds_read_b64_tr_b16 a[124:125], v13 offset:40960
  v_mfma_f32_16x16x32_bf16 v[188:191], a[92:95], a[28:31], v[188:191]
  s_xor_b32 s34, s34, s92
  v_mfma_f32_16x16x32_bf16 v[184:187], a[92:95], a[24:27], 0
  ds_read_b64_tr_b16 a[126:127], v13 offset:41984
  v_mfma_f32_16x16x32_bf16 v[184:187], a[88:91], a[8:11], v[184:187]
  global_load_dword v127, v126, s[70:71] sc1
  v_mfma_f32_16x16x32_bf16 v[180:183], a[88:91], a[4:7], 0
  v_mfma_f32_16x16x32_bf16 v[180:183], a[92:95], a[20:23], v[180:183]
  v_mfma_f32_16x16x32_bf16 v[176:179], a[92:95], a[16:19], 0
  v_mfma_f32_16x16x32_bf16 v[176:179], a[88:91], a[0:3], v[176:179]
  s_waitcnt lgkmcnt(0) vmcnt(13)
  s_barrier
  s_cmp_eq_u32 s69, 0
  s_cbranch_scc1 mid_latepub
mid_latepub_ret:
  v_mfma_f32_16x16x32_bf16 v[192:195], a[96:99], a[0:3], 0
  s_add_u32 m0, s28, 65536
  ds_read_b64_tr_b16 a[64:65], v6 offset:0
  v_mfma_f32_16x16x32_bf16 v[192:195], a[100:103], a[16:19], v[192:195]
  buffer_load_dwordx4 v14, s[8:11], s26 offen offset:0 sc1 lds
  v_mfma_f32_16x16x32_bf16 v[196:199], a[100:103], a[20:23], 0
  ds_read_b64_tr_b16 a[66:67], v6 offset:1024
  v_mfma_f32_16x16x32_bf16 v[196:199], a[96:99], a[4:7], v[196:199]
  ds_read_b64_tr_b16 a[68:69], v6 offset:8192
  v_mfma_f32_16x16x32_bf16 v[200:203], a[96:99], a[8:11], 0
  ds_read_b64_tr_b16 a[70:71], v6 offset:9216
  v_mfma_f32_16x16x32_bf16 v[200:203], a[100:103], a[24:27], v[200:203]
  ds_read_b128 a[32:35], v2 offset:0
  v_mfma_f32_16x16x32_bf16 v[204:207], a[100:103], a[28:31], 0
  buffer_load_dwordx4 v15, s[8:11], s26 offen offset:1024 sc1 lds
  v_mfma_f32_16x16x32_bf16 v[204:207], a[96:99], a[12:15], v[204:207]
  ds_read_b128 a[48:51], v3 offset:0
  ds_read_b128 a[36:39], v2 offset:2048
  v_mfma_f32_16x16x32_bf16 v[220:223], a[104:107], a[12:15], 0
  ds_read_b128 a[52:55], v3 offset:2048
  v_mfma_f32_16x16x32_bf16 v[220:223], a[108:111], a[28:31], v[220:223]
  ds_read_b128 a[40:43], v2 offset:4096
  v_mfma_f32_16x16x32_bf16 v[216:219], a[108:111], a[24:27], 0
  buffer_load_dwordx4 v16, s[8:11], s26 offen offset:2048 sc1 lds
  v_mfma_f32_16x16x32_bf16 v[216:219], a[104:107], a[8:11], v[216:219]
  ds_read_b128 a[56:59], v3 offset:4096
  v_mfma_f32_16x16x32_bf16 v[212:215], a[104:107], a[4:7], 0
  ds_read_b128 a[44:47], v2 offset:6144
  v_mfma_f32_16x16x32_bf16 v[212:215], a[108:111], a[20:23], v[212:215]
  ds_read_b128 a[60:63], v3 offset:6144
  v_mfma_f32_16x16x32_bf16 v[208:211], a[108:111], a[16:19], 0
  ds_read_b64_tr_b16 a[72:73], v7 offset:0
  buffer_load_dwordx4 v17, s[8:11], s26 offen offset:3072 sc1 lds
  v_mfma_f32_16x16x32_bf16 v[208:211], a[104:107], a[0:3], v[208:211]
  ds_read_b64_tr_b16 a[74:75], v7 offset:1024
  v_mfma_f32_16x16x32_bf16 v[224:227], a[112:115], a[0:3], 0
  ds_read_b64_tr_b16 a[76:77], v7 offset:8192
  v_mfma_f32_16x16x32_bf16 v[224:227], a[116:119], a[16:19], v[224:227]
  ds_read_b64_tr_b16 a[78:79], v7 offset:9216
  v_mfma_f32_16x16x32_bf16 v[228:231], a[116:119], a[20:23], 0
  s_add_u32 m0, s28, 69632
  v_mfma_f32_16x16x32_bf16 v[228:231], a[112:115], a[4:7], v[228:231]
  ds_read_b64_tr_b16 a[80:81], v8 offset:0
  v_mfma_f32_16x16x32_bf16 v[232:235], a[112:115], a[8:11], 0
  buffer_load_dwordx4 v18, s[8:11], s26 offen offset:0 sc1 lds
  v_mfma_f32_16x16x32_bf16 v[232:235], a[116:119], a[24:27], v[232:235]
  ds_read_b64_tr_b16 a[82:83], v8 offset:1024
  ds_read_b64_tr_b16 a[84:85], v8 offset:8192
  v_mfma_f32_16x16x32_bf16 v[236:239], a[116:119], a[28:31], 0
  ds_read_b64_tr_b16 a[86:87], v8 offset:9216
  v_mfma_f32_16x16x32_bf16 v[236:239], a[112:115], a[12:15], v[236:239]
  ds_read_b64_tr_b16 a[88:89], v9 offset:0
  v_mfma_f32_16x16x32_bf16 v[252:255], a[120:123], a[12:15], 0
  buffer_load_dwordx4 v19, s[8:11], s26 offen offset:1024 sc1 lds
  v_mfma_f32_16x16x32_bf16 v[252:255], a[124:127], a[28:31], v[252:255]
  ds_read_b64_tr_b16 a[90:91], v9 offset:1024
  v_mfma_f32_16x16x32_bf16 v[248:251], a[124:127], a[24:27], 0
  ds_read_b64_tr_b16 a[92:93], v9 offset:8192
  v_mfma_f32_16x16x32_bf16 v[248:251], a[120:123], a[8:11], v[248:251]
  ds_read_b64_tr_b16 a[94:95], v9 offset:9216
  v_mfma_f32_16x16x32_bf16 v[244:247], a[120:123], a[4:7], 0
  v_mfma_f32_16x16x32_bf16 v[244:247], a[124:127], a[20:23], v[244:247]
  v_mfma_f32_16x16x32_bf16 v[240:243], a[124:127], a[16:19], 0
  v_mfma_f32_16x16x32_bf16 v[240:243], a[120:123], a[0:3], v[240:243]
  s_waitcnt lgkmcnt(0)
  s_mov_b32 s31, 2
  .p2align 6
mid_loop_1:
  v_mfma_f32_16x16x32_bf16 v[128:131], a[64:67], a[32:35], v[128:131]
  s_add_u32 m0, s28, 69632
  v_mfma_f32_16x16x32_bf16 v[128:131], a[68:71], a[48:51], v[128:131]
  ds_read_b64_tr_b16 a[96:97], v10 offset:0
  v_mfma_f32_16x16x32_bf16 v[132:135], a[68:71], a[52:55], v[132:135]
  buffer_load_dwordx4 v20, s[8:11], s26 offen offset:2048 sc1 lds
  v_mfma_f32_16x16x32_bf16 v[132:135], a[64:67], a[36:39], v[132:135]
  ds_read_b64_tr_b16 a[98:99], v10 offset:1024
  v_mfma_f32_16x16x32_bf16 v[136:139], a[64:67], a[40:43], v[136:139]
  ds_read_b64_tr_b16 a[100:101], v10 offset:8192
  v_mfma_f32_16x16x32_bf16 v[136:139], a[68:71], a[56:59], v[136:139]
  buffer_load_dwordx4 v21, s[8:11], s26 offen offset:3072 sc1 lds
  v_mfma_f32_16x16x32_bf16 v[140:143], a[68:71], a[60:63], v[140:143]
  v_mfma_f32_16x16x32_bf16 v[140:143], a[64:67], a[44:47], v[140:143]
  ds_read_b64_tr_b16 a[102:103], v10 offset:9216
  v_mfma_f32_16x16x32_bf16 v[156:159], a[72:75], a[44:47], v[156:159]
  ds_read_b64_tr_b16 a[104:105], v11 offset:0
  v_mfma_f32_16x16x32_bf16 v[156:159], a[76:79], a[60:63], v[156:159]
  s_add_u32 m0, s29, 32768
  v_mfma_f32_16x16x32_bf16 v[152:155], a[76:79], a[56:59], v[152:155]
  ds_read_b64_tr_b16 a[106:107], v11 offset:1024
  v_mfma_f32_16x16x32_bf16 v[152:155], a[72:75], a[40:43], v[152:155]
  buffer_load_dwordx4 v22, s[12:15], s27 offen offset:0 sc1 lds
  v_mfma_f32_16x16x32_bf16 v[148:151], a[72:75], a[36:39], v[148:151]
  ds_read_b64_tr_b16 a[108:109], v11 offset:8192
  v_mfma_f32_16x16x32_bf16 v[148:151], a[76:79], a[52:55], v[148:151]
  v_mfma_f32_16x16x32_bf16 v[144:147], a[76:79], a[48:51], v[144:147]
  ds_read_b64_tr_b16 a[110:111], v11 offset:9216
  v_mfma_f32_16x16x32_bf16 v[144:147], a[72:75], a[32:35], v[144:147]
  ds_read_b64_tr_b16 a[112:113], v12 offset:0
  v_mfma_f32_16x16x32_bf16 v[160:163], a[80:83], a[32:35], v[160:163]
  buffer_load_dwordx4 v23, s[12:15], s27 offen offset:1024 sc1 lds
  v_mfma_f32_16x16x32_bf16 v[160:163], a[84:87], a[48:51], v[160:163]
  ds_read_b64_tr_b16 a[114:115], v12 offset:1024
  v_mfma_f32_16x16x32_bf16 v[164:167], a[84:87], a[52:55], v[164:167]
  ds_read_b64_tr_b16 a[116:117], v12 offset:8192
  v_mfma_f32_16x16x32_bf16 v[164:167], a[80:83], a[36:39], v[164:167]
  buffer_load_dwordx4 v24, s[12:15], s27 offen offset:2048 sc1 lds
  v_mfma_f32_16x16x32_bf16 v[168:171], a[80:83], a[40:43], v[168:171]
  v_mfma_f32_16x16x32_bf16 v[168:171], a[84:87], a[56:59], v[168:171]
  ds_read_b64_tr_b16 a[118:119], v12 offset:9216
  v_mfma_f32_16x16x32_bf16 v[172:175], a[84:87], a[60:63], v[172:175]
  ds_read_b64_tr_b16 a[120:121], v13 offset:0
  v_mfma_f32_16x16x32_bf16 v[172:175], a[80:83], a[44:47], v[172:175]
  ds_read_b64_tr_b16 a[122:123], v13 offset:1024
  v_mfma_f32_16x16x32_bf16 v[188:191], a[88:91], a[44:47], v[188:191]
  buffer_load_dwordx4 v25, s[12:15], s27 offen offset:3072 sc1 lds
  v_mfma_f32_16x16x32_bf16 v[188:191], a[92:95], a[60:63], v[188:191]
  ds_read_b64_tr_b16 a[124:125], v13 offset:8192
  v_mfma_f32_16x16x32_bf16 v[184:187], a[92:95], a[56:59], v[184:187]
  ds_read_b64_tr_b16 a[126:127], v13 offset:9216
  v_mfma_f32_16x16x32_bf16 v[184:187], a[88:91], a[40:43], v[184:187]
  v_mfma_f32_16x16x32_bf16 v[180:183], a[88:91], a[36:39], v[180:183]
  v_mfma_f32_16x16x32_bf16 v[180:183], a[92:95], a[52:55], v[180:183]
  v_mfma_f32_16x16x32_bf16 v[176:179], a[92:95], a[48:51], v[176:179]
  s_add_u32 s26, s26, 128
  v_mfma_f32_16x16x32_bf16 v[176:179], a[88:91], a[32:35], v[176:179]
  s_add_u32 s27, s27, s34
  s_xor_b32 s34, s34, s92
  s_waitcnt lgkmcnt(0) vmcnt(13)
  s_barrier
  v_mfma_f32_16x16x32_bf16 v[192:195], a[96:99], a[32:35], v[192:195]
  s_add_u32 m0, s28, 0
  ds_read_b64_tr_b16 a[64:65], v6 offset:16384
  v_mfma_f32_16x16x32_bf16 v[192:195], a[100:103], a[48:51], v[192:195]
  buffer_load_dwordx4 v14, s[8:11], s26 offen offset:0 sc1 lds
  v_mfma_f32_16x16x32_bf16 v[196:199], a[100:103], a[52:55], v[196:199]
  ds_read_b64_tr_b16 a[66:67], v6 offset:17408
  v_mfma_f32_16x16x32_bf16 v[196:199], a[96:99], a[36:39], v[196:199]
  ds_read_b64_tr_b16 a[68:69], v6 offset:24576
  v_mfma_f32_16x16x32_bf16 v[200:203], a[96:99], a[40:43], v[200:203]
  ds_read_b64_tr_b16 a[70:71], v6 offset:25600
  v_mfma_f32_16x16x32_bf16 v[200:203], a[100:103], a[56:59], v[200:203]
  ds_read_b128 a[0:3], v2 offset:32768
  v_mfma_f32_16x16x32_bf16 v[204:207], a[100:103], a[60:63], v[204:207]
  buffer_load_dwordx4 v15, s[8:11], s26 offen offset:1024 sc1 lds
  v_mfma_f32_16x16x32_bf16 v[204:207], a[96:99], a[44:47], v[204:207]
  ds_read_b128 a[16:19], v3 offset:32768
  ds_read_b128 a[4:7], v2 offset:34816
  v_mfma_f32_16x16x32_bf16 v[220:223], a[104:107], a[44:47], v[220:223]
  ds_read_b128 a[20:23], v3 offset:34816
  v_mfma_f32_16x16x32_bf16 v[220:223], a[108:111], a[60:63], v[220:223]
  ds_read_b128 a[8:11], v2 offset:36864
  v_mfma_f32_16x16x32_bf16 v[216:219], a[108:111], a[56:59], v[216:219]
  buffer_load_dwordx4 v16, s[8:11], s26 offen offset:2048 sc1 lds
  v_mfma_f32_16x16x32_bf16 v[216:219], a[104:107], a[40:43], v[216:219]
  ds_read_b128 a[24:27], v3 offset:36864
  v_mfma_f32_16x16x32_bf16 v[212:215], a[104:107], a[36:39], v[212:215]
  ds_read_b128 a[12:15], v2 offset:38912
  v_mfma_f32_16x16x32_bf16 v[212:215], a[108:111], a[52:55], v[212:215]
  ds_read_b128 a[28:31], v3 offset:38912
  v_mfma_f32_16x16x32_bf16 v[208:211], a[108:111], a[48:51], v[208:211]
  ds_read_b64_tr_b16 a[72:73], v7 offset:16384
  buffer_load_dwordx4 v17, s[8:11], s26 offen offset:3072 sc1 lds
  v_mfma_f32_16x16x32_bf16 v[208:211], a[104:107], a[32:35], v[208:211]
  ds_read_b64_tr_b16 a[74:75], v7 offset:17408
  v_mfma_f32_16x16x32_bf16 v[224:227], a[112:115], a[32:35], v[224:227]
  ds_read_b64_tr_b16 a[76:77], v7 offset:24576
  v_mfma_f32_16x16x32_bf16 v[224:227], a[116:119], a[48:51], v[224:227]
  ds_read_b64_tr_b16 a[78:79], v7 offset:25600
  v_mfma_f32_16x16x32_bf16 v[228:231], a[116:119], a[52:55], v[228:231]
  s_add_u32 m0, s28, 4096
  v_mfma_f32_16x16x32_bf16 v[228:231], a[112:115], a[36:39], v[228:231]
  ds_read_b64_tr_b16 a[80:81], v8 offset:16384
  v_mfma_f32_16x16x32_bf16 v[232:235], a[112:115], a[40:43], v[232:235]
  buffer_load_dwordx4 v18, s[8:11], s26 offen offset:0 sc1 lds
  v_mfma_f32_16x16x32_bf16 v[232:235], a[116:119], a[56:59], v[232:235]
  ds_read_b64_tr_b16 a[82:83], v8 offset:17408
  ds_read_b64_tr_b16 a[84:85], v8 offset:24576
  v_mfma_f32_16x16x32_bf16 v[236:239], a[116:119], a[60:63], v[236:239]
  ds_read_b64_tr_b16 a[86:87], v8 offset:25600
  v_mfma_f32_16x16x32_bf16 v[236:239], a[112:115], a[44:47], v[236:239]
  ds_read_b64_tr_b16 a[88:89], v9 offset:16384
  v_mfma_f32_16x16x32_bf16 v[252:255], a[120:123], a[44:47], v[252:255]
  buffer_load_dwordx4 v19, s[8:11], s26 offen offset:1024 sc1 lds
  v_mfma_f32_16x16x32_bf16 v[252:255], a[124:127], a[60:63], v[252:255]
  ds_read_b64_tr_b16 a[90:91], v9 offset:17408
  v_mfma_f32_16x16x32_bf16 v[248:251], a[124:127], a[56:59], v[248:251]
  ds_read_b64_tr_b16 a[92:93], v9 offset:24576
  v_mfma_f32_16x16x32_bf16 v[248:251], a[120:123], a[40:43], v[248:251]
  ds_read_b64_tr_b16 a[94:95], v9 offset:25600
  v_mfma_f32_16x16x32_bf16 v[244:247], a[120:123], a[36:39], v[244:247]
  v_mfma_f32_16x16x32_bf16 v[244:247], a[124:127], a[52:55], v[244:247]
  v_mfma_f32_16x16x32_bf16 v[240:243], a[124:127], a[48:51], v[240:243]
  v_mfma_f32_16x16x32_bf16 v[240:243], a[120:123], a[32:35], v[240:243]
  s_waitcnt lgkmcnt(0)
  v_mfma_f32_16x16x32_bf16 v[128:131], a[64:67], a[0:3], v[128:131]
  s_add_u32 m0, s28, 4096
  v_mfma_f32_16x16x32_bf16 v[128:131], a[68:71], a[16:19], v[128:131]
  ds_read_b64_tr_b16 a[96:97], v10 offset:16384
  v_mfma_f32_16x16x32_bf16 v[132:135], a[68:71], a[20:23], v[132:135]
  buffer_load_dwordx4 v20, s[8:11], s26 offen offset:2048 sc1 lds
  v_mfma_f32_16x16x32_bf16 v[132:135], a[64:67], a[4:7], v[132:135]
  ds_read_b64_tr_b16 a[98:99], v10 offset:17408
  v_mfma_f32_16x16x32_bf16 v[136:139], a[64:67], a[8:11], v[136:139]
  ds_read_b64_tr_b16 a[100:101], v10 offset:24576
  v_mfma_f32_16x16x32_bf16 v[136:139], a[68:71], a[24:27], v[136:139]
  buffer_load_dwordx4 v21, s[8:11], s26 offen offset:3072 sc1 lds
  v_mfma_f32_16x16x32_bf16 v[140:143], a[68:71], a[28:31], v[140:143]
  v_mfma_f32_16x16x32_bf16 v[140:143], a[64:67], a[12:15], v[140:143]
  ds_read_b64_tr_b16 a[102:103], v10 offset:25600
  v_mfma_f32_16x16x32_bf16 v[156:159], a[72:75], a[12:15], v[156:159]
  ds_read_b64_tr_b16 a[104:105], v11 offset:16384
  v_mfma_f32_16x16x32_bf16 v[156:159], a[76:79], a[28:31], v[156:159]
  s_add_u32 m0, s29, 0
  v_mfma_f32_16x16x32_bf16 v[152:155], a[76:79], a[24:27], v[152:155]
  ds_read_b64_tr_b16 a[106:107], v11 offset:17408
  v_mfma_f32_16x16x32_bf16 v[152:155], a[72:75], a[8:11], v[152:155]
  buffer_load_dwordx4 v22, s[12:15], s27 offen offset:0 sc1 lds
  v_mfma_f32_16x16x32_bf16 v[148:151], a[72:75], a[4:7], v[148:151]
  ds_read_b64_tr_b16 a[108:109], v11 offset:24576
  v_mfma_f32_16x16x32_bf16 v[148:151], a[76:79], a[20:23], v[148:151]
  v_mfma_f32_16x16x32_bf16 v[144:147], a[76:79], a[16:19], v[144:147]
  ds_read_b64_tr_b16 a[110:111], v11 offset:25600
  v_mfma_f32_16x16x32_bf16 v[144:147], a[72:75], a[0:3], v[144:147]
  ds_read_b64_tr_b16 a[112:113], v12 offset:16384
  v_mfma_f32_16x16x32_bf16 v[160:163], a[80:83], a[0:3], v[160:163]
  buffer_load_dwordx4 v23, s[12:15], s27 offen offset:1024 sc1 lds
  v_mfma_f32_16x16x32_bf16 v[160:163], a[84:87], a[16:19], v[160:163]
  ds_read_b64_tr_b16 a[114:115], v12 offset:17408
  v_mfma_f32_16x16x32_bf16 v[164:167], a[84:87], a[20:23], v[164:167]
  ds_read_b64_tr_b16 a[116:117], v12 offset:24576
  v_mfma_f32_16x16x32_bf16 v[164:167], a[80:83], a[4:7], v[164:167]
  buffer_load_dwordx4 v24, s[12:15], s27 offen offset:2048 sc1 lds
  v_mfma_f32_16x16x32_bf16 v[168:171], a[80:83], a[8:11], v[168:171]
  v_mfma_f32_16x16x32_bf16 v[168:171], a[84:87], a[24:27], v[168:171]
  ds_read_b64_tr_b16 a[118:119], v12 offset:25600
  v_mfma_f32_16x16x32_bf16 v[172:175], a[84:87], a[28:31], v[172:175]
  ds_read_b64_tr_b16 a[120:121], v13 offset:16384
  v_mfma_f32_16x16x32_bf16 v[172:175], a[80:83], a[12:15], v[172:175]
  ds_read_b64_tr_b16 a[122:123], v13 offset:17408
  v_mfma_f32_16x16x32_bf16 v[188:191], a[88:91], a[12:15], v[188:191]
  buffer_load_dwordx4 v25, s[12:15], s27 offen offset:3072 sc1 lds
  v_mfma_f32_16x16x32_bf16 v[188:191], a[92:95], a[28:31], v[188:191]
  ds_read_b64_tr_b16 a[124:125], v13 offset:24576
  v_mfma_f32_16x16x32_bf16 v[184:187], a[92:95], a[24:27], v[184:187]
  ds_read_b64_tr_b16 a[126:127], v13 offset:25600
  v_mfma_f32_16x16x32_bf16 v[184:187], a[88:91], a[8:11], v[184:187]
  v_mfma_f32_16x16x32_bf16 v[180:183], a[88:91], a[4:7], v[180:183]
  v_mfma_f32_16x16x32_bf16 v[180:183], a[92:95], a[20:23], v[180:183]
  v_mfma_f32_16x16x32_bf16 v[176:179], a[92:95], a[16:19], v[176:179]
  s_add_u32 s26, s26, 128
  v_mfma_f32_16x16x32_bf16 v[176:179], a[88:91], a[0:3], v[176:179]
  s_add_u32 s27, s27, s34
  s_xor_b32 s34, s34, s92
  s_waitcnt lgkmcnt(0) vmcnt(12)
  s_barrier
  v_mfma_f32_16x16x32_bf16 v[192:195], a[96:99], a[0:3], v[192:195]
  s_add_u32 m0, s28, 32768
  ds_read_b64_tr_b16 a[64:65], v6 offset:32768
  v_mfma_f32_16x16x32_bf16 v[192:195], a[100:103], a[16:19], v[192:195]
  buffer_load_dwordx4 v14, s[8:11], s26 offen offset:0 sc1 lds
  v_mfma_f32_16x16x32_bf16 v[196:199], a[100:103], a[20:23], v[196:199]
  ds_read_b64_tr_b16 a[66:67], v6 offset:33792
  v_mfma_f32_16x16x32_bf16 v[196:199], a[96:99], a[4:7], v[196:199]
  ds_read_b64_tr_b16 a[68:69], v6 offset:40960
  v_mfma_f32_16x16x32_bf16 v[200:203], a[96:99], a[8:11], v[200:203]
  ds_read_b64_tr_b16 a[70:71], v6 offset:41984
  v_mfma_f32_16x16x32_bf16 v[200:203], a[100:103], a[24:27], v[200:203]
  ds_read_b128 a[32:35], v4 offset:0
  v_mfma_f32_16x16x32_bf16 v[204:207], a[100:103], a[28:31], v[204:207]
  buffer_load_dwordx4 v15, s[8:11], s26 offen offset:1024 sc1 lds
  v_mfma_f32_16x16x32_bf16 v[204:207], a[96:99], a[12:15], v[204:207]
  ds_read_b128 a[48:51], v5 offset:0
  ds_read_b128 a[36:39], v4 offset:2048
  v_mfma_f32_16x16x32_bf16 v[220:223], a[104:107], a[12:15], v[220:223]
  ds_read_b128 a[52:55], v5 offset:2048
  v_mfma_f32_16x16x32_bf16 v[220:223], a[108:111], a[28:31], v[220:223]
  ds_read_b128 a[40:43], v4 offset:4096
  v_mfma_f32_16x16x32_bf16 v[216:219], a[108:111], a[24:27], v[216:219]
  buffer_load_dwordx4 v16, s[8:11], s26 offen offset:2048 sc1 lds
  v_mfma_f32_16x16x32_bf16 v[216:219], a[104:107], a[8:11], v[216:219]
  ds_read_b128 a[56:59], v5 offset:4096
  v_mfma_f32_16x16x32_bf16 v[212:215], a[104:107], a[4:7], v[212:215]
  ds_read_b128 a[44:47], v4 offset:6144
  v_mfma_f32_16x16x32_bf16 v[212:215], a[108:111], a[20:23], v[212:215]
  ds_read_b128 a[60:63], v5 offset:6144
  v_mfma_f32_16x16x32_bf16 v[208:211], a[108:111], a[16:19], v[208:211]
  ds_read_b64_tr_b16 a[72:73], v7 offset:32768
  buffer_load_dwordx4 v17, s[8:11], s26 offen offset:3072 sc1 lds
  v_mfma_f32_16x16x32_bf16 v[208:211], a[104:107], a[0:3], v[208:211]
  ds_read_b64_tr_b16 a[74:75], v7 offset:33792
  v_mfma_f32_16x16x32_bf16 v[224:227], a[112:115], a[0:3], v[224:227]
  ds_read_b64_tr_b16 a[76:77], v7 offset:40960
  v_mfma_f32_16x16x32_bf16 v[224:227], a[116:119], a[16:19], v[224:227]
  ds_read_b64_tr_b16 a[78:79], v7 offset:41984
  v_mfma_f32_16x16x32_bf16 v[228:231], a[116:119], a[20:23], v[228:231]
  s_add_u32 m0, s28, 36864
  v_mfma_f32_16x16x32_bf16 v[228:231], a[112:115], a[4:7], v[228:231]
  ds_read_b64_tr_b16 a[80:81], v8 offset:32768
  v_mfma_f32_16x16x32_bf16 v[232:235], a[112:115], a[8:11], v[232:235]
  buffer_load_dwordx4 v18, s[8:11], s26 offen offset:0 sc1 lds
  v_mfma_f32_16x16x32_bf16 v[232:235], a[116:119], a[24:27], v[232:235]
  ds_read_b64_tr_b16 a[82:83], v8 offset:33792
  ds_read_b64_tr_b16 a[84:85], v8 offset:40960
  v_mfma_f32_16x16x32_bf16 v[236:239], a[116:119], a[28:31], v[236:239]
  ds_read_b64_tr_b16 a[86:87], v8 offset:41984
  v_mfma_f32_16x16x32_bf16 v[236:239], a[112:115], a[12:15], v[236:239]
  ds_read_b64_tr_b16 a[88:89], v9 offset:32768
  v_mfma_f32_16x16x32_bf16 v[252:255], a[120:123], a[12:15], v[252:255]
  buffer_load_dwordx4 v19, s[8:11], s26 offen offset:1024 sc1 lds
  v_mfma_f32_16x16x32_bf16 v[252:255], a[124:127], a[28:31], v[252:255]
  ds_read_b64_tr_b16 a[90:91], v9 offset:33792
  v_mfma_f32_16x16x32_bf16 v[248:251], a[124:127], a[24:27], v[248:251]
  ds_read_b64_tr_b16 a[92:93], v9 offset:40960
  v_mfma_f32_16x16x32_bf16 v[248:251], a[120:123], a[8:11], v[248:251]
  ds_read_b64_tr_b16 a[94:95], v9 offset:41984
  v_mfma_f32_16x16x32_bf16 v[244:247], a[120:123], a[4:7], v[244:247]
  v_mfma_f32_16x16x32_bf16 v[244:247], a[124:127], a[20:23], v[244:247]
  v_mfma_f32_16x16x32_bf16 v[240:243], a[124:127], a[16:19], v[240:243]
  v_mfma_f32_16x16x32_bf16 v[240:243], a[120:123], a[0:3], v[240:243]
  s_waitcnt lgkmcnt(0)
  v_mfma_f32_16x16x32_bf16 v[128:131], a[64:67], a[32:35], v[128:131]
  s_add_u32 m0, s28, 36864
  v_mfma_f32_16x16x32_bf16 v[128:131], a[68:71], a[48:51], v[128:131]
  ds_read_b64_tr_b16 a[96:97], v10 offset:32768
  v_mfma_f32_16x16x32_bf16 v[132:135], a[68:71], a[52:55], v[132:135]
  buffer_load_dwordx4 v20, s[8:11], s26 offen offset:2048 sc1 lds
  v_mfma_f32_16x16x32_bf16 v[132:135], a[64:67], a[36:39], v[132:135]
  ds_read_b64_tr_b16 a[98:99], v10 offset:33792
  v_mfma_f32_16x16x32_bf16 v[136:139], a[64:67], a[40:43], v[136:139]
  ds_read_b64_tr_b16 a[100:101], v10 offset:40960
  v_mfma_f32_16x16x32_bf16 v[136:139], a[68:71], a[56:59], v[136:139]
  buffer_load_dwordx4 v21, s[8:11], s26 offen offset:3072 sc1 lds
  v_mfma_f32_16x16x32_bf16 v[140:143], a[68:71], a[60:63], v[140:143]
  v_mfma_f32_16x16x32_bf16 v[140:143], a[64:67], a[44:47], v[140:143]
  ds_read_b64_tr_b16 a[102:103], v10 offset:41984
  v_mfma_f32_16x16x32_bf16 v[156:159], a[72:75], a[44:47], v[156:159]
  ds_read_b64_tr_b16 a[104:105], v11 offset:32768
  v_mfma_f32_16x16x32_bf16 v[156:159], a[76:79], a[60:63], v[156:159]
  s_add_u32 m0, s29, 16384
  v_mfma_f32_16x16x32_bf16 v[152:155], a[76:79], a[56:59], v[152:155]
  ds_read_b64_tr_b16 a[106:107], v11 offset:33792
  v_mfma_f32_16x16x32_bf16 v[152:155], a[72:75], a[40:43], v[152:155]
  buffer_load_dwordx4 v22, s[12:15], s27 offen offset:0 sc1 lds
  v_mfma_f32_16x16x32_bf16 v[148:151], a[72:75], a[36:39], v[148:151]
  ds_read_b64_tr_b16 a[108:109], v11 offset:40960
  v_mfma_f32_16x16x32_bf16 v[148:151], a[76:79], a[52:55], v[148:151]
  v_mfma_f32_16x16x32_bf16 v[144:147], a[76:79], a[48:51], v[144:147]
  ds_read_b64_tr_b16 a[110:111], v11 offset:41984
  v_mfma_f32_16x16x32_bf16 v[144:147], a[72:75], a[32:35], v[144:147]
  ds_read_b64_tr_b16 a[112:113], v12 offset:32768
  v_mfma_f32_16x16x32_bf16 v[160:163], a[80:83], a[32:35], v[160:163]
  buffer_load_dwordx4 v23, s[12:15], s27 offen offset:1024 sc1 lds
  v_mfma_f32_16x16x32_bf16 v[160:163], a[84:87], a[48:51], v[160:163]
  ds_read_b64_tr_b16 a[114:115], v12 offset:33792
  v_mfma_f32_16x16x32_bf16 v[164:167], a[84:87], a[52:55], v[164:167]
  ds_read_b64_tr_b16 a[116:117], v12 offset:40960
  v_mfma_f32_16x16x32_bf16 v[164:167], a[80:83], a[36:39], v[164:167]
  buffer_load_dwordx4 v24, s[12:15], s27 offen offset:2048 sc1 lds
  v_mfma_f32_16x16x32_bf16 v[168:171], a[80:83], a[40:43], v[168:171]
  v_mfma_f32_16x16x32_bf16 v[168:171], a[84:87], a[56:59], v[168:171]
  ds_read_b64_tr_b16 a[118:119], v12 offset:41984
  v_mfma_f32_16x16x32_bf16 v[172:175], a[84:87], a[60:63], v[172:175]
  ds_read_b64_tr_b16 a[120:121], v13 offset:32768
  v_mfma_f32_16x16x32_bf16 v[172:175], a[80:83], a[44:47], v[172:175]
  ds_read_b64_tr_b16 a[122:123], v13 offset:33792
  v_mfma_f32_16x16x32_bf16 v[188:191], a[88:91], a[44:47], v[188:191]
  buffer_load_dwordx4 v25, s[12:15], s27 offen offset:3072 sc1 lds
  v_mfma_f32_16x16x32_bf16 v[188:191], a[92:95], a[60:63], v[188:191]
  ds_read_b64_tr_b16 a[124:125], v13 offset:40960
  v_mfma_f32_16x16x32_bf16 v[184:187], a[92:95], a[56:59], v[184:187]
  ds_read_b64_tr_b16 a[126:127], v13 offset:41984
  v_mfma_f32_16x16x32_bf16 v[184:187], a[88:91], a[40:43], v[184:187]
  v_mfma_f32_16x16x32_bf16 v[180:183], a[88:91], a[36:39], v[180:183]
  v_mfma_f32_16x16x32_bf16 v[180:183], a[92:95], a[52:55], v[180:183]
  v_mfma_f32_16x16x32_bf16 v[176:179], a[92:95], a[48:51], v[176:179]
  s_add_u32 s26, s26, 128
  v_mfma_f32_16x16x32_bf16 v[176:179], a[88:91], a[32:35], v[176:179]
  s_add_u32 s27, s27, s34
  s_xor_b32 s34, s34, s92
  s_waitcnt lgkmcnt(0) vmcnt(12)
  s_barrier
  v_mfma_f32_16x16x32_bf16 v[192:195], a[96:99], a[32:35], v[192:195]
  s_add_u32 m0, s28, 65536
  ds_read_b64_tr_b16 a[64:65], v6 offset:0
  v_mfma_f32_16x16x32_bf16 v[192:195], a[100:103], a[48:51], v[192:195]
  buffer_load_dwordx4 v14, s[8:11], s26 offen offset:0 sc1 lds
  v_mfma_f32_16x16x32_bf16 v[196:199], a[100:103], a[52:55], v[196:199]
  ds_read_b64_tr_b16 a[66:67], v6 offset:1024
  v_mfma_f32_16x16x32_bf16 v[196:199], a[96:99], a[36:39], v[196:199]
  ds_read_b64_tr_b16 a[68:69], v6 offset:8192
  v_mfma_f32_16x16x32_bf16 v[200:203], a[96:99], a[40:43], v[200:203]
  ds_read_b64_tr_b16 a[70:71], v6 offset:9216
  v_mfma_f32_16x16x32_bf16 v[200:203], a[100:103], a[56:59], v[200:203]
  ds_read_b128 a[0:3], v2 offset:0
  v_mfma_f32_16x16x32_bf16 v[204:207], a[100:103], a[60:63], v[204:207]
  buffer_load_dwordx4 v15, s[8:11], s26 offen offset:1024 sc1 lds
  v_mfma_f32_16x16x32_bf16 v[204:207], a[96:99], a[44:47], v[204:207]
  ds_read_b128 a[16:19], v3 offset:0
  ds_read_b128 a[4:7], v2 offset:2048
  v_mfma_f32_16x16x32_bf16 v[220:223], a[104:107], a[44:47], v[220:223]
  ds_read_b128 a[20:23], v3 offset:2048
  v_mfma_f32_16x16x32_bf16 v[220:223], a[108:111], a[60:63], v[220:223]
  ds_read_b128 a[8:11], v2 offset:4096
  v_mfma_f32_16x16x32_bf16 v[216:219], a[108:111], a[56:59], v[216:219]
  buffer_load_dwordx4 v16, s[8:11], s26 offen offset:2048 sc1 lds
  v_mfma_f32_16x16x32_bf16 v[216:219], a[104:107], a[40:43], v[216:219]
  ds_read_b128 a[24:27], v3 offset:4096
  v_mfma_f32_16x16x32_bf16 v[212:215], a[104:107], a[36:39], v[212:215]
  ds_read_b128 a[12:15], v2 offset:6144
  v_mfma_f32_16x16x32_bf16 v[212:215], a[108:111], a[52:55], v[212:215]
  ds_read_b128 a[28:31], v3 offset:6144
  v_mfma_f32_16x16x32_bf16 v[208:211], a[108:111], a[48:51], v[208:211]
  ds_read_b64_tr_b16 a[72:73], v7 offset:0
  buffer_load_dwordx4 v17, s[8:11], s26 offen offset:3072 sc1 lds
  v_mfma_f32_16x16x32_bf16 v[208:211], a[104:107], a[32:35], v[208:211]
  ds_read_b64_tr_b16 a[74:75], v7 offset:1024
  v_mfma_f32_16x16x32_bf16 v[224:227], a[112:115], a[32:35], v[224:227]
  ds_read_b64_tr_b16 a[76:77], v7 offset:8192
  v_mfma_f32_16x16x32_bf16 v[224:227], a[116:119], a[48:51], v[224:227]
  ds_read_b64_tr_b16 a[78:79], v7 offset:9216
  v_mfma_f32_16x16x32_bf16 v[228:231], a[116:119], a[52:55], v[228:231]
  s_add_u32 m0, s28, 69632
  v_mfma_f32_16x16x32_bf16 v[228:231], a[112:115], a[36:39], v[228:231]
  ds_read_b64_tr_b16 a[80:81], v8 offset:0
  v_mfma_f32_16x16x32_bf16 v[232:235], a[112:115], a[40:43], v[232:235]
  buffer_load_dwordx4 v18, s[8:11], s26 offen offset:0 sc1 lds
  v_mfma_f32_16x16x32_bf16 v[232:235], a[116:119], a[56:59], v[232:235]
  ds_read_b64_tr_b16 a[82:83], v8 offset:1024
  ds_read_b64_tr_b16 a[84:85], v8 offset:8192
  v_mfma_f32_16x16x32_bf16 v[236:239], a[116:119], a[60:63], v[236:239]
  ds_read_b64_tr_b16 a[86:87], v8 offset:9216
  v_mfma_f32_16x16x32_bf16 v[236:239], a[112:115], a[44:47], v[236:239]
  ds_read_b64_tr_b16 a[88:89], v9 offset:0
  v_mfma_f32_16x16x32_bf16 v[252:255], a[120:123], a[44:47], v[252:255]
  buffer_load_dwordx4 v19, s[8:11], s26 offen offset:1024 sc1 lds
  v_mfma_f32_16x16x32_bf16 v[252:255], a[124:127], a[60:63], v[252:255]
  ds_read_b64_tr_b16 a[90:91], v9 offset:1024
  v_mfma_f32_16x16x32_bf16 v[248:251], a[124:127], a[56:59], v[248:251]
  ds_read_b64_tr_b16 a[92:93], v9 offset:8192
  v_mfma_f32_16x16x32_bf16 v[248:251], a[120:123], a[40:43], v[248:251]
  ds_read_b64_tr_b16 a[94:95], v9 offset:9216
  v_mfma_f32_16x16x32_bf16 v[244:247], a[120:123], a[36:39], v[244:247]
  v_mfma_f32_16x16x32_bf16 v[244:247], a[124:127], a[52:55], v[244:247]
  v_mfma_f32_16x16x32_bf16 v[240:243], a[124:127], a[48:51], v[240:243]
  v_mfma_f32_16x16x32_bf16 v[240:243], a[120:123], a[32:35], v[240:243]
  s_waitcnt lgkmcnt(0)
  v_mfma_f32_16x16x32_bf16 v[128:131], a[64:67], a[0:3], v[128:131]
  s_add_u32 m0, s28, 69632
  v_mfma_f32_16x16x32_bf16 v[128:131], a[68:71], a[16:19], v[128:131]
  ds_read_b64_tr_b16 a[96:97], v10 offset:0
  v_mfma_f32_16x16x32_bf16 v[132:135], a[68:71], a[20:23], v[132:135]
  buffer_load_dwordx4 v20, s[8:11], s26 offen offset:2048 sc1 lds
  v_mfma_f32_16x16x32_bf16 v[132:135], a[64:67], a[4:7], v[132:135]
  ds_read_b64_tr_b16 a[98:99], v10 offset:1024
  v_mfma_f32_16x16x32_bf16 v[136:139], a[64:67], a[8:11], v[136:139]
  ds_read_b64_tr_b16 a[100:101], v10 offset:8192
  v_mfma_f32_16x16x32_bf16 v[136:139], a[68:71], a[24:27], v[136:139]
  buffer_load_dwordx4 v21, s[8:11], s26 offen offset:3072 sc1 lds
  v_mfma_f32_16x16x32_bf16 v[140:143], a[68:71], a[28:31], v[140:143]
  v_mfma_f32_16x16x32_bf16 v[140:143], a[64:67], a[12:15], v[140:143]
  ds_read_b64_tr_b16 a[102:103], v10 offset:9216
  v_mfma_f32_16x16x32_bf16 v[156:159], a[72:75], a[12:15], v[156:159]
  ds_read_b64_tr_b16 a[104:105], v11 offset:0
  v_mfma_f32_16x16x32_bf16 v[156:159], a[76:79], a[28:31], v[156:159]
  s_add_u32 m0, s29, 32768
  v_mfma_f32_16x16x32_bf16 v[152:155], a[76:79], a[24:27], v[152:155]
  ds_read_b64_tr_b16 a[106:107], v11 offset:1024
  v_mfma_f32_16x16x32_bf16 v[152:155], a[72:75], a[8:11], v[152:155]
  buffer_load_dwordx4 v22, s[12:15], s27 offen offset:0 sc1 lds
  v_mfma_f32_16x16x32_bf16 v[148:151], a[72:75], a[4:7], v[148:151]
  ds_read_b64_tr_b16 a[108:109], v11 offset:8192
  v_mfma_f32_16x16x32_bf16 v[148:151], a[76:79], a[20:23], v[148:151]
  v_mfma_f32_16x16x32_bf16 v[144:147], a[76:79], a[16:19], v[144:147]
  ds_read_b64_tr_b16 a[110:111], v11 offset:9216
  v_mfma_f32_16x16x32_bf16 v[144:147], a[72:75], a[0:3], v[144:147]
  ds_read_b64_tr_b16 a[112:113], v12 offset:0
  v_mfma_f32_16x16x32_bf16 v[160:163], a[80:83], a[0:3], v[160:163]
  buffer_load_dwordx4 v23, s[12:15], s27 offen offset:1024 sc1 lds
  v_mfma_f32_16x16x32_bf16 v[160:163], a[84:87], a[16:19], v[160:163]
  ds_read_b64_tr_b16 a[114:115], v12 offset:1024
  v_mfma_f32_16x16x32_bf16 v[164:167], a[84:87], a[20:23], v[164:167]
  ds_read_b64_tr_b16 a[116:117], v12 offset:8192
  v_mfma_f32_16x16x32_bf16 v[164:167], a[80:83], a[4:7], v[164:167]
  buffer_load_dwordx4 v24, s[12:15], s27 offen offset:2048 sc1 lds
  v_mfma_f32_16x16x32_bf16 v[168:171], a[80:83], a[8:11], v[168:171]
  v_mfma_f32_16x16x32_bf16 v[168:171], a[84:87], a[24:27], v[168:171]
  ds_read_b64_tr_b16 a[118:119], v12 offset:9216
  v_mfma_f32_16x16x32_bf16 v[172:175], a[84:87], a[28:31], v[172:175]
  ds_read_b64_tr_b16 a[120:121], v13 offset:0
  v_mfma_f32_16x16x32_bf16 v[172:175], a[80:83], a[12:15], v[172:175]
  ds_read_b64_tr_b16 a[122:123], v13 offset:1024
  v_mfma_f32_16x16x32_bf16 v[188:191], a[88:91], a[12:15], v[188:191]
  buffer_load_dwordx4 v25, s[12:15], s27 offen offset:3072 sc1 lds
  v_mfma_f32_16x16x32_bf16 v[188:191], a[92:95], a[28:31], v[188:191]
  ds_read_b64_tr_b16 a[124:125], v13 offset:8192
  v_mfma_f32_16x16x32_bf16 v[184:187], a[92:95], a[24:27], v[184:187]
  ds_read_b64_tr_b16 a[126:127], v13 offset:9216
  v_mfma_f32_16x16x32_bf16 v[184:187], a[88:91], a[8:11], v[184:187]
  v_mfma_f32_16x16x32_bf16 v[180:183], a[88:91], a[4:7], v[180:183]
  v_mfma_f32_16x16x32_bf16 v[180:183], a[92:95], a[20:23], v[180:183]
  v_mfma_f32_16x16x32_bf16 v[176:179], a[92:95], a[16:19], v[176:179]
  s_add_u32 s26, s26, 128
  v_mfma_f32_16x16x32_bf16 v[176:179], a[88:91], a[0:3], v[176:179]
  s_add_u32 s27, s27, s34
  s_xor_b32 s34, s34, s92
  s_waitcnt lgkmcnt(0) vmcnt(12)
  s_barrier
  v_mfma_f32_16x16x32_bf16 v[192:195], a[96:99], a[0:3], v[192:195]
  s_add_u32 m0, s28, 0
  ds_read_b64_tr_b16 a[64:65], v6 offset:16384
  v_mfma_f32_16x16x32_bf16 v[192:195], a[100:103], a[16:19], v[192:195]
  buffer_load_dwordx4 v14, s[8:11], s26 offen offset:0 sc1 lds
  v_mfma_f32_16x16x32_bf16 v[196:199], a[100:103], a[20:23], v[196:199]
  ds_read_b64_tr_b16 a[66:67], v6 offset:17408
  v_mfma_f32_16x16x32_bf16 v[196:199], a[96:99], a[4:7], v[196:199]
  ds_read_b64_tr_b16 a[68:69], v6 offset:24576
  v_mfma_f32_16x16x32_bf16 v[200:203], a[96:99], a[8:11], v[200:203]
  ds_read_b64_tr_b16 a[70:71], v6 offset:25600
  v_mfma_f32_16x16x32_bf16 v[200:203], a[100:103], a[24:27], v[200:203]
  ds_read_b128 a[32:35], v2 offset:32768
  v_mfma_f32_16x16x32_bf16 v[204:207], a[100:103], a[28:31], v[204:207]
  buffer_load_dwordx4 v15, s[8:11], s26 offen offset:1024 sc1 lds
  v_mfma_f32_16x16x32_bf16 v[204:207], a[96:99], a[12:15], v[204:207]
  ds_read_b128 a[48:51], v3 offset:32768
  ds_read_b128 a[36:39], v2 offset:34816
  v_mfma_f32_16x16x32_bf16 v[220:223], a[104:107], a[12:15], v[220:223]
  ds_read_b128 a[52:55], v3 offset:34816
  v_mfma_f32_16x16x32_bf16 v[220:223], a[108:111], a[28:31], v[220:223]
  ds_read_b128 a[40:43], v2 offset:36864
  v_mfma_f32_16x16x32_bf16 v[216:219], a[108:111], a[24:27], v[216:219]
  buffer_load_dwordx4 v16, s[8:11], s26 offen offset:2048 sc1 lds
  v_mfma_f32_16x16x32_bf16 v[216:219], a[104:107], a[8:11], v[216:219]
  ds_read_b128 a[56:59], v3 offset:36864
  v_mfma_f32_16x16x32_bf16 v[212:215], a[104:107], a[4:7], v[212:215]
  ds_read_b128 a[44:47], v2 offset:38912
  v_mfma_f32_16x16x32_bf16 v[212:215], a[108:111], a[20:23], v[212:215]
  ds_read_b128 a[60:63], v3 offset:38912
  v_mfma_f32_16x16x32_bf16 v[208:211], a[108:111], a[16:19], v[208:211]
  ds_read_b64_tr_b16 a[72:73], v7 offset:16384
  buffer_load_dwordx4 v17, s[8:11], s26 offen offset:3072 sc1 lds
  v_mfma_f32_16x16x32_bf16 v[208:211], a[104:107], a[0:3], v[208:211]
  ds_read_b64_tr_b16 a[74:75], v7 offset:17408
  v_mfma_f32_16x16x32_bf16 v[224:227], a[112:115], a[0:3], v[224:227]
  ds_read_b64_tr_b16 a[76:77], v7 offset:24576
  v_mfma_f32_16x16x32_bf16 v[224:227], a[116:119], a[16:19], v[224:227]
  ds_read_b64_tr_b16 a[78:79], v7 offset:25600
  v_mfma_f32_16x16x32_bf16 v[228:231], a[116:119], a[20:23], v[228:231]
  s_add_u32 m0, s28, 4096
  v_mfma_f32_16x16x32_bf16 v[228:231], a[112:115], a[4:7], v[228:231]
  ds_read_b64_tr_b16 a[80:81], v8 offset:16384
  v_mfma_f32_16x16x32_bf16 v[232:235], a[112:115], a[8:11], v[232:235]
  buffer_load_dwordx4 v18, s[8:11], s26 offen offset:0 sc1 lds
  v_mfma_f32_16x16x32_bf16 v[232:235], a[116:119], a[24:27], v[232:235]
  ds_read_b64_tr_b16 a[82:83], v8 offset:17408
  ds_read_b64_tr_b16 a[84:85], v8 offset:24576
  v_mfma_f32_16x16x32_bf16 v[236:239], a[116:119], a[28:31], v[236:239]
  ds_read_b64_tr_b16 a[86:87], v8 offset:25600
  v_mfma_f32_16x16x32_bf16 v[236:239], a[112:115], a[12:15], v[236:239]
  ds_read_b64_tr_b16 a[88:89], v9 offset:16384
  v_mfma_f32_16x16x32_bf16 v[252:255], a[120:123], a[12:15], v[252:255]
  buffer_load_dwordx4 v19, s[8:11], s26 offen offset:1024 sc1 lds
  v_mfma_f32_16x16x32_bf16 v[252:255], a[124:127], a[28:31], v[252:255]
  ds_read_b64_tr_b16 a[90:91], v9 offset:17408
  v_mfma_f32_16x16x32_bf16 v[248:251], a[124:127], a[24:27], v[248:251]
  ds_read_b64_tr_b16 a[92:93], v9 offset:24576
  v_mfma_f32_16x16x32_bf16 v[248:251], a[120:123], a[8:11], v[248:251]
  ds_read_b64_tr_b16 a[94:95], v9 offset:25600
  v_mfma_f32_16x16x32_bf16 v[244:247], a[120:123], a[4:7], v[244:247]
  v_mfma_f32_16x16x32_bf16 v[244:247], a[124:127], a[20:23], v[244:247]
  v_mfma_f32_16x16x32_bf16 v[240:243], a[124:127], a[16:19], v[240:243]
  v_mfma_f32_16x16x32_bf16 v[240:243], a[120:123], a[0:3], v[240:243]
  s_waitcnt lgkmcnt(0)
  v_mfma_f32_16x16x32_bf16 v[128:131], a[64:67], a[32:35], v[128:131]
  s_add_u32 m0, s28, 4096
  v_mfma_f32_16x16x32_bf16 v[128:131], a[68:71], a[48:51], v[128:131]
  ds_read_b64_tr_b16 a[96:97], v10 offset:16384
  v_mfma_f32_16x16x32_bf16 v[132:135], a[68:71], a[52:55], v[132:135]
  buffer_load_dwordx4 v20, s[8:11], s26 offen offset:2048 sc1 lds
  v_mfma_f32_16x16x32_bf16 v[132:135], a[64:67], a[36:39], v[132:135]
  ds_read_b64_tr_b16 a[98:99], v10 offset:17408
  v_mfma_f32_16x16x32_bf16 v[136:139], a[64:67], a[40:43], v[136:139]
  ds_read_b64_tr_b16 a[100:101], v10 offset:24576
  v_mfma_f32_16x16x32_bf16 v[136:139], a[68:71], a[56:59], v[136:139]
  buffer_load_dwordx4 v21, s[8:11], s26 offen offset:3072 sc1 lds
  v_mfma_f32_16x16x32_bf16 v[140:143], a[68:71], a[60:63], v[140:143]
  v_mfma_f32_16x16x32_bf16 v[140:143], a[64:67], a[44:47], v[140:143]
  ds_read_b64_tr_b16 a[102:103], v10 offset:25600
  v_mfma_f32_16x16x32_bf16 v[156:159], a[72:75], a[44:47], v[156:159]
  ds_read_b64_tr_b16 a[104:105], v11 offset:16384
  v_mfma_f32_16x16x32_bf16 v[156:159], a[76:79], a[60:63], v[156:159]
  s_add_u32 m0, s29, 0
  v_mfma_f32_16x16x32_bf16 v[152:155], a[76:79], a[56:59], v[152:155]
  ds_read_b64_tr_b16 a[106:107], v11 offset:17408
  v_mfma_f32_16x16x32_bf16 v[152:155], a[72:75], a[40:43], v[152:155]
  buffer_load_dwordx4 v22, s[12:15], s27 offen offset:0 sc1 lds
  v_mfma_f32_16x16x32_bf16 v[148:151], a[72:75], a[36:39], v[148:151]
  ds_read_b64_tr_b16 a[108:109], v11 offset:24576
  v_mfma_f32_16x16x32_bf16 v[148:151], a[76:79], a[52:55], v[148:151]
  v_mfma_f32_16x16x32_bf16 v[144:147], a[76:79], a[48:51], v[144:147]
  ds_read_b64_tr_b16 a[110:111], v11 offset:25600
  v_mfma_f32_16x16x32_bf16 v[144:147], a[72:75], a[32:35], v[144:147]
  ds_read_b64_tr_b16 a[112:113], v12 offset:16384
  v_mfma_f32_16x16x32_bf16 v[160:163], a[80:83], a[32:35], v[160:163]
  buffer_load_dwordx4 v23, s[12:15], s27 offen offset:1024 sc1 lds
  v_mfma_f32_16x16x32_bf16 v[160:163], a[84:87], a[48:51], v[160:163]
  ds_read_b64_tr_b16 a[114:115], v12 offset:17408
  v_mfma_f32_16x16x32_bf16 v[164:167], a[84:87], a[52:55], v[164:167]
  ds_read_b64_tr_b16 a[116:117], v12 offset:24576
  v_mfma_f32_16x16x32_bf16 v[164:167], a[80:83], a[36:39], v[164:167]
  buffer_load_dwordx4 v24, s[12:15], s27 offen offset:2048 sc1 lds
  v_mfma_f32_16x16x32_bf16 v[168:171], a[80:83], a[40:43], v[168:171]
  v_mfma_f32_16x16x32_bf16 v[168:171], a[84:87], a[56:59], v[168:171]
  ds_read_b64_tr_b16 a[118:119], v12 offset:25600
  v_mfma_f32_16x16x32_bf16 v[172:175], a[84:87], a[60:63], v[172:175]
  ds_read_b64_tr_b16 a[120:121], v13 offset:16384
  v_mfma_f32_16x16x32_bf16 v[172:175], a[80:83], a[44:47], v[172:175]
  ds_read_b64_tr_b16 a[122:123], v13 offset:17408
  v_mfma_f32_16x16x32_bf16 v[188:191], a[88:91], a[44:47], v[188:191]
  buffer_load_dwordx4 v25, s[12:15], s27 offen offset:3072 sc1 lds
  v_mfma_f32_16x16x32_bf16 v[188:191], a[92:95], a[60:63], v[188:191]
  ds_read_b64_tr_b16 a[124:125], v13 offset:24576
  v_mfma_f32_16x16x32_bf16 v[184:187], a[92:95], a[56:59], v[184:187]
  ds_read_b64_tr_b16 a[126:127], v13 offset:25600
  v_mfma_f32_16x16x32_bf16 v[184:187], a[88:91], a[40:43], v[184:187]
  v_mfma_f32_16x16x32_bf16 v[180:183], a[88:91], a[36:39], v[180:183]
  v_mfma_f32_16x16x32_bf16 v[180:183], a[92:95], a[52:55], v[180:183]
  v_mfma_f32_16x16x32_bf16 v[176:179], a[92:95], a[48:51], v[176:179]
  s_add_u32 s26, s26, 128
  v_mfma_f32_16x16x32_bf16 v[176:179], a[88:91], a[32:35], v[176:179]
  s_add_u32 s27, s27, s34
  s_xor_b32 s34, s34, s92
  s_waitcnt lgkmcnt(0) vmcnt(12)
  s_barrier
  v_mfma_f32_16x16x32_bf16 v[192:195], a[96:99], a[32:35], v[192:195]
  s_add_u32 m0, s28, 32768
  ds_read_b64_tr_b16 a[64:65], v6 offset:32768
  v_mfma_f32_16x16x32_bf16 v[192:195], a[100:103], a[48:51], v[192:195]
  buffer_load_dwordx4 v14, s[8:11], s26 offen offset:0 sc1 lds
  v_mfma_f32_16x16x32_bf16 v[196:199], a[100:103], a[52:55], v[196:199]
  ds_read_b64_tr_b16 a[66:67], v6 offset:33792
  v_mfma_f32_16x16x32_bf16 v[196:199], a[96:99], a[36:39], v[196:199]
  ds_read_b64_tr_b16 a[68:69], v6 offset:40960
  v_mfma_f32_16x16x32_bf16 v[200:203], a[96:99], a[40:43], v[200:203]
  ds_read_b64_tr_b16 a[70:71], v6 offset:41984
  v_mfma_f32_16x16x32_bf16 v[200:203], a[100:103], a[56:59], v[200:203]
  ds_read_b128 a[0:3], v4 offset:0
  v_mfma_f32_16x16x32_bf16 v[204:207], a[100:103], a[60:63], v[204:207]
  buffer_load_dwordx4 v15, s[8:11], s26 offen offset:1024 sc1 lds
  v_mfma_f32_16x16x32_bf16 v[204:207], a[96:99], a[44:47], v[204:207]
  ds_read_b128 a[16:19], v5 offset:0
  ds_read_b128 a[4:7], v4 offset:2048
  v_mfma_f32_16x16x32_bf16 v[220:223], a[104:107], a[44:47], v[220:223]
  ds_read_b128 a[20:23], v5 offset:2048
  v_mfma_f32_16x16x32_bf16 v[220:223], a[108:111], a[60:63], v[220:223]
  ds_read_b128 a[8:11], v4 offset:4096
  v_mfma_f32_16x16x32_bf16 v[216:219], a[108:111], a[56:59], v[216:219]
  buffer_load_dwordx4 v16, s[8:11], s26 offen offset:2048 sc1 lds
  v_mfma_f32_16x16x32_bf16 v[216:219], a[104:107], a[40:43], v[216:219]
  ds_read_b128 a[24:27], v5 offset:4096
  v_mfma_f32_16x16x32_bf16 v[212:215], a[104:107], a[36:39], v[212:215]
  ds_read_b128 a[12:15], v4 offset:6144
  v_mfma_f32_16x16x32_bf16 v[212:215], a[108:111], a[52:55], v[212:215]
  ds_read_b128 a[28:31], v5 offset:6144
  v_mfma_f32_16x16x32_bf16 v[208:211], a[108:111], a[48:51], v[208:211]
  ds_read_b64_tr_b16 a[72:73], v7 offset:32768
  buffer_load_dwordx4 v17, s[8:11], s26 offen offset:3072 sc1 lds
  v_mfma_f32_16x16x32_bf16 v[208:211], a[104:107], a[32:35], v[208:211]
  ds_read_b64_tr_b16 a[74:75], v7 offset:33792
  v_mfma_f32_16x16x32_bf16 v[224:227], a[112:115], a[32:35], v[224:227]
  ds_read_b64_tr_b16 a[76:77], v7 offset:40960
  v_mfma_f32_16x16x32_bf16 v[224:227], a[116:119], a[48:51], v[224:227]
  ds_read_b64_tr_b16 a[78:79], v7 offset:41984
  v_mfma_f32_16x16x32_bf16 v[228:231], a[116:119], a[52:55], v[228:231]
  s_add_u32 m0, s28, 36864
  v_mfma_f32_16x16x32_bf16 v[228:231], a[112:115], a[36:39], v[228:231]
  ds_read_b64_tr_b16 a[80:81], v8 offset:32768
  v_mfma_f32_16x16x32_bf16 v[232:235], a[112:115], a[40:43], v[232:235]
  buffer_load_dwordx4 v18, s[8:11], s26 offen offset:0 sc1 lds
  v_mfma_f32_16x16x32_bf16 v[232:235], a[116:119], a[56:59], v[232:235]
  ds_read_b64_tr_b16 a[82:83], v8 offset:33792
  ds_read_b64_tr_b16 a[84:85], v8 offset:40960
  v_mfma_f32_16x16x32_bf16 v[236:239], a[116:119], a[60:63], v[236:239]
  ds_read_b64_tr_b16 a[86:87], v8 offset:41984
  v_mfma_f32_16x16x32_bf16 v[236:239], a[112:115], a[44:47], v[236:239]
  ds_read_b64_tr_b16 a[88:89], v9 offset:32768
  v_mfma_f32_16x16x32_bf16 v[252:255], a[120:123], a[44:47], v[252:255]
  buffer_load_dwordx4 v19, s[8:11], s26 offen offset:1024 sc1 lds
  v_mfma_f32_16x16x32_bf16 v[252:255], a[124:127], a[60:63], v[252:255]
  ds_read_b64_tr_b16 a[90:91], v9 offset:33792
  v_mfma_f32_16x16x32_bf16 v[248:251], a[124:127], a[56:59], v[248:251]
  ds_read_b64_tr_b16 a[92:93], v9 offset:40960
  v_mfma_f32_16x16x32_bf16 v[248:251], a[120:123], a[40:43], v[248:251]
  ds_read_b64_tr_b16 a[94:95], v9 offset:41984
  v_mfma_f32_16x16x32_bf16 v[244:247], a[120:123], a[36:39], v[244:247]
  v_mfma_f32_16x16x32_bf16 v[244:247], a[124:127], a[52:55], v[244:247]
  v_mfma_f32_16x16x32_bf16 v[240:243], a[124:127], a[48:51], v[240:243]
  v_mfma_f32_16x16x32_bf16 v[240:243], a[120:123], a[32:35], v[240:243]
  s_waitcnt lgkmcnt(0)
  v_mfma_f32_16x16x32_bf16 v[128:131], a[64:67], a[0:3], v[128:131]
  s_add_u32 m0, s28, 36864
  v_mfma_f32_16x16x32_bf16 v[128:131], a[68:71], a[16:19], v[128:131]
  ds_read_b64_tr_b16 a[96:97], v10 offset:32768
  v_mfma_f32_16x16x32_bf16 v[132:135], a[68:71], a[20:23], v[132:135]
  buffer_load_dwordx4 v20, s[8:11], s26 offen offset:2048 sc1 lds
  v_mfma_f32_16x16x32_bf16 v[132:135], a[64:67], a[4:7], v[132:135]
  ds_read_b64_tr_b16 a[98:99], v10 offset:33792
  v_mfma_f32_16x16x32_bf16 v[136:139], a[64:67], a[8:11], v[136:139]
  ds_read_b64_tr_b16 a[100:101], v10 offset:40960
  v_mfma_f32_16x16x32_bf16 v[136:139], a[68:71], a[24:27], v[136:139]
  buffer_load_dwordx4 v21, s[8:11], s26 offen offset:3072 sc1 lds
  v_mfma_f32_16x16x32_bf16 v[140:143], a[68:71], a[28:31], v[140:143]
  ds_read_b64_tr_b16 a[102:103], v10 offset:41984
  v_mfma_f32_16x16x32_bf16 v[140:143], a[64:67], a[12:15], v[140:143]
  s_add_u32 m0, s29, 16384
  v_mfma_f32_16x16x32_bf16 v[156:159], a[72:75], a[12:15], v[156:159]
  ds_read_b64_tr_b16 a[104:105], v11 offset:32768
  v_mfma_f32_16x16x32_bf16 v[156:159], a[76:79], a[28:31], v[156:159]
  v_mfma_f32_16x16x32_bf16 v[152:155], a[76:79], a[24:27], v[152:155]
  buffer_load_dwordx4 v22, s[12:15], s27 offen offset:0 sc1 lds
  v_mfma_f32_16x16x32_bf16 v[152:155], a[72:75], a[8:11], v[152:155]
  ds_read_b64_tr_b16 a[106:107], v11 offset:33792
  v_mfma_f32_16x16x32_bf16 v[148:151], a[72:75], a[4:7], v[148:151]
  ds_read_b64_tr_b16 a[108:109], v11 offset:40960
  v_mfma_f32_16x16x32_bf16 v[148:151], a[76:79], a[20:23], v[148:151]
  buffer_load_dwordx4 v23, s[12:15], s27 offen offset:1024 sc1 lds
  v_mfma_f32_16x16x32_bf16 v[144:147], a[76:79], a[16:19], v[144:147]
  ds_read_b64_tr_b16 a[110:111], v11 offset:41984
  v_mfma_f32_16x16x32_bf16 v[144:147], a[72:75], a[0:3], v[144:147]
  ds_read_b64_tr_b16 a[112:113], v12 offset:32768
  v_mfma_f32_16x16x32_bf16 v[160:163], a[80:83], a[0:3], v[160:163]
  ds_read_b64_tr_b16 a[114:115], v12 offset:33792
  v_mfma_f32_16x16x32_bf16 v[160:163], a[84:87], a[16:19], v[160:163]
  buffer_load_dwordx4 v24, s[12:15], s27 offen offset:2048 sc1 lds
  v_mfma_f32_16x16x32_bf16 v[164:167], a[84:87], a[20:23], v[164:167]
  v_mfma_f32_16x16x32_bf16 v[164:167], a[80:83], a[4:7], v[164:167]
  ds_read_b64_tr_b16 a[116:117], v12 offset:40960
  v_mfma_f32_16x16x32_bf16 v[168:171], a[80:83], a[8:11], v[168:171]
  ds_read_b64_tr_b16 a[118:119], v12 offset:41984
  v_mfma_f32_16x16x32_bf16 v[168:171], a[84:87], a[24:27], v[168:171]
  buffer_load_dwordx4 v25, s[12:15], s27 offen offset:3072 sc1 lds
  v_mfma_f32_16x16x32_bf16 v[172:175], a[84:87], a[28:31], v[172:175]
  ds_read_b64_tr_b16 a[120:121], v13 offset:32768
  v_mfma_f32_16x16x32_bf16 v[172:175], a[80:83], a[12:15], v[172:175]
  ds_read_b64_tr_b16 a[122:123], v13 offset:33792
  v_mfma_f32_16x16x32_bf16 v[188:191], a[88:91], a[12:15], v[188:191]
  global_load_dword v127, v126, s[70:71] sc1
  v_mfma_f32_16x16x32_bf16 v[188:191], a[92:95], a[28:31], v[188:191]
  ds_read_b64_tr_b16 a[124:125], v13 offset:40960
  v_mfma_f32_16x16x32_bf16 v[184:187], a[92:95], a[24:27], v[184:187]
  ds_read_b64_tr_b16 a[126:127], v13 offset:41984
  v_mfma_f32_16x16x32_bf16 v[184:187], a[88:91], a[8:11], v[184:187]
  v_mfma_f32_16x16x32_bf16 v[180:183], a[88:91], a[4:7], v[180:183]
  v_mfma_f32_16x16x32_bf16 v[180:183], a[92:95], a[20:23], v[180:183]
  v_mfma_f32_16x16x32_bf16 v[176:179], a[92:95], a[16:19], v[176:179]
  s_add_u32 s26, s26, 128
  v_mfma_f32_16x16x32_bf16 v[176:179], a[88:91], a[0:3], v[176:179]
  s_add_u32 s27, s27, s34
  s_xor_b32 s34, s34, s92
  s_waitcnt lgkmcnt(0) vmcnt(13)
  s_barrier
  v_mfma_f32_16x16x32_bf16 v[192:195], a[96:99], a[0:3], v[192:195]
  s_add_u32 m0, s28, 65536
  ds_read_b64_tr_b16 a[64:65], v6 offset:0
  v_mfma_f32_16x16x32_bf16 v[192:195], a[100:103], a[16:19], v[192:195]
  buffer_load_dwordx4 v14, s[8:11], s26 offen offset:0 sc1 lds
  v_mfma_f32_16x16x32_bf16 v[196:199], a[100:103], a[20:23], v[196:199]
  ds_read_b64_tr_b16 a[66:67], v6 offset:1024
  v_mfma_f32_16x16x32_bf16 v[196:199], a[96:99], a[4:7], v[196:199]
  ds_read_b64_tr_b16 a[68:69], v6 offset:8192
  v_mfma_f32_16x16x32_bf16 v[200:203], a[96:99], a[8:11], v[200:203]
  ds_read_b64_tr_b16 a[70:71], v6 offset:9216
  v_mfma_f32_16x16x32_bf16 v[200:203], a[100:103], a[24:27], v[200:203]
  ds_read_b128 a[32:35], v2 offset:0
  v_mfma_f32_16x16x32_bf16 v[204:207], a[100:103], a[28:31], v[204:207]
  buffer_load_dwordx4 v15, s[8:11], s26 offen offset:1024 sc1 lds
  v_mfma_f32_16x16x32_bf16 v[204:207], a[96:99], a[12:15], v[204:207]
  ds_read_b128 a[48:51], v3 offset:0
  ds_read_b128 a[36:39], v2 offset:2048
  v_mfma_f32_16x16x32_bf16 v[220:223], a[104:107], a[12:15], v[220:223]
  ds_read_b128 a[52:55], v3 offset:2048
  v_mfma_f32_16x16x32_bf16 v[220:223], a[108:111], a[28:31], v[220:223]
  ds_read_b128 a[40:43], v2 offset:4096
  v_mfma_f32_16x16x32_bf16 v[216:219], a[108:111], a[24:27], v[216:219]
  buffer_load_dwordx4 v16, s[8:11], s26 offen offset:2048 sc1 lds
  v_mfma_f32_16x16x32_bf16 v[216:219], a[104:107], a[8:11], v[216:219]
  ds_read_b128 a[56:59], v3 offset:4096
  v_mfma_f32_16x16x32_bf16 v[212:215], a[104:107], a[4:7], v[212:215]
  ds_read_b128 a[44:47], v2 offset:6144
  v_mfma_f32_16x16x32_bf16 v[212:215], a[108:111], a[20:23], v[212:215]
  ds_read_b128 a[60:63], v3 offset:6144
  v_mfma_f32_16x16x32_bf16 v[208:211], a[108:111], a[16:19], v[208:211]
  ds_read_b64_tr_b16 a[72:73], v7 offset:0
  buffer_load_dwordx4 v17, s[8:11], s26 offen offset:3072 sc1 lds
  v_mfma_f32_16x16x32_bf16 v[208:211], a[104:107], a[0:3], v[208:211]
  ds_read_b64_tr_b16 a[74:75], v7 offset:1024
  v_mfma_f32_16x16x32_bf16 v[224:227], a[112:115], a[0:3], v[224:227]
  ds_read_b64_tr_b16 a[76:77], v7 offset:8192
  v_mfma_f32_16x16x32_bf16 v[224:227], a[116:119], a[16:19], v[224:227]
  ds_read_b64_tr_b16 a[78:79], v7 offset:9216
  v_mfma_f32_16x16x32_bf16 v[228:231], a[116:119], a[20:23], v[228:231]
  s_add_u32 m0, s28, 69632
  v_mfma_f32_16x16x32_bf16 v[228:231], a[112:115], a[4:7], v[228:231]
  ds_read_b64_tr_b16 a[80:81], v8 offset:0
  v_mfma_f32_16x16x32_bf16 v[232:235], a[112:115], a[8:11], v[232:235]
  buffer_load_dwordx4 v18, s[8:11], s26 offen offset:0 sc1 lds
  v_mfma_f32_16x16x32_bf16 v[232:235], a[116:119], a[24:27], v[232:235]
  ds_read_b64_tr_b16 a[82:83], v8 offset:1024
  ds_read_b64_tr_b16 a[84:85], v8 offset:8192
  v_mfma_f32_16x16x32_bf16 v[236:239], a[116:119], a[28:31], v[236:239]
  ds_read_b64_tr_b16 a[86:87], v8 offset:9216
  v_mfma_f32_16x16x32_bf16 v[236:239], a[112:115], a[12:15], v[236:239]
  ds_read_b64_tr_b16 a[88:89], v9 offset:0
  v_mfma_f32_16x16x32_bf16 v[252:255], a[120:123], a[12:15], v[252:255]
  buffer_load_dwordx4 v19, s[8:11], s26 offen offset:1024 sc1 lds
  v_mfma_f32_16x16x32_bf16 v[252:255], a[124:127], a[28:31], v[252:255]
  ds_read_b64_tr_b16 a[90:91], v9 offset:1024
  v_mfma_f32_16x16x32_bf16 v[248:251], a[124:127], a[24:27], v[248:251]
  ds_read_b64_tr_b16 a[92:93], v9 offset:8192
  v_mfma_f32_16x16x32_bf16 v[248:251], a[120:123], a[8:11], v[248:251]
  ds_read_b64_tr_b16 a[94:95], v9 offset:9216
  v_mfma_f32_16x16x32_bf16 v[244:247], a[120:123], a[4:7], v[244:247]
  v_mfma_f32_16x16x32_bf16 v[244:247], a[124:127], a[20:23], v[244:247]
  v_mfma_f32_16x16x32_bf16 v[240:243], a[124:127], a[16:19], v[240:243]
  v_mfma_f32_16x16x32_bf16 v[240:243], a[120:123], a[0:3], v[240:243]
  s_waitcnt lgkmcnt(0)
  s_sub_u32 s31, s31, 1
  s_cmp_lg_u32 s31, 0
  s_cbranch_scc1 mid_loop_1
  v_mfma_f32_16x16x32_bf16 v[128:131], a[64:67], a[32:35], v[128:131]
  s_add_u32 m0, s28, 69632
  v_mfma_f32_16x16x32_bf16 v[128:131], a[68:71], a[48:51], v[128:131]
  ds_read_b64_tr_b16 a[96:97], v10 offset:0
  v_mfma_f32_16x16x32_bf16 v[132:135], a[68:71], a[52:55], v[132:135]
  buffer_load_dwordx4 v20, s[8:11], s26 offen offset:2048 sc1 lds
  v_mfma_f32_16x16x32_bf16 v[132:135], a[64:67], a[36:39], v[132:135]
  ds_read_b64_tr_b16 a[98:99], v10 offset:1024
  v_mfma_f32_16x16x32_bf16 v[136:139], a[64:67], a[40:43], v[136:139]
  ds_read_b64_tr_b16 a[100:101], v10 offset:8192
  v_mfma_f32_16x16x32_bf16 v[136:139], a[68:71], a[56:59], v[136:139]
  buffer_load_dwordx4 v21, s[8:11], s26 offen offset:3072 sc1 lds
  v_mfma_f32_16x16x32_bf16 v[140:143], a[68:71], a[60:63], v[140:143]
  v_mfma_f32_16x16x32_bf16 v[140:143], a[64:67], a[44:47], v[140:143]
  ds_read_b64_tr_b16 a[102:103], v10 offset:9216
  v_mfma_f32_16x16x32_bf16 v[156:159], a[72:75], a[44:47], v[156:159]
  ds_read_b64_tr_b16 a[104:105], v11 offset:0
  v_mfma_f32_16x16x32_bf16 v[156:159], a[76:79], a[60:63], v[156:159]
  s_add_u32 m0, s29, 32768
  v_mfma_f32_16x16x32_bf16 v[152:155], a[76:79], a[56:59], v[152:155]
  ds_read_b64_tr_b16 a[106:107], v11 offset:1024
  v_mfma_f32_16x16x32_bf16 v[152:155], a[72:75], a[40:43], v[152:155]
  buffer_load_dwordx4 v22, s[12:15], s27 offen offset:0 sc1 lds
  v_mfma_f32_16x16x32_bf16 v[148:151], a[72:75], a[36:39], v[148:151]
  ds_read_b64_tr_b16 a[108:109], v11 offset:8192
  v_mfma_f32_16x16x32_bf16 v[148:151], a[76:79], a[52:55], v[148:151]
  v_mfma_f32_16x16x32_bf16 v[144:147], a[76:79], a[48:51], v[144:147]
  ds_read_b64_tr_b16 a[110:111], v11 offset:9216
  v_mfma_f32_16x16x32_bf16 v[144:147], a[72:75], a[32:35], v[144:147]
  ds_read_b64_tr_b16 a[112:113], v12 offset:0
  v_mfma_f32_16x16x32_bf16 v[160:163], a[80:83], a[32:35], v[160:163]
  buffer_load_dwordx4 v23, s[12:15], s27 offen offset:1024 sc1 lds
  v_mfma_f32_16x16x32_bf16 v[160:163], a[84:87], a[48:51], v[160:163]
  ds_read_b64_tr_b16 a[114:115], v12 offset:1024
  v_mfma_f32_16x16x32_bf16 v[164:167], a[84:87], a[52:55], v[164:167]
  ds_read_b64_tr_b16 a[116:117], v12 offset:8192
  v_mfma_f32_16x16x32_bf16 v[164:167], a[80:83], a[36:39], v[164:167]
  buffer_load_dwordx4 v24, s[12:15], s27 offen offset:2048 sc1 lds
  v_mfma_f32_16x16x32_bf16 v[168:171], a[80:83], a[40:43], v[168:171]
  v_mfma_f32_16x16x32_bf16 v[168:171], a[84:87], a[56:59], v[168:171]
  ds_read_b64_tr_b16 a[118:119], v12 offset:9216
  v_mfma_f32_16x16x32_bf16 v[172:175], a[84:87], a[60:63], v[172:175]
  ds_read_b64_tr_b16 a[120:121], v13 offset:0
  v_mfma_f32_16x16x32_bf16 v[172:175], a[80:83], a[44:47], v[172:175]
  ds_read_b64_tr_b16 a[122:123], v13 offset:1024
  v_mfma_f32_16x16x32_bf16 v[188:191], a[88:91], a[44:47], v[188:191]
  buffer_load_dwordx4 v25, s[12:15], s27 offen offset:3072 sc1 lds
  v_mfma_f32_16x16x32_bf16 v[188:191], a[92:95], a[60:63], v[188:191]
  ds_read_b64_tr_b16 a[124:125], v13 offset:8192
  v_mfma_f32_16x16x32_bf16 v[184:187], a[92:95], a[56:59], v[184:187]
  ds_read_b64_tr_b16 a[126:127], v13 offset:9216
  v_mfma_f32_16x16x32_bf16 v[184:187], a[88:91], a[40:43], v[184:187]
  v_mfma_f32_16x16x32_bf16 v[180:183], a[88:91], a[36:39], v[180:183]
  v_mfma_f32_16x16x32_bf16 v[180:183], a[92:95], a[52:55], v[180:183]
  v_mfma_f32_16x16x32_bf16 v[176:179], a[92:95], a[48:51], v[176:179]
  s_add_u32 s26, s26, 128
  v_mfma_f32_16x16x32_bf16 v[176:179], a[88:91], a[32:35], v[176:179]
  s_add_u32 s27, s27, s34
  s_xor_b32 s34, s34, s92
  s_add_u32 s27, s27, s93
  s_waitcnt lgkmcnt(0) vmcnt(12)
  s_barrier
  v_readfirstlane_b32 s43, v127
  s_nop 3
  s_cmp_ge_u32 s43, s89
  s_cbranch_scc0 mid_opoll
mid_opoll_ret:
  v_mfma_f32_16x16x32_bf16 v[192:195], a[96:99], a[32:35], v[192:195]
  s_add_u32 m0, s28, 0
  ds_read_b64_tr_b16 a[64:65], v6 offset:16384
  v_mfma_f32_16x16x32_bf16 v[192:195], a[100:103], a[48:51], v[192:195]
  buffer_load_dwordx4 v14, s[8:11], s26 offen offset:0 sc1 lds
  v_mfma_f32_16x16x32_bf16 v[196:199], a[100:103], a[52:55], v[196:199]
  ds_read_b64_tr_b16 a[66:67], v6 offset:17408
  v_mfma_f32_16x16x32_bf16 v[196:199], a[96:99], a[36:39], v[196:199]
  ds_read_b64_tr_b16 a[68:69], v6 offset:24576
  v_mfma_f32_16x16x32_bf16 v[200:203], a[96:99], a[40:43], v[200:203]
  ds_read_b64_tr_b16 a[70:71], v6 offset:25600
  v_mfma_f32_16x16x32_bf16 v[200:203], a[100:103], a[56:59], v[200:203]
  ds_read_b128 a[0:3], v2 offset:32768
  v_mfma_f32_16x16x32_bf16 v[204:207], a[100:103], a[60:63], v[204:207]
  buffer_load_dwordx4 v15, s[8:11], s26 offen offset:1024 sc1 lds
  v_mfma_f32_16x16x32_bf16 v[204:207], a[96:99], a[44:47], v[204:207]
  ds_read_b128 a[16:19], v3 offset:32768
  ds_read_b128 a[4:7], v2 offset:34816
  v_mfma_f32_16x16x32_bf16 v[220:223], a[104:107], a[44:47], v[220:223]
  ds_read_b128 a[20:23], v3 offset:34816
  v_mfma_f32_16x16x32_bf16 v[220:223], a[108:111], a[60:63], v[220:223]
  ds_read_b128 a[8:11], v2 offset:36864
  v_mfma_f32_16x16x32_bf16 v[216:219], a[108:111], a[56:59], v[216:219]
  buffer_load_dwordx4 v16, s[8:11], s26 offen offset:2048 sc1 lds
  v_mfma_f32_16x16x32_bf16 v[216:219], a[104:107], a[40:43], v[216:219]
  ds_read_b128 a[24:27], v3 offset:36864
  v_mfma_f32_16x16x32_bf16 v[212:215], a[104:107], a[36:39], v[212:215]
  ds_read_b128 a[12:15], v2 offset:38912
  v_mfma_f32_16x16x32_bf16 v[212:215], a[108:111], a[52:55], v[212:215]
  ds_read_b128 a[28:31], v3 offset:38912
  v_mfma_f32_16x16x32_bf16 v[208:211], a[108:111], a[48:51], v[208:211]
  ds_read_b64_tr_b16 a[72:73], v7 offset:16384
  buffer_load_dwordx4 v17, s[8:11], s26 offen offset:3072 sc1 lds
  v_mfma_f32_16x16x32_bf16 v[208:211], a[104:107], a[32:35], v[208:211]
  ds_read_b64_tr_b16 a[74:75], v7 offset:17408
  v_mfma_f32_16x16x32_bf16 v[224:227], a[112:115], a[32:35], v[224:227]
  ds_read_b64_tr_b16 a[76:77], v7 offset:24576
  v_mfma_f32_16x16x32_bf16 v[224:227], a[116:119], a[48:51], v[224:227]
  ds_read_b64_tr_b16 a[78:79], v7 offset:25600
  v_mfma_f32_16x16x32_bf16 v[228:231], a[116:119], a[52:55], v[228:231]
  s_add_u32 m0, s28, 4096
  v_mfma_f32_16x16x32_bf16 v[228:231], a[112:115], a[36:39], v[228:231]
  ds_read_b64_tr_b16 a[80:81], v8 offset:16384
  v_mfma_f32_16x16x32_bf16 v[232:235], a[112:115], a[40:43], v[232:235]
  buffer_load_dwordx4 v18, s[8:11], s26 offen offset:0 sc1 lds
  v_mfma_f32_16x16x32_bf16 v[232:235], a[116:119], a[56:59], v[232:235]
  ds_read_b64_tr_b16 a[82:83], v8 offset:17408
  ds_read_b64_tr_b16 a[84:85], v8 offset:24576
  v_mfma_f32_16x16x32_bf16 v[236:239], a[116:119], a[60:63], v[236:239]
  ds_read_b64_tr_b16 a[86:87], v8 offset:25600
  v_mfma_f32_16x16x32_bf16 v[236:239], a[112:115], a[44:47], v[236:239]
  ds_read_b64_tr_b16 a[88:89], v9 offset:16384
  v_mfma_f32_16x16x32_bf16 v[252:255], a[120:123], a[44:47], v[252:255]
  buffer_load_dwordx4 v19, s[8:11], s26 offen offset:1024 sc1 lds
  v_mfma_f32_16x16x32_bf16 v[252:255], a[124:127], a[60:63], v[252:255]
  ds_read_b64_tr_b16 a[90:91], v9 offset:17408
  v_mfma_f32_16x16x32_bf16 v[248:251], a[124:127], a[56:59], v[248:251]
  ds_read_b64_tr_b16 a[92:93], v9 offset:24576
  v_mfma_f32_16x16x32_bf16 v[248:251], a[120:123], a[40:43], v[248:251]
  ds_read_b64_tr_b16 a[94:95], v9 offset:25600
  v_mfma_f32_16x16x32_bf16 v[244:247], a[120:123], a[36:39], v[244:247]
  v_mfma_f32_16x16x32_bf16 v[244:247], a[124:127], a[52:55], v[244:247]
  v_mfma_f32_16x16x32_bf16 v[240:243], a[124:127], a[48:51], v[240:243]
  v_mfma_f32_16x16x32_bf16 v[240:243], a[120:123], a[32:35], v[240:243]
  s_waitcnt lgkmcnt(0)
  s_mov_b32 s31, 2
  .p2align 6
mid_loop_2:
  v_mfma_f32_16x16x32_bf16 v[128:131], a[64:67], a[0:3], v[128:131]
  s_add_u32 m0, s28, 4096
  v_mfma_f32_16x16x32_bf16 v[128:131], a[68:71], a[16:19], v[128:131]
  ds_read_b64_tr_b16 a[96:97], v10 offset:16384
  v_mfma_f32_16x16x32_bf16 v[132:135], a[68:71], a[20:23], v[132:135]
  buffer_load_dwordx4 v20, s[8:11], s26 offen offset:2048 sc1 lds
  v_mfma_f32_16x16x32_bf16 v[132:135], a[64:67], a[4:7], v[132:135]
  ds_read_b64_tr_b16 a[98:99], v10 offset:17408
  v_mfma_f32_16x16x32_bf16 v[136:139], a[64:67], a[8:11], v[136:139]
  ds_read_b64_tr_b16 a[100:101], v10 offset:24576
  v_mfma_f32_16x16x32_bf16 v[136:139], a[68:71], a[24:27], v[136:139]
  buffer_load_dwordx4 v21, s[8:11], s26 offen offset:3072 sc1 lds
  v_mfma_f32_16x16x32_bf16 v[140:143], a[68:71], a[28:31], v[140:143]
  v_mfma_f32_16x16x32_bf16 v[140:143], a[64:67], a[12:15], v[140:143]
  ds_read_b64_tr_b16 a[102:103], v10 offset:25600
  v_mfma_f32_16x16x32_bf16 v[156:159], a[72:75], a[12:15], v[156:159]
  ds_read_b64_tr_b16 a[104:105], v11 offset:16384
  v_mfma_f32_16x16x32_bf16 v[156:159], a[76:79], a[28:31], v[156:159]
  s_add_u32 m0, s29, 0
  v_mfma_f32_16x16x32_bf16 v[152:155], a[76:79], a[24:27], v[152:155]
  ds_read_b64_tr_b16 a[106:107], v11 offset:17408
  v_mfma_f32_16x16x32_bf16 v[152:155], a[72:75], a[8:11], v[152:155]
  buffer_load_dwordx4 v22, s[12:15], s27 offen offset:0 sc1 lds
  v_mfma_f32_16x16x32_bf16 v[148:151], a[72:75], a[4:7], v[148:151]
  ds_read_b64_tr_b16 a[108:109], v11 offset:24576
  v_mfma_f32_16x16x32_bf16 v[148:151], a[76:79], a[20:23], v[148:151]
  v_mfma_f32_16x16x32_bf16 v[144:147], a[76:79], a[16:19], v[144:147]
  ds_read_b64_tr_b16 a[110:111], v11 offset:25600
  v_mfma_f32_16x16x32_bf16 v[144:147], a[72:75], a[0:3], v[144:147]
  ds_read_b64_tr_b16 a[112:113], v12 offset:16384
  v_mfma_f32_16x16x32_bf16 v[160:163], a[80:83], a[0:3], v[160:163]
  buffer_load_dwordx4 v23, s[12:15], s27 offen offset:1024 sc1 lds
  v_mfma_f32_16x16x32_bf16 v[160:163], a[84:87], a[16:19], v[160:163]
  ds_read_b64_tr_b16 a[114:115], v12 offset:17408
  v_mfma_f32_16x16x32_bf16 v[164:167], a[84:87], a[20:23], v[164:167]
  ds_read_b64_tr_b16 a[116:117], v12 offset:24576
  v_mfma_f32_16x16x32_bf16 v[164:167], a[80:83], a[4:7], v[164:167]
  buffer_load_dwordx4 v24, s[12:15], s27 offen offset:2048 sc1 lds
  v_mfma_f32_16x16x32_bf16 v[168:171], a[80:83], a[8:11], v[168:171]
  v_mfma_f32_16x16x32_bf16 v[168:171], a[84:87], a[24:27], v[168:171]
  ds_read_b64_tr_b16 a[118:119], v12 offset:25600
  v_mfma_f32_16x16x32_bf16 v[172:175], a[84:87], a[28:31], v[172:175]
  ds_read_b64_tr_b16 a[120:121], v13 offset:16384
  v_mfma_f32_16x16x32_bf16 v[172:175], a[80:83], a[12:15], v[172:175]
  ds_read_b64_tr_b16 a[122:123], v13 offset:17408
  v_mfma_f32_16x16x32_bf16 v[188:191], a[88:91], a[12:15], v[188:191]
  buffer_load_dwordx4 v25, s[12:15], s27 offen offset:3072 sc1 lds
  v_mfma_f32_16x16x32_bf16 v[188:191], a[92:95], a[28:31], v[188:191]
  ds_read_b64_tr_b16 a[124:125], v13 offset:24576
  v_mfma_f32_16x16x32_bf16 v[184:187], a[92:95], a[24:27], v[184:187]
  ds_read_b64_tr_b16 a[126:127], v13 offset:25600
  v_mfma_f32_16x16x32_bf16 v[184:187], a[88:91], a[8:11], v[184:187]
  v_mfma_f32_16x16x32_bf16 v[180:183], a[88:91], a[4:7], v[180:183]
  v_mfma_f32_16x16x32_bf16 v[180:183], a[92:95], a[20:23], v[180:183]
  v_mfma_f32_16x16x32_bf16 v[176:179], a[92:95], a[16:19], v[176:179]
  s_add_u32 s26, s26, 128
  v_mfma_f32_16x16x32_bf16 v[176:179], a[88:91], a[0:3], v[176:179]
  s_add_u32 s27, s27, s34
  s_xor_b32 s34, s34, s92
  s_waitcnt lgkmcnt(0) vmcnt(12)
  s_barrier
  v_mfma_f32_16x16x32_bf16 v[192:195], a[96:99], a[0:3], v[192:195]
  s_add_u32 m0, s28, 32768
  ds_read_b64_tr_b16 a[64:65], v6 offset:32768
  v_mfma_f32_16x16x32_bf16 v[192:195], a[100:103], a[16:19], v[192:195]
  buffer_load_dwordx4 v14, s[8:11], s26 offen offset:0 sc1 lds
  v_mfma_f32_16x16x32_bf16 v[196:199], a[100:103], a[20:23], v[196:199]
  ds_read_b64_tr_b16 a[66:67], v6 offset:33792
  v_mfma_f32_16x16x32_bf16 v[196:199], a[96:99], a[4:7], v[196:199]
  ds_read_b64_tr_b16 a[68:69], v6 offset:40960
  v_mfma_f32_16x16x32_bf16 v[200:203], a[96:99], a[8:11], v[200:203]
  ds_read_b64_tr_b16 a[70:71], v6 offset:41984
  v_mfma_f32_16x16x32_bf16 v[200:203], a[100:103], a[24:27], v[200:203]
  ds_read_b128 a[32:35], v4 offset:0
  v_mfma_f32_16x16x32_bf16 v[204:207], a[100:103], a[28:31], v[204:207]
  buffer_load_dwordx4 v15, s[8:11], s26 offen offset:1024 sc1 lds
  v_mfma_f32_16x16x32_bf16 v[204:207], a[96:99], a[12:15], v[204:207]
  ds_read_b128 a[48:51], v5 offset:0
  ds_read_b128 a[36:39], v4 offset:2048
  v_mfma_f32_16x16x32_bf16 v[220:223], a[104:107], a[12:15], v[220:223]
  ds_read_b128 a[52:55], v5 offset:2048
  v_mfma_f32_16x16x32_bf16 v[220:223], a[108:111], a[28:31], v[220:223]
  ds_read_b128 a[40:43], v4 offset:4096
  v_mfma_f32_16x16x32_bf16 v[216:219], a[108:111], a[24:27], v[216:219]
  buffer_load_dwordx4 v16, s[8:11], s26 offen offset:2048 sc1 lds
  v_mfma_f32_16x16x32_bf16 v[216:219], a[104:107], a[8:11], v[216:219]
  ds_read_b128 a[56:59], v5 offset:4096
  v_mfma_f32_16x16x32_bf16 v[212:215], a[104:107], a[4:7], v[212:215]
  ds_read_b128 a[44:47], v4 offset:6144
  v_mfma_f32_16x16x32_bf16 v[212:215], a[108:111], a[20:23], v[212:215]
  ds_read_b128 a[60:63], v5 offset:6144
  v_mfma_f32_16x16x32_bf16 v[208:211], a[108:111], a[16:19], v[208:211]
  ds_read_b64_tr_b16 a[72:73], v7 offset:32768
  buffer_load_dwordx4 v17, s[8:11], s26 offen offset:3072 sc1 lds
  v_mfma_f32_16x16x32_bf16 v[208:211], a[104:107], a[0:3], v[208:211]
  ds_read_b64_tr_b16 a[74:75], v7 offset:33792
  v_mfma_f32_16x16x32_bf16 v[224:227], a[112:115], a[0:3], v[224:227]
  ds_read_b64_tr_b16 a[76:77], v7 offset:40960
  v_mfma_f32_16x16x32_bf16 v[224:227], a[116:119], a[16:19], v[224:227]
  ds_read_b64_tr_b16 a[78:79], v7 offset:41984
  v_mfma_f32_16x16x32_bf16 v[228:231], a[116:119], a[20:23], v[228:231]
  s_add_u32 m0, s28, 36864
  v_mfma_f32_16x16x32_bf16 v[228:231], a[112:115], a[4:7], v[228:231]
  ds_read_b64_tr_b16 a[80:81], v8 offset:32768
  v_mfma_f32_16x16x32_bf16 v[232:235], a[112:115], a[8:11], v[232:235]
  buffer_load_dwordx4 v18, s[8:11], s26 offen offset:0 sc1 lds
  v_mfma_f32_16x16x32_bf16 v[232:235], a[116:119], a[24:27], v[232:235]
  ds_read_b64_tr_b16 a[82:83], v8 offset:33792
  ds_read_b64_tr_b16 a[84:85], v8 offset:40960
  v_mfma_f32_16x16x32_bf16 v[236:239], a[116:119], a[28:31], v[236:239]
  ds_read_b64_tr_b16 a[86:87], v8 offset:41984
  v_mfma_f32_16x16x32_bf16 v[236:239], a[112:115], a[12:15], v[236:239]
  ds_read_b64_tr_b16 a[88:89], v9 offset:32768
  v_mfma_f32_16x16x32_bf16 v[252:255], a[120:123], a[12:15], v[252:255]
  buffer_load_dwordx4 v19, s[8:11], s26 offen offset:1024 sc1 lds
  v_mfma_f32_16x16x32_bf16 v[252:255], a[124:127], a[28:31], v[252:255]
  ds_read_b64_tr_b16 a[90:91], v9 offset:33792
  v_mfma_f32_16x16x32_bf16 v[248:251], a[124:127], a[24:27], v[248:251]
  ds_read_b64_tr_b16 a[92:93], v9 offset:40960
  v_mfma_f32_16x16x32_bf16 v[248:251], a[120:123], a[8:11], v[248:251]
  ds_read_b64_tr_b16 a[94:95], v9 offset:41984
  v_mfma_f32_16x16x32_bf16 v[244:247], a[120:123], a[4:7], v[244:247]
  v_mfma_f32_16x16x32_bf16 v[244:247], a[124:127], a[20:23], v[244:247]
  v_mfma_f32_16x16x32_bf16 v[240:243], a[124:127], a[16:19], v[240:243]
  v_mfma_f32_16x16x32_bf16 v[240:243], a[120:123], a[0:3], v[240:243]
  s_waitcnt lgkmcnt(0)
  v_mfma_f32_16x16x32_bf16 v[128:131], a[64:67], a[32:35], v[128:131]
  s_add_u32 m0, s28, 36864
  v_mfma_f32_16x16x32_bf16 v[128:131], a[68:71], a[48:51], v[128:131]
  ds_read_b64_tr_b16 a[96:97], v10 offset:32768
  v_mfma_f32_16x16x32_bf16 v[132:135], a[68:71], a[52:55], v[132:135]
  buffer_load_dwordx4 v20, s[8:11], s26 offen offset:2048 sc1 lds
  v_mfma_f32_16x16x32_bf16 v[132:135], a[64:67], a[36:39], v[132:135]
  ds_read_b64_tr_b16 a[98:99], v10 offset:33792
  v_mfma_f32_16x16x32_bf16 v[136:139], a[64:67], a[40:43], v[136:139]
  ds_read_b64_tr_b16 a[100:101], v10 offset:40960
  v_mfma_f32_16x16x32_bf16 v[136:139], a[68:71], a[56:59], v[136:139]
  buffer_load_dwordx4 v21, s[8:11], s26 offen offset:3072 sc1 lds
  v_mfma_f32_16x16x32_bf16 v[140:143], a[68:71], a[60:63], v[140:143]
  v_mfma_f32_16x16x32_bf16 v[140:143], a[64:67], a[44:47], v[140:143]
  ds_read_b64_tr_b16 a[102:103], v10 offset:41984
  v_mfma_f32_16x16x32_bf16 v[156:159], a[72:75], a[44:47], v[156:159]
  ds_read_b64_tr_b16 a[104:105], v11 offset:32768
  v_mfma_f32_16x16x32_bf16 v[156:159], a[76:79], a[60:63], v[156:159]
  s_add_u32 m0, s29, 16384
  v_mfma_f32_16x16x32_bf16 v[152:155], a[76:79], a[56:59], v[152:155]
  ds_read_b64_tr_b16 a[106:107], v11 offset:33792
  v_mfma_f32_16x16x32_bf16 v[152:155], a[72:75], a[40:43], v[152:155]
  buffer_load_dwordx4 v22, s[12:15], s27 offen offset:0 sc1 lds
  v_mfma_f32_16x16x32_bf16 v[148:151], a[72:75], a[36:39], v[148:151]
  ds_read_b64_tr_b16 a[108:109], v11 offset:40960
  v_mfma_f32_16x16x32_bf16 v[148:151], a[76:79], a[52:55], v[148:151]
  v_mfma_f32_16x16x32_bf16 v[144:147], a[76:79], a[48:51], v[144:147]
  ds_read_b64_tr_b16 a[110:111], v11 offset:41984
  v_mfma_f32_16x16x32_bf16 v[144:147], a[72:75], a[32:35], v[144:147]
  ds_read_b64_tr_b16 a[112:113], v12 offset:32768
  v_mfma_f32_16x16x32_bf16 v[160:163], a[80:83], a[32:35], v[160:163]
  buffer_load_dwordx4 v23, s[12:15], s27 offen offset:1024 sc1 lds
  v_mfma_f32_16x16x32_bf16 v[160:163], a[84:87], a[48:51], v[160:163]
  ds_read_b64_tr_b16 a[114:115], v12 offset:33792
  v_mfma_f32_16x16x32_bf16 v[164:167], a[84:87], a[52:55], v[164:167]
  ds_read_b64_tr_b16 a[116:117], v12 offset:40960
  v_mfma_f32_16x16x32_bf16 v[164:167], a[80:83], a[36:39], v[164:167]
  buffer_load_dwordx4 v24, s[12:15], s27 offen offset:2048 sc1 lds
  v_mfma_f32_16x16x32_bf16 v[168:171], a[80:83], a[40:43], v[168:171]
  v_mfma_f32_16x16x32_bf16 v[168:171], a[84:87], a[56:59], v[168:171]
  ds_read_b64_tr_b16 a[118:119], v12 offset:41984
  v_mfma_f32_16x16x32_bf16 v[172:175], a[84:87], a[60:63], v[172:175]
  ds_read_b64_tr_b16 a[120:121], v13 offset:32768
  v_mfma_f32_16x16x32_bf16 v[172:175], a[80:83], a[44:47], v[172:175]
  ds_read_b64_tr_b16 a[122:123], v13 offset:33792
  v_mfma_f32_16x16x32_bf16 v[188:191], a[88:91], a[44:47], v[188:191]
  buffer_load_dwordx4 v25, s[12:15], s27 offen offset:3072 sc1 lds
  v_mfma_f32_16x16x32_bf16 v[188:191], a[92:95], a[60:63], v[188:191]
  ds_read_b64_tr_b16 a[124:125], v13 offset:40960
  v_mfma_f32_16x16x32_bf16 v[184:187], a[92:95], a[56:59], v[184:187]
  ds_read_b64_tr_b16 a[126:127], v13 offset:41984
  v_mfma_f32_16x16x32_bf16 v[184:187], a[88:91], a[40:43], v[184:187]
  v_mfma_f32_16x16x32_bf16 v[180:183], a[88:91], a[36:39], v[180:183]
  v_mfma_f32_16x16x32_bf16 v[180:183], a[92:95], a[52:55], v[180:183]
  v_mfma_f32_16x16x32_bf16 v[176:179], a[92:95], a[48:51], v[176:179]
  s_add_u32 s26, s26, 128
  v_mfma_f32_16x16x32_bf16 v[176:179], a[88:91], a[32:35], v[176:179]
  s_add_u32 s27, s27, s34
  s_xor_b32 s34, s34, s92
  s_waitcnt lgkmcnt(0) vmcnt(12)
  s_barrier
  v_mfma_f32_16x16x32_bf16 v[192:195], a[96:99], a[32:35], v[192:195]
  s_add_u32 m0, s28, 65536
  ds_read_b64_tr_b16 a[64:65], v6 offset:0
  v_mfma_f32_16x16x32_bf16 v[192:195], a[100:103], a[48:51], v[192:195]
  buffer_load_dwordx4 v14, s[8:11], s26 offen offset:0 sc1 lds
  v_mfma_f32_16x16x32_bf16 v[196:199], a[100:103], a[52:55], v[196:199]
  ds_read_b64_tr_b16 a[66:67], v6 offset:1024
  v_mfma_f32_16x16x32_bf16 v[196:199], a[96:99], a[36:39], v[196:199]
  ds_read_b64_tr_b16 a[68:69], v6 offset:8192
  v_mfma_f32_16x16x32_bf16 v[200:203], a[96:99], a[40:43], v[200:203]
  ds_read_b64_tr_b16 a[70:71], v6 offset:9216
  v_mfma_f32_16x16x32_bf16 v[200:203], a[100:103], a[56:59], v[200:203]
  ds_read_b128 a[0:3], v2 offset:0
  v_mfma_f32_16x16x32_bf16 v[204:207], a[100:103], a[60:63], v[204:207]
  buffer_load_dwordx4 v15, s[8:11], s26 offen offset:1024 sc1 lds
  v_mfma_f32_16x16x32_bf16 v[204:207], a[96:99], a[44:47], v[204:207]
  ds_read_b128 a[16:19], v3 offset:0
  ds_read_b128 a[4:7], v2 offset:2048
  v_mfma_f32_16x16x32_bf16 v[220:223], a[104:107], a[44:47], v[220:223]
  ds_read_b128 a[20:23], v3 offset:2048
  v_mfma_f32_16x16x32_bf16 v[220:223], a[108:111], a[60:63], v[220:223]
  ds_read_b128 a[8:11], v2 offset:4096
  v_mfma_f32_16x16x32_bf16 v[216:219], a[108:111], a[56:59], v[216:219]
  buffer_load_dwordx4 v16, s[8:11], s26 offen offset:2048 sc1 lds
  v_mfma_f32_16x16x32_bf16 v[216:219], a[104:107], a[40:43], v[216:219]
  ds_read_b128 a[24:27], v3 offset:4096
  v_mfma_f32_16x16x32_bf16 v[212:215], a[104:107], a[36:39], v[212:215]
  ds_read_b128 a[12:15], v2 offset:6144
  v_mfma_f32_16x16x32_bf16 v[212:215], a[108:111], a[52:55], v[212:215]
  ds_read_b128 a[28:31], v3 offset:6144
  v_mfma_f32_16x16x32_bf16 v[208:211], a[108:111], a[48:51], v[208:211]
  ds_read_b64_tr_b16 a[72:73], v7 offset:0
  buffer_load_dwordx4 v17, s[8:11], s26 offen offset:3072 sc1 lds
  v_mfma_f32_16x16x32_bf16 v[208:211], a[104:107], a[32:35], v[208:211]
  ds_read_b64_tr_b16 a[74:75], v7 offset:1024
  v_mfma_f32_16x16x32_bf16 v[224:227], a[112:115], a[32:35], v[224:227]
  ds_read_b64_tr_b16 a[76:77], v7 offset:8192
  v_mfma_f32_16x16x32_bf16 v[224:227], a[116:119], a[48:51], v[224:227]
  ds_read_b64_tr_b16 a[78:79], v7 offset:9216
  v_mfma_f32_16x16x32_bf16 v[228:231], a[116:119], a[52:55], v[228:231]
  s_add_u32 m0, s28, 69632
  v_mfma_f32_16x16x32_bf16 v[228:231], a[112:115], a[36:39], v[228:231]
  ds_read_b64_tr_b16 a[80:81], v8 offset:0
  v_mfma_f32_16x16x32_bf16 v[232:235], a[112:115], a[40:43], v[232:235]
  buffer_load_dwordx4 v18, s[8:11], s26 offen offset:0 sc1 lds
  v_mfma_f32_16x16x32_bf16 v[232:235], a[116:119], a[56:59], v[232:235]
  ds_read_b64_tr_b16 a[82:83], v8 offset:1024
  ds_read_b64_tr_b16 a[84:85], v8 offset:8192
  v_mfma_f32_16x16x32_bf16 v[236:239], a[116:119], a[60:63], v[236:239]
  ds_read_b64_tr_b16 a[86:87], v8 offset:9216
  v_mfma_f32_16x16x32_bf16 v[236:239], a[112:115], a[44:47], v[236:239]
  ds_read_b64_tr_b16 a[88:89], v9 offset:0
  v_mfma_f32_16x16x32_bf16 v[252:255], a[120:123], a[44:47], v[252:255]
  buffer_load_dwordx4 v19, s[8:11], s26 offen offset:1024 sc1 lds
  v_mfma_f32_16x16x32_bf16 v[252:255], a[124:127], a[60:63], v[252:255]
  ds_read_b64_tr_b16 a[90:91], v9 offset:1024
  v_mfma_f32_16x16x32_bf16 v[248:251], a[124:127], a[56:59], v[248:251]
  ds_read_b64_tr_b16 a[92:93], v9 offset:8192
  v_mfma_f32_16x16x32_bf16 v[248:251], a[120:123], a[40:43], v[248:251]
  ds_read_b64_tr_b16 a[94:95], v9 offset:9216
  v_mfma_f32_16x16x32_bf16 v[244:247], a[120:123], a[36:39], v[244:247]
  v_mfma_f32_16x16x32_bf16 v[244:247], a[124:127], a[52:55], v[244:247]
  v_mfma_f32_16x16x32_bf16 v[240:243], a[124:127], a[48:51], v[240:243]
  v_mfma_f32_16x16x32_bf16 v[240:243], a[120:123], a[32:35], v[240:243]
  s_waitcnt lgkmcnt(0)
  v_mfma_f32_16x16x32_bf16 v[128:131], a[64:67], a[0:3], v[128:131]
  s_add_u32 m0, s28, 69632
  v_mfma_f32_16x16x32_bf16 v[128:131], a[68:71], a[16:19], v[128:131]
  ds_read_b64_tr_b16 a[96:97], v10 offset:0
  v_mfma_f32_16x16x32_bf16 v[132:135], a[68:71], a[20:23], v[132:135]
  buffer_load_dwordx4 v20, s[8:11], s26 offen offset:2048 sc1 lds
  v_mfma_f32_16x16x32_bf16 v[132:135], a[64:67], a[4:7], v[132:135]
  ds_read_b64_tr_b16 a[98:99], v10 offset:1024
  v_mfma_f32_16x16x32_bf16 v[136:139], a[64:67], a[8:11], v[136:139]
  ds_read_b64_tr_b16 a[100:101], v10 offset:8192
  v_mfma_f32_16x16x32_bf16 v[136:139], a[68:71], a[24:27], v[136:139]
  buffer_load_dwordx4 v21, s[8:11], s26 offen offset:3072 sc1 lds
  v_mfma_f32_16x16x32_bf16 v[140:143], a[68:71], a[28:31], v[140:143]
  v_mfma_f32_16x16x32_bf16 v[140:143], a[64:67], a[12:15], v[140:143]
  ds_read_b64_tr_b16 a[102:103], v10 offset:9216
  v_mfma_f32_16x16x32_bf16 v[156:159], a[72:75], a[12:15], v[156:159]
  ds_read_b64_tr_b16 a[104:105], v11 offset:0
  v_mfma_f32_16x16x32_bf16 v[156:159], a[76:79], a[28:31], v[156:159]
  s_add_u32 m0, s29, 32768
  v_mfma_f32_16x16x32_bf16 v[152:155], a[76:79], a[24:27], v[152:155]
  ds_read_b64_tr_b16 a[106:107], v11 offset:1024
  v_mfma_f32_16x16x32_bf16 v[152:155], a[72:75], a[8:11], v[152:155]
  buffer_load_dwordx4 v22, s[12:15], s27 offen offset:0 sc1 lds
  v_mfma_f32_16x16x32_bf16 v[148:151], a[72:75], a[4:7], v[148:151]
  ds_read_b64_tr_b16 a[108:109], v11 offset:8192
  v_mfma_f32_16x16x32_bf16 v[148:151], a[76:79], a[20:23], v[148:151]
  v_mfma_f32_16x16x32_bf16 v[144:147], a[76:79], a[16:19], v[144:147]
  ds_read_b64_tr_b16 a[110:111], v11 offset:9216
  v_mfma_f32_16x16x32_bf16 v[144:147], a[72:75], a[0:3], v[144:147]
  ds_read_b64_tr_b16 a[112:113], v12 offset:0
  v_mfma_f32_16x16x32_bf16 v[160:163], a[80:83], a[0:3], v[160:163]
  buffer_load_dwordx4 v23, s[12:15], s27 offen offset:1024 sc1 lds
  v_mfma_f32_16x16x32_bf16 v[160:163], a[84:87], a[16:19], v[160:163]
  ds_read_b64_tr_b16 a[114:115], v12 offset:1024
  v_mfma_f32_16x16x32_bf16 v[164:167], a[84:87], a[20:23], v[164:167]
  ds_read_b64_tr_b16 a[116:117], v12 offset:8192
  v_mfma_f32_16x16x32_bf16 v[164:167], a[80:83], a[4:7], v[164:167]
  buffer_load_dwordx4 v24, s[12:15], s27 offen offset:2048 sc1 lds
  v_mfma_f32_16x16x32_bf16 v[168:171], a[80:83], a[8:11], v[168:171]
  v_mfma_f32_16x16x32_bf16 v[168:171], a[84:87], a[24:27], v[168:171]
  ds_read_b64_tr_b16 a[118:119], v12 offset:9216
  v_mfma_f32_16x16x32_bf16 v[172:175], a[84:87], a[28:31], v[172:175]
  ds_read_b64_tr_b16 a[120:121], v13 offset:0
  v_mfma_f32_16x16x32_bf16 v[172:175], a[80:83], a[12:15], v[172:175]
  ds_read_b64_tr_b16 a[122:123], v13 offset:1024
  v_mfma_f32_16x16x32_bf16 v[188:191], a[88:91], a[12:15], v[188:191]
  buffer_load_dwordx4 v25, s[12:15], s27 offen offset:3072 sc1 lds
  v_mfma_f32_16x16x32_bf16 v[188:191], a[92:95], a[28:31], v[188:191]
  ds_read_b64_tr_b16 a[124:125], v13 offset:8192
  v_mfma_f32_16x16x32_bf16 v[184:187], a[92:95], a[24:27], v[184:187]
  ds_read_b64_tr_b16 a[126:127], v13 offset:9216
  v_mfma_f32_16x16x32_bf16 v[184:187], a[88:91], a[8:11], v[184:187]
  v_mfma_f32_16x16x32_bf16 v[180:183], a[88:91], a[4:7], v[180:183]
  v_mfma_f32_16x16x32_bf16 v[180:183], a[92:95], a[20:23], v[180:183]
  v_mfma_f32_16x16x32_bf16 v[176:179], a[92:95], a[16:19], v[176:179]
  s_add_u32 s26, s26, 128
  v_mfma_f32_16x16x32_bf16 v[176:179], a[88:91], a[0:3], v[176:179]
  s_add_u32 s27, s27, s34
  s_xor_b32 s34, s34, s92
  s_waitcnt lgkmcnt(0) vmcnt(12)
  s_barrier
  v_mfma_f32_16x16x32_bf16 v[192:195], a[96:99], a[0:3], v[192:195]
  s_add_u32 m0, s28, 0
  ds_read_b64_tr_b16 a[64:65], v6 offset:16384
  v_mfma_f32_16x16x32_bf16 v[192:195], a[100:103], a[16:19], v[192:195]
  buffer_load_dwordx4 v14, s[8:11], s26 offen offset:0 sc1 lds
  v_mfma_f32_16x16x32_bf16 v[196:199], a[100:103], a[20:23], v[196:199]
  ds_read_b64_tr_b16 a[66:67], v6 offset:17408
  v_mfma_f32_16x16x32_bf16 v[196:199], a[96:99], a[4:7], v[196:199]
  ds_read_b64_tr_b16 a[68:69], v6 offset:24576
  v_mfma_f32_16x16x32_bf16 v[200:203], a[96:99], a[8:11], v[200:203]
  ds_read_b64_tr_b16 a[70:71], v6 offset:25600
  v_mfma_f32_16x16x32_bf16 v[200:203], a[100:103], a[24:27], v[200:203]
  ds_read_b128 a[32:35], v2 offset:32768
  v_mfma_f32_16x16x32_bf16 v[204:207], a[100:103], a[28:31], v[204:207]
  buffer_load_dwordx4 v15, s[8:11], s26 offen offset:1024 sc1 lds
  v_mfma_f32_16x16x32_bf16 v[204:207], a[96:99], a[12:15], v[204:207]
  ds_read_b128 a[48:51], v3 offset:32768
  ds_read_b128 a[36:39], v2 offset:34816
  v_mfma_f32_16x16x32_bf16 v[220:223], a[104:107], a[12:15], v[220:223]
  ds_read_b128 a[52:55], v3 offset:34816
  v_mfma_f32_16x16x32_bf16 v[220:223], a[108:111], a[28:31], v[220:223]
  ds_read_b128 a[40:43], v2 offset:36864
  v_mfma_f32_16x16x32_bf16 v[216:219], a[108:111], a[24:27], v[216:219]
  buffer_load_dwordx4 v16, s[8:11], s26 offen offset:2048 sc1 lds
  v_mfma_f32_16x16x32_bf16 v[216:219], a[104:107], a[8:11], v[216:219]
  ds_read_b128 a[56:59], v3 offset:36864
  v_mfma_f32_16x16x32_bf16 v[212:215], a[104:107], a[4:7], v[212:215]
  ds_read_b128 a[44:47], v2 offset:38912
  v_mfma_f32_16x16x32_bf16 v[212:215], a[108:111], a[20:23], v[212:215]
  ds_read_b128 a[60:63], v3 offset:38912
  v_mfma_f32_16x16x32_bf16 v[208:211], a[108:111], a[16:19], v[208:211]
  ds_read_b64_tr_b16 a[72:73], v7 offset:16384
  buffer_load_dwordx4 v17, s[8:11], s26 offen offset:3072 sc1 lds
  v_mfma_f32_16x16x32_bf16 v[208:211], a[104:107], a[0:3], v[208:211]
  ds_read_b64_tr_b16 a[74:75], v7 offset:17408
  v_mfma_f32_16x16x32_bf16 v[224:227], a[112:115], a[0:3], v[224:227]
  ds_read_b64_tr_b16 a[76:77], v7 offset:24576
  v_mfma_f32_16x16x32_bf16 v[224:227], a[116:119], a[16:19], v[224:227]
  ds_read_b64_tr_b16 a[78:79], v7 offset:25600
  v_mfma_f32_16x16x32_bf16 v[228:231], a[116:119], a[20:23], v[228:231]
  s_add_u32 m0, s28, 4096
  v_mfma_f32_16x16x32_bf16 v[228:231], a[112:115], a[4:7], v[228:231]
  ds_read_b64_tr_b16 a[80:81], v8 offset:16384
  v_mfma_f32_16x16x32_bf16 v[232:235], a[112:115], a[8:11], v[232:235]
  buffer_load_dwordx4 v18, s[8:11], s26 offen offset:0 sc1 lds
  v_mfma_f32_16x16x32_bf16 v[232:235], a[116:119], a[24:27], v[232:235]
  ds_read_b64_tr_b16 a[82:83], v8 offset:17408
  ds_read_b64_tr_b16 a[84:85], v8 offset:24576
  v_mfma_f32_16x16x32_bf16 v[236:239], a[116:119], a[28:31], v[236:239]
  ds_read_b64_tr_b16 a[86:87], v8 offset:25600
  v_mfma_f32_16x16x32_bf16 v[236:239], a[112:115], a[12:15], v[236:239]
  ds_read_b64_tr_b16 a[88:89], v9 offset:16384
  v_mfma_f32_16x16x32_bf16 v[252:255], a[120:123], a[12:15], v[252:255]
  buffer_load_dwordx4 v19, s[8:11], s26 offen offset:1024 sc1 lds
  v_mfma_f32_16x16x32_bf16 v[252:255], a[124:127], a[28:31], v[252:255]
  ds_read_b64_tr_b16 a[90:91], v9 offset:17408
  v_mfma_f32_16x16x32_bf16 v[248:251], a[124:127], a[24:27], v[248:251]
  ds_read_b64_tr_b16 a[92:93], v9 offset:24576
  v_mfma_f32_16x16x32_bf16 v[248:251], a[120:123], a[8:11], v[248:251]
  ds_read_b64_tr_b16 a[94:95], v9 offset:25600
  v_mfma_f32_16x16x32_bf16 v[244:247], a[120:123], a[4:7], v[244:247]
  v_mfma_f32_16x16x32_bf16 v[244:247], a[124:127], a[20:23], v[244:247]
  v_mfma_f32_16x16x32_bf16 v[240:243], a[124:127], a[16:19], v[240:243]
  v_mfma_f32_16x16x32_bf16 v[240:243], a[120:123], a[0:3], v[240:243]
  s_waitcnt lgkmcnt(0)
  v_mfma_f32_16x16x32_bf16 v[128:131], a[64:67], a[32:35], v[128:131]
  s_add_u32 m0, s28, 4096
  v_mfma_f32_16x16x32_bf16 v[128:131], a[68:71], a[48:51], v[128:131]
  ds_read_b64_tr_b16 a[96:97], v10 offset:16384
  v_mfma_f32_16x16x32_bf16 v[132:135], a[68:71], a[52:55], v[132:135]
  buffer_load_dwordx4 v20, s[8:11], s26 offen offset:2048 sc1 lds
  v_mfma_f32_16x16x32_bf16 v[132:135], a[64:67], a[36:39], v[132:135]
  ds_read_b64_tr_b16 a[98:99], v10 offset:17408
  v_mfma_f32_16x16x32_bf16 v[136:139], a[64:67], a[40:43], v[136:139]
  ds_read_b64_tr_b16 a[100:101], v10 offset:24576
  v_mfma_f32_16x16x32_bf16 v[136:139], a[68:71], a[56:59], v[136:139]
  buffer_load_dwordx4 v21, s[8:11], s26 offen offset:3072 sc1 lds
  v_mfma_f32_16x16x32_bf16 v[140:143], a[68:71], a[60:63], v[140:143]
  v_mfma_f32_16x16x32_bf16 v[140:143], a[64:67], a[44:47], v[140:143]
  ds_read_b64_tr_b16 a[102:103], v10 offset:25600
  v_mfma_f32_16x16x32_bf16 v[156:159], a[72:75], a[44:47], v[156:159]
  ds_read_b64_tr_b16 a[104:105], v11 offset:16384
  v_mfma_f32_16x16x32_bf16 v[156:159], a[76:79], a[60:63], v[156:159]
  s_add_u32 m0, s29, 0
  v_mfma_f32_16x16x32_bf16 v[152:155], a[76:79], a[56:59], v[152:155]
  ds_read_b64_tr_b16 a[106:107], v11 offset:17408
  v_mfma_f32_16x16x32_bf16 v[152:155], a[72:75], a[40:43], v[152:155]
  buffer_load_dwordx4 v22, s[12:15], s27 offen offset:0 sc1 lds
  v_mfma_f32_16x16x32_bf16 v[148:151], a[72:75], a[36:39], v[148:151]
  ds_read_b64_tr_b16 a[108:109], v11 offset:24576
  v_mfma_f32_16x16x32_bf16 v[148:151], a[76:79], a[52:55], v[148:151]
  v_mfma_f32_16x16x32_bf16 v[144:147], a[76:79], a[48:51], v[144:147]
  ds_read_b64_tr_b16 a[110:111], v11 offset:25600
  v_mfma_f32_16x16x32_bf16 v[144:147], a[72:75], a[32:35], v[144:147]
  ds_read_b64_tr_b16 a[112:113], v12 offset:16384
  v_mfma_f32_16x16x32_bf16 v[160:163], a[80:83], a[32:35], v[160:163]
  buffer_load_dwordx4 v23, s[12:15], s27 offen offset:1024 sc1 lds
  v_mfma_f32_16x16x32_bf16 v[160:163], a[84:87], a[48:51], v[160:163]
  ds_read_b64_tr_b16 a[114:115], v12 offset:17408
  v_mfma_f32_16x16x32_bf16 v[164:167], a[84:87], a[52:55], v[164:167]
  ds_read_b64_tr_b16 a[116:117], v12 offset:24576
  v_mfma_f32_16x16x32_bf16 v[164:167], a[80:83], a[36:39], v[164:167]
  buffer_load_dwordx4 v24, s[12:15], s27 offen offset:2048 sc1 lds
  v_mfma_f32_16x16x32_bf16 v[168:171], a[80:83], a[40:43], v[168:171]
  v_mfma_f32_16x16x32_bf16 v[168:171], a[84:87], a[56:59], v[168:171]
  ds_read_b64_tr_b16 a[118:119], v12 offset:25600
  v_mfma_f32_16x16x32_bf16 v[172:175], a[84:87], a[60:63], v[172:175]
  ds_read_b64_tr_b16 a[120:121], v13 offset:16384
  v_mfma_f32_16x16x32_bf16 v[172:175], a[80:83], a[44:47], v[172:175]
  ds_read_b64_tr_b16 a[122:123], v13 offset:17408
  v_mfma_f32_16x16x32_bf16 v[188:191], a[88:91], a[44:47], v[188:191]
  buffer_load_dwordx4 v25, s[12:15], s27 offen offset:3072 sc1 lds
  v_mfma_f32_16x16x32_bf16 v[188:191], a[92:95], a[60:63], v[188:191]
  ds_read_b64_tr_b16 a[124:125], v13 offset:24576
  v_mfma_f32_16x16x32_bf16 v[184:187], a[92:95], a[56:59], v[184:187]
  ds_read_b64_tr_b16 a[126:127], v13 offset:25600
  v_mfma_f32_16x16x32_bf16 v[184:187], a[88:91], a[40:43], v[184:187]
  v_mfma_f32_16x16x32_bf16 v[180:183], a[88:91], a[36:39], v[180:183]
  v_mfma_f32_16x16x32_bf16 v[180:183], a[92:95], a[52:55], v[180:183]
  v_mfma_f32_16x16x32_bf16 v[176:179], a[92:95], a[48:51], v[176:179]
  s_add_u32 s26, s26, 128
  v_mfma_f32_16x16x32_bf16 v[176:179], a[88:91], a[32:35], v[176:179]
  s_add_u32 s27, s27, s34
  s_xor_b32 s34, s34, s92
  s_waitcnt lgkmcnt(0) vmcnt(12)
  s_barrier
  v_mfma_f32_16x16x32_bf16 v[192:195], a[96:99], a[32:35], v[192:195]
  s_add_u32 m0, s28, 32768
  ds_read_b64_tr_b16 a[64:65], v6 offset:32768
  v_mfma_f32_16x16x32_bf16 v[192:195], a[100:103], a[48:51], v[192:195]
  buffer_load_dwordx4 v14, s[8:11], s26 offen offset:0 sc1 lds
  v_mfma_f32_16x16x32_bf16 v[196:199], a[100:103], a[52:55], v[196:199]
  ds_read_b64_tr_b16 a[66:67], v6 offset:33792
  v_mfma_f32_16x16x32_bf16 v[196:199], a[96:99], a[36:39], v[196:199]
  ds_read_b64_tr_b16 a[68:69], v6 offset:40960
  v_mfma_f32_16x16x32_bf16 v[200:203], a[96:99], a[40:43], v[200:203]
  ds_read_b64_tr_b16 a[70:71], v6 offset:41984
  v_mfma_f32_16x16x32_bf16 v[200:203], a[100:103], a[56:59], v[200:203]
  ds_read_b128 a[0:3], v4 offset:0
  v_mfma_f32_16x16x32_bf16 v[204:207], a[100:103], a[60:63], v[204:207]
  buffer_load_dwordx4 v15, s[8:11], s26 offen offset:1024 sc1 lds
  v_mfma_f32_16x16x32_bf16 v[204:207], a[96:99], a[44:47], v[204:207]
  ds_read_b128 a[16:19], v5 offset:0
  ds_read_b128 a[4:7], v4 offset:2048
  v_mfma_f32_16x16x32_bf16 v[220:223], a[104:107], a[44:47], v[220:223]
  ds_read_b128 a[20:23], v5 offset:2048
  v_mfma_f32_16x16x32_bf16 v[220:223], a[108:111], a[60:63], v[220:223]
  ds_read_b128 a[8:11], v4 offset:4096
  v_mfma_f32_16x16x32_bf16 v[216:219], a[108:111], a[56:59], v[216:219]
  buffer_load_dwordx4 v16, s[8:11], s26 offen offset:2048 sc1 lds
  v_mfma_f32_16x16x32_bf16 v[216:219], a[104:107], a[40:43], v[216:219]
  ds_read_b128 a[24:27], v5 offset:4096
  v_mfma_f32_16x16x32_bf16 v[212:215], a[104:107], a[36:39], v[212:215]
  ds_read_b128 a[12:15], v4 offset:6144
  v_mfma_f32_16x16x32_bf16 v[212:215], a[108:111], a[52:55], v[212:215]
  ds_read_b128 a[28:31], v5 offset:6144
  v_mfma_f32_16x16x32_bf16 v[208:211], a[108:111], a[48:51], v[208:211]
  ds_read_b64_tr_b16 a[72:73], v7 offset:32768
  buffer_load_dwordx4 v17, s[8:11], s26 offen offset:3072 sc1 lds
  v_mfma_f32_16x16x32_bf16 v[208:211], a[104:107], a[32:35], v[208:211]
  ds_read_b64_tr_b16 a[74:75], v7 offset:33792
  v_mfma_f32_16x16x32_bf16 v[224:227], a[112:115], a[32:35], v[224:227]
  ds_read_b64_tr_b16 a[76:77], v7 offset:40960
  v_mfma_f32_16x16x32_bf16 v[224:227], a[116:119], a[48:51], v[224:227]
  ds_read_b64_tr_b16 a[78:79], v7 offset:41984
  v_mfma_f32_16x16x32_bf16 v[228:231], a[116:119], a[52:55], v[228:231]
  s_add_u32 m0, s28, 36864
  v_mfma_f32_16x16x32_bf16 v[228:231], a[112:115], a[36:39], v[228:231]
  ds_read_b64_tr_b16 a[80:81], v8 offset:32768
  v_mfma_f32_16x16x32_bf16 v[232:235], a[112:115], a[40:43], v[232:235]
  buffer_load_dwordx4 v18, s[8:11], s26 offen offset:0 sc1 lds
  v_mfma_f32_16x16x32_bf16 v[232:235], a[116:119], a[56:59], v[232:235]
  ds_read_b64_tr_b16 a[82:83], v8 offset:33792
  ds_read_b64_tr_b16 a[84:85], v8 offset:40960
  v_mfma_f32_16x16x32_bf16 v[236:239], a[116:119], a[60:63], v[236:239]
  ds_read_b64_tr_b16 a[86:87], v8 offset:41984
  v_mfma_f32_16x16x32_bf16 v[236:239], a[112:115], a[44:47], v[236:239]
  ds_read_b64_tr_b16 a[88:89], v9 offset:32768
  v_mfma_f32_16x16x32_bf16 v[252:255], a[120:123], a[44:47], v[252:255]
  buffer_load_dwordx4 v19, s[8:11], s26 offen offset:1024 sc1 lds
  v_mfma_f32_16x16x32_bf16 v[252:255], a[124:127], a[60:63], v[252:255]
  ds_read_b64_tr_b16 a[90:91], v9 offset:33792
  v_mfma_f32_16x16x32_bf16 v[248:251], a[124:127], a[56:59], v[248:251]
  ds_read_b64_tr_b16 a[92:93], v9 offset:40960
  v_mfma_f32_16x16x32_bf16 v[248:251], a[120:123], a[40:43], v[248:251]
  ds_read_b64_tr_b16 a[94:95], v9 offset:41984
  v_mfma_f32_16x16x32_bf16 v[244:247], a[120:123], a[36:39], v[244:247]
  v_mfma_f32_16x16x32_bf16 v[244:247], a[124:127], a[52:55], v[244:247]
  v_mfma_f32_16x16x32_bf16 v[240:243], a[124:127], a[48:51], v[240:243]
  v_mfma_f32_16x16x32_bf16 v[240:243], a[120:123], a[32:35], v[240:243]
  s_waitcnt lgkmcnt(0)
  v_mfma_f32_16x16x32_bf16 v[128:131], a[64:67], a[0:3], v[128:131]
  s_add_u32 m0, s28, 36864
  v_mfma_f32_16x16x32_bf16 v[128:131], a[68:71], a[16:19], v[128:131]
  ds_read_b64_tr_b16 a[96:97], v10 offset:32768
  v_mfma_f32_16x16x32_bf16 v[132:135], a[68:71], a[20:23], v[132:135]
  buffer_load_dwordx4 v20, s[8:11], s26 offen offset:2048 sc1 lds
  v_mfma_f32_16x16x32_bf16 v[132:135], a[64:67], a[4:7], v[132:135]
  ds_read_b64_tr_b16 a[98:99], v10 offset:33792
  v_mfma_f32_16x16x32_bf16 v[136:139], a[64:67], a[8:11], v[136:139]
  ds_read_b64_tr_b16 a[100:101], v10 offset:40960
  v_mfma_f32_16x16x32_bf16 v[136:139], a[68:71], a[24:27], v[136:139]
  buffer_load_dwordx4 v21, s[8:11], s26 offen offset:3072 sc1 lds
  v_mfma_f32_16x16x32_bf16 v[140:143], a[68:71], a[28:31], v[140:143]
  v_mfma_f32_16x16x32_bf16 v[140:143], a[64:67], a[12:15], v[140:143]
  ds_read_b64_tr_b16 a[102:103], v10 offset:41984
  v_mfma_f32_16x16x32_bf16 v[156:159], a[72:75], a[12:15], v[156:159]
  ds_read_b64_tr_b16 a[104:105], v11 offset:32768
  v_mfma_f32_16x16x32_bf16 v[156:159], a[76:79], a[28:31], v[156:159]
  s_add_u32 m0, s29, 16384
  v_mfma_f32_16x16x32_bf16 v[152:155], a[76:79], a[24:27], v[152:155]
  ds_read_b64_tr_b16 a[106:107], v11 offset:33792
  v_mfma_f32_16x16x32_bf16 v[152:155], a[72:75], a[8:11], v[152:155]
  buffer_load_dwordx4 v22, s[12:15], s27 offen offset:0 sc1 lds
  v_mfma_f32_16x16x32_bf16 v[148:151], a[72:75], a[4:7], v[148:151]
  ds_read_b64_tr_b16 a[108:109], v11 offset:40960
  v_mfma_f32_16x16x32_bf16 v[148:151], a[76:79], a[20:23], v[148:151]
  v_mfma_f32_16x16x32_bf16 v[144:147], a[76:79], a[16:19], v[144:147]
  ds_read_b64_tr_b16 a[110:111], v11 offset:41984
  v_mfma_f32_16x16x32_bf16 v[144:147], a[72:75], a[0:3], v[144:147]
  ds_read_b64_tr_b16 a[112:113], v12 offset:32768
  v_mfma_f32_16x16x32_bf16 v[160:163], a[80:83], a[0:3], v[160:163]
  buffer_load_dwordx4 v23, s[12:15], s27 offen offset:1024 sc1 lds
  v_mfma_f32_16x16x32_bf16 v[160:163], a[84:87], a[16:19], v[160:163]
  ds_read_b64_tr_b16 a[114:115], v12 offset:33792
  v_mfma_f32_16x16x32_bf16 v[164:167], a[84:87], a[20:23], v[164:167]
  ds_read_b64_tr_b16 a[116:117], v12 offset:40960
  v_mfma_f32_16x16x32_bf16 v[164:167], a[80:83], a[4:7], v[164:167]
  buffer_load_dwordx4 v24, s[12:15], s27 offen offset:2048 sc1 lds
  v_mfma_f32_16x16x32_bf16 v[168:171], a[80:83], a[8:11], v[168:171]
  v_mfma_f32_16x16x32_bf16 v[168:171], a[84:87], a[24:27], v[168:171]
  ds_read_b64_tr_b16 a[118:119], v12 offset:41984
  v_mfma_f32_16x16x32_bf16 v[172:175], a[84:87], a[28:31], v[172:175]
  ds_read_b64_tr_b16 a[120:121], v13 offset:32768
  v_mfma_f32_16x16x32_bf16 v[172:175], a[80:83], a[12:15], v[172:175]
  ds_read_b64_tr_b16 a[122:123], v13 offset:33792
  v_mfma_f32_16x16x32_bf16 v[188:191], a[88:91], a[12:15], v[188:191]
  buffer_load_dwordx4 v25, s[12:15], s27 offen offset:3072 sc1 lds
  v_mfma_f32_16x16x32_bf16 v[188:191], a[92:95], a[28:31], v[188:191]
  ds_read_b64_tr_b16 a[124:125], v13 offset:40960
  v_mfma_f32_16x16x32_bf16 v[184:187], a[92:95], a[24:27], v[184:187]
  ds_read_b64_tr_b16 a[126:127], v13 offset:41984
  v_mfma_f32_16x16x32_bf16 v[184:187], a[88:91], a[8:11], v[184:187]
  v_mfma_f32_16x16x32_bf16 v[180:183], a[88:91], a[4:7], v[180:183]
  v_mfma_f32_16x16x32_bf16 v[180:183], a[92:95], a[20:23], v[180:183]
  v_mfma_f32_16x16x32_bf16 v[176:179], a[92:95], a[16:19], v[176:179]
  s_add_u32 s26, s26, 128
  v_mfma_f32_16x16x32_bf16 v[176:179], a[88:91], a[0:3], v[176:179]
  s_add_u32 s27, s27, s34
  s_xor_b32 s34, s34, s92
  s_waitcnt lgkmcnt(0) vmcnt(12)
  s_barrier
  v_mfma_f32_16x16x32_bf16 v[192:195], a[96:99], a[0:3], v[192:195]
  s_add_u32 m0, s28, 65536
  ds_read_b64_tr_b16 a[64:65], v6 offset:0
  v_mfma_f32_16x16x32_bf16 v[192:195], a[100:103], a[16:19], v[192:195]
  buffer_load_dwordx4 v14, s[8:11], s26 offen offset:0 sc1 lds
  v_mfma_f32_16x16x32_bf16 v[196:199], a[100:103], a[20:23], v[196:199]
  ds_read_b64_tr_b16 a[66:67], v6 offset:1024
  v_mfma_f32_16x16x32_bf16 v[196:199], a[96:99], a[4:7], v[196:199]
  ds_read_b64_tr_b16 a[68:69], v6 offset:8192
  v_mfma_f32_16x16x32_bf16 v[200:203], a[96:99], a[8:11], v[200:203]
  ds_read_b64_tr_b16 a[70:71], v6 offset:9216
  v_mfma_f32_16x16x32_bf16 v[200:203], a[100:103], a[24:27], v[200:203]
  ds_read_b128 a[32:35], v2 offset:0
  v_mfma_f32_16x16x32_bf16 v[204:207], a[100:103], a[28:31], v[204:207]
  buffer_load_dwordx4 v15, s[8:11], s26 offen offset:1024 sc1 lds
  v_mfma_f32_16x16x32_bf16 v[204:207], a[96:99], a[12:15], v[204:207]
  ds_read_b128 a[48:51], v3 offset:0
  ds_read_b128 a[36:39], v2 offset:2048
  v_mfma_f32_16x16x32_bf16 v[220:223], a[104:107], a[12:15], v[220:223]
  ds_read_b128 a[52:55], v3 offset:2048
  v_mfma_f32_16x16x32_bf16 v[220:223], a[108:111], a[28:31], v[220:223]
  ds_read_b128 a[40:43], v2 offset:4096
  v_mfma_f32_16x16x32_bf16 v[216:219], a[108:111], a[24:27], v[216:219]
  buffer_load_dwordx4 v16, s[8:11], s26 offen offset:2048 sc1 lds
  v_mfma_f32_16x16x32_bf16 v[216:219], a[104:107], a[8:11], v[216:219]
  ds_read_b128 a[56:59], v3 offset:4096
  v_mfma_f32_16x16x32_bf16 v[212:215], a[104:107], a[4:7], v[212:215]
  ds_read_b128 a[44:47], v2 offset:6144
  v_mfma_f32_16x16x32_bf16 v[212:215], a[108:111], a[20:23], v[212:215]
  ds_read_b128 a[60:63], v3 offset:6144
  v_mfma_f32_16x16x32_bf16 v[208:211], a[108:111], a[16:19], v[208:211]
  ds_read_b64_tr_b16 a[72:73], v7 offset:0
  buffer_load_dwordx4 v17, s[8:11], s26 offen offset:3072 sc1 lds
  v_mfma_f32_16x16x32_bf16 v[208:211], a[104:107], a[0:3], v[208:211]
  ds_read_b64_tr_b16 a[74:75], v7 offset:1024
  v_mfma_f32_16x16x32_bf16 v[224:227], a[112:115], a[0:3], v[224:227]
  ds_read_b64_tr_b16 a[76:77], v7 offset:8192
  v_mfma_f32_16x16x32_bf16 v[224:227], a[116:119], a[16:19], v[224:227]
  ds_read_b64_tr_b16 a[78:79], v7 offset:9216
  v_mfma_f32_16x16x32_bf16 v[228:231], a[116:119], a[20:23], v[228:231]
  s_add_u32 m0, s28, 69632
  v_mfma_f32_16x16x32_bf16 v[228:231], a[112:115], a[4:7], v[228:231]
  ds_read_b64_tr_b16 a[80:81], v8 offset:0
  v_mfma_f32_16x16x32_bf16 v[232:235], a[112:115], a[8:11], v[232:235]
  buffer_load_dwordx4 v18, s[8:11], s26 offen offset:0 sc1 lds
  v_mfma_f32_16x16x32_bf16 v[232:235], a[116:119], a[24:27], v[232:235]
  ds_read_b64_tr_b16 a[82:83], v8 offset:1024
  ds_read_b64_tr_b16 a[84:85], v8 offset:8192
  v_mfma_f32_16x16x32_bf16 v[236:239], a[116:119], a[28:31], v[236:239]
  ds_read_b64_tr_b16 a[86:87], v8 offset:9216
  v_mfma_f32_16x16x32_bf16 v[236:239], a[112:115], a[12:15], v[236:239]
  ds_read_b64_tr_b16 a[88:89], v9 offset:0
  v_mfma_f32_16x16x32_bf16 v[252:255], a[120:123], a[12:15], v[252:255]
  buffer_load_dwordx4 v19, s[8:11], s26 offen offset:1024 sc1 lds
  v_mfma_f32_16x16x32_bf16 v[252:255], a[124:127], a[28:31], v[252:255]
  ds_read_b64_tr_b16 a[90:91], v9 offset:1024
  v_mfma_f32_16x16x32_bf16 v[248:251], a[124:127], a[24:27], v[248:251]
  ds_read_b64_tr_b16 a[92:93], v9 offset:8192
  v_mfma_f32_16x16x32_bf16 v[248:251], a[120:123], a[8:11], v[248:251]
  ds_read_b64_tr_b16 a[94:95], v9 offset:9216
  v_mfma_f32_16x16x32_bf16 v[244:247], a[120:123], a[4:7], v[244:247]
  v_mfma_f32_16x16x32_bf16 v[244:247], a[124:127], a[20:23], v[244:247]
  v_mfma_f32_16x16x32_bf16 v[240:243], a[124:127], a[16:19], v[240:243]
  v_mfma_f32_16x16x32_bf16 v[240:243], a[120:123], a[0:3], v[240:243]
  s_waitcnt lgkmcnt(0)
  v_mfma_f32_16x16x32_bf16 v[128:131], a[64:67], a[32:35], v[128:131]
  s_add_u32 m0, s28, 69632
  v_mfma_f32_16x16x32_bf16 v[128:131], a[68:71], a[48:51], v[128:131]
  ds_read_b64_tr_b16 a[96:97], v10 offset:0
  v_mfma_f32_16x16x32_bf16 v[132:135], a[68:71], a[52:55], v[132:135]
  buffer_load_dwordx4 v20, s[8:11], s26 offen offset:2048 sc1 lds
  v_mfma_f32_16x16x32_bf16 v[132:135], a[64:67], a[36:39], v[132:135]
  ds_read_b64_tr_b16 a[98:99], v10 offset:1024
  v_mfma_f32_16x16x32_bf16 v[136:139], a[64:67], a[40:43], v[136:139]
  ds_read_b64_tr_b16 a[100:101], v10 offset:8192
  v_mfma_f32_16x16x32_bf16 v[136:139], a[68:71], a[56:59], v[136:139]
  buffer_load_dwordx4 v21, s[8:11], s26 offen offset:3072 sc1 lds
  v_mfma_f32_16x16x32_bf16 v[140:143], a[68:71], a[60:63], v[140:143]
  v_mfma_f32_16x16x32_bf16 v[140:143], a[64:67], a[44:47], v[140:143]
  ds_read_b64_tr_b16 a[102:103], v10 offset:9216
  v_mfma_f32_16x16x32_bf16 v[156:159], a[72:75], a[44:47], v[156:159]
  ds_read_b64_tr_b16 a[104:105], v11 offset:0
  v_mfma_f32_16x16x32_bf16 v[156:159], a[76:79], a[60:63], v[156:159]
  s_add_u32 m0, s29, 32768
  v_mfma_f32_16x16x32_bf16 v[152:155], a[76:79], a[56:59], v[152:155]
  ds_read_b64_tr_b16 a[106:107], v11 offset:1024
  v_mfma_f32_16x16x32_bf16 v[152:155], a[72:75], a[40:43], v[152:155]
  buffer_load_dwordx4 v22, s[12:15], s27 offen offset:0 sc1 lds
  v_mfma_f32_16x16x32_bf16 v[148:151], a[72:75], a[36:39], v[148:151]
  ds_read_b64_tr_b16 a[108:109], v11 offset:8192
  v_mfma_f32_16x16x32_bf16 v[148:151], a[76:79], a[52:55], v[148:151]
  v_mfma_f32_16x16x32_bf16 v[144:147], a[76:79], a[48:51], v[144:147]
  ds_read_b64_tr_b16 a[110:111], v11 offset:9216
  v_mfma_f32_16x16x32_bf16 v[144:147], a[72:75], a[32:35], v[144:147]
  ds_read_b64_tr_b16 a[112:113], v12 offset:0
  v_mfma_f32_16x16x32_bf16 v[160:163], a[80:83], a[32:35], v[160:163]
  buffer_load_dwordx4 v23, s[12:15], s27 offen offset:1024 sc1 lds
  v_mfma_f32_16x16x32_bf16 v[160:163], a[84:87], a[48:51], v[160:163]
  ds_read_b64_tr_b16 a[114:115], v12 offset:1024
  v_mfma_f32_16x16x32_bf16 v[164:167], a[84:87], a[52:55], v[164:167]
  ds_read_b64_tr_b16 a[116:117], v12 offset:8192
  v_mfma_f32_16x16x32_bf16 v[164:167], a[80:83], a[36:39], v[164:167]
  buffer_load_dwordx4 v24, s[12:15], s27 offen offset:2048 sc1 lds
  v_mfma_f32_16x16x32_bf16 v[168:171], a[80:83], a[40:43], v[168:171]
  v_mfma_f32_16x16x32_bf16 v[168:171], a[84:87], a[56:59], v[168:171]
  ds_read_b64_tr_b16 a[118:119], v12 offset:9216
  v_mfma_f32_16x16x32_bf16 v[172:175], a[84:87], a[60:63], v[172:175]
  ds_read_b64_tr_b16 a[120:121], v13 offset:0
  v_mfma_f32_16x16x32_bf16 v[172:175], a[80:83], a[44:47], v[172:175]
  ds_read_b64_tr_b16 a[122:123], v13 offset:1024
  v_mfma_f32_16x16x32_bf16 v[188:191], a[88:91], a[44:47], v[188:191]
  buffer_load_dwordx4 v25, s[12:15], s27 offen offset:3072 sc1 lds
  v_mfma_f32_16x16x32_bf16 v[188:191], a[92:95], a[60:63], v[188:191]
  ds_read_b64_tr_b16 a[124:125], v13 offset:8192
  v_mfma_f32_16x16x32_bf16 v[184:187], a[92:95], a[56:59], v[184:187]
  ds_read_b64_tr_b16 a[126:127], v13 offset:9216
  v_mfma_f32_16x16x32_bf16 v[184:187], a[88:91], a[40:43], v[184:187]
  v_mfma_f32_16x16x32_bf16 v[180:183], a[88:91], a[36:39], v[180:183]
  v_mfma_f32_16x16x32_bf16 v[180:183], a[92:95], a[52:55], v[180:183]
  v_mfma_f32_16x16x32_bf16 v[176:179], a[92:95], a[48:51], v[176:179]
  s_add_u32 s26, s26, 128
  v_mfma_f32_16x16x32_bf16 v[176:179], a[88:91], a[32:35], v[176:179]
  s_add_u32 s27, s27, s34
  s_xor_b32 s34, s34, s92
  s_waitcnt lgkmcnt(0) vmcnt(12)
  s_barrier
  v_mfma_f32_16x16x32_bf16 v[192:195], a[96:99], a[32:35], v[192:195]
  s_add_u32 m0, s28, 0
  ds_read_b64_tr_b16 a[64:65], v6 offset:16384
  v_mfma_f32_16x16x32_bf16 v[192:195], a[100:103], a[48:51], v[192:195]
  buffer_load_dwordx4 v14, s[8:11], s26 offen offset:0 sc1 lds
  v_mfma_f32_16x16x32_bf16 v[196:199], a[100:103], a[52:55], v[196:199]
  ds_read_b64_tr_b16 a[66:67], v6 offset:17408
  v_mfma_f32_16x16x32_bf16 v[196:199], a[96:99], a[36:39], v[196:199]
  ds_read_b64_tr_b16 a[68:69], v6 offset:24576
  v_mfma_f32_16x16x32_bf16 v[200:203], a[96:99], a[40:43], v[200:203]
  ds_read_b64_tr_b16 a[70:71], v6 offset:25600
  v_mfma_f32_16x16x32_bf16 v[200:203], a[100:103], a[56:59], v[200:203]
  ds_read_b128 a[0:3], v2 offset:32768
  v_mfma_f32_16x16x32_bf16 v[204:207], a[100:103], a[60:63], v[204:207]
  buffer_load_dwordx4 v15, s[8:11], s26 offen offset:1024 sc1 lds
  v_mfma_f32_16x16x32_bf16 v[204:207], a[96:99], a[44:47], v[204:207]
  ds_read_b128 a[16:19], v3 offset:32768
  ds_read_b128 a[4:7], v2 offset:34816
  v_mfma_f32_16x16x32_bf16 v[220:223], a[104:107], a[44:47], v[220:223]
  ds_read_b128 a[20:23], v3 offset:34816
  v_mfma_f32_16x16x32_bf16 v[220:223], a[108:111], a[60:63], v[220:223]
  ds_read_b128 a[8:11], v2 offset:36864
  v_mfma_f32_16x16x32_bf16 v[216:219], a[108:111], a[56:59], v[216:219]
  buffer_load_dwordx4 v16, s[8:11], s26 offen offset:2048 sc1 lds
  v_mfma_f32_16x16x32_bf16 v[216:219], a[104:107], a[40:43], v[216:219]
  ds_read_b128 a[24:27], v3 offset:36864
  v_mfma_f32_16x16x32_bf16 v[212:215], a[104:107], a[36:39], v[212:215]
  ds_read_b128 a[12:15], v2 offset:38912
  v_mfma_f32_16x16x32_bf16 v[212:215], a[108:111], a[52:55], v[212:215]
  ds_read_b128 a[28:31], v3 offset:38912
  v_mfma_f32_16x16x32_bf16 v[208:211], a[108:111], a[48:51], v[208:211]
  ds_read_b64_tr_b16 a[72:73], v7 offset:16384
  buffer_load_dwordx4 v17, s[8:11], s26 offen offset:3072 sc1 lds
  v_mfma_f32_16x16x32_bf16 v[208:211], a[104:107], a[32:35], v[208:211]
  ds_read_b64_tr_b16 a[74:75], v7 offset:17408
  v_mfma_f32_16x16x32_bf16 v[224:227], a[112:115], a[32:35], v[224:227]
  ds_read_b64_tr_b16 a[76:77], v7 offset:24576
  v_mfma_f32_16x16x32_bf16 v[224:227], a[116:119], a[48:51], v[224:227]
  ds_read_b64_tr_b16 a[78:79], v7 offset:25600
  v_mfma_f32_16x16x32_bf16 v[228:231], a[116:119], a[52:55], v[228:231]
  s_add_u32 m0, s28, 4096
  v_mfma_f32_16x16x32_bf16 v[228:231], a[112:115], a[36:39], v[228:231]
  ds_read_b64_tr_b16 a[80:81], v8 offset:16384
  v_mfma_f32_16x16x32_bf16 v[232:235], a[112:115], a[40:43], v[232:235]
  buffer_load_dwordx4 v18, s[8:11], s26 offen offset:0 sc1 lds
  v_mfma_f32_16x16x32_bf16 v[232:235], a[116:119], a[56:59], v[232:235]
  ds_read_b64_tr_b16 a[82:83], v8 offset:17408
  ds_read_b64_tr_b16 a[84:85], v8 offset:24576
  v_mfma_f32_16x16x32_bf16 v[236:239], a[116:119], a[60:63], v[236:239]
  ds_read_b64_tr_b16 a[86:87], v8 offset:25600
  v_mfma_f32_16x16x32_bf16 v[236:239], a[112:115], a[44:47], v[236:239]
  ds_read_b64_tr_b16 a[88:89], v9 offset:16384
  v_mfma_f32_16x16x32_bf16 v[252:255], a[120:123], a[44:47], v[252:255]
  buffer_load_dwordx4 v19, s[8:11], s26 offen offset:1024 sc1 lds
  v_mfma_f32_16x16x32_bf16 v[252:255], a[124:127], a[60:63], v[252:255]
  ds_read_b64_tr_b16 a[90:91], v9 offset:17408
  v_mfma_f32_16x16x32_bf16 v[248:251], a[124:127], a[56:59], v[248:251]
  ds_read_b64_tr_b16 a[92:93], v9 offset:24576
  v_mfma_f32_16x16x32_bf16 v[248:251], a[120:123], a[40:43], v[248:251]
  ds_read_b64_tr_b16 a[94:95], v9 offset:25600
  v_mfma_f32_16x16x32_bf16 v[244:247], a[120:123], a[36:39], v[244:247]
  v_mfma_f32_16x16x32_bf16 v[244:247], a[124:127], a[52:55], v[244:247]
  v_mfma_f32_16x16x32_bf16 v[240:243], a[124:127], a[48:51], v[240:243]
  v_mfma_f32_16x16x32_bf16 v[240:243], a[120:123], a[32:35], v[240:243]
  s_waitcnt lgkmcnt(0)
  s_sub_u32 s31, s31, 1
  s_cmp_lg_u32 s31, 0
  s_cbranch_scc1 mid_loop_2
  v_mfma_f32_16x16x32_bf16 v[128:131], a[64:67], a[0:3], v[128:131]
  s_add_u32 m0, s28, 4096
  v_mfma_f32_16x16x32_bf16 v[128:131], a[68:71], a[16:19], v[128:131]
  ds_read_b64_tr_b16 a[96:97], v10 offset:16384
  v_mfma_f32_16x16x32_bf16 v[132:135], a[68:71], a[20:23], v[132:135]
  buffer_load_dwordx4 v20, s[8:11], s26 offen offset:2048 sc1 lds
  v_mfma_f32_16x16x32_bf16 v[132:135], a[64:67], a[4:7], v[132:135]
  ds_read_b64_tr_b16 a[98:99], v10 offset:17408
  v_mfma_f32_16x16x32_bf16 v[136:139], a[64:67], a[8:11], v[136:139]
  ds_read_b64_tr_b16 a[100:101], v10 offset:24576
  v_mfma_f32_16x16x32_bf16 v[136:139], a[68:71], a[24:27], v[136:139]
  buffer_load_dwordx4 v21, s[8:11], s26 offen offset:3072 sc1 lds
  v_mfma_f32_16x16x32_bf16 v[140:143], a[68:71], a[28:31], v[140:143]
  v_mfma_f32_16x16x32_bf16 v[140:143], a[64:67], a[12:15], v[140:143]
  ds_read_b64_tr_b16 a[102:103], v10 offset:25600
  v_mfma_f32_16x16x32_bf16 v[156:159], a[72:75], a[12:15], v[156:159]
  ds_read_b64_tr_b16 a[104:105], v11 offset:16384
  v_mfma_f32_16x16x32_bf16 v[156:159], a[76:79], a[28:31], v[156:159]
  s_add_u32 m0, s29, 0
  v_mfma_f32_16x16x32_bf16 v[152:155], a[76:79], a[24:27], v[152:155]
  ds_read_b64_tr_b16 a[106:107], v11 offset:17408
  v_mfma_f32_16x16x32_bf16 v[152:155], a[72:75], a[8:11], v[152:155]
  buffer_load_dwordx4 v22, s[12:15], s27 offen offset:0 sc1 lds
  v_mfma_f32_16x16x32_bf16 v[148:151], a[72:75], a[4:7], v[148:151]
  ds_read_b64_tr_b16 a[108:109], v11 offset:24576
  v_mfma_f32_16x16x32_bf16 v[148:151], a[76:79], a[20:23], v[148:151]
  v_mfma_f32_16x16x32_bf16 v[144:147], a[76:79], a[16:19], v[144:147]
  ds_read_b64_tr_b16 a[110:111], v11 offset:25600
  v_mfma_f32_16x16x32_bf16 v[144:147], a[72:75], a[0:3], v[144:147]
  ds_read_b64_tr_b16 a[112:113], v12 offset:16384
  v_mfma_f32_16x16x32_bf16 v[160:163], a[80:83], a[0:3], v[160:163]
  buffer_load_dwordx4 v23, s[12:15], s27 offen offset:1024 sc1 lds
  v_mfma_f32_16x16x32_bf16 v[160:163], a[84:87], a[16:19], v[160:163]
  ds_read_b64_tr_b16 a[114:115], v12 offset:17408
  v_mfma_f32_16x16x32_bf16 v[164:167], a[84:87], a[20:23], v[164:167]
  ds_read_b64_tr_b16 a[116:117], v12 offset:24576
  v_mfma_f32_16x16x32_bf16 v[164:167], a[80:83], a[4:7], v[164:167]
  buffer_load_dwordx4 v24, s[12:15], s27 offen offset:2048 sc1 lds
  v_mfma_f32_16x16x32_bf16 v[168:171], a[80:83], a[8:11], v[168:171]
  v_mfma_f32_16x16x32_bf16 v[168:171], a[84:87], a[24:27], v[168:171]
  ds_read_b64_tr_b16 a[118:119], v12 offset:25600
  v_mfma_f32_16x16x32_bf16 v[172:175], a[84:87], a[28:31], v[172:175]
  ds_read_b64_tr_b16 a[120:121], v13 offset:16384
  v_mfma_f32_16x16x32_bf16 v[172:175], a[80:83], a[12:15], v[172:175]
  ds_read_b64_tr_b16 a[122:123], v13 offset:17408
  v_mfma_f32_16x16x32_bf16 v[188:191], a[88:91], a[12:15], v[188:191]
  buffer_load_dwordx4 v25, s[12:15], s27 offen offset:3072 sc1 lds
  v_mfma_f32_16x16x32_bf16 v[188:191], a[92:95], a[28:31], v[188:191]
  ds_read_b64_tr_b16 a[124:125], v13 offset:24576
  v_mfma_f32_16x16x32_bf16 v[184:187], a[92:95], a[24:27], v[184:187]
  ds_read_b64_tr_b16 a[126:127], v13 offset:25600
  v_mfma_f32_16x16x32_bf16 v[184:187], a[88:91], a[8:11], v[184:187]
  v_mfma_f32_16x16x32_bf16 v[180:183], a[88:91], a[4:7], v[180:183]
  v_mfma_f32_16x16x32_bf16 v[180:183], a[92:95], a[20:23], v[180:183]
  v_mfma_f32_16x16x32_bf16 v[176:179], a[92:95], a[16:19], v[176:179]
  s_add_u32 s26, s26, 128
  v_mfma_f32_16x16x32_bf16 v[176:179], a[88:91], a[0:3], v[176:179]
  s_add_u32 s27, s27, s34
  s_xor_b32 s34, s34, s92
  s_waitcnt lgkmcnt(0) vmcnt(12)
  s_barrier
  v_mfma_f32_16x16x32_bf16 v[192:195], a[96:99], a[0:3], v[192:195]
  s_add_u32 m0, s28, 32768
  ds_read_b64_tr_b16 a[64:65], v6 offset:32768
  v_mfma_f32_16x16x32_bf16 v[192:195], a[100:103], a[16:19], v[192:195]
  buffer_load_dwordx4 v14, s[8:11], s26 offen offset:0 sc1 lds
  v_mfma_f32_16x16x32_bf16 v[196:199], a[100:103], a[20:23], v[196:199]
  ds_read_b64_tr_b16 a[66:67], v6 offset:33792
  v_mfma_f32_16x16x32_bf16 v[196:199], a[96:99], a[4:7], v[196:199]
  ds_read_b64_tr_b16 a[68:69], v6 offset:40960
  v_mfma_f32_16x16x32_bf16 v[200:203], a[96:99], a[8:11], v[200:203]
  ds_read_b64_tr_b16 a[70:71], v6 offset:41984
  v_mfma_f32_16x16x32_bf16 v[200:203], a[100:103], a[24:27], v[200:203]
  ds_read_b128 a[32:35], v4 offset:0
  v_mfma_f32_16x16x32_bf16 v[204:207], a[100:103], a[28:31], v[204:207]
  buffer_load_dwordx4 v15, s[8:11], s26 offen offset:1024 sc1 lds
  v_mfma_f32_16x16x32_bf16 v[204:207], a[96:99], a[12:15], v[204:207]
  ds_read_b128 a[48:51], v5 offset:0
  ds_read_b128 a[36:39], v4 offset:2048
  v_mfma_f32_16x16x32_bf16 v[220:223], a[104:107], a[12:15], v[220:223]
  ds_read_b128 a[52:55], v5 offset:2048
  v_mfma_f32_16x16x32_bf16 v[220:223], a[108:111], a[28:31], v[220:223]
  ds_read_b128 a[40:43], v4 offset:4096
  v_mfma_f32_16x16x32_bf16 v[216:219], a[108:111], a[24:27], v[216:219]
  buffer_load_dwordx4 v16, s[8:11], s26 offen offset:2048 sc1 lds
  v_mfma_f32_16x16x32_bf16 v[216:219], a[104:107], a[8:11], v[216:219]
  ds_read_b128 a[56:59], v5 offset:4096
  v_mfma_f32_16x16x32_bf16 v[212:215], a[104:107], a[4:7], v[212:215]
  ds_read_b128 a[44:47], v4 offset:6144
  v_mfma_f32_16x16x32_bf16 v[212:215], a[108:111], a[20:23], v[212:215]
  ds_read_b128 a[60:63], v5 offset:6144
  v_mfma_f32_16x16x32_bf16 v[208:211], a[108:111], a[16:19], v[208:211]
  ds_read_b64_tr_b16 a[72:73], v7 offset:32768
  buffer_load_dwordx4 v17, s[8:11], s26 offen offset:3072 sc1 lds
  v_mfma_f32_16x16x32_bf16 v[208:211], a[104:107], a[0:3], v[208:211]
  ds_read_b64_tr_b16 a[74:75], v7 offset:33792
  v_mfma_f32_16x16x32_bf16 v[224:227], a[112:115], a[0:3], v[224:227]
  ds_read_b64_tr_b16 a[76:77], v7 offset:40960
  v_mfma_f32_16x16x32_bf16 v[224:227], a[116:119], a[16:19], v[224:227]
  ds_read_b64_tr_b16 a[78:79], v7 offset:41984
  v_mfma_f32_16x16x32_bf16 v[228:231], a[116:119], a[20:23], v[228:231]
  s_add_u32 m0, s28, 36864
  v_mfma_f32_16x16x32_bf16 v[228:231], a[112:115], a[4:7], v[228:231]
  ds_read_b64_tr_b16 a[80:81], v8 offset:32768
  v_mfma_f32_16x16x32_bf16 v[232:235], a[112:115], a[8:11], v[232:235]
  buffer_load_dwordx4 v18, s[8:11], s26 offen offset:0 sc1 lds
  v_mfma_f32_16x16x32_bf16 v[232:235], a[116:119], a[24:27], v[232:235]
  ds_read_b64_tr_b16 a[82:83], v8 offset:33792
  ds_read_b64_tr_b16 a[84:85], v8 offset:40960
  v_mfma_f32_16x16x32_bf16 v[236:239], a[116:119], a[28:31], v[236:239]
  ds_read_b64_tr_b16 a[86:87], v8 offset:41984
  v_mfma_f32_16x16x32_bf16 v[236:239], a[112:115], a[12:15], v[236:239]
  ds_read_b64_tr_b16 a[88:89], v9 offset:32768
  v_mfma_f32_16x16x32_bf16 v[252:255], a[120:123], a[12:15], v[252:255]
  buffer_load_dwordx4 v19, s[8:11], s26 offen offset:1024 sc1 lds
  v_mfma_f32_16x16x32_bf16 v[252:255], a[124:127], a[28:31], v[252:255]
  ds_read_b64_tr_b16 a[90:91], v9 offset:33792
  v_mfma_f32_16x16x32_bf16 v[248:251], a[124:127], a[24:27], v[248:251]
  ds_read_b64_tr_b16 a[92:93], v9 offset:40960
  v_mfma_f32_16x16x32_bf16 v[248:251], a[120:123], a[8:11], v[248:251]
  ds_read_b64_tr_b16 a[94:95], v9 offset:41984
  v_mfma_f32_16x16x32_bf16 v[244:247], a[120:123], a[4:7], v[244:247]
  v_mfma_f32_16x16x32_bf16 v[244:247], a[124:127], a[20:23], v[244:247]
  v_mfma_f32_16x16x32_bf16 v[240:243], a[124:127], a[16:19], v[240:243]
  v_mfma_f32_16x16x32_bf16 v[240:243], a[120:123], a[0:3], v[240:243]
  s_waitcnt lgkmcnt(0)
  v_mfma_f32_16x16x32_bf16 v[128:131], a[64:67], a[32:35], v[128:131]
  s_add_u32 m0, s28, 36864
  v_mfma_f32_16x16x32_bf16 v[128:131], a[68:71], a[48:51], v[128:131]
  ds_read_b64_tr_b16 a[96:97], v10 offset:32768
  v_mfma_f32_16x16x32_bf16 v[132:135], a[68:71], a[52:55], v[132:135]
  buffer_load_dwordx4 v20, s[8:11], s26 offen offset:2048 sc1 lds
  v_mfma_f32_16x16x32_bf16 v[132:135], a[64:67], a[36:39], v[132:135]
  ds_read_b64_tr_b16 a[98:99], v10 offset:33792
  v_mfma_f32_16x16x32_bf16 v[136:139], a[64:67], a[40:43], v[136:139]
  ds_read_b64_tr_b16 a[100:101], v10 offset:40960
  v_mfma_f32_16x16x32_bf16 v[136:139], a[68:71], a[56:59], v[136:139]
  buffer_load_dwordx4 v21, s[8:11], s26 offen offset:3072 sc1 lds
  v_mfma_f32_16x16x32_bf16 v[140:143], a[68:71], a[60:63], v[140:143]
  v_mfma_f32_16x16x32_bf16 v[140:143], a[64:67], a[44:47], v[140:143]
  ds_read_b64_tr_b16 a[102:103], v10 offset:41984
  v_mfma_f32_16x16x32_bf16 v[156:159], a[72:75], a[44:47], v[156:159]
  ds_read_b64_tr_b16 a[104:105], v11 offset:32768
  v_mfma_f32_16x16x32_bf16 v[156:159], a[76:79], a[60:63], v[156:159]
  s_add_u32 m0, s29, 16384
  v_mfma_f32_16x16x32_bf16 v[152:155], a[76:79], a[56:59], v[152:155]
  ds_read_b64_tr_b16 a[106:107], v11 offset:33792
  v_mfma_f32_16x16x32_bf16 v[152:155], a[72:75], a[40:43], v[152:155]
  buffer_load_dwordx4 v22, s[12:15], s27 offen offset:0 sc1 lds
  v_mfma_f32_16x16x32_bf16 v[148:151], a[72:75], a[36:39], v[148:151]
  ds_read_b64_tr_b16 a[108:109], v11 offset:40960
  v_mfma_f32_16x16x32_bf16 v[148:151], a[76:79], a[52:55], v[148:151]
  v_mfma_f32_16x16x32_bf16 v[144:147], a[76:79], a[48:51], v[144:147]
  ds_read_b64_tr_b16 a[110:111], v11 offset:41984
  v_mfma_f32_16x16x32_bf16 v[144:147], a[72:75], a[32:35], v[144:147]
  ds_read_b64_tr_b16 a[112:113], v12 offset:32768
  v_mfma_f32_16x16x32_bf16 v[160:163], a[80:83], a[32:35], v[160:163]
  buffer_load_dwordx4 v23, s[12:15], s27 offen offset:1024 sc1 lds
  v_mfma_f32_16x16x32_bf16 v[160:163], a[84:87], a[48:51], v[160:163]
  ds_read_b64_tr_b16 a[114:115], v12 offset:33792
  v_mfma_f32_16x16x32_bf16 v[164:167], a[84:87], a[52:55], v[164:167]
  ds_read_b64_tr_b16 a[116:117], v12 offset:40960
  v_mfma_f32_16x16x32_bf16 v[164:167], a[80:83], a[36:39], v[164:167]
  buffer_load_dwordx4 v24, s[12:15], s27 offen offset:2048 sc1 lds
  v_mfma_f32_16x16x32_bf16 v[168:171], a[80:83], a[40:43], v[168:171]
  v_mfma_f32_16x16x32_bf16 v[168:171], a[84:87], a[56:59], v[168:171]
  ds_read_b64_tr_b16 a[118:119], v12 offset:41984
  v_mfma_f32_16x16x32_bf16 v[172:175], a[84:87], a[60:63], v[172:175]
  ds_read_b64_tr_b16 a[120:121], v13 offset:32768
  v_mfma_f32_16x16x32_bf16 v[172:175], a[80:83], a[44:47], v[172:175]
  ds_read_b64_tr_b16 a[122:123], v13 offset:33792
  v_mfma_f32_16x16x32_bf16 v[188:191], a[88:91], a[44:47], v[188:191]
  buffer_load_dwordx4 v25, s[12:15], s27 offen offset:3072 sc1 lds
  v_mfma_f32_16x16x32_bf16 v[188:191], a[92:95], a[60:63], v[188:191]
  ds_read_b64_tr_b16 a[124:125], v13 offset:40960
  v_mfma_f32_16x16x32_bf16 v[184:187], a[92:95], a[56:59], v[184:187]
  ds_read_b64_tr_b16 a[126:127], v13 offset:41984
  v_mfma_f32_16x16x32_bf16 v[184:187], a[88:91], a[40:43], v[184:187]
  v_mfma_f32_16x16x32_bf16 v[180:183], a[88:91], a[36:39], v[180:183]
  v_mfma_f32_16x16x32_bf16 v[180:183], a[92:95], a[52:55], v[180:183]
  v_mfma_f32_16x16x32_bf16 v[176:179], a[92:95], a[48:51], v[176:179]
  s_add_u32 s26, s26, 128
  v_mfma_f32_16x16x32_bf16 v[176:179], a[88:91], a[32:35], v[176:179]
  s_add_u32 s27, s27, s34
  s_xor_b32 s34, s34, s92
  s_waitcnt lgkmcnt(0) vmcnt(12)
  s_barrier
  v_mfma_f32_16x16x32_bf16 v[192:195], a[96:99], a[32:35], v[192:195]
  s_add_u32 m0, s28, 65536
  ds_read_b64_tr_b16 a[64:65], v6 offset:0
  v_mfma_f32_16x16x32_bf16 v[192:195], a[100:103], a[48:51], v[192:195]
  buffer_load_dwordx4 v14, s[8:11], s26 offen offset:0 sc1 lds
  v_mfma_f32_16x16x32_bf16 v[196:199], a[100:103], a[52:55], v[196:199]
  ds_read_b64_tr_b16 a[66:67], v6 offset:1024
  v_mfma_f32_16x16x32_bf16 v[196:199], a[96:99], a[36:39], v[196:199]
  ds_read_b64_tr_b16 a[68:69], v6 offset:8192
  v_mfma_f32_16x16x32_bf16 v[200:203], a[96:99], a[40:43], v[200:203]
  ds_read_b64_tr_b16 a[70:71], v6 offset:9216
  v_mfma_f32_16x16x32_bf16 v[200:203], a[100:103], a[56:59], v[200:203]
  ds_read_b128 a[0:3], v2 offset:0
  v_mfma_f32_16x16x32_bf16 v[204:207], a[100:103], a[60:63], v[204:207]
  buffer_load_dwordx4 v15, s[8:11], s26 offen offset:1024 sc1 lds
  v_mfma_f32_16x16x32_bf16 v[204:207], a[96:99], a[44:47], v[204:207]
  ds_read_b128 a[16:19], v3 offset:0
  ds_read_b128 a[4:7], v2 offset:2048
  v_mfma_f32_16x16x32_bf16 v[220:223], a[104:107], a[44:47], v[220:223]
  ds_read_b128 a[20:23], v3 offset:2048
  v_mfma_f32_16x16x32_bf16 v[220:223], a[108:111], a[60:63], v[220:223]
  ds_read_b128 a[8:11], v2 offset:4096
  v_mfma_f32_16x16x32_bf16 v[216:219], a[108:111], a[56:59], v[216:219]
  buffer_load_dwordx4 v16, s[8:11], s26 offen offset:2048 sc1 lds
  v_mfma_f32_16x16x32_bf16 v[216:219], a[104:107], a[40:43], v[216:219]
  ds_read_b128 a[24:27], v3 offset:4096
  v_mfma_f32_16x16x32_bf16 v[212:215], a[104:107], a[36:39], v[212:215]
  ds_read_b128 a[12:15], v2 offset:6144
  v_mfma_f32_16x16x32_bf16 v[212:215], a[108:111], a[52:55], v[212:215]
  ds_read_b128 a[28:31], v3 offset:6144
  v_mfma_f32_16x16x32_bf16 v[208:211], a[108:111], a[48:51], v[208:211]
  ds_read_b64_tr_b16 a[72:73], v7 offset:0
  buffer_load_dwordx4 v17, s[8:11], s26 offen offset:3072 sc1 lds
  v_mfma_f32_16x16x32_bf16 v[208:211], a[104:107], a[32:35], v[208:211]
  ds_read_b64_tr_b16 a[74:75], v7 offset:1024
  v_mfma_f32_16x16x32_bf16 v[224:227], a[112:115], a[32:35], v[224:227]
  ds_read_b64_tr_b16 a[76:77], v7 offset:8192
  v_mfma_f32_16x16x32_bf16 v[224:227], a[116:119], a[48:51], v[224:227]
  ds_read_b64_tr_b16 a[78:79], v7 offset:9216
  v_mfma_f32_16x16x32_bf16 v[228:231], a[116:119], a[52:55], v[228:231]
  s_add_u32 m0, s28, 69632
  v_mfma_f32_16x16x32_bf16 v[228:231], a[112:115], a[36:39], v[228:231]
  ds_read_b64_tr_b16 a[80:81], v8 offset:0
  v_mfma_f32_16x16x32_bf16 v[232:235], a[112:115], a[40:43], v[232:235]
  buffer_load_dwordx4 v18, s[8:11], s26 offen offset:0 sc1 lds
  v_mfma_f32_16x16x32_bf16 v[232:235], a[116:119], a[56:59], v[232:235]
  ds_read_b64_tr_b16 a[82:83], v8 offset:1024
  ds_read_b64_tr_b16 a[84:85], v8 offset:8192
  v_mfma_f32_16x16x32_bf16 v[236:239], a[116:119], a[60:63], v[236:239]
  ds_read_b64_tr_b16 a[86:87], v8 offset:9216
  v_mfma_f32_16x16x32_bf16 v[236:239], a[112:115], a[44:47], v[236:239]
  ds_read_b64_tr_b16 a[88:89], v9 offset:0
  v_mfma_f32_16x16x32_bf16 v[252:255], a[120:123], a[44:47], v[252:255]
  buffer_load_dwordx4 v19, s[8:11], s26 offen offset:1024 sc1 lds
  v_mfma_f32_16x16x32_bf16 v[252:255], a[124:127], a[60:63], v[252:255]
  ds_read_b64_tr_b16 a[90:91], v9 offset:1024
  v_mfma_f32_16x16x32_bf16 v[248:251], a[124:127], a[56:59], v[248:251]
  ds_read_b64_tr_b16 a[92:93], v9 offset:8192
  v_mfma_f32_16x16x32_bf16 v[248:251], a[120:123], a[40:43], v[248:251]
  ds_read_b64_tr_b16 a[94:95], v9 offset:9216
  v_mfma_f32_16x16x32_bf16 v[244:247], a[120:123], a[36:39], v[244:247]
  v_mfma_f32_16x16x32_bf16 v[244:247], a[124:127], a[52:55], v[244:247]
  v_mfma_f32_16x16x32_bf16 v[240:243], a[124:127], a[48:51], v[240:243]
  v_mfma_f32_16x16x32_bf16 v[240:243], a[120:123], a[32:35], v[240:243]
  s_waitcnt lgkmcnt(0)
  v_mfma_f32_16x16x32_bf16 v[128:131], a[64:67], a[0:3], v[128:131]
  s_add_u32 m0, s28, 69632
  v_mfma_f32_16x16x32_bf16 v[128:131], a[68:71], a[16:19], v[128:131]
  ds_read_b64_tr_b16 a[96:97], v10 offset:0
  v_mfma_f32_16x16x32_bf16 v[132:135], a[68:71], a[20:23], v[132:135]
  buffer_load_dwordx4 v20, s[8:11], s26 offen offset:2048 sc1 lds
  v_mfma_f32_16x16x32_bf16 v[132:135], a[64:67], a[4:7], v[132:135]
  ds_read_b64_tr_b16 a[98:99], v10 offset:1024
  v_mfma_f32_16x16x32_bf16 v[136:139], a[64:67], a[8:11], v[136:139]
  ds_read_b64_tr_b16 a[100:101], v10 offset:8192
  v_mfma_f32_16x16x32_bf16 v[136:139], a[68:71], a[24:27], v[136:139]
  buffer_load_dwordx4 v21, s[8:11], s26 offen offset:3072 sc1 lds
  v_mfma_f32_16x16x32_bf16 v[140:143], a[68:71], a[28:31], v[140:143]
  v_mfma_f32_16x16x32_bf16 v[140:143], a[64:67], a[12:15], v[140:143]
  ds_read_b64_tr_b16 a[102:103], v10 offset:9216
  v_mfma_f32_16x16x32_bf16 v[156:159], a[72:75], a[12:15], v[156:159]
  ds_read_b64_tr_b16 a[104:105], v11 offset:0
  v_mfma_f32_16x16x32_bf16 v[156:159], a[76:79], a[28:31], v[156:159]
  s_add_u32 m0, s29, 32768
  v_mfma_f32_16x16x32_bf16 v[152:155], a[76:79], a[24:27], v[152:155]
  ds_read_b64_tr_b16 a[106:107], v11 offset:1024
  v_mfma_f32_16x16x32_bf16 v[152:155], a[72:75], a[8:11], v[152:155]
  buffer_load_dwordx4 v22, s[12:15], s27 offen offset:0 sc1 lds
  v_mfma_f32_16x16x32_bf16 v[148:151], a[72:75], a[4:7], v[148:151]
  ds_read_b64_tr_b16 a[108:109], v11 offset:8192
  v_mfma_f32_16x16x32_bf16 v[148:151], a[76:79], a[20:23], v[148:151]
  v_mfma_f32_16x16x32_bf16 v[144:147], a[76:79], a[16:19], v[144:147]
  ds_read_b64_tr_b16 a[110:111], v11 offset:9216
  v_mfma_f32_16x16x32_bf16 v[144:147], a[72:75], a[0:3], v[144:147]
  ds_read_b64_tr_b16 a[112:113], v12 offset:0
  v_mfma_f32_16x16x32_bf16 v[160:163], a[80:83], a[0:3], v[160:163]
  buffer_load_dwordx4 v23, s[12:15], s27 offen offset:1024 sc1 lds
  v_mfma_f32_16x16x32_bf16 v[160:163], a[84:87], a[16:19], v[160:163]
  ds_read_b64_tr_b16 a[114:115], v12 offset:1024
  v_mfma_f32_16x16x32_bf16 v[164:167], a[84:87], a[20:23], v[164:167]
  ds_read_b64_tr_b16 a[116:117], v12 offset:8192
  v_mfma_f32_16x16x32_bf16 v[164:167], a[80:83], a[4:7], v[164:167]
  buffer_load_dwordx4 v24, s[12:15], s27 offen offset:2048 sc1 lds
  v_mfma_f32_16x16x32_bf16 v[168:171], a[80:83], a[8:11], v[168:171]
  v_mfma_f32_16x16x32_bf16 v[168:171], a[84:87], a[24:27], v[168:171]
  ds_read_b64_tr_b16 a[118:119], v12 offset:9216
  v_mfma_f32_16x16x32_bf16 v[172:175], a[84:87], a[28:31], v[172:175]
  ds_read_b64_tr_b16 a[120:121], v13 offset:0
  v_mfma_f32_16x16x32_bf16 v[172:175], a[80:83], a[12:15], v[172:175]
  ds_read_b64_tr_b16 a[122:123], v13 offset:1024
  v_mfma_f32_16x16x32_bf16 v[188:191], a[88:91], a[12:15], v[188:191]
  buffer_load_dwordx4 v25, s[12:15], s27 offen offset:3072 sc1 lds
  v_mfma_f32_16x16x32_bf16 v[188:191], a[92:95], a[28:31], v[188:191]
  ds_read_b64_tr_b16 a[124:125], v13 offset:8192
  v_mfma_f32_16x16x32_bf16 v[184:187], a[92:95], a[24:27], v[184:187]
  ds_read_b64_tr_b16 a[126:127], v13 offset:9216
  v_mfma_f32_16x16x32_bf16 v[184:187], a[88:91], a[8:11], v[184:187]
  v_mfma_f32_16x16x32_bf16 v[180:183], a[88:91], a[4:7], v[180:183]
  v_mfma_f32_16x16x32_bf16 v[180:183], a[92:95], a[20:23], v[180:183]
  v_mfma_f32_16x16x32_bf16 v[176:179], a[92:95], a[16:19], v[176:179]
  s_add_u32 s26, s26, 128
  v_mfma_f32_16x16x32_bf16 v[176:179], a[88:91], a[0:3], v[176:179]
  s_add_u32 s27, s27, s34
  s_xor_b32 s34, s34, s92
  s_waitcnt lgkmcnt(0) vmcnt(12)
  s_barrier
  v_mfma_f32_16x16x32_bf16 v[192:195], a[96:99], a[0:3], v[192:195]
  s_add_u32 m0, s28, 0
  ds_read_b64_tr_b16 a[64:65], v6 offset:16384
  v_mfma_f32_16x16x32_bf16 v[192:195], a[100:103], a[16:19], v[192:195]
  buffer_load_dwordx4 v14, s[8:11], s26 offen offset:0 sc1 lds
  v_mfma_f32_16x16x32_bf16 v[196:199], a[100:103], a[20:23], v[196:199]
  ds_read_b64_tr_b16 a[66:67], v6 offset:17408
  v_mfma_f32_16x16x32_bf16 v[196:199], a[96:99], a[4:7], v[196:199]
  ds_read_b64_tr_b16 a[68:69], v6 offset:24576
  v_mfma_f32_16x16x32_bf16 v[200:203], a[96:99], a[8:11], v[200:203]
  ds_read_b64_tr_b16 a[70:71], v6 offset:25600
  v_mfma_f32_16x16x32_bf16 v[200:203], a[100:103], a[24:27], v[200:203]
  ds_read_b128 a[32:35], v2 offset:32768
  v_mfma_f32_16x16x32_bf16 v[204:207], a[100:103], a[28:31], v[204:207]
  buffer_load_dwordx4 v15, s[8:11], s26 offen offset:1024 sc1 lds
  v_mfma_f32_16x16x32_bf16 v[204:207], a[96:99], a[12:15], v[204:207]
  ds_read_b128 a[48:51], v3 offset:32768
  ds_read_b128 a[36:39], v2 offset:34816
  v_mfma_f32_16x16x32_bf16 v[220:223], a[104:107], a[12:15], v[220:223]
  ds_read_b128 a[52:55], v3 offset:34816
  v_mfma_f32_16x16x32_bf16 v[220:223], a[108:111], a[28:31], v[220:223]
  ds_read_b128 a[40:43], v2 offset:36864
  v_mfma_f32_16x16x32_bf16 v[216:219], a[108:111], a[24:27], v[216:219]
  buffer_load_dwordx4 v16, s[8:11], s26 offen offset:2048 sc1 lds
  v_mfma_f32_16x16x32_bf16 v[216:219], a[104:107], a[8:11], v[216:219]
  ds_read_b128 a[56:59], v3 offset:36864
  v_mfma_f32_16x16x32_bf16 v[212:215], a[104:107], a[4:7], v[212:215]
  ds_read_b128 a[44:47], v2 offset:38912
  v_mfma_f32_16x16x32_bf16 v[212:215], a[108:111], a[20:23], v[212:215]
  ds_read_b128 a[60:63], v3 offset:38912
  v_mfma_f32_16x16x32_bf16 v[208:211], a[108:111], a[16:19], v[208:211]
  ds_read_b64_tr_b16 a[72:73], v7 offset:16384
  buffer_load_dwordx4 v17, s[8:11], s26 offen offset:3072 sc1 lds
  v_mfma_f32_16x16x32_bf16 v[208:211], a[104:107], a[0:3], v[208:211]
  ds_read_b64_tr_b16 a[74:75], v7 offset:17408
  v_mfma_f32_16x16x32_bf16 v[224:227], a[112:115], a[0:3], v[224:227]
  ds_read_b64_tr_b16 a[76:77], v7 offset:24576
  v_mfma_f32_16x16x32_bf16 v[224:227], a[116:119], a[16:19], v[224:227]
  ds_read_b64_tr_b16 a[78:79], v7 offset:25600
  v_mfma_f32_16x16x32_bf16 v[228:231], a[116:119], a[20:23], v[228:231]
  s_add_u32 m0, s28, 4096
  v_mfma_f32_16x16x32_bf16 v[228:231], a[112:115], a[4:7], v[228:231]
  ds_read_b64_tr_b16 a[80:81], v8 offset:16384
  v_mfma_f32_16x16x32_bf16 v[232:235], a[112:115], a[8:11], v[232:235]
  buffer_load_dwordx4 v18, s[8:11], s26 offen offset:0 sc1 lds
  v_mfma_f32_16x16x32_bf16 v[232:235], a[116:119], a[24:27], v[232:235]
  ds_read_b64_tr_b16 a[82:83], v8 offset:17408
  ds_read_b64_tr_b16 a[84:85], v8 offset:24576
  v_mfma_f32_16x16x32_bf16 v[236:239], a[116:119], a[28:31], v[236:239]
  ds_read_b64_tr_b16 a[86:87], v8 offset:25600
  v_mfma_f32_16x16x32_bf16 v[236:239], a[112:115], a[12:15], v[236:239]
  ds_read_b64_tr_b16 a[88:89], v9 offset:16384
  v_mfma_f32_16x16x32_bf16 v[252:255], a[120:123], a[12:15], v[252:255]
  buffer_load_dwordx4 v19, s[8:11], s26 offen offset:1024 sc1 lds
  v_mfma_f32_16x16x32_bf16 v[252:255], a[124:127], a[28:31], v[252:255]
  ds_read_b64_tr_b16 a[90:91], v9 offset:17408
  v_mfma_f32_16x16x32_bf16 v[248:251], a[124:127], a[24:27], v[248:251]
  ds_read_b64_tr_b16 a[92:93], v9 offset:24576
  v_mfma_f32_16x16x32_bf16 v[248:251], a[120:123], a[8:11], v[248:251]
  ds_read_b64_tr_b16 a[94:95], v9 offset:25600
  v_mfma_f32_16x16x32_bf16 v[244:247], a[120:123], a[4:7], v[244:247]
  v_mfma_f32_16x16x32_bf16 v[244:247], a[124:127], a[20:23], v[244:247]
  v_mfma_f32_16x16x32_bf16 v[240:243], a[124:127], a[16:19], v[240:243]
  v_mfma_f32_16x16x32_bf16 v[240:243], a[120:123], a[0:3], v[240:243]
  s_waitcnt lgkmcnt(0)
  v_mfma_f32_16x16x32_bf16 v[128:131], a[64:67], a[32:35], v[128:131]
  s_add_u32 m0, s28, 4096
  v_mfma_f32_16x16x32_bf16 v[128:131], a[68:71], a[48:51], v[128:131]
  ds_read_b64_tr_b16 a[96:97], v10 offset:16384
  v_mfma_f32_16x16x32_bf16 v[132:135], a[68:71], a[52:55], v[132:135]
  buffer_load_dwordx4 v20, s[8:11], s26 offen offset:2048 sc1 lds
  v_mfma_f32_16x16x32_bf16 v[132:135], a[64:67], a[36:39], v[132:135]
  ds_read_b64_tr_b16 a[98:99], v10 offset:17408
  v_mfma_f32_16x16x32_bf16 v[136:139], a[64:67], a[40:43], v[136:139]
  ds_read_b64_tr_b16 a[100:101], v10 offset:24576
  v_mfma_f32_16x16x32_bf16 v[136:139], a[68:71], a[56:59], v[136:139]
  buffer_load_dwordx4 v21, s[8:11], s26 offen offset:3072 sc1 lds
  v_mfma_f32_16x16x32_bf16 v[140:143], a[68:71], a[60:63], v[140:143]
  v_mfma_f32_16x16x32_bf16 v[140:143], a[64:67], a[44:47], v[140:143]
  ds_read_b64_tr_b16 a[102:103], v10 offset:25600
  v_mfma_f32_16x16x32_bf16 v[156:159], a[72:75], a[44:47], v[156:159]
  ds_read_b64_tr_b16 a[104:105], v11 offset:16384
  v_mfma_f32_16x16x32_bf16 v[156:159], a[76:79], a[60:63], v[156:159]
  s_add_u32 m0, s29, 0
  v_mfma_f32_16x16x32_bf16 v[152:155], a[76:79], a[56:59], v[152:155]
  ds_read_b64_tr_b16 a[106:107], v11 offset:17408
  v_mfma_f32_16x16x32_bf16 v[152:155], a[72:75], a[40:43], v[152:155]
  buffer_load_dwordx4 v22, s[12:15], s27 offen offset:0 sc1 lds
  v_mfma_f32_16x16x32_bf16 v[148:151], a[72:75], a[36:39], v[148:151]
  ds_read_b64_tr_b16 a[108:109], v11 offset:24576
  v_mfma_f32_16x16x32_bf16 v[148:151], a[76:79], a[52:55], v[148:151]
  v_mfma_f32_16x16x32_bf16 v[144:147], a[76:79], a[48:51], v[144:147]
  ds_read_b64_tr_b16 a[110:111], v11 offset:25600
  v_mfma_f32_16x16x32_bf16 v[144:147], a[72:75], a[32:35], v[144:147]
  ds_read_b64_tr_b16 a[112:113], v12 offset:16384
  v_mfma_f32_16x16x32_bf16 v[160:163], a[80:83], a[32:35], v[160:163]
  buffer_load_dwordx4 v23, s[12:15], s27 offen offset:1024 sc1 lds
  v_mfma_f32_16x16x32_bf16 v[160:163], a[84:87], a[48:51], v[160:163]
  ds_read_b64_tr_b16 a[114:115], v12 offset:17408
  v_mfma_f32_16x16x32_bf16 v[164:167], a[84:87], a[52:55], v[164:167]
  ds_read_b64_tr_b16 a[116:117], v12 offset:24576
  v_mfma_f32_16x16x32_bf16 v[164:167], a[80:83], a[36:39], v[164:167]
  buffer_load_dwordx4 v24, s[12:15], s27 offen offset:2048 sc1 lds
  v_mfma_f32_16x16x32_bf16 v[168:171], a[80:83], a[40:43], v[168:171]
  v_mfma_f32_16x16x32_bf16 v[168:171], a[84:87], a[56:59], v[168:171]
  ds_read_b64_tr_b16 a[118:119], v12 offset:25600
  v_mfma_f32_16x16x32_bf16 v[172:175], a[84:87], a[60:63], v[172:175]
  ds_read_b64_tr_b16 a[120:121], v13 offset:16384
  v_mfma_f32_16x16x32_bf16 v[172:175], a[80:83], a[44:47], v[172:175]
  ds_read_b64_tr_b16 a[122:123], v13 offset:17408
  v_mfma_f32_16x16x32_bf16 v[188:191], a[88:91], a[44:47], v[188:191]
  buffer_load_dwordx4 v25, s[12:15], s27 offen offset:3072 sc1 lds
  v_mfma_f32_16x16x32_bf16 v[188:191], a[92:95], a[60:63], v[188:191]
  ds_read_b64_tr_b16 a[124:125], v13 offset:24576
  v_mfma_f32_16x16x32_bf16 v[184:187], a[92:95], a[56:59], v[184:187]
  ds_read_b64_tr_b16 a[126:127], v13 offset:25600
  v_mfma_f32_16x16x32_bf16 v[184:187], a[88:91], a[40:43], v[184:187]
  v_mfma_f32_16x16x32_bf16 v[180:183], a[88:91], a[36:39], v[180:183]
  v_mfma_f32_16x16x32_bf16 v[180:183], a[92:95], a[52:55], v[180:183]
  v_mfma_f32_16x16x32_bf16 v[176:179], a[92:95], a[48:51], v[176:179]
  s_add_u32 s26, s26, 128
  v_mfma_f32_16x16x32_bf16 v[176:179], a[88:91], a[32:35], v[176:179]
  s_add_u32 s27, s27, s34
  s_xor_b32 s34, s34, s92
  s_waitcnt lgkmcnt(0) vmcnt(12)
  s_barrier
  v_mfma_f32_16x16x32_bf16 v[192:195], a[96:99], a[32:35], v[192:195]
  s_add_u32 m0, s48, 0
  ds_read_b64_tr_b16 a[64:65], v6 offset:32768
  v_mfma_f32_16x16x32_bf16 v[192:195], a[100:103], a[48:51], v[192:195]
  buffer_load_dwordx4 v26, s[52:55], s44 offen offset:0 sc1 lds
  v_mfma_f32_16x16x32_bf16 v[196:199], a[100:103], a[52:55], v[196:199]
  ds_read_b64_tr_b16 a[66:67], v6 offset:33792
  v_mfma_f32_16x16x32_bf16 v[196:199], a[96:99], a[36:39], v[196:199]
  ds_read_b64_tr_b16 a[68:69], v6 offset:40960
  v_mfma_f32_16x16x32_bf16 v[200:203], a[96:99], a[40:43], v[200:203]
  ds_read_b64_tr_b16 a[70:71], v6 offset:41984
  buffer_load_dwordx4 v27, s[52:55], s44 offen offset:1024 sc1 lds
  v_mfma_f32_16x16x32_bf16 v[200:203], a[100:103], a[56:59], v[200:203]
  ds_read_b128 a[0:3], v4 offset:0
  v_mfma_f32_16x16x32_bf16 v[204:207], a[100:103], a[60:63], v[204:207]
  ds_read_b128 a[16:19], v5 offset:0
  v_mfma_f32_16x16x32_bf16 v[204:207], a[96:99], a[44:47], v[204:207]
  ds_read_b128 a[4:7], v4 offset:2048
  v_mfma_f32_16x16x32_bf16 v[220:223], a[104:107], a[44:47], v[220:223]
  buffer_load_dwordx4 v28, s[52:55], s44 offen offset:2048 sc1 lds
  v_mfma_f32_16x16x32_bf16 v[220:223], a[108:111], a[60:63], v[220:223]
  ds_read_b128 a[20:23], v5 offset:2048
  ds_read_b128 a[8:11], v4 offset:4096
  v_mfma_f32_16x16x32_bf16 v[216:219], a[108:111], a[56:59], v[216:219]
  ds_read_b128 a[24:27], v5 offset:4096
  v_mfma_f32_16x16x32_bf16 v[216:219], a[104:107], a[40:43], v[216:219]
  buffer_load_dwordx4 v29, s[52:55], s44 offen offset:3072 sc1 lds
  v_mfma_f32_16x16x32_bf16 v[212:215], a[104:107], a[36:39], v[212:215]
  ds_read_b128 a[12:15], v4 offset:6144
  v_mfma_f32_16x16x32_bf16 v[212:215], a[108:111], a[52:55], v[212:215]
  ds_read_b128 a[28:31], v5 offset:6144
  v_mfma_f32_16x16x32_bf16 v[208:211], a[108:111], a[48:51], v[208:211]
  s_add_u32 m0, s48, 4096
  ds_read_b64_tr_b16 a[72:73], v7 offset:32768
  v_mfma_f32_16x16x32_bf16 v[208:211], a[104:107], a[32:35], v[208:211]
  buffer_load_dwordx4 v26, s[52:55], s45 offen offset:0 sc1 lds
  v_mfma_f32_16x16x32_bf16 v[224:227], a[112:115], a[32:35], v[224:227]
  ds_read_b64_tr_b16 a[74:75], v7 offset:33792
  v_mfma_f32_16x16x32_bf16 v[224:227], a[116:119], a[48:51], v[224:227]
  ds_read_b64_tr_b16 a[76:77], v7 offset:40960
  v_mfma_f32_16x16x32_bf16 v[228:231], a[116:119], a[52:55], v[228:231]
  ds_read_b64_tr_b16 a[78:79], v7 offset:41984
  buffer_load_dwordx4 v27, s[52:55], s45 offen offset:1024 sc1 lds
  v_mfma_f32_16x16x32_bf16 v[228:231], a[112:115], a[36:39], v[228:231]
  ds_read_b64_tr_b16 a[80:81], v8 offset:32768
  v_mfma_f32_16x16x32_bf16 v[232:235], a[112:115], a[40:43], v[232:235]
  ds_read_b64_tr_b16 a[82:83], v8 offset:33792
  v_mfma_f32_16x16x32_bf16 v[232:235], a[116:119], a[56:59], v[232:235]
  ds_read_b64_tr_b16 a[84:85], v8 offset:40960
  v_mfma_f32_16x16x32_bf16 v[236:239], a[116:119], a[60:63], v[236:239]
  buffer_load_dwordx4 v28, s[52:55], s45 offen offset:2048 sc1 lds
  v_mfma_f32_16x16x32_bf16 v[236:239], a[112:115], a[44:47], v[236:239]
  ds_read_b64_tr_b16 a[86:87], v8 offset:41984
  ds_read_b64_tr_b16 a[88:89], v9 offset:32768
  v_mfma_f32_16x16x32_bf16 v[252:255], a[120:123], a[44:47], v[252:255]
  ds_read_b64_tr_b16 a[90:91], v9 offset:33792
  v_mfma_f32_16x16x32_bf16 v[252:255], a[124:127], a[60:63], v[252:255]
  buffer_load_dwordx4 v29, s[52:55], s45 offen offset:3072 sc1 lds
  v_mfma_f32_16x16x32_bf16 v[248:251], a[124:127], a[56:59], v[248:251]
  ds_read_b64_tr_b16 a[92:93], v9 offset:40960
  v_mfma_f32_16x16x32_bf16 v[248:251], a[120:123], a[40:43], v[248:251]
  ds_read_b64_tr_b16 a[94:95], v9 offset:41984
  v_mfma_f32_16x16x32_bf16 v[244:247], a[120:123], a[36:39], v[244:247]
  v_mfma_f32_16x16x32_bf16 v[244:247], a[124:127], a[52:55], v[244:247]
  v_mfma_f32_16x16x32_bf16 v[240:243], a[124:127], a[48:51], v[240:243]
  v_mfma_f32_16x16x32_bf16 v[240:243], a[120:123], a[32:35], v[240:243]
  s_waitcnt lgkmcnt(0)
  v_mfma_f32_16x16x32_bf16 v[128:131], a[64:67], a[0:3], v[128:131]
  ds_read_b64_tr_b16 a[96:97], v10 offset:32768
  v_mfma_f32_16x16x32_bf16 v[128:131], a[68:71], a[16:19], v[128:131]
  buffer_load_ushort v52, v43, s[56:59], s49 offen offset:0
  v_mfma_f32_16x16x32_bf16 v[132:135], a[68:71], a[20:23], v[132:135]
  ds_read_b64_tr_b16 a[98:99], v10 offset:33792
  v_mfma_f32_16x16x32_bf16 v[132:135], a[64:67], a[4:7], v[132:135]
  v_mfma_f32_16x16x32_bf16 v[136:139], a[64:67], a[8:11], v[136:139]
  ds_read_b64_tr_b16 a[100:101], v10 offset:40960
  v_mfma_f32_16x16x32_bf16 v[136:139], a[68:71], a[24:27], v[136:139]
  ds_read_b64_tr_b16 a[102:103], v10 offset:41984
  v_mfma_f32_16x16x32_bf16 v[140:143], a[68:71], a[28:31], v[140:143]
  v_mfma_f32_16x16x32_bf16 v[140:143], a[64:67], a[12:15], v[140:143]
  ds_read_b64_tr_b16 a[104:105], v11 offset:32768
  v_mfma_f32_16x16x32_bf16 v[156:159], a[72:75], a[12:15], v[156:159]
  buffer_load_ushort v54, v43, s[56:59], s49 offen offset:32
  v_mfma_f32_16x16x32_bf16 v[156:159], a[76:79], a[28:31], v[156:159]
  ds_read_b64_tr_b16 a[106:107], v11 offset:33792
  v_mfma_f32_16x16x32_bf16 v[152:155], a[76:79], a[24:27], v[152:155]
  v_mfma_f32_16x16x32_bf16 v[152:155], a[72:75], a[8:11], v[152:155]
  ds_read_b64_tr_b16 a[108:109], v11 offset:40960
  v_mfma_f32_16x16x32_bf16 v[148:151], a[72:75], a[4:7], v[148:151]
  ds_read_b64_tr_b16 a[110:111], v11 offset:41984
  v_mfma_f32_16x16x32_bf16 v[148:151], a[76:79], a[20:23], v[148:151]
  v_mfma_f32_16x16x32_bf16 v[144:147], a[76:79], a[16:19], v[144:147]
  ds_read_b64_tr_b16 a[112:113], v12 offset:32768
  v_mfma_f32_16x16x32_bf16 v[144:147], a[72:75], a[0:3], v[144:147]
  buffer_load_ushort v56, v43, s[56:59], s49 offen offset:64
  v_mfma_f32_16x16x32_bf16 v[160:163], a[80:83], a[0:3], v[160:163]
  ds_read_b64_tr_b16 a[114:115], v12 offset:33792
  v_mfma_f32_16x16x32_bf16 v[160:163], a[84:87], a[16:19], v[160:163]
  v_mfma_f32_16x16x32_bf16 v[164:167], a[84:87], a[20:23], v[164:167]
  ds_read_b64_tr_b16 a[116:117], v12 offset:40960
  v_mfma_f32_16x16x32_bf16 v[164:167], a[80:83], a[4:7], v[164:167]
  ds_read_b64_tr_b16 a[118:119], v12 offset:41984
  v_mfma_f32_16x16x32_bf16 v[168:171], a[80:83], a[8:11], v[168:171]
  v_mfma_f32_16x16x32_bf16 v[168:171], a[84:87], a[24:27], v[168:171]
  ds_read_b64_tr_b16 a[120:121], v13 offset:32768
  v_mfma_f32_16x16x32_bf16 v[172:175], a[84:87], a[28:31], v[172:175]
  buffer_load_ushort v58, v43, s[56:59], s49 offen offset:96
  v_mfma_f32_16x16x32_bf16 v[172:175], a[80:83], a[12:15], v[172:175]
  ds_read_b64_tr_b16 a[122:123], v13 offset:33792
  v_mfma_f32_16x16x32_bf16 v[188:191], a[88:91], a[12:15], v[188:191]
  v_mfma_f32_16x16x32_bf16 v[188:191], a[92:95], a[28:31], v[188:191]
  ds_read_b64_tr_b16 a[124:125], v13 offset:40960
  v_mfma_f32_16x16x32_bf16 v[184:187], a[92:95], a[24:27], v[184:187]
  ds_read_b64_tr_b16 a[126:127], v13 offset:41984
  v_mfma_f32_16x16x32_bf16 v[184:187], a[88:91], a[8:11], v[184:187]
  v_mfma_f32_16x16x32_bf16 v[180:183], a[88:91], a[4:7], v[180:183]
  v_mfma_f32_16x16x32_bf16 v[180:183], a[92:95], a[20:23], v[180:183]
  v_mfma_f32_16x16x32_bf16 v[176:179], a[92:95], a[16:19], v[176:179]
  v_mfma_f32_16x16x32_bf16 v[176:179], a[88:91], a[0:3], v[176:179]
  s_waitcnt lgkmcnt(0) vmcnt(12)
  s_barrier
  v_mfma_f32_16x16x32_bf16 v[192:195], a[96:99], a[0:3], v[192:195]
  s_add_u32 m0, s48, 32768
  ds_read_b64_tr_b16 a[64:65], v6 offset:0
  v_mfma_f32_16x16x32_bf16 v[192:195], a[100:103], a[16:19], v[192:195]
  buffer_load_dwordx4 v26, s[52:55], s46 offen offset:0 sc1 lds
  v_mfma_f32_16x16x32_bf16 v[196:199], a[100:103], a[20:23], v[196:199]
  ds_read_b64_tr_b16 a[66:67], v6 offset:1024
  v_mfma_f32_16x16x32_bf16 v[196:199], a[96:99], a[4:7], v[196:199]
  ds_read_b64_tr_b16 a[68:69], v6 offset:8192
  v_mfma_f32_16x16x32_bf16 v[200:203], a[96:99], a[8:11], v[200:203]
  ds_read_b64_tr_b16 a[70:71], v6 offset:9216
  buffer_load_dwordx4 v27, s[52:55], s46 offen offset:1024 sc1 lds
  v_mfma_f32_16x16x32_bf16 v[200:203], a[100:103], a[24:27], v[200:203]
  ds_read_b128 a[32:35], v2 offset:0
  v_mfma_f32_16x16x32_bf16 v[204:207], a[100:103], a[28:31], v[204:207]
  ds_read_b128 a[48:51], v3 offset:0
  v_mfma_f32_16x16x32_bf16 v[204:207], a[96:99], a[12:15], v[204:207]
  ds_read_b128 a[36:39], v2 offset:2048
  v_mfma_f32_16x16x32_bf16 v[220:223], a[104:107], a[12:15], v[220:223]
  buffer_load_dwordx4 v28, s[52:55], s46 offen offset:2048 sc1 lds
  v_mfma_f32_16x16x32_bf16 v[220:223], a[108:111], a[28:31], v[220:223]
  ds_read_b128 a[52:55], v3 offset:2048
  ds_read_b128 a[40:43], v2 offset:4096
  v_mfma_f32_16x16x32_bf16 v[216:219], a[108:111], a[24:27], v[216:219]
  ds_read_b128 a[56:59], v3 offset:4096
  v_mfma_f32_16x16x32_bf16 v[216:219], a[104:107], a[8:11], v[216:219]
  buffer_load_dwordx4 v29, s[52:55], s46 offen offset:3072 sc1 lds
  v_mfma_f32_16x16x32_bf16 v[212:215], a[104:107], a[4:7], v[212:215]
  ds_read_b128 a[44:47], v2 offset:6144
  v_mfma_f32_16x16x32_bf16 v[212:215], a[108:111], a[20:23], v[212:215]
  ds_read_b128 a[60:63], v3 offset:6144
  v_mfma_f32_16x16x32_bf16 v[208:211], a[108:111], a[16:19], v[208:211]
  s_add_u32 m0, s48, 36864
  ds_read_b64_tr_b16 a[72:73], v7 offset:0
  v_mfma_f32_16x16x32_bf16 v[208:211], a[104:107], a[0:3], v[208:211]
  buffer_load_dwordx4 v26, s[52:55], s47 offen offset:0 sc1 lds
  v_mfma_f32_16x16x32_bf16 v[224:227], a[112:115], a[0:3], v[224:227]
  ds_read_b64_tr_b16 a[74:75], v7 offset:1024
  v_mfma_f32_16x16x32_bf16 v[224:227], a[116:119], a[16:19], v[224:227]
  ds_read_b64_tr_b16 a[76:77], v7 offset:8192
  v_mfma_f32_16x16x32_bf16 v[228:231], a[116:119], a[20:23], v[228:231]
  ds_read_b64_tr_b16 a[78:79], v7 offset:9216
  buffer_load_dwordx4 v27, s[52:55], s47 offen offset:1024 sc1 lds
  v_mfma_f32_16x16x32_bf16 v[228:231], a[112:115], a[4:7], v[228:231]
  ds_read_b64_tr_b16 a[80:81], v8 offset:0
  v_mfma_f32_16x16x32_bf16 v[232:235], a[112:115], a[8:11], v[232:235]
  ds_read_b64_tr_b16 a[82:83], v8 offset:1024
  v_mfma_f32_16x16x32_bf16 v[232:235], a[116:119], a[24:27], v[232:235]
  ds_read_b64_tr_b16 a[84:85], v8 offset:8192
  v_mfma_f32_16x16x32_bf16 v[236:239], a[116:119], a[28:31], v[236:239]
  buffer_load_dwordx4 v28, s[52:55], s47 offen offset:2048 sc1 lds
  v_mfma_f32_16x16x32_bf16 v[236:239], a[112:115], a[12:15], v[236:239]
  ds_read_b64_tr_b16 a[86:87], v8 offset:9216
  ds_read_b64_tr_b16 a[88:89], v9 offset:0
  v_mfma_f32_16x16x32_bf16 v[252:255], a[120:123], a[12:15], v[252:255]
  ds_read_b64_tr_b16 a[90:91], v9 offset:1024
  v_mfma_f32_16x16x32_bf16 v[252:255], a[124:127], a[28:31], v[252:255]
  buffer_load_dwordx4 v29, s[52:55], s47 offen offset:3072 sc1 lds
  v_mfma_f32_16x16x32_bf16 v[248:251], a[124:127], a[24:27], v[248:251]
  ds_read_b64_tr_b16 a[92:93], v9 offset:8192
  v_mfma_f32_16x16x32_bf16 v[248:251], a[120:123], a[8:11], v[248:251]
  ds_read_b64_tr_b16 a[94:95], v9 offset:9216
  v_mfma_f32_16x16x32_bf16 v[244:247], a[120:123], a[4:7], v[244:247]
  v_mfma_f32_16x16x32_bf16 v[244:247], a[124:127], a[20:23], v[244:247]
  v_mfma_f32_16x16x32_bf16 v[240:243], a[124:127], a[16:19], v[240:243]
  v_mfma_f32_16x16x32_bf16 v[240:243], a[120:123], a[0:3], v[240:243]
  s_waitcnt lgkmcnt(0)
  v_mfma_f32_16x16x32_bf16 v[128:131], a[64:67], a[32:35], v[128:131]
  ds_read_b64_tr_b16 a[96:97], v10 offset:0
  v_mfma_f32_16x16x32_bf16 v[128:131], a[68:71], a[48:51], v[128:131]
  ds_read_b64_tr_b16 a[98:99], v10 offset:1024
  v_mfma_f32_16x16x32_bf16 v[132:135], a[68:71], a[52:55], v[132:135]
  v_mfma_f32_16x16x32_bf16 v[132:135], a[64:67], a[36:39], v[132:135]
  ds_read_b64_tr_b16 a[100:101], v10 offset:8192
  v_mfma_f32_16x16x32_bf16 v[136:139], a[64:67], a[40:43], v[136:139]
  v_mfma_f32_16x16x32_bf16 v[136:139], a[68:71], a[56:59], v[136:139]
  ds_read_b64_tr_b16 a[102:103], v10 offset:9216
  v_mfma_f32_16x16x32_bf16 v[140:143], a[68:71], a[60:63], v[140:143]
  ds_read_b64_tr_b16 a[104:105], v11 offset:0
  v_mfma_f32_16x16x32_bf16 v[140:143], a[64:67], a[44:47], v[140:143]
  v_mfma_f32_16x16x32_bf16 v[156:159], a[72:75], a[44:47], v[156:159]
  ds_read_b64_tr_b16 a[106:107], v11 offset:1024
  v_mfma_f32_16x16x32_bf16 v[156:159], a[76:79], a[60:63], v[156:159]
  v_mfma_f32_16x16x32_bf16 v[152:155], a[76:79], a[56:59], v[152:155]
  ds_read_b64_tr_b16 a[108:109], v11 offset:8192
  v_mfma_f32_16x16x32_bf16 v[152:155], a[72:75], a[40:43], v[152:155]
  ds_read_b64_tr_b16 a[110:111], v11 offset:9216
  v_mfma_f32_16x16x32_bf16 v[148:151], a[72:75], a[36:39], v[148:151]
  v_mfma_f32_16x16x32_bf16 v[148:151], a[76:79], a[52:55], v[148:151]
  ds_read_b64_tr_b16 a[112:113], v12 offset:0
  v_mfma_f32_16x16x32_bf16 v[144:147], a[76:79], a[48:51], v[144:147]
  v_mfma_f32_16x16x32_bf16 v[144:147], a[72:75], a[32:35], v[144:147]
  ds_read_b64_tr_b16 a[114:115], v12 offset:1024
  v_mfma_f32_16x16x32_bf16 v[160:163], a[80:83], a[32:35], v[160:163]
  ds_read_b64_tr_b16 a[116:117], v12 offset:8192
  v_mfma_f32_16x16x32_bf16 v[160:163], a[84:87], a[48:51], v[160:163]
  v_mfma_f32_16x16x32_bf16 v[164:167], a[84:87], a[52:55], v[164:167]
  ds_read_b64_tr_b16 a[118:119], v12 offset:9216
  v_mfma_f32_16x16x32_bf16 v[164:167], a[80:83], a[36:39], v[164:167]
  v_mfma_f32_16x16x32_bf16 v[168:171], a[80:83], a[40:43], v[168:171]
  ds_read_b64_tr_b16 a[120:121], v13 offset:0
  v_mfma_f32_16x16x32_bf16 v[168:171], a[84:87], a[56:59], v[168:171]
  ds_read_b64_tr_b16 a[122:123], v13 offset:1024
  v_mfma_f32_16x16x32_bf16 v[172:175], a[84:87], a[60:63], v[172:175]
  v_mfma_f32_16x16x32_bf16 v[172:175], a[80:83], a[44:47], v[172:175]
  ds_read_b64_tr_b16 a[124:125], v13 offset:8192
  v_mfma_f32_16x16x32_bf16 v[188:191], a[88:91], a[44:47], v[188:191]
  v_mfma_f32_16x16x32_bf16 v[188:191], a[92:95], a[60:63], v[188:191]
  ds_read_b64_tr_b16 a[126:127], v13 offset:9216
  v_mfma_f32_16x16x32_bf16 v[184:187], a[92:95], a[56:59], v[184:187]
  v_mfma_f32_16x16x32_bf16 v[184:187], a[88:91], a[40:43], v[184:187]
  v_mfma_f32_16x16x32_bf16 v[180:183], a[88:91], a[36:39], v[180:183]
  v_mfma_f32_16x16x32_bf16 v[180:183], a[92:95], a[52:55], v[180:183]
  v_mfma_f32_16x16x32_bf16 v[176:179], a[92:95], a[48:51], v[176:179]
  v_mfma_f32_16x16x32_bf16 v[176:179], a[88:91], a[32:35], v[176:179]
  s_waitcnt lgkmcnt(0)
  v_mfma_f32_16x16x32_bf16 v[192:195], a[96:99], a[32:35], v[192:195]
  v_mfma_f32_16x16x32_bf16 v[192:195], a[100:103], a[48:51], v[192:195]
  v_mfma_f32_16x16x32_bf16 v[196:199], a[100:103], a[52:55], v[196:199]
  v_mfma_f32_16x16x32_bf16 v[196:199], a[96:99], a[36:39], v[196:199]
  v_mfma_f32_16x16x32_bf16 v[200:203], a[96:99], a[40:43], v[200:203]
  v_mfma_f32_16x16x32_bf16 v[200:203], a[100:103], a[56:59], v[200:203]
  v_mfma_f32_16x16x32_bf16 v[204:207], a[100:103], a[60:63], v[204:207]
  v_mfma_f32_16x16x32_bf16 v[204:207], a[96:99], a[44:47], v[204:207]
  v_mfma_f32_16x16x32_bf16 v[220:223], a[104:107], a[44:47], v[220:223]
  v_mfma_f32_16x16x32_bf16 v[220:223], a[108:111], a[60:63], v[220:223]
  v_mfma_f32_16x16x32_bf16 v[216:219], a[108:111], a[56:59], v[216:219]
  v_mfma_f32_16x16x32_bf16 v[216:219], a[104:107], a[40:43], v[216:219]
  v_mfma_f32_16x16x32_bf16 v[212:215], a[104:107], a[36:39], v[212:215]
  v_mfma_f32_16x16x32_bf16 v[212:215], a[108:111], a[52:55], v[212:215]
  v_mfma_f32_16x16x32_bf16 v[208:211], a[108:111], a[48:51], v[208:211]
  v_mfma_f32_16x16x32_bf16 v[208:211], a[104:107], a[32:35], v[208:211]
  v_mfma_f32_16x16x32_bf16 v[224:227], a[112:115], a[32:35], v[224:227]
  v_mfma_f32_16x16x32_bf16 v[224:227], a[116:119], a[48:51], v[224:227]
  v_mfma_f32_16x16x32_bf16 v[228:231], a[116:119], a[52:55], v[228:231]
  v_mfma_f32_16x16x32_bf16 v[228:231], a[112:115], a[36:39], v[228:231]
  v_mfma_f32_16x16x32_bf16 v[232:235], a[112:115], a[40:43], v[232:235]
  v_mfma_f32_16x16x32_bf16 v[232:235], a[116:119], a[56:59], v[232:235]
  v_mfma_f32_16x16x32_bf16 v[236:239], a[116:119], a[60:63], v[236:239]
  v_mfma_f32_16x16x32_bf16 v[236:239], a[112:115], a[44:47], v[236:239]
  v_mfma_f32_16x16x32_bf16 v[252:255], a[120:123], a[44:47], v[252:255]
  v_mfma_f32_16x16x32_bf16 v[252:255], a[124:127], a[60:63], v[252:255]
  v_mfma_f32_16x16x32_bf16 v[248:251], a[124:127], a[56:59], v[248:251]
  v_mfma_f32_16x16x32_bf16 v[248:251], a[120:123], a[40:43], v[248:251]
  v_mfma_f32_16x16x32_bf16 v[244:247], a[120:123], a[36:39], v[244:247]
  v_mfma_f32_16x16x32_bf16 v[244:247], a[124:127], a[52:55], v[244:247]
  v_mfma_f32_16x16x32_bf16 v[240:243], a[124:127], a[48:51], v[240:243]
  v_mfma_f32_16x16x32_bf16 v[240:243], a[120:123], a[32:35], v[240:243]
  s_waitcnt vmcnt(0)
  s_cmp_eq_u32 s36, 1
  s_cbranch_scc1 mid_epi_wo
  v_lshlrev_b32 v52, 16, v52
  v_mov_b32 v53, v52
  v_lshlrev_b32 v54, 16, v54
  v_mov_b32 v55, v54
  v_lshlrev_b32 v56, 16, v56
  v_mov_b32 v57, v56
  v_lshlrev_b32 v58, 16, v58
  v_mov_b32 v59, v58
  ds_read_b64 v[60:61], v30 offset:0
  ds_read_b64 v[62:63], v31 offset:0
  ds_read_b64 v[64:65], v32 offset:0
  ds_read_b64 v[66:67], v33 offset:0
  ds_read_b64 v[68:69], v34 offset:0
  ds_read_b64 v[70:71], v35 offset:0
  ds_read_b64 v[72:73], v36 offset:0
  ds_read_b64 v[74:75], v37 offset:0
  s_waitcnt lgkmcnt(0)
  v_lshlrev_b32 v92, 16, v60
  v_and_b32 v93, 0xffff0000, v60
  v_lshlrev_b32 v94, 16, v61
  v_and_b32 v95, 0xffff0000, v61
  v_pk_add_f32 v[128:129], v[128:129], v[52:53]
  v_pk_add_f32 v[130:131], v[130:131], v[52:53]
  v_pk_mul_f32 v[128:129], v[128:129], v[92:93]
  v_pk_mul_f32 v[130:131], v[130:131], v[94:95]
  v_cvt_pk_bf16_f32 v44, v128, v129
  v_cvt_pk_bf16_f32 v45, v130, v131
  ds_write_b64 v30, v[44:45] offset:0
  v_lshlrev_b32 v92, 16, v62
  v_and_b32 v93, 0xffff0000, v62
  v_lshlrev_b32 v94, 16, v63
  v_and_b32 v95, 0xffff0000, v63
  v_pk_add_f32 v[144:145], v[144:145], v[52:53]
  v_pk_add_f32 v[146:147], v[146:147], v[52:53]
  v_pk_mul_f32 v[144:145], v[144:145], v[92:93]
  v_pk_mul_f32 v[146:147], v[146:147], v[94:95]
  v_cvt_pk_bf16_f32 v46, v144, v145
  v_cvt_pk_bf16_f32 v47, v146, v147
  ds_write_b64 v31, v[46:47] offset:0
  v_lshlrev_b32 v92, 16, v64
  v_and_b32 v93, 0xffff0000, v64
  v_lshlrev_b32 v94, 16, v65
  v_and_b32 v95, 0xffff0000, v65
  v_pk_add_f32 v[160:161], v[160:161], v[52:53]
  v_pk_add_f32 v[162:163], v[162:163], v[52:53]
  v_pk_mul_f32 v[160:161], v[160:161], v[92:93]
  v_pk_mul_f32 v[162:163], v[162:163], v[94:95]
  v_cvt_pk_bf16_f32 v48, v160, v161
  v_cvt_pk_bf16_f32 v49, v162, v163
  ds_write_b64 v32, v[48:49] offset:0
  v_lshlrev_b32 v92, 16, v66
  v_and_b32 v93, 0xffff0000, v66
  v_lshlrev_b32 v94, 16, v67
  v_and_b32 v95, 0xffff0000, v67
  v_pk_add_f32 v[176:177], v[176:177], v[52:53]
  v_pk_add_f32 v[178:179], v[178:179], v[52:53]
  v_pk_mul_f32 v[176:177], v[176:177], v[92:93]
  v_pk_mul_f32 v[178:179], v[178:179], v[94:95]
  v_cvt_pk_bf16_f32 v50, v176, v177
  v_cvt_pk_bf16_f32 v51, v178, v179
  ds_write_b64 v33, v[50:51] offset:0
  v_lshlrev_b32 v92, 16, v68
  v_and_b32 v93, 0xffff0000, v68
  v_lshlrev_b32 v94, 16, v69
  v_and_b32 v95, 0xffff0000, v69
  v_pk_add_f32 v[192:193], v[192:193], v[52:53]
  v_pk_add_f32 v[194:195], v[194:195], v[52:53]
  v_pk_mul_f32 v[192:193], v[192:193], v[92:93]
  v_pk_mul_f32 v[194:195], v[194:195], v[94:95]
  v_cvt_pk_bf16_f32 v44, v192, v193
  v_cvt_pk_bf16_f32 v45, v194, v195
  ds_write_b64 v34, v[44:45] offset:0
  v_lshlrev_b32 v92, 16, v70
  v_and_b32 v93, 0xffff0000, v70
  v_lshlrev_b32 v94, 16, v71
  v_and_b32 v95, 0xffff0000, v71
  v_pk_add_f32 v[208:209], v[208:209], v[52:53]
  v_pk_add_f32 v[210:211], v[210:211], v[52:53]
  v_pk_mul_f32 v[208:209], v[208:209], v[92:93]
  v_pk_mul_f32 v[210:211], v[210:211], v[94:95]
  v_cvt_pk_bf16_f32 v46, v208, v209
  v_cvt_pk_bf16_f32 v47, v210, v211
  ds_write_b64 v35, v[46:47] offset:0
  v_lshlrev_b32 v92, 16, v72
  v_and_b32 v93, 0xffff0000, v72
  v_lshlrev_b32 v94, 16, v73
  v_and_b32 v95, 0xffff0000, v73
  v_pk_add_f32 v[224:225], v[224:225], v[52:53]
  v_pk_add_f32 v[226:227], v[226:227], v[52:53]
  v_pk_mul_f32 v[224:225], v[224:225], v[92:93]
  v_pk_mul_f32 v[226:227], v[226:227], v[94:95]
  v_cvt_pk_bf16_f32 v48, v224, v225
  v_cvt_pk_bf16_f32 v49, v226, v227
  ds_write_b64 v36, v[48:49] offset:0
  v_lshlrev_b32 v92, 16, v74
  v_and_b32 v93, 0xffff0000, v74
  v_lshlrev_b32 v94, 16, v75
  v_and_b32 v95, 0xffff0000, v75
  v_pk_add_f32 v[240:241], v[240:241], v[52:53]
  v_pk_add_f32 v[242:243], v[242:243], v[52:53]
  v_pk_mul_f32 v[240:241], v[240:241], v[92:93]
  v_pk_mul_f32 v[242:243], v[242:243], v[94:95]
  v_cvt_pk_bf16_f32 v50, v240, v241
  v_cvt_pk_bf16_f32 v51, v242, v243
  ds_write_b64 v37, v[50:51] offset:0
  ds_read_b64 v[76:77], v30 offset:4096
  ds_read_b64 v[78:79], v31 offset:4096
  ds_read_b64 v[80:81], v32 offset:4096
  ds_read_b64 v[82:83], v33 offset:4096
  ds_read_b64 v[84:85], v34 offset:4096
  ds_read_b64 v[86:87], v35 offset:4096
  ds_read_b64 v[88:89], v36 offset:4096
  ds_read_b64 v[90:91], v37 offset:4096
  ds_read_b128 v[96:99], v38 offset:0
  ds_read_b128 v[100:103], v39 offset:1024
  ds_read_b128 v[104:107], v40 offset:2048
  ds_read_b128 v[108:111], v41 offset:3072
  s_waitcnt lgkmcnt(4)
  v_lshlrev_b32 v92, 16, v76
  v_and_b32 v93, 0xffff0000, v76
  v_lshlrev_b32 v94, 16, v77
  v_and_b32 v95, 0xffff0000, v77
  v_pk_add_f32 v[132:133], v[132:133], v[54:55]
  v_pk_add_f32 v[134:135], v[134:135], v[54:55]
  v_pk_mul_f32 v[132:133], v[132:133], v[92:93]
  v_pk_mul_f32 v[134:135], v[134:135], v[94:95]
  v_cvt_pk_bf16_f32 v44, v132, v133
  v_cvt_pk_bf16_f32 v45, v134, v135
  ds_write_b64 v30, v[44:45] offset:4096
  v_lshlrev_b32 v92, 16, v78
  v_and_b32 v93, 0xffff0000, v78
  v_lshlrev_b32 v94, 16, v79
  v_and_b32 v95, 0xffff0000, v79
  v_pk_add_f32 v[148:149], v[148:149], v[54:55]
  v_pk_add_f32 v[150:151], v[150:151], v[54:55]
  v_pk_mul_f32 v[148:149], v[148:149], v[92:93]
  v_pk_mul_f32 v[150:151], v[150:151], v[94:95]
  v_cvt_pk_bf16_f32 v46, v148, v149
  v_cvt_pk_bf16_f32 v47, v150, v151
  ds_write_b64 v31, v[46:47] offset:4096
  v_lshlrev_b32 v92, 16, v80
  v_and_b32 v93, 0xffff0000, v80
  v_lshlrev_b32 v94, 16, v81
  v_and_b32 v95, 0xffff0000, v81
  v_pk_add_f32 v[164:165], v[164:165], v[54:55]
  v_pk_add_f32 v[166:167], v[166:167], v[54:55]
  v_pk_mul_f32 v[164:165], v[164:165], v[92:93]
  v_pk_mul_f32 v[166:167], v[166:167], v[94:95]
  v_cvt_pk_bf16_f32 v48, v164, v165
  v_cvt_pk_bf16_f32 v49, v166, v167
  ds_write_b64 v32, v[48:49] offset:4096
  v_lshlrev_b32 v92, 16, v82
  v_and_b32 v93, 0xffff0000, v82
  v_lshlrev_b32 v94, 16, v83
  v_and_b32 v95, 0xffff0000, v83
  v_pk_add_f32 v[180:181], v[180:181], v[54:55]
  v_pk_add_f32 v[182:183], v[182:183], v[54:55]
  v_pk_mul_f32 v[180:181], v[180:181], v[92:93]
  v_pk_mul_f32 v[182:183], v[182:183], v[94:95]
  v_cvt_pk_bf16_f32 v50, v180, v181
  v_cvt_pk_bf16_f32 v51, v182, v183
  ds_write_b64 v33, v[50:51] offset:4096
  v_lshlrev_b32 v92, 16, v84
  v_and_b32 v93, 0xffff0000, v84
  v_lshlrev_b32 v94, 16, v85
  v_and_b32 v95, 0xffff0000, v85
  v_pk_add_f32 v[196:197], v[196:197], v[54:55]
  v_pk_add_f32 v[198:199], v[198:199], v[54:55]
  v_pk_mul_f32 v[196:197], v[196:197], v[92:93]
  v_pk_mul_f32 v[198:199], v[198:199], v[94:95]
  v_cvt_pk_bf16_f32 v44, v196, v197
  v_cvt_pk_bf16_f32 v45, v198, v199
  ds_write_b64 v34, v[44:45] offset:4096
  v_lshlrev_b32 v92, 16, v86
  v_and_b32 v93, 0xffff0000, v86
  v_lshlrev_b32 v94, 16, v87
  v_and_b32 v95, 0xffff0000, v87
  v_pk_add_f32 v[212:213], v[212:213], v[54:55]
  v_pk_add_f32 v[214:215], v[214:215], v[54:55]
  v_pk_mul_f32 v[212:213], v[212:213], v[92:93]
  v_pk_mul_f32 v[214:215], v[214:215], v[94:95]
  v_cvt_pk_bf16_f32 v46, v212, v213
  v_cvt_pk_bf16_f32 v47, v214, v215
  ds_write_b64 v35, v[46:47] offset:4096
  v_lshlrev_b32 v92, 16, v88
  v_and_b32 v93, 0xffff0000, v88
  v_lshlrev_b32 v94, 16, v89
  v_and_b32 v95, 0xffff0000, v89
  v_pk_add_f32 v[228:229], v[228:229], v[54:55]
  v_pk_add_f32 v[230:231], v[230:231], v[54:55]
  v_pk_mul_f32 v[228:229], v[228:229], v[92:93]
  v_pk_mul_f32 v[230:231], v[230:231], v[94:95]
  v_cvt_pk_bf16_f32 v48, v228, v229
  v_cvt_pk_bf16_f32 v49, v230, v231
  ds_write_b64 v36, v[48:49] offset:4096
  v_lshlrev_b32 v92, 16, v90
  v_and_b32 v93, 0xffff0000, v90
  v_lshlrev_b32 v94, 16, v91
  v_and_b32 v95, 0xffff0000, v91
  v_pk_add_f32 v[244:245], v[244:245], v[54:55]
  v_pk_add_f32 v[246:247], v[246:247], v[54:55]
  v_pk_mul_f32 v[244:245], v[244:245], v[92:93]
  v_pk_mul_f32 v[246:247], v[246:247], v[94:95]
  v_cvt_pk_bf16_f32 v50, v244, v245
  v_cvt_pk_bf16_f32 v51, v246, v247
  ds_write_b64 v37, v[50:51] offset:4096
  ds_read_b64 v[60:61], v30 offset:32768
  ds_read_b64 v[62:63], v31 offset:32768
  ds_read_b64 v[64:65], v32 offset:32768
  ds_read_b64 v[66:67], v33 offset:32768
  ds_read_b64 v[68:69], v34 offset:32768
  ds_read_b64 v[70:71], v35 offset:32768
  ds_read_b64 v[72:73], v36 offset:32768
  ds_read_b64 v[74:75], v37 offset:32768
  s_waitcnt lgkmcnt(15)
  buffer_store_dwordx4 v[96:99], v42, s[16:19], s30 offen sc1
  s_add_u32 s30, s30, s37
  buffer_store_dwordx4 v[100:103], v42, s[16:19], s30 offen sc1
  s_add_u32 s30, s30, s37
  buffer_store_dwordx4 v[104:107], v42, s[16:19], s30 offen sc1
  s_add_u32 s30, s30, s37
  buffer_store_dwordx4 v[108:111], v42, s[16:19], s30 offen sc1
  s_add_u32 s30, s30, s37
  ds_read_b128 v[112:115], v38 offset:4096
  ds_read_b128 v[116:119], v39 offset:5120
  ds_read_b128 v[120:123], v40 offset:6144
  ds_read_b128 v[124:127], v41 offset:7168
  s_waitcnt lgkmcnt(4)
  v_lshlrev_b32 v92, 16, v60
  v_and_b32 v93, 0xffff0000, v60
  v_lshlrev_b32 v94, 16, v61
  v_and_b32 v95, 0xffff0000, v61
  v_pk_add_f32 v[136:137], v[136:137], v[56:57]
  v_pk_add_f32 v[138:139], v[138:139], v[56:57]
  v_pk_mul_f32 v[136:137], v[136:137], v[92:93]
  v_pk_mul_f32 v[138:139], v[138:139], v[94:95]
  v_cvt_pk_bf16_f32 v44, v136, v137
  v_cvt_pk_bf16_f32 v45, v138, v139
  ds_write_b64 v30, v[44:45] offset:32768
  v_lshlrev_b32 v92, 16, v62
  v_and_b32 v93, 0xffff0000, v62
  v_lshlrev_b32 v94, 16, v63
  v_and_b32 v95, 0xffff0000, v63
  v_pk_add_f32 v[152:153], v[152:153], v[56:57]
  v_pk_add_f32 v[154:155], v[154:155], v[56:57]
  v_pk_mul_f32 v[152:153], v[152:153], v[92:93]
  v_pk_mul_f32 v[154:155], v[154:155], v[94:95]
  v_cvt_pk_bf16_f32 v46, v152, v153
  v_cvt_pk_bf16_f32 v47, v154, v155
  ds_write_b64 v31, v[46:47] offset:32768
  v_lshlrev_b32 v92, 16, v64
  v_and_b32 v93, 0xffff0000, v64
  v_lshlrev_b32 v94, 16, v65
  v_and_b32 v95, 0xffff0000, v65
  v_pk_add_f32 v[168:169], v[168:169], v[56:57]
  v_pk_add_f32 v[170:171], v[170:171], v[56:57]
  v_pk_mul_f32 v[168:169], v[168:169], v[92:93]
  v_pk_mul_f32 v[170:171], v[170:171], v[94:95]
  v_cvt_pk_bf16_f32 v48, v168, v169
  v_cvt_pk_bf16_f32 v49, v170, v171
  ds_write_b64 v32, v[48:49] offset:32768
  v_lshlrev_b32 v92, 16, v66
  v_and_b32 v93, 0xffff0000, v66
  v_lshlrev_b32 v94, 16, v67
  v_and_b32 v95, 0xffff0000, v67
  v_pk_add_f32 v[184:185], v[184:185], v[56:57]
  v_pk_add_f32 v[186:187], v[186:187], v[56:57]
  v_pk_mul_f32 v[184:185], v[184:185], v[92:93]
  v_pk_mul_f32 v[186:187], v[186:187], v[94:95]
  v_cvt_pk_bf16_f32 v50, v184, v185
  v_cvt_pk_bf16_f32 v51, v186, v187
  ds_write_b64 v33, v[50:51] offset:32768
  v_lshlrev_b32 v92, 16, v68
  v_and_b32 v93, 0xffff0000, v68
  v_lshlrev_b32 v94, 16, v69
  v_and_b32 v95, 0xffff0000, v69
  v_pk_add_f32 v[200:201], v[200:201], v[56:57]
  v_pk_add_f32 v[202:203], v[202:203], v[56:57]
  v_pk_mul_f32 v[200:201], v[200:201], v[92:93]
  v_pk_mul_f32 v[202:203], v[202:203], v[94:95]
  v_cvt_pk_bf16_f32 v44, v200, v201
  v_cvt_pk_bf16_f32 v45, v202, v203
  ds_write_b64 v34, v[44:45] offset:32768
  v_lshlrev_b32 v92, 16, v70
  v_and_b32 v93, 0xffff0000, v70
  v_lshlrev_b32 v94, 16, v71
  v_and_b32 v95, 0xffff0000, v71
  v_pk_add_f32 v[216:217], v[216:217], v[56:57]
  v_pk_add_f32 v[218:219], v[218:219], v[56:57]
  v_pk_mul_f32 v[216:217], v[216:217], v[92:93]
  v_pk_mul_f32 v[218:219], v[218:219], v[94:95]
  v_cvt_pk_bf16_f32 v46, v216, v217
  v_cvt_pk_bf16_f32 v47, v218, v219
  ds_write_b64 v35, v[46:47] offset:32768
  v_lshlrev_b32 v92, 16, v72
  v_and_b32 v93, 0xffff0000, v72
  v_lshlrev_b32 v94, 16, v73
  v_and_b32 v95, 0xffff0000, v73
  v_pk_add_f32 v[232:233], v[232:233], v[56:57]
  v_pk_add_f32 v[234:235], v[234:235], v[56:57]
  v_pk_mul_f32 v[232:233], v[232:233], v[92:93]
  v_pk_mul_f32 v[234:235], v[234:235], v[94:95]
  v_cvt_pk_bf16_f32 v48, v232, v233
  v_cvt_pk_bf16_f32 v49, v234, v235
  ds_write_b64 v36, v[48:49] offset:32768
  v_lshlrev_b32 v92, 16, v74
  v_and_b32 v93, 0xffff0000, v74
  v_lshlrev_b32 v94, 16, v75
  v_and_b32 v95, 0xffff0000, v75
  v_pk_add_f32 v[248:249], v[248:249], v[56:57]
  v_pk_add_f32 v[250:251], v[250:251], v[56:57]
  v_pk_mul_f32 v[248:249], v[248:249], v[92:93]
  v_pk_mul_f32 v[250:251], v[250:251], v[94:95]
  v_cvt_pk_bf16_f32 v50, v248, v249
  v_cvt_pk_bf16_f32 v51, v250, v251
  ds_write_b64 v37, v[50:51] offset:32768
  ds_read_b64 v[76:77], v30 offset:36864
  ds_read_b64 v[78:79], v31 offset:36864
  ds_read_b64 v[80:81], v32 offset:36864
  ds_read_b64 v[82:83], v33 offset:36864
  ds_read_b64 v[84:85], v34 offset:36864
  ds_read_b64 v[86:87], v35 offset:36864
  ds_read_b64 v[88:89], v36 offset:36864
  ds_read_b64 v[90:91], v37 offset:36864
  s_waitcnt lgkmcnt(15)
  buffer_store_dwordx4 v[112:115], v42, s[16:19], s30 offen sc1
  s_add_u32 s30, s30, s37
  buffer_store_dwordx4 v[116:119], v42, s[16:19], s30 offen sc1
  s_add_u32 s30, s30, s37
  buffer_store_dwordx4 v[120:123], v42, s[16:19], s30 offen sc1
  s_add_u32 s30, s30, s37
  buffer_store_dwordx4 v[124:127], v42, s[16:19], s30 offen sc1
  s_add_u32 s30, s30, s37
  ds_read_b128 v[96:99], v38 offset:32768
  ds_read_b128 v[100:103], v39 offset:33792
  ds_read_b128 v[104:107], v40 offset:34816
  ds_read_b128 v[108:111], v41 offset:35840
  s_waitcnt lgkmcnt(4)
  v_lshlrev_b32 v92, 16, v76
  v_and_b32 v93, 0xffff0000, v76
  v_lshlrev_b32 v94, 16, v77
  v_and_b32 v95, 0xffff0000, v77
  v_pk_add_f32 v[140:141], v[140:141], v[58:59]
  v_pk_add_f32 v[142:143], v[142:143], v[58:59]
  v_pk_mul_f32 v[140:141], v[140:141], v[92:93]
  v_pk_mul_f32 v[142:143], v[142:143], v[94:95]
  v_cvt_pk_bf16_f32 v44, v140, v141
  v_cvt_pk_bf16_f32 v45, v142, v143
  ds_write_b64 v30, v[44:45] offset:36864
  v_lshlrev_b32 v92, 16, v78
  v_and_b32 v93, 0xffff0000, v78
  v_lshlrev_b32 v94, 16, v79
  v_and_b32 v95, 0xffff0000, v79
  v_pk_add_f32 v[156:157], v[156:157], v[58:59]
  v_pk_add_f32 v[158:159], v[158:159], v[58:59]
  v_pk_mul_f32 v[156:157], v[156:157], v[92:93]
  v_pk_mul_f32 v[158:159], v[158:159], v[94:95]
  v_cvt_pk_bf16_f32 v46, v156, v157
  v_cvt_pk_bf16_f32 v47, v158, v159
  ds_write_b64 v31, v[46:47] offset:36864
  v_lshlrev_b32 v92, 16, v80
  v_and_b32 v93, 0xffff0000, v80
  v_lshlrev_b32 v94, 16, v81
  v_and_b32 v95, 0xffff0000, v81
  v_pk_add_f32 v[172:173], v[172:173], v[58:59]
  v_pk_add_f32 v[174:175], v[174:175], v[58:59]
  v_pk_mul_f32 v[172:173], v[172:173], v[92:93]
  v_pk_mul_f32 v[174:175], v[174:175], v[94:95]
  v_cvt_pk_bf16_f32 v48, v172, v173
  v_cvt_pk_bf16_f32 v49, v174, v175
  ds_write_b64 v32, v[48:49] offset:36864
  v_lshlrev_b32 v92, 16, v82
  v_and_b32 v93, 0xffff0000, v82
  v_lshlrev_b32 v94, 16, v83
  v_and_b32 v95, 0xffff0000, v83
  v_pk_add_f32 v[188:189], v[188:189], v[58:59]
  v_pk_add_f32 v[190:191], v[190:191], v[58:59]
  v_pk_mul_f32 v[188:189], v[188:189], v[92:93]
  v_pk_mul_f32 v[190:191], v[190:191], v[94:95]
  v_cvt_pk_bf16_f32 v50, v188, v189
  v_cvt_pk_bf16_f32 v51, v190, v191
  ds_write_b64 v33, v[50:51] offset:36864
  v_lshlrev_b32 v92, 16, v84
  v_and_b32 v93, 0xffff0000, v84
  v_lshlrev_b32 v94, 16, v85
  v_and_b32 v95, 0xffff0000, v85
  v_pk_add_f32 v[204:205], v[204:205], v[58:59]
  v_pk_add_f32 v[206:207], v[206:207], v[58:59]
  v_pk_mul_f32 v[204:205], v[204:205], v[92:93]
  v_pk_mul_f32 v[206:207], v[206:207], v[94:95]
  v_cvt_pk_bf16_f32 v44, v204, v205
  v_cvt_pk_bf16_f32 v45, v206, v207
  ds_write_b64 v34, v[44:45] offset:36864
  v_lshlrev_b32 v92, 16, v86
  v_and_b32 v93, 0xffff0000, v86
  v_lshlrev_b32 v94, 16, v87
  v_and_b32 v95, 0xffff0000, v87
  v_pk_add_f32 v[220:221], v[220:221], v[58:59]
  v_pk_add_f32 v[222:223], v[222:223], v[58:59]
  v_pk_mul_f32 v[220:221], v[220:221], v[92:93]
  v_pk_mul_f32 v[222:223], v[222:223], v[94:95]
  v_cvt_pk_bf16_f32 v46, v220, v221
  v_cvt_pk_bf16_f32 v47, v222, v223
  ds_write_b64 v35, v[46:47] offset:36864
  v_lshlrev_b32 v92, 16, v88
  v_and_b32 v93, 0xffff0000, v88
  v_lshlrev_b32 v94, 16, v89
  v_and_b32 v95, 0xffff0000, v89
  v_pk_add_f32 v[236:237], v[236:237], v[58:59]
  v_pk_add_f32 v[238:239], v[238:239], v[58:59]
  v_pk_mul_f32 v[236:237], v[236:237], v[92:93]
  v_pk_mul_f32 v[238:239], v[238:239], v[94:95]
  v_cvt_pk_bf16_f32 v48, v236, v237
  v_cvt_pk_bf16_f32 v49, v238, v239
  ds_write_b64 v36, v[48:49] offset:36864
  v_lshlrev_b32 v92, 16, v90
  v_and_b32 v93, 0xffff0000, v90
  v_lshlrev_b32 v94, 16, v91
  v_and_b32 v95, 0xffff0000, v91
  v_pk_add_f32 v[252:253], v[252:253], v[58:59]
  v_pk_add_f32 v[254:255], v[254:255], v[58:59]
  v_pk_mul_f32 v[252:253], v[252:253], v[92:93]
  v_pk_mul_f32 v[254:255], v[254:255], v[94:95]
  v_cvt_pk_bf16_f32 v50, v252, v253
  v_cvt_pk_bf16_f32 v51, v254, v255
  ds_write_b64 v37, v[50:51] offset:36864
  s_waitcnt lgkmcnt(8)
  buffer_store_dwordx4 v[96:99], v42, s[16:19], s30 offen sc1
  s_add_u32 s30, s30, s37
  buffer_store_dwordx4 v[100:103], v42, s[16:19], s30 offen sc1
  s_add_u32 s30, s30, s37
  buffer_store_dwordx4 v[104:107], v42, s[16:19], s30 offen sc1
  s_add_u32 s30, s30, s37
  buffer_store_dwordx4 v[108:111], v42, s[16:19], s30 offen sc1
  s_add_u32 s30, s30, s37
  ds_read_b128 v[112:115], v38 offset:36864
  ds_read_b128 v[116:119], v39 offset:37888
  ds_read_b128 v[120:123], v40 offset:38912
  ds_read_b128 v[124:127], v41 offset:39936
  s_waitcnt lgkmcnt(0)
  buffer_store_dwordx4 v[112:115], v42, s[16:19], s30 offen sc1
  s_add_u32 s30, s30, s37
  buffer_store_dwordx4 v[116:119], v42, s[16:19], s30 offen sc1
  s_add_u32 s30, s30, s37
  buffer_store_dwordx4 v[120:123], v42, s[16:19], s30 offen sc1
  s_add_u32 s30, s30, s37
  buffer_store_dwordx4 v[124:127], v42, s[16:19], s30 offen sc1
  s_add_u32 s30, s30, s37
  s_branch mid_fin
mid_epi_wo:
  s_nop 7
  v_cvt_pk_bf16_f32 v44, v128, v129
  v_cvt_pk_bf16_f32 v45, v130, v131
  ds_write_b64 v30, v[44:45] offset:0
  v_cvt_pk_bf16_f32 v46, v144, v145
  v_cvt_pk_bf16_f32 v47, v146, v147
  ds_write_b64 v31, v[46:47] offset:0
  v_cvt_pk_bf16_f32 v48, v160, v161
  v_cvt_pk_bf16_f32 v49, v162, v163
  ds_write_b64 v32, v[48:49] offset:0
  v_cvt_pk_bf16_f32 v50, v176, v177
  v_cvt_pk_bf16_f32 v51, v178, v179
  ds_write_b64 v33, v[50:51] offset:0
  v_cvt_pk_bf16_f32 v44, v192, v193
  v_cvt_pk_bf16_f32 v45, v194, v195
  ds_write_b64 v34, v[44:45] offset:0
  v_cvt_pk_bf16_f32 v46, v208, v209
  v_cvt_pk_bf16_f32 v47, v210, v211
  ds_write_b64 v35, v[46:47] offset:0
  v_cvt_pk_bf16_f32 v48, v224, v225
  v_cvt_pk_bf16_f32 v49, v226, v227
  ds_write_b64 v36, v[48:49] offset:0
  v_cvt_pk_bf16_f32 v50, v240, v241
  v_cvt_pk_bf16_f32 v51, v242, v243
  ds_write_b64 v37, v[50:51] offset:0
  ds_read_b128 v[96:99], v38 offset:0
  ds_read_b128 v[100:103], v39 offset:1024
  ds_read_b128 v[104:107], v40 offset:2048
  ds_read_b128 v[108:111], v41 offset:3072
  v_cvt_pk_bf16_f32 v44, v132, v133
  v_cvt_pk_bf16_f32 v45, v134, v135
  ds_write_b64 v30, v[44:45] offset:4096
  v_cvt_pk_bf16_f32 v46, v148, v149
  v_cvt_pk_bf16_f32 v47, v150, v151
  ds_write_b64 v31, v[46:47] offset:4096
  v_cvt_pk_bf16_f32 v48, v164, v165
  v_cvt_pk_bf16_f32 v49, v166, v167
  ds_write_b64 v32, v[48:49] offset:4096
  v_cvt_pk_bf16_f32 v50, v180, v181
  v_cvt_pk_bf16_f32 v51, v182, v183
  ds_write_b64 v33, v[50:51] offset:4096
  v_cvt_pk_bf16_f32 v44, v196, v197
  v_cvt_pk_bf16_f32 v45, v198, v199
  ds_write_b64 v34, v[44:45] offset:4096
  v_cvt_pk_bf16_f32 v46, v212, v213
  v_cvt_pk_bf16_f32 v47, v214, v215
  ds_write_b64 v35, v[46:47] offset:4096
  v_cvt_pk_bf16_f32 v48, v228, v229
  v_cvt_pk_bf16_f32 v49, v230, v231
  ds_write_b64 v36, v[48:49] offset:4096
  v_cvt_pk_bf16_f32 v50, v244, v245
  v_cvt_pk_bf16_f32 v51, v246, v247
  ds_write_b64 v37, v[50:51] offset:4096
  s_waitcnt lgkmcnt(8)
  buffer_store_dwordx4 v[96:99], v42, s[16:19], s30 offen sc1
  s_add_u32 s30, s30, s37
  buffer_store_dwordx4 v[100:103], v42, s[16:19], s30 offen sc1
  s_add_u32 s30, s30, s37
  buffer_store_dwordx4 v[104:107], v42, s[16:19], s30 offen sc1
  s_add_u32 s30, s30, s37
  buffer_store_dwordx4 v[108:111], v42, s[16:19], s30 offen sc1
  s_add_u32 s30, s30, s37
  ds_read_b128 v[112:115], v38 offset:4096
  ds_read_b128 v[116:119], v39 offset:5120
  ds_read_b128 v[120:123], v40 offset:6144
  ds_read_b128 v[124:127], v41 offset:7168
  v_cvt_pk_bf16_f32 v44, v136, v137
  v_cvt_pk_bf16_f32 v45, v138, v139
  ds_write_b64 v30, v[44:45] offset:32768
  v_cvt_pk_bf16_f32 v46, v152, v153
  v_cvt_pk_bf16_f32 v47, v154, v155
  ds_write_b64 v31, v[46:47] offset:32768
  v_cvt_pk_bf16_f32 v48, v168, v169
  v_cvt_pk_bf16_f32 v49, v170, v171
  ds_write_b64 v32, v[48:49] offset:32768
  v_cvt_pk_bf16_f32 v50, v184, v185
  v_cvt_pk_bf16_f32 v51, v186, v187
  ds_write_b64 v33, v[50:51] offset:32768
  v_cvt_pk_bf16_f32 v44, v200, v201
  v_cvt_pk_bf16_f32 v45, v202, v203
  ds_write_b64 v34, v[44:45] offset:32768
  v_cvt_pk_bf16_f32 v46, v216, v217
  v_cvt_pk_bf16_f32 v47, v218, v219
  ds_write_b64 v35, v[46:47] offset:32768
  v_cvt_pk_bf16_f32 v48, v232, v233
  v_cvt_pk_bf16_f32 v49, v234, v235
  ds_write_b64 v36, v[48:49] offset:32768
  v_cvt_pk_bf16_f32 v50, v248, v249
  v_cvt_pk_bf16_f32 v51, v250, v251
  ds_write_b64 v37, v[50:51] offset:32768
  s_waitcnt lgkmcnt(8)
  buffer_store_dwordx4 v[112:115], v42, s[16:19], s30 offen sc1
  s_add_u32 s30, s30, s37
  buffer_store_dwordx4 v[116:119], v42, s[16:19], s30 offen sc1
  s_add_u32 s30, s30, s37
  buffer_store_dwordx4 v[120:123], v42, s[16:19], s30 offen sc1
  s_add_u32 s30, s30, s37
  buffer_store_dwordx4 v[124:127], v42, s[16:19], s30 offen sc1
  s_add_u32 s30, s30, s37
  ds_read_b128 v[96:99], v38 offset:32768
  ds_read_b128 v[100:103], v39 offset:33792
  ds_read_b128 v[104:107], v40 offset:34816
  ds_read_b128 v[108:111], v41 offset:35840
  v_cvt_pk_bf16_f32 v44, v140, v141
  v_cvt_pk_bf16_f32 v45, v142, v143
  ds_write_b64 v30, v[44:45] offset:36864
  v_cvt_pk_bf16_f32 v46, v156, v157
  v_cvt_pk_bf16_f32 v47, v158, v159
  ds_write_b64 v31, v[46:47] offset:36864
  v_cvt_pk_bf16_f32 v48, v172, v173
  v_cvt_pk_bf16_f32 v49, v174, v175
  ds_write_b64 v32, v[48:49] offset:36864
  v_cvt_pk_bf16_f32 v50, v188, v189
  v_cvt_pk_bf16_f32 v51, v190, v191
  ds_write_b64 v33, v[50:51] offset:36864
  v_cvt_pk_bf16_f32 v44, v204, v205
  v_cvt_pk_bf16_f32 v45, v206, v207
  ds_write_b64 v34, v[44:45] offset:36864
  v_cvt_pk_bf16_f32 v46, v220, v221
  v_cvt_pk_bf16_f32 v47, v222, v223
  ds_write_b64 v35, v[46:47] offset:36864
  v_cvt_pk_bf16_f32 v48, v236, v237
  v_cvt_pk_bf16_f32 v49, v238, v239
  ds_write_b64 v36, v[48:49] offset:36864
  v_cvt_pk_bf16_f32 v50, v252, v253
  v_cvt_pk_bf16_f32 v51, v254, v255
  ds_write_b64 v37, v[50:51] offset:36864
  s_waitcnt lgkmcnt(8)
  buffer_store_dwordx4 v[96:99], v42, s[16:19], s30 offen sc1
  s_add_u32 s30, s30, s37
  buffer_store_dwordx4 v[100:103], v42, s[16:19], s30 offen sc1
  s_add_u32 s30, s30, s37
  buffer_store_dwordx4 v[104:107], v42, s[16:19], s30 offen sc1
  s_add_u32 s30, s30, s37
  buffer_store_dwordx4 v[108:111], v42, s[16:19], s30 offen sc1
  s_add_u32 s30, s30, s37
  ds_read_b128 v[112:115], v38 offset:36864
  ds_read_b128 v[116:119], v39 offset:37888
  ds_read_b128 v[120:123], v40 offset:38912
  ds_read_b128 v[124:127], v41 offset:39936
  s_waitcnt lgkmcnt(0)
  buffer_store_dwordx4 v[112:115], v42, s[16:19], s30 offen sc1
  s_add_u32 s30, s30, s37
  buffer_store_dwordx4 v[116:119], v42, s[16:19], s30 offen sc1
  s_add_u32 s30, s30, s37
  buffer_store_dwordx4 v[120:123], v42, s[16:19], s30 offen sc1
  s_add_u32 s30, s30, s37
  buffer_store_dwordx4 v[124:127], v42, s[16:19], s30 offen sc1
  s_add_u32 s30, s30, s37
mid_fin:
  s_mov_b32 s69, 0
fin_entry:
  s_barrier
  s_load_dwordx2 s[22:23], s[0:1], 80
  s_load_dwordx2 s[24:25], s[0:1], 0
  s_and_b32 s36, s2, 7
  s_lshr_b32 s37, s2, 3
  s_lshr_b32 s38, s36, 1
  s_lshl_b32 s38, s38, 3
  s_and_b32 s42, s37, 7
  s_add_u32 s38, s38, s42
  s_and_b32 s39, s36, 1
  s_lshl_b32 s39, s39, 2
  s_lshr_b32 s42, s37, 3
  s_add_u32 s39, s39, s42
  s_mul_i32 s26, s38, 229376
  s_lshl_b32 s27, s39, 8
  s_lshl_b32 s30, s38, 17
  s_add_u32 s30, s30, s27
  s_lshl_b32 s51, s38, 3
  s_add_u32 s51, s51, s39
  s_lshl_b32 s51, s51, 8
  s_add_u32 s51, s51, 69632
  s_mul_i32 s28, s3, 2048
  s_mul_i32 s29, s3, 4096
  s_add_u32 s29, s29, 49152
  v_and_b32 v123, 63, v0
  v_lshrrev_b32 v120, 3, v123
  s_mul_i32 s40, s3, 16
  v_add_u32 v120, s40, v120
  s_mov_b32 s41, 3584
  v_lshrrev_b32 v122, 1, v120
  v_xor_b32 v122, v122, v123
  v_and_b32 v122, 7, v122
  v_lshlrev_b32 v122, 4, v122
  v_mul_lo_u32 v121, v120, s41
  s_lshl_b32 s42, s41, 3
  v_add_u32 v2, v121, v122
  v_add_u32 v121, s42, v121
  v_xor_b32 v3, 64, v122
  v_add_u32 v3, v3, v121
  v_subrev_u32 v3, 1024, v3
  v_and_b32 v125, 63, v0
  v_lshrrev_b32 v120, 4, v125
  s_lshl_b32 s40, s3, 4
  v_add_u32 v120, s40, v120
  v_and_b32 v123, 15, v125
  s_mov_b32 s41, 2048
  v_add_u32 v121, 0, v120
  v_and_b32 v122, 3, v121
  v_lshrrev_b32 v124, 1, v121
  v_and_b32 v124, 4, v124
  v_or_b32 v122, v122, v124
  v_lshlrev_b32 v122, 1, v122
  v_xor_b32 v122, v122, v123
  v_lshlrev_b32 v122, 4, v122
  v_mul_lo_u32 v121, v121, s41
  v_add_u32 v121, v121, v122
  v_mov_b32 v4, v121
  v_add_u32 v121, 4, v120
  v_and_b32 v122, 3, v121
  v_lshrrev_b32 v124, 1, v121
  v_and_b32 v124, 4, v124
  v_or_b32 v122, v122, v124
  v_lshlrev_b32 v122, 1, v122
  v_xor_b32 v122, v122, v123
  v_lshlrev_b32 v122, 4, v122
  v_mul_lo_u32 v121, v121, s41
  v_add_u32 v121, v121, v122
  v_subrev_u32 v5, 1024, v121
  v_add_u32 v121, 8, v120
  v_and_b32 v122, 3, v121
  v_lshrrev_b32 v124, 1, v121
  v_and_b32 v124, 4, v124
  v_or_b32 v122, v122, v124
  v_lshlrev_b32 v122, 1, v122
  v_xor_b32 v122, v122, v123
  v_lshlrev_b32 v122, 4, v122
  v_mul_lo_u32 v121, v121, s41
  v_add_u32 v121, v121, v122
  v_subrev_u32 v6, 2048, v121
  v_add_u32 v121, 12, v120
  v_and_b32 v122, 3, v121
  v_lshrrev_b32 v124, 1, v121
  v_and_b32 v124, 4, v124
  v_or_b32 v122, v122, v124
  v_lshlrev_b32 v122, 1, v122
  v_xor_b32 v122, v122, v123
  v_lshlrev_b32 v122, 4, v122
  v_mul_lo_u32 v121, v121, s41
  v_add_u32 v121, v121, v122
  v_subrev_u32 v7, 3072, v121
  s_add_u32 s8, s6, 58720256
  s_addc_u32 s9, s7, 0
  s_mov_b32 s10, 7340032
  s_mov_b32 s11, 0x20000
  s_mov_b32 s12, s98
  s_mov_b32 s13, s99
  s_mov_b32 s14, 3670016
  s_mov_b32 s15, 0x20000
  v_mov_b32 v23, s51
  global_load_dword v22, v23, s[70:71] sc1
  s_add_u32 m0, s29, 32768
  s_nop 0
  buffer_load_dwordx4 v4, s[12:15], s27 offen offset:0 lds
  buffer_load_dwordx4 v5, s[12:15], s27 offen offset:1024 lds
  buffer_load_dwordx4 v6, s[12:15], s27 offen offset:2048 lds
  buffer_load_dwordx4 v7, s[12:15], s27 offen offset:3072 lds
  s_add_u32 s27, s27, 131072
  s_add_u32 m0, s29, 49152
  s_nop 0
  buffer_load_dwordx4 v4, s[12:15], s27 offen offset:0 lds
  buffer_load_dwordx4 v5, s[12:15], s27 offen offset:1024 lds
  buffer_load_dwordx4 v6, s[12:15], s27 offen offset:2048 lds
  buffer_load_dwordx4 v7, s[12:15], s27 offen offset:3072 lds
  s_add_u32 s27, s27, 131072
  s_add_u32 m0, s29, 65536
  s_nop 0
  buffer_load_dwordx4 v4, s[12:15], s27 offen offset:0 lds
  buffer_load_dwordx4 v5, s[12:15], s27 offen offset:1024 lds
  buffer_load_dwordx4 v6, s[12:15], s27 offen offset:2048 lds
  buffer_load_dwordx4 v7, s[12:15], s27 offen offset:3072 lds
  s_add_u32 s27, s27, 131072
  s_waitcnt vmcnt(12)
  s_cmp_eq_u32 s69, 0
  s_cbranch_scc0 fin_pub
  s_mov_b32 s63, 0
  v_and_b32 v20, 7, v0
  v_lshlrev_b32 v20, 8, v20
  v_add_u32 v20, s60, v20
  v_mov_b32 v21, 1
  s_mov_b64 exec, s[62:63]
  global_atomic_add v20, v21, s[70:71] sc1
  s_mov_b64 exec, -1
fin_pub:
  s_add_u32 m0, s29, 81920
  s_nop 0
  buffer_load_dwordx4 v4, s[12:15], s27 offen offset:0 lds
  buffer_load_dwordx4 v5, s[12:15], s27 offen offset:1024 lds
  buffer_load_dwordx4 v6, s[12:15], s27 offen offset:2048 lds
  buffer_load_dwordx4 v7, s[12:15], s27 offen offset:3072 lds
  s_add_u32 s27, s27, 131072
  s_add_u32 m0, s29, 0
  s_nop 0
  buffer_load_dwordx4 v4, s[12:15], s27 offen offset:0 lds
  buffer_load_dwordx4 v5, s[12:15], s27 offen offset:1024 lds
  buffer_load_dwordx4 v6, s[12:15], s27 offen offset:2048 lds
  buffer_load_dwordx4 v7, s[12:15], s27 offen offset:3072 lds
  s_add_u32 s27, s27, 131072
  s_add_u32 m0, s29, 16384
  s_nop 0
  buffer_load_dwordx4 v4, s[12:15], s27 offen offset:0 lds
  buffer_load_dwordx4 v5, s[12:15], s27 offen offset:1024 lds
  buffer_load_dwordx4 v6, s[12:15], s27 offen offset:2048 lds
  buffer_load_dwordx4 v7, s[12:15], s27 offen offset:3072 lds
  s_add_u32 s27, s27, 131072
  s_waitcnt lgkmcnt(0)
  s_mov_b32 s16, s22
  s_mov_b32 s17, s23
  s_mov_b32 s18, 4194304
  s_mov_b32 s19, 0x20000
  s_mov_b32 s52, s24
  s_mov_b32 s53, s25
  s_mov_b32 s54, 4194304
  s_mov_b32 s55, 0x20000
  s_add_u32 s56, s6, 67108864
  s_addc_u32 s57, s7, 0
  s_mov_b32 s58, 4194304
  s_mov_b32 s59, 0x20000
  s_add_u32 s60, s6, 71303168
  s_addc_u32 s61, s7, 0
  s_mov_b32 s62, 4194304
  s_mov_b32 s63, 0x20000
  v_and_b32 v125, 63, v0
  s_and_b32 s40, s3, 1
  s_lshr_b32 s41, s3, 1
  v_and_b32 v120, 15, v125
  v_lshrrev_b32 v121, 4, v125
  v_lshrrev_b32 v122, 1, v120
  v_xor_b32 v122, v122, v121
  v_lshlrev_b32 v122, 4, v122
  s_mul_i32 s42, s40, 4096
  v_lshlrev_b32 v123, 7, v120
  v_add3_u32 v122, v122, v123, s42
  v_add_u32 v8, 0, v122
  v_xor_b32 v9, 64, v8
  v_lshrrev_b32 v122, 2, v120
  v_lshl_add_u32 v123, v121, 3, v122
  v_mul_u32_u24 v123, 256, v123
  v_and_b32 v124, 3, v120
  v_lshl_add_u32 v123, v124, 3, v123
  v_and_b32 v124, 1, v121
  v_lshl_or_b32 v122, v124, 2, v122
  s_mul_i32 s42, s41, 4
  s_add_u32 s43, s42, 0
  v_xor_b32 v124, s43, v122
  v_lshl_add_u32 v124, v124, 5, v123
  v_add_u32 v10, 49152, v124
  v_add_u32 v11, 114688, v124
  s_add_u32 s43, s42, 1
  v_xor_b32 v124, s43, v122
  v_lshl_add_u32 v124, v124, 5, v123
  v_add_u32 v12, 49152, v124
  v_add_u32 v13, 114688, v124
  s_add_u32 s43, s42, 2
  v_xor_b32 v124, s43, v122
  v_lshl_add_u32 v124, v124, 5, v123
  v_add_u32 v14, 49152, v124
  v_add_u32 v15, 114688, v124
  s_add_u32 s43, s42, 3
  v_xor_b32 v124, s43, v122
  v_lshl_add_u32 v124, v124, 5, v123
  v_add_u32 v16, 49152, v124
  v_add_u32 v17, 114688, v124
  v_and_b32 v100, 15, v0
  v_bfe_u32 v101, v0, 4, 2
  v_add_u32 v102, 0, v101
  v_xor_b32 v103, v102, v100
  v_lshlrev_b32 v103, 4, v103
  v_lshl_add_u32 v102, v102, 11, v103
  v_subrev_u32 v26, 0, v102
  v_add_u32 v102, 4, v101
  v_xor_b32 v103, v102, v100
  v_lshlrev_b32 v103, 4, v103
  v_lshl_add_u32 v102, v102, 11, v103
  v_subrev_u32 v27, 1024, v102
  v_add_u32 v102, 8, v101
  v_xor_b32 v103, v102, v100
  v_lshlrev_b32 v103, 4, v103
  v_lshl_add_u32 v102, v102, 11, v103
  v_subrev_u32 v28, 2048, v102
  v_add_u32 v102, 12, v101
  v_xor_b32 v103, v102, v100
  v_lshlrev_b32 v103, 4, v103
  v_lshl_add_u32 v102, v102, 11, v103
  v_subrev_u32 v29, 3072, v102
  s_lshl_b32 s48, s3, 12
  s_lshl_b32 s44, s3, 15
  s_add_u32 s44, s44, s30
  s_and_b32 s42, s3, 1
  s_lshl_b32 s49, s42, 13
  s_add_u32 s49, s49, 49152
  s_lshr_b32 s43, s3, 1
  s_lshl_b32 s50, s43, 3
  v_and_b32 v123, 63, v0
  v_and_b32 v120, 15, v123
  v_lshrrev_b32 v121, 4, v123
  v_lshrrev_b32 v122, 1, v121
  v_xor_b32 v122, v122, v120
  v_xor_b32 v122, s50, v122
  v_lshlrev_b32 v122, 4, v122
  v_and_b32 v121, 1, v121
  v_lshl_add_u32 v122, v121, 3, v122
  v_lshl_add_u32 v122, v120, 8, v122
  v_add_u32 v30, s49, v122
  v_xor_b32 v31, 32, v30
  v_xor_b32 v32, 64, v30
  v_xor_b32 v33, 96, v30
  v_lshrrev_b32 v120, 3, v123
  v_and_b32 v121, 7, v123
  v_xor_b32 v122, v121, v120
  v_xor_b32 v122, s50, v122
  v_lshlrev_b32 v122, 4, v122
  v_lshl_add_u32 v122, v120, 8, v122
  v_add_u32 v38, s49, v122
  v_xor_b32 v39, 128, v38
  v_and_b32 v120, 63, v0
  v_lshrrev_b32 v121, 3, v120
  v_and_b32 v120, 7, v120
  s_mov_b32 s41, 2048
  v_mul_lo_u32 v42, v121, s41
  v_lshl_add_u32 v42, v120, 4, v42
  s_lshl_b32 s42, s42, 16
  s_lshl_b32 s43, s43, 7
  s_add_u32 s30, s30, s42
  s_add_u32 s30, s30, s43
  v_mov_b32 v56, 0xbfb8aa3b
  v_mov_b32 v57, 0xbfb8aa3b
  v_mov_b32 v58, 1.0
  v_mov_b32 v59, 1.0
  v_readfirstlane_b32 s43, v22
  s_nop 3
  s_cmp_ge_u32 s43, 7
  s_cbranch_scc1 fin_go
  v_mov_b32 v20, s51
  s_mov_b64 exec, 1
  s_mov_b32 s42, 0x40000
  global_load_dword v112, v20, s[70:71] sc1
  s_sleep 4
  global_load_dword v113, v20, s[70:71] sc1
  s_sleep 4
  global_load_dword v114, v20, s[70:71] sc1
  s_sleep 4
  global_load_dword v115, v20, s[70:71] sc1
fin_poll:
  s_waitcnt vmcnt(3)
  v_readfirstlane_b32 s43, v112
  s_sub_u32 s42, s42, 1
  s_cbranch_scc1 fin_poll_ok
  s_nop 1
  s_cmp_ge_u32 s43, 7
  s_cbranch_scc1 fin_poll_ok
  global_load_dword v112, v20, s[70:71] sc1
  s_sleep 4
  s_waitcnt vmcnt(3)
  v_readfirstlane_b32 s43, v113
  s_sub_u32 s42, s42, 1
  s_cbranch_scc1 fin_poll_ok
  s_nop 1
  s_cmp_ge_u32 s43, 7
  s_cbranch_scc1 fin_poll_ok
  global_load_dword v113, v20, s[70:71] sc1
  s_sleep 4
  s_waitcnt vmcnt(3)
  v_readfirstlane_b32 s43, v114
  s_sub_u32 s42, s42, 1
  s_cbranch_scc1 fin_poll_ok
  s_nop 1
  s_cmp_ge_u32 s43, 7
  s_cbranch_scc1 fin_poll_ok
  global_load_dword v114, v20, s[70:71] sc1
  s_sleep 4
  s_waitcnt vmcnt(3)
  v_readfirstlane_b32 s43, v115
  s_sub_u32 s42, s42, 1
  s_cbranch_scc1 fin_poll_ok
  s_nop 1
  s_cmp_ge_u32 s43, 7
  s_cbranch_scc1 fin_poll_ok
  global_load_dword v115, v20, s[70:71] sc1
  s_sleep 4
  s_branch fin_poll
fin_poll_ok:
  s_mov_b64 exec, -1
fin_go:
  s_add_u32 m0, s28, 16384
  s_nop 0
  buffer_load_dwordx4 v2, s[8:11], s26 offen offset:0 sc1 lds
  buffer_load_dwordx4 v3, s[8:11], s26 offen offset:1024 sc1 lds
  s_add_u32 s26, s26, 128
  s_add_u32 m0, s28, 24576
  s_nop 0
  buffer_load_dwordx4 v2, s[8:11], s26 offen offset:0 sc1 lds
  buffer_load_dwordx4 v3, s[8:11], s26 offen offset:1024 sc1 lds
  s_add_u32 s26, s26, 128
  s_add_u32 m0, s28, 32768
  s_nop 0
  buffer_load_dwordx4 v2, s[8:11], s26 offen offset:0 sc1 lds
  buffer_load_dwordx4 v3, s[8:11], s26 offen offset:1024 sc1 lds
  s_add_u32 s26, s26, 128
  s_add_u32 m0, s28, 40960
  s_nop 0
  buffer_load_dwordx4 v2, s[8:11], s26 offen offset:0 sc1 lds
  buffer_load_dwordx4 v3, s[8:11], s26 offen offset:1024 sc1 lds
  s_add_u32 s26, s26, 128
  s_add_u32 m0, s28, 0
  s_nop 0
  buffer_load_dwordx4 v2, s[8:11], s26 offen offset:0 sc1 lds
  buffer_load_dwordx4 v3, s[8:11], s26 offen offset:1024 sc1 lds
  s_add_u32 s26, s26, 128
  s_add_u32 m0, s28, 8192
  s_nop 0
  buffer_load_dwordx4 v2, s[8:11], s26 offen offset:0 sc1 lds
  buffer_load_dwordx4 v3, s[8:11], s26 offen offset:1024 sc1 lds
  s_add_u32 s26, s26, 128
  s_waitcnt vmcnt(10)
  s_barrier
  ds_read_b64_tr_b16 a[32:33], v10 offset:32768
  ds_read_b64_tr_b16 a[34:35], v10 offset:33792
  ds_read_b64_tr_b16 a[36:37], v10 offset:40960
  ds_read_b64_tr_b16 a[38:39], v10 offset:41984
  ds_read_b128 a[0:3], v8 offset:16384
  ds_read_b128 a[8:11], v9 offset:16384
  ds_read_b128 a[4:7], v8 offset:18432
  ds_read_b128 a[12:15], v9 offset:18432
  ds_read_b64_tr_b16 a[40:41], v12 offset:32768
  ds_read_b64_tr_b16 a[42:43], v12 offset:33792
  ds_read_b64_tr_b16 a[44:45], v12 offset:40960
  ds_read_b64_tr_b16 a[46:47], v12 offset:41984
  s_waitcnt lgkmcnt(0)
  v_mfma_f32_16x16x32_bf16 v[128:131], a[32:35], a[0:3], 0
  ds_read_b64_tr_b16 a[48:49], v14 offset:32768
  ds_read_b64_tr_b16 a[50:51], v14 offset:33792
  v_mfma_f32_16x16x32_bf16 v[128:131], a[36:39], a[8:11], v[128:131]
  ds_read_b64_tr_b16 a[52:53], v14 offset:40960
  v_mfma_f32_16x16x32_bf16 v[132:135], a[36:39], a[12:15], 0
  ds_read_b64_tr_b16 a[54:55], v14 offset:41984
  v_mfma_f32_16x16x32_bf16 v[132:135], a[32:35], a[4:7], v[132:135]
  ds_read_b64_tr_b16 a[56:57], v16 offset:32768
  ds_read_b64_tr_b16 a[58:59], v16 offset:33792
  v_mfma_f32_16x16x32_bf16 v[140:143], a[40:43], a[4:7], 0
  ds_read_b64_tr_b16 a[60:61], v16 offset:40960
  v_mfma_f32_16x16x32_bf16 v[140:143], a[44:47], a[12:15], v[140:143]
  ds_read_b64_tr_b16 a[62:63], v16 offset:41984
  v_mfma_f32_16x16x32_bf16 v[136:139], a[44:47], a[8:11], 0
  v_mfma_f32_16x16x32_bf16 v[136:139], a[40:43], a[0:3], v[136:139]
  s_waitcnt lgkmcnt(0) vmcnt(8)
  s_barrier
  v_mfma_f32_16x16x32_bf16 v[144:147], a[48:51], a[0:3], 0
  s_add_u32 m0, s28, 16384
  ds_read_b64_tr_b16 a[32:33], v10 offset:49152
  buffer_load_dwordx4 v2, s[8:11], s26 offen offset:0 sc1 lds
  v_mfma_f32_16x16x32_bf16 v[144:147], a[52:55], a[8:11], v[144:147]
  ds_read_b64_tr_b16 a[34:35], v10 offset:50176
  ds_read_b64_tr_b16 a[36:37], v10 offset:57344
  v_mfma_f32_16x16x32_bf16 v[148:151], a[52:55], a[12:15], 0
  ds_read_b64_tr_b16 a[38:39], v10 offset:58368
  ds_read_b128 a[16:19], v8 offset:24576
  buffer_load_dwordx4 v3, s[8:11], s26 offen offset:1024 sc1 lds
  v_mfma_f32_16x16x32_bf16 v[148:151], a[48:51], a[4:7], v[148:151]
  ds_read_b128 a[24:27], v9 offset:24576
  ds_read_b128 a[20:23], v8 offset:26624
  v_mfma_f32_16x16x32_bf16 v[156:159], a[56:59], a[4:7], 0
  ds_read_b128 a[28:31], v9 offset:26624
  s_add_u32 m0, s29, 32768
  ds_read_b64_tr_b16 a[40:41], v12 offset:49152
  v_mfma_f32_16x16x32_bf16 v[156:159], a[60:63], a[12:15], v[156:159]
  buffer_load_dwordx4 v4, s[12:15], s27 offen offset:0 lds
  ds_read_b64_tr_b16 a[42:43], v12 offset:50176
  v_mfma_f32_16x16x32_bf16 v[152:155], a[60:63], a[8:11], 0
  ds_read_b64_tr_b16 a[44:45], v12 offset:57344
  ds_read_b64_tr_b16 a[46:47], v12 offset:58368
  v_mfma_f32_16x16x32_bf16 v[152:155], a[56:59], a[0:3], v[152:155]
  s_waitcnt lgkmcnt(0)
  v_mfma_f32_16x16x32_bf16 v[128:131], a[32:35], a[16:19], v[128:131]
  s_add_u32 m0, s29, 32768
  ds_read_b64_tr_b16 a[48:49], v14 offset:49152
  v_mfma_f32_16x16x32_bf16 v[128:131], a[36:39], a[24:27], v[128:131]
  buffer_load_dwordx4 v5, s[12:15], s27 offen offset:1024 lds
  ds_read_b64_tr_b16 a[50:51], v14 offset:50176
  v_mfma_f32_16x16x32_bf16 v[132:135], a[36:39], a[28:31], v[132:135]
  ds_read_b64_tr_b16 a[52:53], v14 offset:57344
  buffer_load_dwordx4 v6, s[12:15], s27 offen offset:2048 lds
  v_mfma_f32_16x16x32_bf16 v[132:135], a[32:35], a[20:23], v[132:135]
  ds_read_b64_tr_b16 a[54:55], v14 offset:58368
  v_mfma_f32_16x16x32_bf16 v[140:143], a[40:43], a[20:23], v[140:143]
  ds_read_b64_tr_b16 a[56:57], v16 offset:49152
  ds_read_b64_tr_b16 a[58:59], v16 offset:50176
  v_mfma_f32_16x16x32_bf16 v[140:143], a[44:47], a[28:31], v[140:143]
  buffer_load_dwordx4 v7, s[12:15], s27 offen offset:3072 lds
  ds_read_b64_tr_b16 a[60:61], v16 offset:57344
  v_mfma_f32_16x16x32_bf16 v[136:139], a[44:47], a[24:27], v[136:139]
  ds_read_b64_tr_b16 a[62:63], v16 offset:58368
  s_add_u32 s26, s26, 128
  v_mfma_f32_16x16x32_bf16 v[136:139], a[40:43], a[16:19], v[136:139]
  s_add_u32 s27, s27, 131072
  s_waitcnt lgkmcnt(0) vmcnt(12)
  s_barrier
  v_mfma_f32_16x16x32_bf16 v[144:147], a[48:51], a[16:19], v[144:147]
  s_add_u32 m0, s28, 24576
  ds_read_b64_tr_b16 a[32:33], v11 offset:0
  buffer_load_dwordx4 v2, s[8:11], s26 offen offset:0 sc1 lds
  v_mfma_f32_16x16x32_bf16 v[144:147], a[52:55], a[24:27], v[144:147]
  ds_read_b64_tr_b16 a[34:35], v11 offset:1024
  ds_read_b64_tr_b16 a[36:37], v11 offset:8192
  v_mfma_f32_16x16x32_bf16 v[148:151], a[52:55], a[28:31], v[148:151]
  ds_read_b64_tr_b16 a[38:39], v11 offset:9216
  ds_read_b128 a[0:3], v8 offset:32768
  buffer_load_dwordx4 v3, s[8:11], s26 offen offset:1024 sc1 lds
  v_mfma_f32_16x16x32_bf16 v[148:151], a[48:51], a[20:23], v[148:151]
  ds_read_b128 a[8:11], v9 offset:32768
  ds_read_b128 a[4:7], v8 offset:34816
  v_mfma_f32_16x16x32_bf16 v[156:159], a[56:59], a[20:23], v[156:159]
  ds_read_b128 a[12:15], v9 offset:34816
  s_add_u32 m0, s29, 49152
  ds_read_b64_tr_b16 a[40:41], v13 offset:0
  v_mfma_f32_16x16x32_bf16 v[156:159], a[60:63], a[28:31], v[156:159]
  buffer_load_dwordx4 v4, s[12:15], s27 offen offset:0 lds
  ds_read_b64_tr_b16 a[42:43], v13 offset:1024
  v_mfma_f32_16x16x32_bf16 v[152:155], a[60:63], a[24:27], v[152:155]
  ds_read_b64_tr_b16 a[44:45], v13 offset:8192
  ds_read_b64_tr_b16 a[46:47], v13 offset:9216
  v_mfma_f32_16x16x32_bf16 v[152:155], a[56:59], a[16:19], v[152:155]
  s_waitcnt lgkmcnt(0)
  v_mfma_f32_16x16x32_bf16 v[128:131], a[32:35], a[0:3], v[128:131]
  s_add_u32 m0, s29, 49152
  ds_read_b64_tr_b16 a[48:49], v15 offset:0
  v_mfma_f32_16x16x32_bf16 v[128:131], a[36:39], a[8:11], v[128:131]
  buffer_load_dwordx4 v5, s[12:15], s27 offen offset:1024 lds
  ds_read_b64_tr_b16 a[50:51], v15 offset:1024
  v_mfma_f32_16x16x32_bf16 v[132:135], a[36:39], a[12:15], v[132:135]
  ds_read_b64_tr_b16 a[52:53], v15 offset:8192
  buffer_load_dwordx4 v6, s[12:15], s27 offen offset:2048 lds
  v_mfma_f32_16x16x32_bf16 v[132:135], a[32:35], a[4:7], v[132:135]
  ds_read_b64_tr_b16 a[54:55], v15 offset:9216
  v_mfma_f32_16x16x32_bf16 v[140:143], a[40:43], a[4:7], v[140:143]
  ds_read_b64_tr_b16 a[56:57], v17 offset:0
  ds_read_b64_tr_b16 a[58:59], v17 offset:1024
  v_mfma_f32_16x16x32_bf16 v[140:143], a[44:47], a[12:15], v[140:143]
  buffer_load_dwordx4 v7, s[12:15], s27 offen offset:3072 lds
  ds_read_b64_tr_b16 a[60:61], v17 offset:8192
  v_mfma_f32_16x16x32_bf16 v[136:139], a[44:47], a[8:11], v[136:139]
  ds_read_b64_tr_b16 a[62:63], v17 offset:9216
  s_add_u32 s26, s26, 128
  v_mfma_f32_16x16x32_bf16 v[136:139], a[40:43], a[0:3], v[136:139]
  s_add_u32 s27, s27, 131072
  s_waitcnt lgkmcnt(0) vmcnt(16)
  s_barrier
  v_mfma_f32_16x16x32_bf16 v[144:147], a[48:51], a[0:3], v[144:147]
  s_add_u32 m0, s28, 32768
  ds_read_b64_tr_b16 a[32:33], v11 offset:16384
  buffer_load_dwordx4 v2, s[8:11], s26 offen offset:0 sc1 lds
  v_mfma_f32_16x16x32_bf16 v[144:147], a[52:55], a[8:11], v[144:147]
  ds_read_b64_tr_b16 a[34:35], v11 offset:17408
  ds_read_b64_tr_b16 a[36:37], v11 offset:24576
  v_mfma_f32_16x16x32_bf16 v[148:151], a[52:55], a[12:15], v[148:151]
  ds_read_b64_tr_b16 a[38:39], v11 offset:25600
  ds_read_b128 a[16:19], v8 offset:40960
  buffer_load_dwordx4 v3, s[8:11], s26 offen offset:1024 sc1 lds
  v_mfma_f32_16x16x32_bf16 v[148:151], a[48:51], a[4:7], v[148:151]
  ds_read_b128 a[24:27], v9 offset:40960
  ds_read_b128 a[20:23], v8 offset:43008
  v_mfma_f32_16x16x32_bf16 v[156:159], a[56:59], a[4:7], v[156:159]
  ds_read_b128 a[28:31], v9 offset:43008
  s_add_u32 m0, s29, 65536
  ds_read_b64_tr_b16 a[40:41], v13 offset:16384
  v_mfma_f32_16x16x32_bf16 v[156:159], a[60:63], a[12:15], v[156:159]
  buffer_load_dwordx4 v4, s[12:15], s27 offen offset:0 lds
  ds_read_b64_tr_b16 a[42:43], v13 offset:17408
  v_mfma_f32_16x16x32_bf16 v[152:155], a[60:63], a[8:11], v[152:155]
  ds_read_b64_tr_b16 a[44:45], v13 offset:24576
  ds_read_b64_tr_b16 a[46:47], v13 offset:25600
  v_mfma_f32_16x16x32_bf16 v[152:155], a[56:59], a[0:3], v[152:155]
  s_waitcnt lgkmcnt(0)
  v_mfma_f32_16x16x32_bf16 v[128:131], a[32:35], a[16:19], v[128:131]
  s_add_u32 m0, s29, 65536
  ds_read_b64_tr_b16 a[48:49], v15 offset:16384
  v_mfma_f32_16x16x32_bf16 v[128:131], a[36:39], a[24:27], v[128:131]
  buffer_load_dwordx4 v5, s[12:15], s27 offen offset:1024 lds
  ds_read_b64_tr_b16 a[50:51], v15 offset:17408
  v_mfma_f32_16x16x32_bf16 v[132:135], a[36:39], a[28:31], v[132:135]
  ds_read_b64_tr_b16 a[52:53], v15 offset:24576
  buffer_load_dwordx4 v6, s[12:15], s27 offen offset:2048 lds
  v_mfma_f32_16x16x32_bf16 v[132:135], a[32:35], a[20:23], v[132:135]
  ds_read_b64_tr_b16 a[54:55], v15 offset:25600
  v_mfma_f32_16x16x32_bf16 v[140:143], a[40:43], a[20:23], v[140:143]
  ds_read_b64_tr_b16 a[56:57], v17 offset:16384
  ds_read_b64_tr_b16 a[58:59], v17 offset:17408
  v_mfma_f32_16x16x32_bf16 v[140:143], a[44:47], a[28:31], v[140:143]
  buffer_load_dwordx4 v7, s[12:15], s27 offen offset:3072 lds
  ds_read_b64_tr_b16 a[60:61], v17 offset:24576
  v_mfma_f32_16x16x32_bf16 v[136:139], a[44:47], a[24:27], v[136:139]
  ds_read_b64_tr_b16 a[62:63], v17 offset:25600
  s_add_u32 s26, s26, 128
  v_mfma_f32_16x16x32_bf16 v[136:139], a[40:43], a[16:19], v[136:139]
  s_add_u32 s27, s27, 131072
  s_waitcnt lgkmcnt(0) vmcnt(20)
  s_barrier
  v_mfma_f32_16x16x32_bf16 v[144:147], a[48:51], a[16:19], v[144:147]
  s_add_u32 m0, s28, 40960
  ds_read_b64_tr_b16 a[32:33], v10 offset:0
  buffer_load_dwordx4 v2, s[8:11], s26 offen offset:0 sc1 lds
  v_mfma_f32_16x16x32_bf16 v[144:147], a[52:55], a[24:27], v[144:147]
  ds_read_b64_tr_b16 a[34:35], v10 offset:1024
  ds_read_b64_tr_b16 a[36:37], v10 offset:8192
  v_mfma_f32_16x16x32_bf16 v[148:151], a[52:55], a[28:31], v[148:151]
  ds_read_b64_tr_b16 a[38:39], v10 offset:9216
  ds_read_b128 a[0:3], v8 offset:0
  buffer_load_dwordx4 v3, s[8:11], s26 offen offset:1024 sc1 lds
  v_mfma_f32_16x16x32_bf16 v[148:151], a[48:51], a[20:23], v[148:151]
  ds_read_b128 a[8:11], v9 offset:0
  ds_read_b128 a[4:7], v8 offset:2048
  v_mfma_f32_16x16x32_bf16 v[156:159], a[56:59], a[20:23], v[156:159]
  ds_read_b128 a[12:15], v9 offset:2048
  s_add_u32 m0, s29, 81920
  ds_read_b64_tr_b16 a[40:41], v12 offset:0
  v_mfma_f32_16x16x32_bf16 v[156:159], a[60:63], a[28:31], v[156:159]
  buffer_load_dwordx4 v4, s[12:15], s27 offen offset:0 lds
  ds_read_b64_tr_b16 a[42:43], v12 offset:1024
  v_mfma_f32_16x16x32_bf16 v[152:155], a[60:63], a[24:27], v[152:155]
  ds_read_b64_tr_b16 a[44:45], v12 offset:8192
  ds_read_b64_tr_b16 a[46:47], v12 offset:9216
  v_mfma_f32_16x16x32_bf16 v[152:155], a[56:59], a[16:19], v[152:155]
  s_waitcnt lgkmcnt(0)
  v_mfma_f32_16x16x32_bf16 v[128:131], a[32:35], a[0:3], v[128:131]
  s_add_u32 m0, s29, 81920
  ds_read_b64_tr_b16 a[48:49], v14 offset:0
  v_mfma_f32_16x16x32_bf16 v[128:131], a[36:39], a[8:11], v[128:131]
  buffer_load_dwordx4 v5, s[12:15], s27 offen offset:1024 lds
  ds_read_b64_tr_b16 a[50:51], v14 offset:1024
  v_mfma_f32_16x16x32_bf16 v[132:135], a[36:39], a[12:15], v[132:135]
  ds_read_b64_tr_b16 a[52:53], v14 offset:8192
  buffer_load_dwordx4 v6, s[12:15], s27 offen offset:2048 lds
  v_mfma_f32_16x16x32_bf16 v[132:135], a[32:35], a[4:7], v[132:135]
  ds_read_b64_tr_b16 a[54:55], v14 offset:9216
  v_mfma_f32_16x16x32_bf16 v[140:143], a[40:43], a[4:7], v[140:143]
  ds_read_b64_tr_b16 a[56:57], v16 offset:0
  ds_read_b64_tr_b16 a[58:59], v16 offset:1024
  v_mfma_f32_16x16x32_bf16 v[140:143], a[44:47], a[12:15], v[140:143]
  buffer_load_dwordx4 v7, s[12:15], s27 offen offset:3072 lds
  ds_read_b64_tr_b16 a[60:61], v16 offset:8192
  v_mfma_f32_16x16x32_bf16 v[136:139], a[44:47], a[8:11], v[136:139]
  ds_read_b64_tr_b16 a[62:63], v16 offset:9216
  s_add_u32 s26, s26, 128
  v_mfma_f32_16x16x32_bf16 v[136:139], a[40:43], a[0:3], v[136:139]
  s_add_u32 s27, s27, 131072
  s_waitcnt lgkmcnt(0) vmcnt(24)
  s_barrier
  v_mfma_f32_16x16x32_bf16 v[144:147], a[48:51], a[0:3], v[144:147]
  s_add_u32 m0, s28, 0
  ds_read_b64_tr_b16 a[32:33], v10 offset:16384
  buffer_load_dwordx4 v2, s[8:11], s26 offen offset:0 sc1 lds
  v_mfma_f32_16x16x32_bf16 v[144:147], a[52:55], a[8:11], v[144:147]
  ds_read_b64_tr_b16 a[34:35], v10 offset:17408
  ds_read_b64_tr_b16 a[36:37], v10 offset:24576
  v_mfma_f32_16x16x32_bf16 v[148:151], a[52:55], a[12:15], v[148:151]
  ds_read_b64_tr_b16 a[38:39], v10 offset:25600
  ds_read_b128 a[16:19], v8 offset:8192
  buffer_load_dwordx4 v3, s[8:11], s26 offen offset:1024 sc1 lds
  v_mfma_f32_16x16x32_bf16 v[148:151], a[48:51], a[4:7], v[148:151]
  ds_read_b128 a[24:27], v9 offset:8192
  ds_read_b128 a[20:23], v8 offset:10240
  v_mfma_f32_16x16x32_bf16 v[156:159], a[56:59], a[4:7], v[156:159]
  ds_read_b128 a[28:31], v9 offset:10240
  s_add_u32 m0, s29, 0
  ds_read_b64_tr_b16 a[40:41], v12 offset:16384
  v_mfma_f32_16x16x32_bf16 v[156:159], a[60:63], a[12:15], v[156:159]
  buffer_load_dwordx4 v4, s[12:15], s27 offen offset:0 lds
  ds_read_b64_tr_b16 a[42:43], v12 offset:17408
  v_mfma_f32_16x16x32_bf16 v[152:155], a[60:63], a[8:11], v[152:155]
  ds_read_b64_tr_b16 a[44:45], v12 offset:24576
  ds_read_b64_tr_b16 a[46:47], v12 offset:25600
  v_mfma_f32_16x16x32_bf16 v[152:155], a[56:59], a[0:3], v[152:155]
  s_waitcnt lgkmcnt(0)
  v_mfma_f32_16x16x32_bf16 v[128:131], a[32:35], a[16:19], v[128:131]
  s_add_u32 m0, s29, 0
  ds_read_b64_tr_b16 a[48:49], v14 offset:16384
  v_mfma_f32_16x16x32_bf16 v[128:131], a[36:39], a[24:27], v[128:131]
  buffer_load_dwordx4 v5, s[12:15], s27 offen offset:1024 lds
  ds_read_b64_tr_b16 a[50:51], v14 offset:17408
  v_mfma_f32_16x16x32_bf16 v[132:135], a[36:39], a[28:31], v[132:135]
  ds_read_b64_tr_b16 a[52:53], v14 offset:24576
  buffer_load_dwordx4 v6, s[12:15], s27 offen offset:2048 lds
  v_mfma_f32_16x16x32_bf16 v[132:135], a[32:35], a[20:23], v[132:135]
  ds_read_b64_tr_b16 a[54:55], v14 offset:25600
  v_mfma_f32_16x16x32_bf16 v[140:143], a[40:43], a[20:23], v[140:143]
  ds_read_b64_tr_b16 a[56:57], v16 offset:16384
  ds_read_b64_tr_b16 a[58:59], v16 offset:17408
  v_mfma_f32_16x16x32_bf16 v[140:143], a[44:47], a[28:31], v[140:143]
  buffer_load_dwordx4 v7, s[12:15], s27 offen offset:3072 lds
  ds_read_b64_tr_b16 a[60:61], v16 offset:24576
  v_mfma_f32_16x16x32_bf16 v[136:139], a[44:47], a[24:27], v[136:139]
  ds_read_b64_tr_b16 a[62:63], v16 offset:25600
  s_add_u32 s26, s26, 128
  v_mfma_f32_16x16x32_bf16 v[136:139], a[40:43], a[16:19], v[136:139]
  s_add_u32 s27, s27, 131072
  s_waitcnt lgkmcnt(0) vmcnt(24)
  s_barrier
  v_mfma_f32_16x16x32_bf16 v[144:147], a[48:51], a[16:19], v[144:147]
  s_add_u32 m0, s28, 8192
  ds_read_b64_tr_b16 a[32:33], v10 offset:32768
  buffer_load_dwordx4 v2, s[8:11], s26 offen offset:0 sc1 lds
  v_mfma_f32_16x16x32_bf16 v[144:147], a[52:55], a[24:27], v[144:147]
  ds_read_b64_tr_b16 a[34:35], v10 offset:33792
  ds_read_b64_tr_b16 a[36:37], v10 offset:40960
  v_mfma_f32_16x16x32_bf16 v[148:151], a[52:55], a[28:31], v[148:151]
  ds_read_b64_tr_b16 a[38:39], v10 offset:41984
  ds_read_b128 a[0:3], v8 offset:16384
  buffer_load_dwordx4 v3, s[8:11], s26 offen offset:1024 sc1 lds
  v_mfma_f32_16x16x32_bf16 v[148:151], a[48:51], a[20:23], v[148:151]
  ds_read_b128 a[8:11], v9 offset:16384
  ds_read_b128 a[4:7], v8 offset:18432
  v_mfma_f32_16x16x32_bf16 v[156:159], a[56:59], a[20:23], v[156:159]
  ds_read_b128 a[12:15], v9 offset:18432
  s_add_u32 m0, s29, 16384
  ds_read_b64_tr_b16 a[40:41], v12 offset:32768
  v_mfma_f32_16x16x32_bf16 v[156:159], a[60:63], a[28:31], v[156:159]
  buffer_load_dwordx4 v4, s[12:15], s27 offen offset:0 lds
  ds_read_b64_tr_b16 a[42:43], v12 offset:33792
  v_mfma_f32_16x16x32_bf16 v[152:155], a[60:63], a[24:27], v[152:155]
  ds_read_b64_tr_b16 a[44:45], v12 offset:40960
  ds_read_b64_tr_b16 a[46:47], v12 offset:41984
  v_mfma_f32_16x16x32_bf16 v[152:155], a[56:59], a[16:19], v[152:155]
  s_waitcnt lgkmcnt(0)
  v_mfma_f32_16x16x32_bf16 v[128:131], a[32:35], a[0:3], v[128:131]
  s_add_u32 m0, s29, 16384
  ds_read_b64_tr_b16 a[48:49], v14 offset:32768
  v_mfma_f32_16x16x32_bf16 v[128:131], a[36:39], a[8:11], v[128:131]
  buffer_load_dwordx4 v5, s[12:15], s27 offen offset:1024 lds
  ds_read_b64_tr_b16 a[50:51], v14 offset:33792
  v_mfma_f32_16x16x32_bf16 v[132:135], a[36:39], a[12:15], v[132:135]
  ds_read_b64_tr_b16 a[52:53], v14 offset:40960
  buffer_load_dwordx4 v6, s[12:15], s27 offen offset:2048 lds
  v_mfma_f32_16x16x32_bf16 v[132:135], a[32:35], a[4:7], v[132:135]
  ds_read_b64_tr_b16 a[54:55], v14 offset:41984
  ds_read_b64_tr_b16 a[56:57], v16 offset:32768
  v_mfma_f32_16x16x32_bf16 v[140:143], a[40:43], a[4:7], v[140:143]
  buffer_load_dwordx4 v7, s[12:15], s27 offen offset:3072 lds
  ds_read_b64_tr_b16 a[58:59], v16 offset:33792
  v_mfma_f32_16x16x32_bf16 v[140:143], a[44:47], a[12:15], v[140:143]
  ds_read_b64_tr_b16 a[60:61], v16 offset:40960
  global_load_dword v24, v23, s[70:71] offset:64 sc1
  v_mfma_f32_16x16x32_bf16 v[136:139], a[44:47], a[8:11], v[136:139]
  ds_read_b64_tr_b16 a[62:63], v16 offset:41984
  s_add_u32 s26, s26, 128
  v_mfma_f32_16x16x32_bf16 v[136:139], a[40:43], a[0:3], v[136:139]
  s_add_u32 s27, s27, 131072
  s_waitcnt lgkmcnt(0) vmcnt(25)
  s_barrier
  v_mfma_f32_16x16x32_bf16 v[144:147], a[48:51], a[0:3], v[144:147]
  s_add_u32 m0, s28, 16384
  ds_read_b64_tr_b16 a[32:33], v10 offset:49152
  buffer_load_dwordx4 v2, s[8:11], s26 offen offset:0 sc1 lds
  v_mfma_f32_16x16x32_bf16 v[144:147], a[52:55], a[8:11], v[144:147]
  ds_read_b64_tr_b16 a[34:35], v10 offset:50176
  ds_read_b64_tr_b16 a[36:37], v10 offset:57344
  v_mfma_f32_16x16x32_bf16 v[148:151], a[52:55], a[12:15], v[148:151]
  ds_read_b64_tr_b16 a[38:39], v10 offset:58368
  ds_read_b128 a[16:19], v8 offset:24576
  buffer_load_dwordx4 v3, s[8:11], s26 offen offset:1024 sc1 lds
  v_mfma_f32_16x16x32_bf16 v[148:151], a[48:51], a[4:7], v[148:151]
  ds_read_b128 a[24:27], v9 offset:24576
  ds_read_b128 a[20:23], v8 offset:26624
  v_mfma_f32_16x16x32_bf16 v[156:159], a[56:59], a[4:7], v[156:159]
  ds_read_b128 a[28:31], v9 offset:26624
  s_add_u32 m0, s29, 32768
  ds_read_b64_tr_b16 a[40:41], v12 offset:49152
  v_mfma_f32_16x16x32_bf16 v[156:159], a[60:63], a[12:15], v[156:159]
  buffer_load_dwordx4 v4, s[12:15], s27 offen offset:0 lds
  ds_read_b64_tr_b16 a[42:43], v12 offset:50176
  v_mfma_f32_16x16x32_bf16 v[152:155], a[60:63], a[8:11], v[152:155]
  ds_read_b64_tr_b16 a[44:45], v12 offset:57344
  ds_read_b64_tr_b16 a[46:47], v12 offset:58368
  v_mfma_f32_16x16x32_bf16 v[152:155], a[56:59], a[0:3], v[152:155]
  s_waitcnt lgkmcnt(0)
  v_mfma_f32_16x16x32_bf16 v[128:131], a[32:35], a[16:19], v[128:131]
  s_add_u32 m0, s29, 32768
  ds_read_b64_tr_b16 a[48:49], v14 offset:49152
  v_mfma_f32_16x16x32_bf16 v[128:131], a[36:39], a[24:27], v[128:131]
  buffer_load_dwordx4 v5, s[12:15], s27 offen offset:1024 lds
  ds_read_b64_tr_b16 a[50:51], v14 offset:50176
  v_mfma_f32_16x16x32_bf16 v[132:135], a[36:39], a[28:31], v[132:135]
  ds_read_b64_tr_b16 a[52:53], v14 offset:57344
  buffer_load_dwordx4 v6, s[12:15], s27 offen offset:2048 lds
  v_mfma_f32_16x16x32_bf16 v[132:135], a[32:35], a[20:23], v[132:135]
  ds_read_b64_tr_b16 a[54:55], v14 offset:58368
  v_mfma_f32_16x16x32_bf16 v[140:143], a[40:43], a[20:23], v[140:143]
  ds_read_b64_tr_b16 a[56:57], v16 offset:49152
  ds_read_b64_tr_b16 a[58:59], v16 offset:50176
  v_mfma_f32_16x16x32_bf16 v[140:143], a[44:47], a[28:31], v[140:143]
  buffer_load_dwordx4 v7, s[12:15], s27 offen offset:3072 lds
  ds_read_b64_tr_b16 a[60:61], v16 offset:57344
  v_mfma_f32_16x16x32_bf16 v[136:139], a[44:47], a[24:27], v[136:139]
  ds_read_b64_tr_b16 a[62:63], v16 offset:58368
  s_add_u32 s26, s26, 128
  v_mfma_f32_16x16x32_bf16 v[136:139], a[40:43], a[16:19], v[136:139]
  s_add_u32 s27, s27, 131072
  s_waitcnt lgkmcnt(0) vmcnt(25)
  s_barrier
  v_mfma_f32_16x16x32_bf16 v[144:147], a[48:51], a[16:19], v[144:147]
  s_add_u32 m0, s28, 24576
  ds_read_b64_tr_b16 a[32:33], v11 offset:0
  buffer_load_dwordx4 v2, s[8:11], s26 offen offset:0 sc1 lds
  v_mfma_f32_16x16x32_bf16 v[144:147], a[52:55], a[24:27], v[144:147]
  ds_read_b64_tr_b16 a[34:35], v11 offset:1024
  ds_read_b64_tr_b16 a[36:37], v11 offset:8192
  v_mfma_f32_16x16x32_bf16 v[148:151], a[52:55], a[28:31], v[148:151]
  ds_read_b64_tr_b16 a[38:39], v11 offset:9216
  ds_read_b128 a[0:3], v8 offset:32768
  buffer_load_dwordx4 v3, s[8:11], s26 offen offset:1024 sc1 lds
  v_mfma_f32_16x16x32_bf16 v[148:151], a[48:51], a[20:23], v[148:151]
  ds_read_b128 a[8:11], v9 offset:32768
  ds_read_b128 a[4:7], v8 offset:34816
  v_mfma_f32_16x16x32_bf16 v[156:159], a[56:59], a[20:23], v[156:159]
  ds_read_b128 a[12:15], v9 offset:34816
  s_add_u32 m0, s29, 49152
  ds_read_b64_tr_b16 a[40:41], v13 offset:0
  v_mfma_f32_16x16x32_bf16 v[156:159], a[60:63], a[28:31], v[156:159]
  buffer_load_dwordx4 v4, s[12:15], s27 offen offset:0 lds
  ds_read_b64_tr_b16 a[42:43], v13 offset:1024
  v_mfma_f32_16x16x32_bf16 v[152:155], a[60:63], a[24:27], v[152:155]
  ds_read_b64_tr_b16 a[44:45], v13 offset:8192
  ds_read_b64_tr_b16 a[46:47], v13 offset:9216
  v_mfma_f32_16x16x32_bf16 v[152:155], a[56:59], a[16:19], v[152:155]
  s_waitcnt lgkmcnt(0)
  v_mfma_f32_16x16x32_bf16 v[128:131], a[32:35], a[0:3], v[128:131]
  s_add_u32 m0, s29, 49152
  ds_read_b64_tr_b16 a[48:49], v15 offset:0
  v_mfma_f32_16x16x32_bf16 v[128:131], a[36:39], a[8:11], v[128:131]
  buffer_load_dwordx4 v5, s[12:15], s27 offen offset:1024 lds
  ds_read_b64_tr_b16 a[50:51], v15 offset:1024
  v_mfma_f32_16x16x32_bf16 v[132:135], a[36:39], a[12:15], v[132:135]
  ds_read_b64_tr_b16 a[52:53], v15 offset:8192
  buffer_load_dwordx4 v6, s[12:15], s27 offen offset:2048 lds
  v_mfma_f32_16x16x32_bf16 v[132:135], a[32:35], a[4:7], v[132:135]
  ds_read_b64_tr_b16 a[54:55], v15 offset:9216
  v_mfma_f32_16x16x32_bf16 v[140:143], a[40:43], a[4:7], v[140:143]
  ds_read_b64_tr_b16 a[56:57], v17 offset:0
  ds_read_b64_tr_b16 a[58:59], v17 offset:1024
  v_mfma_f32_16x16x32_bf16 v[140:143], a[44:47], a[12:15], v[140:143]
  buffer_load_dwordx4 v7, s[12:15], s27 offen offset:3072 lds
  ds_read_b64_tr_b16 a[60:61], v17 offset:8192
  v_mfma_f32_16x16x32_bf16 v[136:139], a[44:47], a[8:11], v[136:139]
  ds_read_b64_tr_b16 a[62:63], v17 offset:9216
  s_add_u32 s26, s26, 128
  v_mfma_f32_16x16x32_bf16 v[136:139], a[40:43], a[0:3], v[136:139]
  s_add_u32 s27, s27, 131072
  s_waitcnt lgkmcnt(0) vmcnt(12)
  s_barrier
  v_readfirstlane_b32 s43, v24
  s_nop 3
  s_cmp_ge_u32 s43, 7
  s_cbranch_scc0 fin_hpoll
fin_hpoll_ret:
  v_mfma_f32_16x16x32_bf16 v[144:147], a[48:51], a[0:3], v[144:147]
  s_add_u32 m0, s28, 32768
  ds_read_b64_tr_b16 a[32:33], v11 offset:16384
  buffer_load_dwordx4 v2, s[8:11], s26 offen offset:0 sc1 lds
  v_mfma_f32_16x16x32_bf16 v[144:147], a[52:55], a[8:11], v[144:147]
  ds_read_b64_tr_b16 a[34:35], v11 offset:17408
  ds_read_b64_tr_b16 a[36:37], v11 offset:24576
  v_mfma_f32_16x16x32_bf16 v[148:151], a[52:55], a[12:15], v[148:151]
  ds_read_b64_tr_b16 a[38:39], v11 offset:25600
  ds_read_b128 a[16:19], v8 offset:40960
  buffer_load_dwordx4 v3, s[8:11], s26 offen offset:1024 sc1 lds
  v_mfma_f32_16x16x32_bf16 v[148:151], a[48:51], a[4:7], v[148:151]
  ds_read_b128 a[24:27], v9 offset:40960
  ds_read_b128 a[20:23], v8 offset:43008
  v_mfma_f32_16x16x32_bf16 v[156:159], a[56:59], a[4:7], v[156:159]
  ds_read_b128 a[28:31], v9 offset:43008
  s_add_u32 m0, s29, 65536
  ds_read_b64_tr_b16 a[40:41], v13 offset:16384
  v_mfma_f32_16x16x32_bf16 v[156:159], a[60:63], a[12:15], v[156:159]
  buffer_load_dwordx4 v4, s[12:15], s27 offen offset:0 lds
  ds_read_b64_tr_b16 a[42:43], v13 offset:17408
  v_mfma_f32_16x16x32_bf16 v[152:155], a[60:63], a[8:11], v[152:155]
  ds_read_b64_tr_b16 a[44:45], v13 offset:24576
  ds_read_b64_tr_b16 a[46:47], v13 offset:25600
  v_mfma_f32_16x16x32_bf16 v[152:155], a[56:59], a[0:3], v[152:155]
  s_waitcnt lgkmcnt(0)
  v_mfma_f32_16x16x32_bf16 v[128:131], a[32:35], a[16:19], v[128:131]
  s_add_u32 m0, s29, 65536
  ds_read_b64_tr_b16 a[48:49], v15 offset:16384
  v_mfma_f32_16x16x32_bf16 v[128:131], a[36:39], a[24:27], v[128:131]
  buffer_load_dwordx4 v5, s[12:15], s27 offen offset:1024 lds
  ds_read_b64_tr_b16 a[50:51], v15 offset:17408
  v_mfma_f32_16x16x32_bf16 v[132:135], a[36:39], a[28:31], v[132:135]
  ds_read_b64_tr_b16 a[52:53], v15 offset:24576
  buffer_load_dwordx4 v6, s[12:15], s27 offen offset:2048 lds
  v_mfma_f32_16x16x32_bf16 v[132:135], a[32:35], a[20:23], v[132:135]
  ds_read_b64_tr_b16 a[54:55], v15 offset:25600
  v_mfma_f32_16x16x32_bf16 v[140:143], a[40:43], a[20:23], v[140:143]
  ds_read_b64_tr_b16 a[56:57], v17 offset:16384
  ds_read_b64_tr_b16 a[58:59], v17 offset:17408
  v_mfma_f32_16x16x32_bf16 v[140:143], a[44:47], a[28:31], v[140:143]
  buffer_load_dwordx4 v7, s[12:15], s27 offen offset:3072 lds
  ds_read_b64_tr_b16 a[60:61], v17 offset:24576
  v_mfma_f32_16x16x32_bf16 v[136:139], a[44:47], a[24:27], v[136:139]
  ds_read_b64_tr_b16 a[62:63], v17 offset:25600
  s_add_u32 s26, s26, 128
  v_mfma_f32_16x16x32_bf16 v[136:139], a[40:43], a[16:19], v[136:139]
  s_add_u32 s27, s27, 131072
  s_waitcnt lgkmcnt(0) vmcnt(25)
  s_barrier
  v_mfma_f32_16x16x32_bf16 v[144:147], a[48:51], a[16:19], v[144:147]
  s_add_u32 m0, s28, 40960
  ds_read_b64_tr_b16 a[32:33], v10 offset:0
  buffer_load_dwordx4 v2, s[8:11], s26 offen offset:0 sc1 lds
  v_mfma_f32_16x16x32_bf16 v[144:147], a[52:55], a[24:27], v[144:147]
  ds_read_b64_tr_b16 a[34:35], v10 offset:1024
  ds_read_b64_tr_b16 a[36:37], v10 offset:8192
  v_mfma_f32_16x16x32_bf16 v[148:151], a[52:55], a[28:31], v[148:151]
  ds_read_b64_tr_b16 a[38:39], v10 offset:9216
  ds_read_b128 a[0:3], v8 offset:0
  buffer_load_dwordx4 v3, s[8:11], s26 offen offset:1024 sc1 lds
  v_mfma_f32_16x16x32_bf16 v[148:151], a[48:51], a[20:23], v[148:151]
  ds_read_b128 a[8:11], v9 offset:0
  ds_read_b128 a[4:7], v8 offset:2048
  v_mfma_f32_16x16x32_bf16 v[156:159], a[56:59], a[20:23], v[156:159]
  ds_read_b128 a[12:15], v9 offset:2048
  s_add_u32 m0, s29, 81920
  ds_read_b64_tr_b16 a[40:41], v12 offset:0
  v_mfma_f32_16x16x32_bf16 v[156:159], a[60:63], a[28:31], v[156:159]
  buffer_load_dwordx4 v4, s[12:15], s27 offen offset:0 lds
  ds_read_b64_tr_b16 a[42:43], v12 offset:1024
  v_mfma_f32_16x16x32_bf16 v[152:155], a[60:63], a[24:27], v[152:155]
  ds_read_b64_tr_b16 a[44:45], v12 offset:8192
  ds_read_b64_tr_b16 a[46:47], v12 offset:9216
  v_mfma_f32_16x16x32_bf16 v[152:155], a[56:59], a[16:19], v[152:155]
  s_waitcnt lgkmcnt(0)
  v_mfma_f32_16x16x32_bf16 v[128:131], a[32:35], a[0:3], v[128:131]
  s_add_u32 m0, s29, 81920
  ds_read_b64_tr_b16 a[48:49], v14 offset:0
  v_mfma_f32_16x16x32_bf16 v[128:131], a[36:39], a[8:11], v[128:131]
  buffer_load_dwordx4 v5, s[12:15], s27 offen offset:1024 lds
  ds_read_b64_tr_b16 a[50:51], v14 offset:1024
  v_mfma_f32_16x16x32_bf16 v[132:135], a[36:39], a[12:15], v[132:135]
  ds_read_b64_tr_b16 a[52:53], v14 offset:8192
  buffer_load_dwordx4 v6, s[12:15], s27 offen offset:2048 lds
  v_mfma_f32_16x16x32_bf16 v[132:135], a[32:35], a[4:7], v[132:135]
  ds_read_b64_tr_b16 a[54:55], v14 offset:9216
  v_mfma_f32_16x16x32_bf16 v[140:143], a[40:43], a[4:7], v[140:143]
  ds_read_b64_tr_b16 a[56:57], v16 offset:0
  ds_read_b64_tr_b16 a[58:59], v16 offset:1024
  v_mfma_f32_16x16x32_bf16 v[140:143], a[44:47], a[12:15], v[140:143]
  buffer_load_dwordx4 v7, s[12:15], s27 offen offset:3072 lds
  ds_read_b64_tr_b16 a[60:61], v16 offset:8192
  v_mfma_f32_16x16x32_bf16 v[136:139], a[44:47], a[8:11], v[136:139]
  ds_read_b64_tr_b16 a[62:63], v16 offset:9216
  s_add_u32 s26, s26, 128
  v_mfma_f32_16x16x32_bf16 v[136:139], a[40:43], a[0:3], v[136:139]
  s_add_u32 s27, s27, 131072
  s_waitcnt lgkmcnt(0) vmcnt(25)
  s_barrier
  v_mfma_f32_16x16x32_bf16 v[144:147], a[48:51], a[0:3], v[144:147]
  s_add_u32 m0, s28, 0
  ds_read_b64_tr_b16 a[32:33], v10 offset:16384
  buffer_load_dwordx4 v2, s[8:11], s26 offen offset:0 sc1 lds
  v_mfma_f32_16x16x32_bf16 v[144:147], a[52:55], a[8:11], v[144:147]
  ds_read_b64_tr_b16 a[34:35], v10 offset:17408
  ds_read_b64_tr_b16 a[36:37], v10 offset:24576
  v_mfma_f32_16x16x32_bf16 v[148:151], a[52:55], a[12:15], v[148:151]
  ds_read_b64_tr_b16 a[38:39], v10 offset:25600
  ds_read_b128 a[16:19], v8 offset:8192
  buffer_load_dwordx4 v3, s[8:11], s26 offen offset:1024 sc1 lds
  v_mfma_f32_16x16x32_bf16 v[148:151], a[48:51], a[4:7], v[148:151]
  ds_read_b128 a[24:27], v9 offset:8192
  ds_read_b128 a[20:23], v8 offset:10240
  v_mfma_f32_16x16x32_bf16 v[156:159], a[56:59], a[4:7], v[156:159]
  ds_read_b128 a[28:31], v9 offset:10240
  s_add_u32 m0, s29, 0
  ds_read_b64_tr_b16 a[40:41], v12 offset:16384
  v_mfma_f32_16x16x32_bf16 v[156:159], a[60:63], a[12:15], v[156:159]
  buffer_load_dwordx4 v4, s[12:15], s27 offen offset:0 lds
  ds_read_b64_tr_b16 a[42:43], v12 offset:17408
  v_mfma_f32_16x16x32_bf16 v[152:155], a[60:63], a[8:11], v[152:155]
  ds_read_b64_tr_b16 a[44:45], v12 offset:24576
  ds_read_b64_tr_b16 a[46:47], v12 offset:25600
  v_mfma_f32_16x16x32_bf16 v[152:155], a[56:59], a[0:3], v[152:155]
  s_waitcnt lgkmcnt(0)
  v_mfma_f32_16x16x32_bf16 v[128:131], a[32:35], a[16:19], v[128:131]
  s_add_u32 m0, s29, 0
  ds_read_b64_tr_b16 a[48:49], v14 offset:16384
  v_mfma_f32_16x16x32_bf16 v[128:131], a[36:39], a[24:27], v[128:131]
  buffer_load_dwordx4 v5, s[12:15], s27 offen offset:1024 lds
  ds_read_b64_tr_b16 a[50:51], v14 offset:17408
  v_mfma_f32_16x16x32_bf16 v[132:135], a[36:39], a[28:31], v[132:135]
  ds_read_b64_tr_b16 a[52:53], v14 offset:24576
  buffer_load_dwordx4 v6, s[12:15], s27 offen offset:2048 lds
  v_mfma_f32_16x16x32_bf16 v[132:135], a[32:35], a[20:23], v[132:135]
  ds_read_b64_tr_b16 a[54:55], v14 offset:25600
  v_mfma_f32_16x16x32_bf16 v[140:143], a[40:43], a[20:23], v[140:143]
  ds_read_b64_tr_b16 a[56:57], v16 offset:16384
  ds_read_b64_tr_b16 a[58:59], v16 offset:17408
  v_mfma_f32_16x16x32_bf16 v[140:143], a[44:47], a[28:31], v[140:143]
  buffer_load_dwordx4 v7, s[12:15], s27 offen offset:3072 lds
  ds_read_b64_tr_b16 a[60:61], v16 offset:24576
  v_mfma_f32_16x16x32_bf16 v[136:139], a[44:47], a[24:27], v[136:139]
  ds_read_b64_tr_b16 a[62:63], v16 offset:25600
  s_add_u32 s26, s26, 128
  v_mfma_f32_16x16x32_bf16 v[136:139], a[40:43], a[16:19], v[136:139]
  s_add_u32 s27, s27, 131072
  s_waitcnt lgkmcnt(0) vmcnt(24)
  s_barrier
  v_mfma_f32_16x16x32_bf16 v[144:147], a[48:51], a[16:19], v[144:147]
  s_add_u32 m0, s28, 8192
  ds_read_b64_tr_b16 a[32:33], v10 offset:32768
  buffer_load_dwordx4 v2, s[8:11], s26 offen offset:0 sc1 lds
  v_mfma_f32_16x16x32_bf16 v[144:147], a[52:55], a[24:27], v[144:147]
  ds_read_b64_tr_b16 a[34:35], v10 offset:33792
  ds_read_b64_tr_b16 a[36:37], v10 offset:40960
  v_mfma_f32_16x16x32_bf16 v[148:151], a[52:55], a[28:31], v[148:151]
  ds_read_b64_tr_b16 a[38:39], v10 offset:41984
  ds_read_b128 a[0:3], v8 offset:16384
  buffer_load_dwordx4 v3, s[8:11], s26 offen offset:1024 sc1 lds
  v_mfma_f32_16x16x32_bf16 v[148:151], a[48:51], a[20:23], v[148:151]
  ds_read_b128 a[8:11], v9 offset:16384
  ds_read_b128 a[4:7], v8 offset:18432
  v_mfma_f32_16x16x32_bf16 v[156:159], a[56:59], a[20:23], v[156:159]
  ds_read_b128 a[12:15], v9 offset:18432
  s_add_u32 m0, s29, 16384
  ds_read_b64_tr_b16 a[40:41], v12 offset:32768
  v_mfma_f32_16x16x32_bf16 v[156:159], a[60:63], a[28:31], v[156:159]
  buffer_load_dwordx4 v4, s[12:15], s27 offen offset:0 lds
  ds_read_b64_tr_b16 a[42:43], v12 offset:33792
  v_mfma_f32_16x16x32_bf16 v[152:155], a[60:63], a[24:27], v[152:155]
  ds_read_b64_tr_b16 a[44:45], v12 offset:40960
  ds_read_b64_tr_b16 a[46:47], v12 offset:41984
  v_mfma_f32_16x16x32_bf16 v[152:155], a[56:59], a[16:19], v[152:155]
  s_waitcnt lgkmcnt(0)
  v_mfma_f32_16x16x32_bf16 v[128:131], a[32:35], a[0:3], v[128:131]
  s_add_u32 m0, s29, 16384
  ds_read_b64_tr_b16 a[48:49], v14 offset:32768
  v_mfma_f32_16x16x32_bf16 v[128:131], a[36:39], a[8:11], v[128:131]
  buffer_load_dwordx4 v5, s[12:15], s27 offen offset:1024 lds
  ds_read_b64_tr_b16 a[50:51], v14 offset:33792
  v_mfma_f32_16x16x32_bf16 v[132:135], a[36:39], a[12:15], v[132:135]
  ds_read_b64_tr_b16 a[52:53], v14 offset:40960
  buffer_load_dwordx4 v6, s[12:15], s27 offen offset:2048 lds
  v_mfma_f32_16x16x32_bf16 v[132:135], a[32:35], a[4:7], v[132:135]
  ds_read_b64_tr_b16 a[54:55], v14 offset:41984
  v_mfma_f32_16x16x32_bf16 v[140:143], a[40:43], a[4:7], v[140:143]
  ds_read_b64_tr_b16 a[56:57], v16 offset:32768
  ds_read_b64_tr_b16 a[58:59], v16 offset:33792
  v_mfma_f32_16x16x32_bf16 v[140:143], a[44:47], a[12:15], v[140:143]
  buffer_load_dwordx4 v7, s[12:15], s27 offen offset:3072 lds
  ds_read_b64_tr_b16 a[60:61], v16 offset:40960
  v_mfma_f32_16x16x32_bf16 v[136:139], a[44:47], a[8:11], v[136:139]
  ds_read_b64_tr_b16 a[62:63], v16 offset:41984
  s_add_u32 s26, s26, 128
  v_mfma_f32_16x16x32_bf16 v[136:139], a[40:43], a[0:3], v[136:139]
  s_add_u32 s27, s27, 131072
  s_waitcnt lgkmcnt(0) vmcnt(24)
  s_barrier
  v_mfma_f32_16x16x32_bf16 v[144:147], a[48:51], a[0:3], v[144:147]
  s_add_u32 m0, s28, 16384
  ds_read_b64_tr_b16 a[32:33], v10 offset:49152
  buffer_load_dwordx4 v2, s[8:11], s26 offen offset:0 sc1 lds
  v_mfma_f32_16x16x32_bf16 v[144:147], a[52:55], a[8:11], v[144:147]
  ds_read_b64_tr_b16 a[34:35], v10 offset:50176
  ds_read_b64_tr_b16 a[36:37], v10 offset:57344
  v_mfma_f32_16x16x32_bf16 v[148:151], a[52:55], a[12:15], v[148:151]
  ds_read_b64_tr_b16 a[38:39], v10 offset:58368
  ds_read_b128 a[16:19], v8 offset:24576
  buffer_load_dwordx4 v3, s[8:11], s26 offen offset:1024 sc1 lds
  v_mfma_f32_16x16x32_bf16 v[148:151], a[48:51], a[4:7], v[148:151]
  ds_read_b128 a[24:27], v9 offset:24576
  ds_read_b128 a[20:23], v8 offset:26624
  v_mfma_f32_16x16x32_bf16 v[156:159], a[56:59], a[4:7], v[156:159]
  ds_read_b128 a[28:31], v9 offset:26624
  s_add_u32 m0, s29, 32768
  ds_read_b64_tr_b16 a[40:41], v12 offset:49152
  v_mfma_f32_16x16x32_bf16 v[156:159], a[60:63], a[12:15], v[156:159]
  buffer_load_dwordx4 v4, s[12:15], s27 offen offset:0 lds
  ds_read_b64_tr_b16 a[42:43], v12 offset:50176
  v_mfma_f32_16x16x32_bf16 v[152:155], a[60:63], a[8:11], v[152:155]
  ds_read_b64_tr_b16 a[44:45], v12 offset:57344
  ds_read_b64_tr_b16 a[46:47], v12 offset:58368
  v_mfma_f32_16x16x32_bf16 v[152:155], a[56:59], a[0:3], v[152:155]
  s_waitcnt lgkmcnt(0)
  v_mfma_f32_16x16x32_bf16 v[128:131], a[32:35], a[16:19], v[128:131]
  s_add_u32 m0, s29, 32768
  ds_read_b64_tr_b16 a[48:49], v14 offset:49152
  v_mfma_f32_16x16x32_bf16 v[128:131], a[36:39], a[24:27], v[128:131]
  buffer_load_dwordx4 v5, s[12:15], s27 offen offset:1024 lds
  ds_read_b64_tr_b16 a[50:51], v14 offset:50176
  v_mfma_f32_16x16x32_bf16 v[132:135], a[36:39], a[28:31], v[132:135]
  ds_read_b64_tr_b16 a[52:53], v14 offset:57344
  buffer_load_dwordx4 v6, s[12:15], s27 offen offset:2048 lds
  v_mfma_f32_16x16x32_bf16 v[132:135], a[32:35], a[20:23], v[132:135]
  ds_read_b64_tr_b16 a[54:55], v14 offset:58368
  v_mfma_f32_16x16x32_bf16 v[140:143], a[40:43], a[20:23], v[140:143]
  ds_read_b64_tr_b16 a[56:57], v16 offset:49152
  ds_read_b64_tr_b16 a[58:59], v16 offset:50176
  v_mfma_f32_16x16x32_bf16 v[140:143], a[44:47], a[28:31], v[140:143]
  buffer_load_dwordx4 v7, s[12:15], s27 offen offset:3072 lds
  ds_read_b64_tr_b16 a[60:61], v16 offset:57344
  v_mfma_f32_16x16x32_bf16 v[136:139], a[44:47], a[24:27], v[136:139]
  ds_read_b64_tr_b16 a[62:63], v16 offset:58368
  s_add_u32 s26, s26, 128
  v_mfma_f32_16x16x32_bf16 v[136:139], a[40:43], a[16:19], v[136:139]
  s_add_u32 s27, s27, 131072
  s_waitcnt lgkmcnt(0) vmcnt(24)
  s_barrier
  v_mfma_f32_16x16x32_bf16 v[144:147], a[48:51], a[16:19], v[144:147]
  s_add_u32 m0, s28, 24576
  ds_read_b64_tr_b16 a[32:33], v11 offset:0
  buffer_load_dwordx4 v2, s[8:11], s26 offen offset:0 sc1 lds
  v_mfma_f32_16x16x32_bf16 v[144:147], a[52:55], a[24:27], v[144:147]
  ds_read_b64_tr_b16 a[34:35], v11 offset:1024
  ds_read_b64_tr_b16 a[36:37], v11 offset:8192
  v_mfma_f32_16x16x32_bf16 v[148:151], a[52:55], a[28:31], v[148:151]
  ds_read_b64_tr_b16 a[38:39], v11 offset:9216
  ds_read_b128 a[0:3], v8 offset:32768
  buffer_load_dwordx4 v3, s[8:11], s26 offen offset:1024 sc1 lds
  v_mfma_f32_16x16x32_bf16 v[148:151], a[48:51], a[20:23], v[148:151]
  ds_read_b128 a[8:11], v9 offset:32768
  ds_read_b128 a[4:7], v8 offset:34816
  v_mfma_f32_16x16x32_bf16 v[156:159], a[56:59], a[20:23], v[156:159]
  ds_read_b128 a[12:15], v9 offset:34816
  s_add_u32 m0, s29, 49152
  ds_read_b64_tr_b16 a[40:41], v13 offset:0
  v_mfma_f32_16x16x32_bf16 v[156:159], a[60:63], a[28:31], v[156:159]
  buffer_load_dwordx4 v4, s[12:15], s27 offen offset:0 lds
  ds_read_b64_tr_b16 a[42:43], v13 offset:1024
  v_mfma_f32_16x16x32_bf16 v[152:155], a[60:63], a[24:27], v[152:155]
  ds_read_b64_tr_b16 a[44:45], v13 offset:8192
  ds_read_b64_tr_b16 a[46:47], v13 offset:9216
  v_mfma_f32_16x16x32_bf16 v[152:155], a[56:59], a[16:19], v[152:155]
  s_waitcnt lgkmcnt(0)
  v_mfma_f32_16x16x32_bf16 v[128:131], a[32:35], a[0:3], v[128:131]
  s_add_u32 m0, s29, 49152
  ds_read_b64_tr_b16 a[48:49], v15 offset:0
  v_mfma_f32_16x16x32_bf16 v[128:131], a[36:39], a[8:11], v[128:131]
  buffer_load_dwordx4 v5, s[12:15], s27 offen offset:1024 lds
  ds_read_b64_tr_b16 a[50:51], v15 offset:1024
  v_mfma_f32_16x16x32_bf16 v[132:135], a[36:39], a[12:15], v[132:135]
  ds_read_b64_tr_b16 a[52:53], v15 offset:8192
  buffer_load_dwordx4 v6, s[12:15], s27 offen offset:2048 lds
  v_mfma_f32_16x16x32_bf16 v[132:135], a[32:35], a[4:7], v[132:135]
  ds_read_b64_tr_b16 a[54:55], v15 offset:9216
  v_mfma_f32_16x16x32_bf16 v[140:143], a[40:43], a[4:7], v[140:143]
  ds_read_b64_tr_b16 a[56:57], v17 offset:0
  ds_read_b64_tr_b16 a[58:59], v17 offset:1024
  v_mfma_f32_16x16x32_bf16 v[140:143], a[44:47], a[12:15], v[140:143]
  buffer_load_dwordx4 v7, s[12:15], s27 offen offset:3072 lds
  ds_read_b64_tr_b16 a[60:61], v17 offset:8192
  v_mfma_f32_16x16x32_bf16 v[136:139], a[44:47], a[8:11], v[136:139]
  ds_read_b64_tr_b16 a[62:63], v17 offset:9216
  s_add_u32 s26, s26, 128
  v_mfma_f32_16x16x32_bf16 v[136:139], a[40:43], a[0:3], v[136:139]
  s_add_u32 s27, s27, 131072
  s_waitcnt lgkmcnt(0) vmcnt(24)
  s_barrier
  v_mfma_f32_16x16x32_bf16 v[144:147], a[48:51], a[0:3], v[144:147]
  s_add_u32 m0, s28, 32768
  ds_read_b64_tr_b16 a[32:33], v11 offset:16384
  buffer_load_dwordx4 v2, s[8:11], s26 offen offset:0 sc1 lds
  v_mfma_f32_16x16x32_bf16 v[144:147], a[52:55], a[8:11], v[144:147]
  ds_read_b64_tr_b16 a[34:35], v11 offset:17408
  ds_read_b64_tr_b16 a[36:37], v11 offset:24576
  v_mfma_f32_16x16x32_bf16 v[148:151], a[52:55], a[12:15], v[148:151]
  ds_read_b64_tr_b16 a[38:39], v11 offset:25600
  ds_read_b128 a[16:19], v8 offset:40960
  buffer_load_dwordx4 v3, s[8:11], s26 offen offset:1024 sc1 lds
  v_mfma_f32_16x16x32_bf16 v[148:151], a[48:51], a[4:7], v[148:151]
  ds_read_b128 a[24:27], v9 offset:40960
  ds_read_b128 a[20:23], v8 offset:43008
  v_mfma_f32_16x16x32_bf16 v[156:159], a[56:59], a[4:7], v[156:159]
  ds_read_b128 a[28:31], v9 offset:43008
  s_add_u32 m0, s29, 65536
  ds_read_b64_tr_b16 a[40:41], v13 offset:16384
  v_mfma_f32_16x16x32_bf16 v[156:159], a[60:63], a[12:15], v[156:159]
  buffer_load_dwordx4 v4, s[12:15], s27 offen offset:0 lds
  ds_read_b64_tr_b16 a[42:43], v13 offset:17408
  v_mfma_f32_16x16x32_bf16 v[152:155], a[60:63], a[8:11], v[152:155]
  ds_read_b64_tr_b16 a[44:45], v13 offset:24576
  ds_read_b64_tr_b16 a[46:47], v13 offset:25600
  v_mfma_f32_16x16x32_bf16 v[152:155], a[56:59], a[0:3], v[152:155]
  s_waitcnt lgkmcnt(0)
  v_mfma_f32_16x16x32_bf16 v[128:131], a[32:35], a[16:19], v[128:131]
  s_add_u32 m0, s29, 65536
  ds_read_b64_tr_b16 a[48:49], v15 offset:16384
  v_mfma_f32_16x16x32_bf16 v[128:131], a[36:39], a[24:27], v[128:131]
  buffer_load_dwordx4 v5, s[12:15], s27 offen offset:1024 lds
  ds_read_b64_tr_b16 a[50:51], v15 offset:17408
  v_mfma_f32_16x16x32_bf16 v[132:135], a[36:39], a[28:31], v[132:135]
  ds_read_b64_tr_b16 a[52:53], v15 offset:24576
  buffer_load_dwordx4 v6, s[12:15], s27 offen offset:2048 lds
  v_mfma_f32_16x16x32_bf16 v[132:135], a[32:35], a[20:23], v[132:135]
  ds_read_b64_tr_b16 a[54:55], v15 offset:25600
  v_mfma_f32_16x16x32_bf16 v[140:143], a[40:43], a[20:23], v[140:143]
  ds_read_b64_tr_b16 a[56:57], v17 offset:16384
  ds_read_b64_tr_b16 a[58:59], v17 offset:17408
  v_mfma_f32_16x16x32_bf16 v[140:143], a[44:47], a[28:31], v[140:143]
  buffer_load_dwordx4 v7, s[12:15], s27 offen offset:3072 lds
  ds_read_b64_tr_b16 a[60:61], v17 offset:24576
  v_mfma_f32_16x16x32_bf16 v[136:139], a[44:47], a[24:27], v[136:139]
  ds_read_b64_tr_b16 a[62:63], v17 offset:25600
  s_add_u32 s26, s26, 128
  v_mfma_f32_16x16x32_bf16 v[136:139], a[40:43], a[16:19], v[136:139]
  s_add_u32 s27, s27, 131072
  s_waitcnt lgkmcnt(0) vmcnt(24)
  s_barrier
  v_mfma_f32_16x16x32_bf16 v[144:147], a[48:51], a[16:19], v[144:147]
  s_add_u32 m0, s28, 40960
  ds_read_b64_tr_b16 a[32:33], v10 offset:0
  buffer_load_dwordx4 v2, s[8:11], s26 offen offset:0 sc1 lds
  v_mfma_f32_16x16x32_bf16 v[144:147], a[52:55], a[24:27], v[144:147]
  ds_read_b64_tr_b16 a[34:35], v10 offset:1024
  ds_read_b64_tr_b16 a[36:37], v10 offset:8192
  v_mfma_f32_16x16x32_bf16 v[148:151], a[52:55], a[28:31], v[148:151]
  ds_read_b64_tr_b16 a[38:39], v10 offset:9216
  ds_read_b128 a[0:3], v8 offset:0
  buffer_load_dwordx4 v3, s[8:11], s26 offen offset:1024 sc1 lds
  v_mfma_f32_16x16x32_bf16 v[148:151], a[48:51], a[20:23], v[148:151]
  ds_read_b128 a[8:11], v9 offset:0
  ds_read_b128 a[4:7], v8 offset:2048
  v_mfma_f32_16x16x32_bf16 v[156:159], a[56:59], a[20:23], v[156:159]
  ds_read_b128 a[12:15], v9 offset:2048
  s_add_u32 m0, s29, 81920
  ds_read_b64_tr_b16 a[40:41], v12 offset:0
  v_mfma_f32_16x16x32_bf16 v[156:159], a[60:63], a[28:31], v[156:159]
  buffer_load_dwordx4 v4, s[12:15], s27 offen offset:0 lds
  ds_read_b64_tr_b16 a[42:43], v12 offset:1024
  v_mfma_f32_16x16x32_bf16 v[152:155], a[60:63], a[24:27], v[152:155]
  ds_read_b64_tr_b16 a[44:45], v12 offset:8192
  ds_read_b64_tr_b16 a[46:47], v12 offset:9216
  v_mfma_f32_16x16x32_bf16 v[152:155], a[56:59], a[16:19], v[152:155]
  s_waitcnt lgkmcnt(0)
  v_mfma_f32_16x16x32_bf16 v[128:131], a[32:35], a[0:3], v[128:131]
  s_add_u32 m0, s29, 81920
  ds_read_b64_tr_b16 a[48:49], v14 offset:0
  v_mfma_f32_16x16x32_bf16 v[128:131], a[36:39], a[8:11], v[128:131]
  buffer_load_dwordx4 v5, s[12:15], s27 offen offset:1024 lds
  ds_read_b64_tr_b16 a[50:51], v14 offset:1024
  v_mfma_f32_16x16x32_bf16 v[132:135], a[36:39], a[12:15], v[132:135]
  ds_read_b64_tr_b16 a[52:53], v14 offset:8192
  buffer_load_dwordx4 v6, s[12:15], s27 offen offset:2048 lds
  v_mfma_f32_16x16x32_bf16 v[132:135], a[32:35], a[4:7], v[132:135]
  ds_read_b64_tr_b16 a[54:55], v14 offset:9216
  v_mfma_f32_16x16x32_bf16 v[140:143], a[40:43], a[4:7], v[140:143]
  ds_read_b64_tr_b16 a[56:57], v16 offset:0
  ds_read_b64_tr_b16 a[58:59], v16 offset:1024
  v_mfma_f32_16x16x32_bf16 v[140:143], a[44:47], a[12:15], v[140:143]
  buffer_load_dwordx4 v7, s[12:15], s27 offen offset:3072 lds
  ds_read_b64_tr_b16 a[60:61], v16 offset:8192
  v_mfma_f32_16x16x32_bf16 v[136:139], a[44:47], a[8:11], v[136:139]
  ds_read_b64_tr_b16 a[62:63], v16 offset:9216
  s_add_u32 s26, s26, 128
  v_mfma_f32_16x16x32_bf16 v[136:139], a[40:43], a[0:3], v[136:139]
  s_add_u32 s27, s27, 131072
  s_waitcnt lgkmcnt(0) vmcnt(24)
  s_barrier
  v_mfma_f32_16x16x32_bf16 v[144:147], a[48:51], a[0:3], v[144:147]
  s_add_u32 m0, s28, 0
  ds_read_b64_tr_b16 a[32:33], v10 offset:16384
  buffer_load_dwordx4 v2, s[8:11], s26 offen offset:0 sc1 lds
  v_mfma_f32_16x16x32_bf16 v[144:147], a[52:55], a[8:11], v[144:147]
  ds_read_b64_tr_b16 a[34:35], v10 offset:17408
  ds_read_b64_tr_b16 a[36:37], v10 offset:24576
  v_mfma_f32_16x16x32_bf16 v[148:151], a[52:55], a[12:15], v[148:151]
  ds_read_b64_tr_b16 a[38:39], v10 offset:25600
  ds_read_b128 a[16:19], v8 offset:8192
  buffer_load_dwordx4 v3, s[8:11], s26 offen offset:1024 sc1 lds
  v_mfma_f32_16x16x32_bf16 v[148:151], a[48:51], a[4:7], v[148:151]
  ds_read_b128 a[24:27], v9 offset:8192
  ds_read_b128 a[20:23], v8 offset:10240
  v_mfma_f32_16x16x32_bf16 v[156:159], a[56:59], a[4:7], v[156:159]
  ds_read_b128 a[28:31], v9 offset:10240
  s_add_u32 m0, s29, 0
  ds_read_b64_tr_b16 a[40:41], v12 offset:16384
  v_mfma_f32_16x16x32_bf16 v[156:159], a[60:63], a[12:15], v[156:159]
  buffer_load_dwordx4 v4, s[12:15], s27 offen offset:0 lds
  ds_read_b64_tr_b16 a[42:43], v12 offset:17408
  v_mfma_f32_16x16x32_bf16 v[152:155], a[60:63], a[8:11], v[152:155]
  ds_read_b64_tr_b16 a[44:45], v12 offset:24576
  ds_read_b64_tr_b16 a[46:47], v12 offset:25600
  v_mfma_f32_16x16x32_bf16 v[152:155], a[56:59], a[0:3], v[152:155]
  s_waitcnt lgkmcnt(0)
  v_mfma_f32_16x16x32_bf16 v[128:131], a[32:35], a[16:19], v[128:131]
  s_add_u32 m0, s29, 0
  ds_read_b64_tr_b16 a[48:49], v14 offset:16384
  v_mfma_f32_16x16x32_bf16 v[128:131], a[36:39], a[24:27], v[128:131]
  buffer_load_dwordx4 v5, s[12:15], s27 offen offset:1024 lds
  ds_read_b64_tr_b16 a[50:51], v14 offset:17408
  v_mfma_f32_16x16x32_bf16 v[132:135], a[36:39], a[28:31], v[132:135]
  ds_read_b64_tr_b16 a[52:53], v14 offset:24576
  buffer_load_dwordx4 v6, s[12:15], s27 offen offset:2048 lds
  v_mfma_f32_16x16x32_bf16 v[132:135], a[32:35], a[20:23], v[132:135]
  ds_read_b64_tr_b16 a[54:55], v14 offset:25600
  v_mfma_f32_16x16x32_bf16 v[140:143], a[40:43], a[20:23], v[140:143]
  ds_read_b64_tr_b16 a[56:57], v16 offset:16384
  ds_read_b64_tr_b16 a[58:59], v16 offset:17408
  v_mfma_f32_16x16x32_bf16 v[140:143], a[44:47], a[28:31], v[140:143]
  buffer_load_dwordx4 v7, s[12:15], s27 offen offset:3072 lds
  ds_read_b64_tr_b16 a[60:61], v16 offset:24576
  v_mfma_f32_16x16x32_bf16 v[136:139], a[44:47], a[24:27], v[136:139]
  ds_read_b64_tr_b16 a[62:63], v16 offset:25600
  s_add_u32 s26, s26, 128
  v_mfma_f32_16x16x32_bf16 v[136:139], a[40:43], a[16:19], v[136:139]
  s_add_u32 s27, s27, 131072
  s_waitcnt lgkmcnt(0) vmcnt(24)
  s_barrier
  v_mfma_f32_16x16x32_bf16 v[144:147], a[48:51], a[16:19], v[144:147]
  s_add_u32 m0, s28, 8192
  ds_read_b64_tr_b16 a[32:33], v10 offset:32768
  buffer_load_dwordx4 v2, s[8:11], s26 offen offset:0 sc1 lds
  v_mfma_f32_16x16x32_bf16 v[144:147], a[52:55], a[24:27], v[144:147]
  ds_read_b64_tr_b16 a[34:35], v10 offset:33792
  ds_read_b64_tr_b16 a[36:37], v10 offset:40960
  v_mfma_f32_16x16x32_bf16 v[148:151], a[52:55], a[28:31], v[148:151]
  ds_read_b64_tr_b16 a[38:39], v10 offset:41984
  ds_read_b128 a[0:3], v8 offset:16384
  buffer_load_dwordx4 v3, s[8:11], s26 offen offset:1024 sc1 lds
  v_mfma_f32_16x16x32_bf16 v[148:151], a[48:51], a[20:23], v[148:151]
  ds_read_b128 a[8:11], v9 offset:16384
  ds_read_b128 a[4:7], v8 offset:18432
  v_mfma_f32_16x16x32_bf16 v[156:159], a[56:59], a[20:23], v[156:159]
  ds_read_b128 a[12:15], v9 offset:18432
  s_add_u32 m0, s29, 16384
  ds_read_b64_tr_b16 a[40:41], v12 offset:32768
  v_mfma_f32_16x16x32_bf16 v[156:159], a[60:63], a[28:31], v[156:159]
  buffer_load_dwordx4 v4, s[12:15], s27 offen offset:0 lds
  ds_read_b64_tr_b16 a[42:43], v12 offset:33792
  v_mfma_f32_16x16x32_bf16 v[152:155], a[60:63], a[24:27], v[152:155]
  ds_read_b64_tr_b16 a[44:45], v12 offset:40960
  ds_read_b64_tr_b16 a[46:47], v12 offset:41984
  v_mfma_f32_16x16x32_bf16 v[152:155], a[56:59], a[16:19], v[152:155]
  s_waitcnt lgkmcnt(0)
  v_mfma_f32_16x16x32_bf16 v[128:131], a[32:35], a[0:3], v[128:131]
  s_add_u32 m0, s29, 16384
  ds_read_b64_tr_b16 a[48:49], v14 offset:32768
  v_mfma_f32_16x16x32_bf16 v[128:131], a[36:39], a[8:11], v[128:131]
  buffer_load_dwordx4 v5, s[12:15], s27 offen offset:1024 lds
  ds_read_b64_tr_b16 a[50:51], v14 offset:33792
  v_mfma_f32_16x16x32_bf16 v[132:135], a[36:39], a[12:15], v[132:135]
  ds_read_b64_tr_b16 a[52:53], v14 offset:40960
  buffer_load_dwordx4 v6, s[12:15], s27 offen offset:2048 lds
  v_mfma_f32_16x16x32_bf16 v[132:135], a[32:35], a[4:7], v[132:135]
  ds_read_b64_tr_b16 a[54:55], v14 offset:41984
  ds_read_b64_tr_b16 a[56:57], v16 offset:32768
  v_mfma_f32_16x16x32_bf16 v[140:143], a[40:43], a[4:7], v[140:143]
  buffer_load_dwordx4 v7, s[12:15], s27 offen offset:3072 lds
  ds_read_b64_tr_b16 a[58:59], v16 offset:33792
  v_mfma_f32_16x16x32_bf16 v[140:143], a[44:47], a[12:15], v[140:143]
  ds_read_b64_tr_b16 a[60:61], v16 offset:40960
  global_load_dword v22, v23, s[70:71] offset:128 sc1
  v_mfma_f32_16x16x32_bf16 v[136:139], a[44:47], a[8:11], v[136:139]
  ds_read_b64_tr_b16 a[62:63], v16 offset:41984
  s_add_u32 s26, s26, 128
  v_mfma_f32_16x16x32_bf16 v[136:139], a[40:43], a[0:3], v[136:139]
  s_add_u32 s27, s27, 131072
  s_waitcnt lgkmcnt(0) vmcnt(25)
  s_barrier
  v_mfma_f32_16x16x32_bf16 v[144:147], a[48:51], a[0:3], v[144:147]
  s_add_u32 m0, s28, 16384
  ds_read_b64_tr_b16 a[32:33], v10 offset:49152
  buffer_load_dwordx4 v2, s[8:11], s26 offen offset:0 sc1 lds
  v_mfma_f32_16x16x32_bf16 v[144:147], a[52:55], a[8:11], v[144:147]
  ds_read_b64_tr_b16 a[34:35], v10 offset:50176
  ds_read_b64_tr_b16 a[36:37], v10 offset:57344
  v_mfma_f32_16x16x32_bf16 v[148:151], a[52:55], a[12:15], v[148:151]
  ds_read_b64_tr_b16 a[38:39], v10 offset:58368
  ds_read_b128 a[16:19], v8 offset:24576
  buffer_load_dwordx4 v3, s[8:11], s26 offen offset:1024 sc1 lds
  v_mfma_f32_16x16x32_bf16 v[148:151], a[48:51], a[4:7], v[148:151]
  ds_read_b128 a[24:27], v9 offset:24576
  ds_read_b128 a[20:23], v8 offset:26624
  v_mfma_f32_16x16x32_bf16 v[156:159], a[56:59], a[4:7], v[156:159]
  ds_read_b128 a[28:31], v9 offset:26624
  s_add_u32 m0, s29, 32768
  ds_read_b64_tr_b16 a[40:41], v12 offset:49152
  v_mfma_f32_16x16x32_bf16 v[156:159], a[60:63], a[12:15], v[156:159]
  buffer_load_dwordx4 v4, s[12:15], s27 offen offset:0 lds
  ds_read_b64_tr_b16 a[42:43], v12 offset:50176
  v_mfma_f32_16x16x32_bf16 v[152:155], a[60:63], a[8:11], v[152:155]
  ds_read_b64_tr_b16 a[44:45], v12 offset:57344
  ds_read_b64_tr_b16 a[46:47], v12 offset:58368
  v_mfma_f32_16x16x32_bf16 v[152:155], a[56:59], a[0:3], v[152:155]
  s_waitcnt lgkmcnt(0)
  v_mfma_f32_16x16x32_bf16 v[128:131], a[32:35], a[16:19], v[128:131]
  s_add_u32 m0, s29, 32768
  ds_read_b64_tr_b16 a[48:49], v14 offset:49152
  v_mfma_f32_16x16x32_bf16 v[128:131], a[36:39], a[24:27], v[128:131]
  buffer_load_dwordx4 v5, s[12:15], s27 offen offset:1024 lds
  ds_read_b64_tr_b16 a[50:51], v14 offset:50176
  v_mfma_f32_16x16x32_bf16 v[132:135], a[36:39], a[28:31], v[132:135]
  ds_read_b64_tr_b16 a[52:53], v14 offset:57344
  buffer_load_dwordx4 v6, s[12:15], s27 offen offset:2048 lds
  v_mfma_f32_16x16x32_bf16 v[132:135], a[32:35], a[20:23], v[132:135]
  ds_read_b64_tr_b16 a[54:55], v14 offset:58368
  v_mfma_f32_16x16x32_bf16 v[140:143], a[40:43], a[20:23], v[140:143]
  ds_read_b64_tr_b16 a[56:57], v16 offset:49152
  ds_read_b64_tr_b16 a[58:59], v16 offset:50176
  v_mfma_f32_16x16x32_bf16 v[140:143], a[44:47], a[28:31], v[140:143]
  buffer_load_dwordx4 v7, s[12:15], s27 offen offset:3072 lds
  ds_read_b64_tr_b16 a[60:61], v16 offset:57344
  v_mfma_f32_16x16x32_bf16 v[136:139], a[44:47], a[24:27], v[136:139]
  ds_read_b64_tr_b16 a[62:63], v16 offset:58368
  s_add_u32 s26, s26, 128
  v_mfma_f32_16x16x32_bf16 v[136:139], a[40:43], a[16:19], v[136:139]
  s_add_u32 s27, s27, 131072
  s_waitcnt lgkmcnt(0) vmcnt(25)
  s_barrier
  v_mfma_f32_16x16x32_bf16 v[144:147], a[48:51], a[16:19], v[144:147]
  s_add_u32 m0, s28, 24576
  ds_read_b64_tr_b16 a[32:33], v11 offset:0
  buffer_load_dwordx4 v2, s[8:11], s26 offen offset:0 sc1 lds
  v_mfma_f32_16x16x32_bf16 v[144:147], a[52:55], a[24:27], v[144:147]
  ds_read_b64_tr_b16 a[34:35], v11 offset:1024
  ds_read_b64_tr_b16 a[36:37], v11 offset:8192
  v_mfma_f32_16x16x32_bf16 v[148:151], a[52:55], a[28:31], v[148:151]
  ds_read_b64_tr_b16 a[38:39], v11 offset:9216
  ds_read_b128 a[0:3], v8 offset:32768
  buffer_load_dwordx4 v3, s[8:11], s26 offen offset:1024 sc1 lds
  v_mfma_f32_16x16x32_bf16 v[148:151], a[48:51], a[20:23], v[148:151]
  ds_read_b128 a[8:11], v9 offset:32768
  ds_read_b128 a[4:7], v8 offset:34816
  v_mfma_f32_16x16x32_bf16 v[156:159], a[56:59], a[20:23], v[156:159]
  ds_read_b128 a[12:15], v9 offset:34816
  s_add_u32 m0, s29, 49152
  ds_read_b64_tr_b16 a[40:41], v13 offset:0
  v_mfma_f32_16x16x32_bf16 v[156:159], a[60:63], a[28:31], v[156:159]
  buffer_load_dwordx4 v4, s[12:15], s27 offen offset:0 lds
  ds_read_b64_tr_b16 a[42:43], v13 offset:1024
  v_mfma_f32_16x16x32_bf16 v[152:155], a[60:63], a[24:27], v[152:155]
  ds_read_b64_tr_b16 a[44:45], v13 offset:8192
  ds_read_b64_tr_b16 a[46:47], v13 offset:9216
  v_mfma_f32_16x16x32_bf16 v[152:155], a[56:59], a[16:19], v[152:155]
  s_waitcnt lgkmcnt(0)
  v_mfma_f32_16x16x32_bf16 v[128:131], a[32:35], a[0:3], v[128:131]
  s_add_u32 m0, s29, 49152
  ds_read_b64_tr_b16 a[48:49], v15 offset:0
  v_mfma_f32_16x16x32_bf16 v[128:131], a[36:39], a[8:11], v[128:131]
  buffer_load_dwordx4 v5, s[12:15], s27 offen offset:1024 lds
  ds_read_b64_tr_b16 a[50:51], v15 offset:1024
  v_mfma_f32_16x16x32_bf16 v[132:135], a[36:39], a[12:15], v[132:135]
  ds_read_b64_tr_b16 a[52:53], v15 offset:8192
  buffer_load_dwordx4 v6, s[12:15], s27 offen offset:2048 lds
  v_mfma_f32_16x16x32_bf16 v[132:135], a[32:35], a[4:7], v[132:135]
  ds_read_b64_tr_b16 a[54:55], v15 offset:9216
  v_mfma_f32_16x16x32_bf16 v[140:143], a[40:43], a[4:7], v[140:143]
  ds_read_b64_tr_b16 a[56:57], v17 offset:0
  ds_read_b64_tr_b16 a[58:59], v17 offset:1024
  v_mfma_f32_16x16x32_bf16 v[140:143], a[44:47], a[12:15], v[140:143]
  buffer_load_dwordx4 v7, s[12:15], s27 offen offset:3072 lds
  ds_read_b64_tr_b16 a[60:61], v17 offset:8192
  v_mfma_f32_16x16x32_bf16 v[136:139], a[44:47], a[8:11], v[136:139]
  ds_read_b64_tr_b16 a[62:63], v17 offset:9216
  s_add_u32 s26, s26, 128
  v_mfma_f32_16x16x32_bf16 v[136:139], a[40:43], a[0:3], v[136:139]
  s_add_u32 s27, s27, 131072
  s_waitcnt lgkmcnt(0) vmcnt(25)
  s_barrier
  v_mfma_f32_16x16x32_bf16 v[144:147], a[48:51], a[0:3], v[144:147]
  s_add_u32 m0, s28, 32768
  ds_read_b64_tr_b16 a[32:33], v11 offset:16384
  buffer_load_dwordx4 v2, s[8:11], s26 offen offset:0 sc1 lds
  v_mfma_f32_16x16x32_bf16 v[144:147], a[52:55], a[8:11], v[144:147]
  ds_read_b64_tr_b16 a[34:35], v11 offset:17408
  ds_read_b64_tr_b16 a[36:37], v11 offset:24576
  v_mfma_f32_16x16x32_bf16 v[148:151], a[52:55], a[12:15], v[148:151]
  ds_read_b64_tr_b16 a[38:39], v11 offset:25600
  ds_read_b128 a[16:19], v8 offset:40960
  buffer_load_dwordx4 v3, s[8:11], s26 offen offset:1024 sc1 lds
  v_mfma_f32_16x16x32_bf16 v[148:151], a[48:51], a[4:7], v[148:151]
  ds_read_b128 a[24:27], v9 offset:40960
  ds_read_b128 a[20:23], v8 offset:43008
  v_mfma_f32_16x16x32_bf16 v[156:159], a[56:59], a[4:7], v[156:159]
  ds_read_b128 a[28:31], v9 offset:43008
  s_add_u32 m0, s29, 65536
  ds_read_b64_tr_b16 a[40:41], v13 offset:16384
  v_mfma_f32_16x16x32_bf16 v[156:159], a[60:63], a[12:15], v[156:159]
  buffer_load_dwordx4 v4, s[12:15], s27 offen offset:0 lds
  ds_read_b64_tr_b16 a[42:43], v13 offset:17408
  v_mfma_f32_16x16x32_bf16 v[152:155], a[60:63], a[8:11], v[152:155]
  ds_read_b64_tr_b16 a[44:45], v13 offset:24576
  ds_read_b64_tr_b16 a[46:47], v13 offset:25600
  v_mfma_f32_16x16x32_bf16 v[152:155], a[56:59], a[0:3], v[152:155]
  s_waitcnt lgkmcnt(0)
  v_mfma_f32_16x16x32_bf16 v[128:131], a[32:35], a[16:19], v[128:131]
  s_add_u32 m0, s29, 65536
  ds_read_b64_tr_b16 a[48:49], v15 offset:16384
  v_mfma_f32_16x16x32_bf16 v[128:131], a[36:39], a[24:27], v[128:131]
  buffer_load_dwordx4 v5, s[12:15], s27 offen offset:1024 lds
  ds_read_b64_tr_b16 a[50:51], v15 offset:17408
  v_mfma_f32_16x16x32_bf16 v[132:135], a[36:39], a[28:31], v[132:135]
  ds_read_b64_tr_b16 a[52:53], v15 offset:24576
  buffer_load_dwordx4 v6, s[12:15], s27 offen offset:2048 lds
  v_mfma_f32_16x16x32_bf16 v[132:135], a[32:35], a[20:23], v[132:135]
  ds_read_b64_tr_b16 a[54:55], v15 offset:25600
  v_mfma_f32_16x16x32_bf16 v[140:143], a[40:43], a[20:23], v[140:143]
  ds_read_b64_tr_b16 a[56:57], v17 offset:16384
  ds_read_b64_tr_b16 a[58:59], v17 offset:17408
  v_mfma_f32_16x16x32_bf16 v[140:143], a[44:47], a[28:31], v[140:143]
  buffer_load_dwordx4 v7, s[12:15], s27 offen offset:3072 lds
  ds_read_b64_tr_b16 a[60:61], v17 offset:24576
  v_mfma_f32_16x16x32_bf16 v[136:139], a[44:47], a[24:27], v[136:139]
  ds_read_b64_tr_b16 a[62:63], v17 offset:25600
  s_add_u32 s26, s26, 128
  v_mfma_f32_16x16x32_bf16 v[136:139], a[40:43], a[16:19], v[136:139]
  s_add_u32 s27, s27, 131072
  s_waitcnt lgkmcnt(0) vmcnt(25)
  s_barrier
  v_mfma_f32_16x16x32_bf16 v[144:147], a[48:51], a[16:19], v[144:147]
  s_add_u32 m0, s28, 40960
  ds_read_b64_tr_b16 a[32:33], v10 offset:0
  buffer_load_dwordx4 v2, s[8:11], s26 offen offset:0 sc1 lds
  v_mfma_f32_16x16x32_bf16 v[144:147], a[52:55], a[24:27], v[144:147]
  ds_read_b64_tr_b16 a[34:35], v10 offset:1024
  ds_read_b64_tr_b16 a[36:37], v10 offset:8192
  v_mfma_f32_16x16x32_bf16 v[148:151], a[52:55], a[28:31], v[148:151]
  ds_read_b64_tr_b16 a[38:39], v10 offset:9216
  ds_read_b128 a[0:3], v8 offset:0
  buffer_load_dwordx4 v3, s[8:11], s26 offen offset:1024 sc1 lds
  v_mfma_f32_16x16x32_bf16 v[148:151], a[48:51], a[20:23], v[148:151]
  ds_read_b128 a[8:11], v9 offset:0
  ds_read_b128 a[4:7], v8 offset:2048
  v_mfma_f32_16x16x32_bf16 v[156:159], a[56:59], a[20:23], v[156:159]
  ds_read_b128 a[12:15], v9 offset:2048
  s_add_u32 m0, s29, 81920
  ds_read_b64_tr_b16 a[40:41], v12 offset:0
  v_mfma_f32_16x16x32_bf16 v[156:159], a[60:63], a[28:31], v[156:159]
  buffer_load_dwordx4 v4, s[12:15], s27 offen offset:0 lds
  ds_read_b64_tr_b16 a[42:43], v12 offset:1024
  v_mfma_f32_16x16x32_bf16 v[152:155], a[60:63], a[24:27], v[152:155]
  ds_read_b64_tr_b16 a[44:45], v12 offset:8192
  ds_read_b64_tr_b16 a[46:47], v12 offset:9216
  v_mfma_f32_16x16x32_bf16 v[152:155], a[56:59], a[16:19], v[152:155]
  s_waitcnt lgkmcnt(0)
  v_mfma_f32_16x16x32_bf16 v[128:131], a[32:35], a[0:3], v[128:131]
  s_add_u32 m0, s29, 81920
  ds_read_b64_tr_b16 a[48:49], v14 offset:0
  v_mfma_f32_16x16x32_bf16 v[128:131], a[36:39], a[8:11], v[128:131]
  buffer_load_dwordx4 v5, s[12:15], s27 offen offset:1024 lds
  ds_read_b64_tr_b16 a[50:51], v14 offset:1024
  v_mfma_f32_16x16x32_bf16 v[132:135], a[36:39], a[12:15], v[132:135]
  ds_read_b64_tr_b16 a[52:53], v14 offset:8192
  buffer_load_dwordx4 v6, s[12:15], s27 offen offset:2048 lds
  v_mfma_f32_16x16x32_bf16 v[132:135], a[32:35], a[4:7], v[132:135]
  ds_read_b64_tr_b16 a[54:55], v14 offset:9216
  v_mfma_f32_16x16x32_bf16 v[140:143], a[40:43], a[4:7], v[140:143]
  ds_read_b64_tr_b16 a[56:57], v16 offset:0
  ds_read_b64_tr_b16 a[58:59], v16 offset:1024
  v_mfma_f32_16x16x32_bf16 v[140:143], a[44:47], a[12:15], v[140:143]
  buffer_load_dwordx4 v7, s[12:15], s27 offen offset:3072 lds
  ds_read_b64_tr_b16 a[60:61], v16 offset:8192
  v_mfma_f32_16x16x32_bf16 v[136:139], a[44:47], a[8:11], v[136:139]
  ds_read_b64_tr_b16 a[62:63], v16 offset:9216
  s_add_u32 s26, s26, 128
  v_mfma_f32_16x16x32_bf16 v[136:139], a[40:43], a[0:3], v[136:139]
  s_add_u32 s27, s27, 131072
  s_waitcnt lgkmcnt(0) vmcnt(25)
  s_barrier
  v_mfma_f32_16x16x32_bf16 v[144:147], a[48:51], a[0:3], v[144:147]
  s_add_u32 m0, s48, 49152
  ds_read_b64_tr_b16 a[32:33], v10 offset:16384
  buffer_load_dwordx4 v26, s[52:55], s44 offen offset:0 sc1 lds
  v_mfma_f32_16x16x32_bf16 v[144:147], a[52:55], a[8:11], v[144:147]
  ds_read_b64_tr_b16 a[34:35], v10 offset:17408
  ds_read_b64_tr_b16 a[36:37], v10 offset:24576
  v_mfma_f32_16x16x32_bf16 v[148:151], a[52:55], a[12:15], v[148:151]
  ds_read_b64_tr_b16 a[38:39], v10 offset:25600
  buffer_load_dwordx4 v27, s[52:55], s44 offen offset:1024 sc1 lds
  ds_read_b128 a[16:19], v8 offset:8192
  v_mfma_f32_16x16x32_bf16 v[148:151], a[48:51], a[4:7], v[148:151]
  ds_read_b128 a[24:27], v9 offset:8192
  ds_read_b128 a[20:23], v8 offset:10240
  v_mfma_f32_16x16x32_bf16 v[156:159], a[56:59], a[4:7], v[156:159]
  buffer_load_dwordx4 v28, s[52:55], s44 offen offset:2048 sc1 lds
  ds_read_b128 a[28:31], v9 offset:10240
  ds_read_b64_tr_b16 a[40:41], v12 offset:16384
  v_mfma_f32_16x16x32_bf16 v[156:159], a[60:63], a[12:15], v[156:159]
  ds_read_b64_tr_b16 a[42:43], v12 offset:17408
  buffer_load_dwordx4 v29, s[52:55], s44 offen offset:3072 sc1 lds
  v_mfma_f32_16x16x32_bf16 v[152:155], a[60:63], a[8:11], v[152:155]
  ds_read_b64_tr_b16 a[44:45], v12 offset:24576
  ds_read_b64_tr_b16 a[46:47], v12 offset:25600
  v_mfma_f32_16x16x32_bf16 v[152:155], a[56:59], a[0:3], v[152:155]
  s_waitcnt lgkmcnt(0)
  v_mfma_f32_16x16x32_bf16 v[128:131], a[32:35], a[16:19], v[128:131]
  ds_read_b64_tr_b16 a[48:49], v14 offset:16384
  ds_read_b64_tr_b16 a[50:51], v14 offset:17408
  v_mfma_f32_16x16x32_bf16 v[128:131], a[36:39], a[24:27], v[128:131]
  ds_read_b64_tr_b16 a[52:53], v14 offset:24576
  v_mfma_f32_16x16x32_bf16 v[132:135], a[36:39], a[28:31], v[132:135]
  ds_read_b64_tr_b16 a[54:55], v14 offset:25600
  v_mfma_f32_16x16x32_bf16 v[132:135], a[32:35], a[20:23], v[132:135]
  ds_read_b64_tr_b16 a[56:57], v16 offset:16384
  ds_read_b64_tr_b16 a[58:59], v16 offset:17408
  v_mfma_f32_16x16x32_bf16 v[140:143], a[40:43], a[20:23], v[140:143]
  ds_read_b64_tr_b16 a[60:61], v16 offset:24576
  v_mfma_f32_16x16x32_bf16 v[140:143], a[44:47], a[28:31], v[140:143]
  ds_read_b64_tr_b16 a[62:63], v16 offset:25600
  v_mfma_f32_16x16x32_bf16 v[136:139], a[44:47], a[24:27], v[136:139]
  v_mfma_f32_16x16x32_bf16 v[136:139], a[40:43], a[16:19], v[136:139]
  s_waitcnt lgkmcnt(0) vmcnt(22)
  s_barrier
  v_readfirstlane_b32 s43, v22
  s_nop 3
  s_cmp_ge_u32 s43, 2
  s_cbranch_scc0 fin_spoll
fin_spoll_ret:
  v_mfma_f32_16x16x32_bf16 v[144:147], a[48:51], a[16:19], v[144:147]
  s_add_u32 m0, s48, 65536
  ds_read_b64_tr_b16 a[32:33], v10 offset:32768
  buffer_load_dwordx4 v26, s[56:59], s44 offen offset:0 sc1 lds
  v_mfma_f32_16x16x32_bf16 v[144:147], a[52:55], a[24:27], v[144:147]
  ds_read_b64_tr_b16 a[34:35], v10 offset:33792
  ds_read_b64_tr_b16 a[36:37], v10 offset:40960
  v_mfma_f32_16x16x32_bf16 v[148:151], a[52:55], a[28:31], v[148:151]
  ds_read_b64_tr_b16 a[38:39], v10 offset:41984
  buffer_load_dwordx4 v27, s[56:59], s44 offen offset:1024 sc1 lds
  ds_read_b128 a[0:3], v8 offset:16384
  v_mfma_f32_16x16x32_bf16 v[148:151], a[48:51], a[20:23], v[148:151]
  ds_read_b128 a[8:11], v9 offset:16384
  ds_read_b128 a[4:7], v8 offset:18432
  v_mfma_f32_16x16x32_bf16 v[156:159], a[56:59], a[20:23], v[156:159]
  buffer_load_dwordx4 v28, s[56:59], s44 offen offset:2048 sc1 lds
  ds_read_b128 a[12:15], v9 offset:18432
  ds_read_b64_tr_b16 a[40:41], v12 offset:32768
  v_mfma_f32_16x16x32_bf16 v[156:159], a[60:63], a[28:31], v[156:159]
  ds_read_b64_tr_b16 a[42:43], v12 offset:33792
  buffer_load_dwordx4 v29, s[56:59], s44 offen offset:3072 sc1 lds
  v_mfma_f32_16x16x32_bf16 v[152:155], a[60:63], a[24:27], v[152:155]
  ds_read_b64_tr_b16 a[44:45], v12 offset:40960
  ds_read_b64_tr_b16 a[46:47], v12 offset:41984
  v_mfma_f32_16x16x32_bf16 v[152:155], a[56:59], a[16:19], v[152:155]
  s_waitcnt lgkmcnt(0)
  v_mfma_f32_16x16x32_bf16 v[128:131], a[32:35], a[0:3], v[128:131]
  ds_read_b64_tr_b16 a[48:49], v14 offset:32768
  ds_read_b64_tr_b16 a[50:51], v14 offset:33792
  v_mfma_f32_16x16x32_bf16 v[128:131], a[36:39], a[8:11], v[128:131]
  ds_read_b64_tr_b16 a[52:53], v14 offset:40960
  v_mfma_f32_16x16x32_bf16 v[132:135], a[36:39], a[12:15], v[132:135]
  ds_read_b64_tr_b16 a[54:55], v14 offset:41984
  v_mfma_f32_16x16x32_bf16 v[132:135], a[32:35], a[4:7], v[132:135]
  ds_read_b64_tr_b16 a[56:57], v16 offset:32768
  ds_read_b64_tr_b16 a[58:59], v16 offset:33792
  v_mfma_f32_16x16x32_bf16 v[140:143], a[40:43], a[4:7], v[140:143]
  ds_read_b64_tr_b16 a[60:61], v16 offset:40960
  v_mfma_f32_16x16x32_bf16 v[140:143], a[44:47], a[12:15], v[140:143]
  ds_read_b64_tr_b16 a[62:63], v16 offset:41984
  v_mfma_f32_16x16x32_bf16 v[136:139], a[44:47], a[8:11], v[136:139]
  v_mfma_f32_16x16x32_bf16 v[136:139], a[40:43], a[0:3], v[136:139]
  s_waitcnt lgkmcnt(0) vmcnt(20)
  s_barrier
  v_mfma_f32_16x16x32_bf16 v[144:147], a[48:51], a[0:3], v[144:147]
  s_add_u32 m0, s48, 81920
  ds_read_b64_tr_b16 a[32:33], v10 offset:49152
  buffer_load_dwordx4 v26, s[60:63], s44 offen offset:0 sc1 lds
  v_mfma_f32_16x16x32_bf16 v[144:147], a[52:55], a[8:11], v[144:147]
  ds_read_b64_tr_b16 a[34:35], v10 offset:50176
  ds_read_b64_tr_b16 a[36:37], v10 offset:57344
  v_mfma_f32_16x16x32_bf16 v[148:151], a[52:55], a[12:15], v[148:151]
  ds_read_b64_tr_b16 a[38:39], v10 offset:58368
  buffer_load_dwordx4 v27, s[60:63], s44 offen offset:1024 sc1 lds
  ds_read_b128 a[16:19], v8 offset:24576
  v_mfma_f32_16x16x32_bf16 v[148:151], a[48:51], a[4:7], v[148:151]
  ds_read_b128 a[24:27], v9 offset:24576
  ds_read_b128 a[20:23], v8 offset:26624
  v_mfma_f32_16x16x32_bf16 v[156:159], a[56:59], a[4:7], v[156:159]
  buffer_load_dwordx4 v28, s[60:63], s44 offen offset:2048 sc1 lds
  ds_read_b128 a[28:31], v9 offset:26624
  ds_read_b64_tr_b16 a[40:41], v12 offset:49152
  v_mfma_f32_16x16x32_bf16 v[156:159], a[60:63], a[12:15], v[156:159]
  ds_read_b64_tr_b16 a[42:43], v12 offset:50176
  buffer_load_dwordx4 v29, s[60:63], s44 offen offset:3072 sc1 lds
  v_mfma_f32_16x16x32_bf16 v[152:155], a[60:63], a[8:11], v[152:155]
  ds_read_b64_tr_b16 a[44:45], v12 offset:57344
  ds_read_b64_tr_b16 a[46:47], v12 offset:58368
  v_mfma_f32_16x16x32_bf16 v[152:155], a[56:59], a[0:3], v[152:155]
  s_waitcnt lgkmcnt(0)
  v_mfma_f32_16x16x32_bf16 v[128:131], a[32:35], a[16:19], v[128:131]
  ds_read_b64_tr_b16 a[48:49], v14 offset:49152
  ds_read_b64_tr_b16 a[50:51], v14 offset:50176
  v_mfma_f32_16x16x32_bf16 v[128:131], a[36:39], a[24:27], v[128:131]
  ds_read_b64_tr_b16 a[52:53], v14 offset:57344
  v_mfma_f32_16x16x32_bf16 v[132:135], a[36:39], a[28:31], v[132:135]
  ds_read_b64_tr_b16 a[54:55], v14 offset:58368
  v_mfma_f32_16x16x32_bf16 v[132:135], a[32:35], a[20:23], v[132:135]
  ds_read_b64_tr_b16 a[56:57], v16 offset:49152
  ds_read_b64_tr_b16 a[58:59], v16 offset:50176
  v_mfma_f32_16x16x32_bf16 v[140:143], a[40:43], a[20:23], v[140:143]
  ds_read_b64_tr_b16 a[60:61], v16 offset:57344
  v_mfma_f32_16x16x32_bf16 v[140:143], a[44:47], a[28:31], v[140:143]
  ds_read_b64_tr_b16 a[62:63], v16 offset:58368
  v_mfma_f32_16x16x32_bf16 v[136:139], a[44:47], a[24:27], v[136:139]
  v_mfma_f32_16x16x32_bf16 v[136:139], a[40:43], a[16:19], v[136:139]
  s_waitcnt lgkmcnt(0) vmcnt(18)
  s_barrier
  v_mfma_f32_16x16x32_bf16 v[144:147], a[48:51], a[16:19], v[144:147]
  ds_read_b64_tr_b16 a[32:33], v11 offset:0
  ds_read_b64_tr_b16 a[34:35], v11 offset:1024
  v_mfma_f32_16x16x32_bf16 v[144:147], a[52:55], a[24:27], v[144:147]
  ds_read_b64_tr_b16 a[36:37], v11 offset:8192
  ds_read_b64_tr_b16 a[38:39], v11 offset:9216
  v_mfma_f32_16x16x32_bf16 v[148:151], a[52:55], a[28:31], v[148:151]
  ds_read_b128 a[0:3], v8 offset:32768
  ds_read_b128 a[8:11], v9 offset:32768
  v_mfma_f32_16x16x32_bf16 v[148:151], a[48:51], a[20:23], v[148:151]
  ds_read_b128 a[4:7], v8 offset:34816
  ds_read_b128 a[12:15], v9 offset:34816
  v_mfma_f32_16x16x32_bf16 v[156:159], a[56:59], a[20:23], v[156:159]
  ds_read_b64_tr_b16 a[40:41], v13 offset:0
  ds_read_b64_tr_b16 a[42:43], v13 offset:1024
  v_mfma_f32_16x16x32_bf16 v[156:159], a[60:63], a[28:31], v[156:159]
  ds_read_b64_tr_b16 a[44:45], v13 offset:8192
  ds_read_b64_tr_b16 a[46:47], v13 offset:9216
  v_mfma_f32_16x16x32_bf16 v[152:155], a[60:63], a[24:27], v[152:155]
  v_mfma_f32_16x16x32_bf16 v[152:155], a[56:59], a[16:19], v[152:155]
  s_waitcnt lgkmcnt(0)
  v_mfma_f32_16x16x32_bf16 v[128:131], a[32:35], a[0:3], v[128:131]
  ds_read_b64_tr_b16 a[48:49], v15 offset:0
  ds_read_b64_tr_b16 a[50:51], v15 offset:1024
  v_mfma_f32_16x16x32_bf16 v[128:131], a[36:39], a[8:11], v[128:131]
  ds_read_b64_tr_b16 a[52:53], v15 offset:8192
  v_mfma_f32_16x16x32_bf16 v[132:135], a[36:39], a[12:15], v[132:135]
  ds_read_b64_tr_b16 a[54:55], v15 offset:9216
  v_mfma_f32_16x16x32_bf16 v[132:135], a[32:35], a[4:7], v[132:135]
  ds_read_b64_tr_b16 a[56:57], v17 offset:0
  ds_read_b64_tr_b16 a[58:59], v17 offset:1024
  v_mfma_f32_16x16x32_bf16 v[140:143], a[40:43], a[4:7], v[140:143]
  ds_read_b64_tr_b16 a[60:61], v17 offset:8192
  v_mfma_f32_16x16x32_bf16 v[140:143], a[44:47], a[12:15], v[140:143]
  ds_read_b64_tr_b16 a[62:63], v17 offset:9216
  v_mfma_f32_16x16x32_bf16 v[136:139], a[44:47], a[8:11], v[136:139]
  v_mfma_f32_16x16x32_bf16 v[136:139], a[40:43], a[0:3], v[136:139]
  s_waitcnt lgkmcnt(0) vmcnt(12)
  s_barrier
  v_mfma_f32_16x16x32_bf16 v[144:147], a[48:51], a[0:3], v[144:147]
  ds_read_b64_tr_b16 a[32:33], v11 offset:16384
  ds_read_b64_tr_b16 a[34:35], v11 offset:17408
  v_mfma_f32_16x16x32_bf16 v[144:147], a[52:55], a[8:11], v[144:147]
  ds_read_b64_tr_b16 a[36:37], v11 offset:24576
  ds_read_b64_tr_b16 a[38:39], v11 offset:25600
  v_mfma_f32_16x16x32_bf16 v[148:151], a[52:55], a[12:15], v[148:151]
  ds_read_b128 a[16:19], v8 offset:40960
  ds_read_b128 a[24:27], v9 offset:40960
  v_mfma_f32_16x16x32_bf16 v[148:151], a[48:51], a[4:7], v[148:151]
  ds_read_b128 a[20:23], v8 offset:43008
  ds_read_b128 a[28:31], v9 offset:43008
  v_mfma_f32_16x16x32_bf16 v[156:159], a[56:59], a[4:7], v[156:159]
  ds_read_b64_tr_b16 a[40:41], v13 offset:16384
  ds_read_b64_tr_b16 a[42:43], v13 offset:17408
  v_mfma_f32_16x16x32_bf16 v[156:159], a[60:63], a[12:15], v[156:159]
  ds_read_b64_tr_b16 a[44:45], v13 offset:24576
  ds_read_b64_tr_b16 a[46:47], v13 offset:25600
  v_mfma_f32_16x16x32_bf16 v[152:155], a[60:63], a[8:11], v[152:155]
  v_mfma_f32_16x16x32_bf16 v[152:155], a[56:59], a[0:3], v[152:155]
  s_waitcnt lgkmcnt(0)
  v_mfma_f32_16x16x32_bf16 v[128:131], a[32:35], a[16:19], v[128:131]
  ds_read_b64_tr_b16 a[48:49], v15 offset:16384
  ds_read_b64_tr_b16 a[50:51], v15 offset:17408
  v_mfma_f32_16x16x32_bf16 v[128:131], a[36:39], a[24:27], v[128:131]
  ds_read_b64_tr_b16 a[52:53], v15 offset:24576
  v_mfma_f32_16x16x32_bf16 v[132:135], a[36:39], a[28:31], v[132:135]
  ds_read_b64_tr_b16 a[54:55], v15 offset:25600
  v_mfma_f32_16x16x32_bf16 v[132:135], a[32:35], a[20:23], v[132:135]
  ds_read_b64_tr_b16 a[56:57], v17 offset:16384
  ds_read_b64_tr_b16 a[58:59], v17 offset:17408
  v_mfma_f32_16x16x32_bf16 v[140:143], a[40:43], a[20:23], v[140:143]
  ds_read_b64_tr_b16 a[60:61], v17 offset:24576
  v_mfma_f32_16x16x32_bf16 v[140:143], a[44:47], a[28:31], v[140:143]
  ds_read_b64_tr_b16 a[62:63], v17 offset:25600
  v_mfma_f32_16x16x32_bf16 v[136:139], a[44:47], a[24:27], v[136:139]
  v_mfma_f32_16x16x32_bf16 v[136:139], a[40:43], a[16:19], v[136:139]
  s_waitcnt lgkmcnt(0)
  v_mfma_f32_16x16x32_bf16 v[144:147], a[48:51], a[16:19], v[144:147]
  v_mfma_f32_16x16x32_bf16 v[144:147], a[52:55], a[24:27], v[144:147]
  v_mfma_f32_16x16x32_bf16 v[148:151], a[52:55], a[28:31], v[148:151]
  v_mfma_f32_16x16x32_bf16 v[148:151], a[48:51], a[20:23], v[148:151]
  v_mfma_f32_16x16x32_bf16 v[156:159], a[56:59], a[20:23], v[156:159]
  v_mfma_f32_16x16x32_bf16 v[156:159], a[60:63], a[28:31], v[156:159]
  v_mfma_f32_16x16x32_bf16 v[152:155], a[60:63], a[24:27], v[152:155]
  v_mfma_f32_16x16x32_bf16 v[152:155], a[56:59], a[16:19], v[152:155]
  s_waitcnt vmcnt(0)
  s_barrier
  s_nop 7
  ds_read_b64 v[64:65], v30 offset:0
  ds_read_b64 v[66:67], v30 offset:16384
  ds_read_b64 v[68:69], v30 offset:32768
  ds_read_b64 v[70:71], v31 offset:0
  ds_read_b64 v[72:73], v31 offset:16384
  ds_read_b64 v[74:75], v31 offset:32768
  ds_read_b64 v[76:77], v32 offset:0
  ds_read_b64 v[78:79], v32 offset:16384
  ds_read_b64 v[80:81], v32 offset:32768
  ds_read_b64 v[82:83], v33 offset:0
  ds_read_b64 v[84:85], v33 offset:16384
  ds_read_b64 v[86:87], v33 offset:32768
  s_waitcnt lgkmcnt(0)
  v_pk_mul_f32 v[112:113], v[128:129], v[56:57]
  v_pk_mul_f32 v[114:115], v[130:131], v[56:57]
  v_exp_f32 v112, v112
  v_exp_f32 v113, v113
  v_exp_f32 v114, v114
  v_exp_f32 v115, v115
  v_lshlrev_b32 v116, 16, v66
  v_and_b32 v117, 0xffff0000, v66
  v_lshlrev_b32 v120, 16, v68
  v_and_b32 v121, 0xffff0000, v68
  v_lshlrev_b32 v118, 16, v67
  v_and_b32 v119, 0xffff0000, v67
  v_lshlrev_b32 v122, 16, v69
  v_and_b32 v123, 0xffff0000, v69
  v_pk_add_f32 v[112:113], v[112:113], v[58:59]
  v_pk_add_f32 v[114:115], v[114:115], v[58:59]
  v_rcp_f32 v112, v112
  v_rcp_f32 v113, v113
  v_rcp_f32 v114, v114
  v_rcp_f32 v115, v115
  v_pk_add_f32 v[116:117], v[116:117], v[120:121]
  v_pk_add_f32 v[118:119], v[118:119], v[122:123]
  v_lshlrev_b32 v120, 16, v64
  v_and_b32 v121, 0xffff0000, v64
  v_lshlrev_b32 v122, 16, v65
  v_and_b32 v123, 0xffff0000, v65
  v_pk_mul_f32 v[112:113], v[112:113], v[128:129]
  v_pk_mul_f32 v[114:115], v[114:115], v[130:131]
  v_pk_fma_f32 v[112:113], v[112:113], v[116:117], v[120:121]
  v_pk_fma_f32 v[114:115], v[114:115], v[118:119], v[122:123]
  v_cvt_pk_bf16_f32 v44, v112, v113
  v_cvt_pk_bf16_f32 v45, v114, v115
  ds_write_b64 v30, v[44:45] offset:0
  v_pk_mul_f32 v[112:113], v[136:137], v[56:57]
  v_pk_mul_f32 v[114:115], v[138:139], v[56:57]
  v_exp_f32 v112, v112
  v_exp_f32 v113, v113
  v_exp_f32 v114, v114
  v_exp_f32 v115, v115
  v_lshlrev_b32 v116, 16, v72
  v_and_b32 v117, 0xffff0000, v72
  v_lshlrev_b32 v120, 16, v74
  v_and_b32 v121, 0xffff0000, v74
  v_lshlrev_b32 v118, 16, v73
  v_and_b32 v119, 0xffff0000, v73
  v_lshlrev_b32 v122, 16, v75
  v_and_b32 v123, 0xffff0000, v75
  v_pk_add_f32 v[112:113], v[112:113], v[58:59]
  v_pk_add_f32 v[114:115], v[114:115], v[58:59]
  v_rcp_f32 v112, v112
  v_rcp_f32 v113, v113
  v_rcp_f32 v114, v114
  v_rcp_f32 v115, v115
  v_pk_add_f32 v[116:117], v[116:117], v[120:121]
  v_pk_add_f32 v[118:119], v[118:119], v[122:123]
  v_lshlrev_b32 v120, 16, v70
  v_and_b32 v121, 0xffff0000, v70
  v_lshlrev_b32 v122, 16, v71
  v_and_b32 v123, 0xffff0000, v71
  v_pk_mul_f32 v[112:113], v[112:113], v[136:137]
  v_pk_mul_f32 v[114:115], v[114:115], v[138:139]
  v_pk_fma_f32 v[112:113], v[112:113], v[116:117], v[120:121]
  v_pk_fma_f32 v[114:115], v[114:115], v[118:119], v[122:123]
  v_cvt_pk_bf16_f32 v46, v112, v113
  v_cvt_pk_bf16_f32 v47, v114, v115
  ds_write_b64 v31, v[46:47] offset:0
  v_pk_mul_f32 v[112:113], v[144:145], v[56:57]
  v_pk_mul_f32 v[114:115], v[146:147], v[56:57]
  v_exp_f32 v112, v112
  v_exp_f32 v113, v113
  v_exp_f32 v114, v114
  v_exp_f32 v115, v115
  v_lshlrev_b32 v116, 16, v78
  v_and_b32 v117, 0xffff0000, v78
  v_lshlrev_b32 v120, 16, v80
  v_and_b32 v121, 0xffff0000, v80
  v_lshlrev_b32 v118, 16, v79
  v_and_b32 v119, 0xffff0000, v79
  v_lshlrev_b32 v122, 16, v81
  v_and_b32 v123, 0xffff0000, v81
  v_pk_add_f32 v[112:113], v[112:113], v[58:59]
  v_pk_add_f32 v[114:115], v[114:115], v[58:59]
  v_rcp_f32 v112, v112
  v_rcp_f32 v113, v113
  v_rcp_f32 v114, v114
  v_rcp_f32 v115, v115
  v_pk_add_f32 v[116:117], v[116:117], v[120:121]
  v_pk_add_f32 v[118:119], v[118:119], v[122:123]
  v_lshlrev_b32 v120, 16, v76
  v_and_b32 v121, 0xffff0000, v76
  v_lshlrev_b32 v122, 16, v77
  v_and_b32 v123, 0xffff0000, v77
  v_pk_mul_f32 v[112:113], v[112:113], v[144:145]
  v_pk_mul_f32 v[114:115], v[114:115], v[146:147]
  v_pk_fma_f32 v[112:113], v[112:113], v[116:117], v[120:121]
  v_pk_fma_f32 v[114:115], v[114:115], v[118:119], v[122:123]
  v_cvt_pk_bf16_f32 v48, v112, v113
  v_cvt_pk_bf16_f32 v49, v114, v115
  ds_write_b64 v32, v[48:49] offset:0
  v_pk_mul_f32 v[112:113], v[152:153], v[56:57]
  v_pk_mul_f32 v[114:115], v[154:155], v[56:57]
  v_exp_f32 v112, v112
  v_exp_f32 v113, v113
  v_exp_f32 v114, v114
  v_exp_f32 v115, v115
  v_lshlrev_b32 v116, 16, v84
  v_and_b32 v117, 0xffff0000, v84
  v_lshlrev_b32 v120, 16, v86
  v_and_b32 v121, 0xffff0000, v86
  v_lshlrev_b32 v118, 16, v85
  v_and_b32 v119, 0xffff0000, v85
  v_lshlrev_b32 v122, 16, v87
  v_and_b32 v123, 0xffff0000, v87
  v_pk_add_f32 v[112:113], v[112:113], v[58:59]
  v_pk_add_f32 v[114:115], v[114:115], v[58:59]
  v_rcp_f32 v112, v112
  v_rcp_f32 v113, v113
  v_rcp_f32 v114, v114
  v_rcp_f32 v115, v115
  v_pk_add_f32 v[116:117], v[116:117], v[120:121]
  v_pk_add_f32 v[118:119], v[118:119], v[122:123]
  v_lshlrev_b32 v120, 16, v82
  v_and_b32 v121, 0xffff0000, v82
  v_lshlrev_b32 v122, 16, v83
  v_and_b32 v123, 0xffff0000, v83
  v_pk_mul_f32 v[112:113], v[112:113], v[152:153]
  v_pk_mul_f32 v[114:115], v[114:115], v[154:155]
  v_pk_fma_f32 v[112:113], v[112:113], v[116:117], v[120:121]
  v_pk_fma_f32 v[114:115], v[114:115], v[118:119], v[122:123]
  v_cvt_pk_bf16_f32 v50, v112, v113
  v_cvt_pk_bf16_f32 v51, v114, v115
  ds_write_b64 v33, v[50:51] offset:0
  ds_read_b64 v[88:89], v30 offset:4096
  ds_read_b64 v[90:91], v30 offset:20480
  ds_read_b64 v[92:93], v30 offset:36864
  ds_read_b64 v[94:95], v31 offset:4096
  ds_read_b64 v[96:97], v31 offset:20480
  ds_read_b64 v[98:99], v31 offset:36864
  ds_read_b64 v[100:101], v32 offset:4096
  ds_read_b64 v[102:103], v32 offset:20480
  ds_read_b64 v[104:105], v32 offset:36864
  ds_read_b64 v[106:107], v33 offset:4096
  ds_read_b64 v[108:109], v33 offset:20480
  ds_read_b64 v[110:111], v33 offset:36864
  ds_read_b128 v[160:163], v38 offset:0
  ds_read_b128 v[164:167], v39 offset:2048
  s_waitcnt lgkmcnt(2)
  v_pk_mul_f32 v[112:113], v[132:133], v[56:57]
  v_pk_mul_f32 v[114:115], v[134:135], v[56:57]
  v_exp_f32 v112, v112
  v_exp_f32 v113, v113
  v_exp_f32 v114, v114
  v_exp_f32 v115, v115
  v_lshlrev_b32 v116, 16, v90
  v_and_b32 v117, 0xffff0000, v90
  v_lshlrev_b32 v120, 16, v92
  v_and_b32 v121, 0xffff0000, v92
  v_lshlrev_b32 v118, 16, v91
  v_and_b32 v119, 0xffff0000, v91
  v_lshlrev_b32 v122, 16, v93
  v_and_b32 v123, 0xffff0000, v93
  v_pk_add_f32 v[112:113], v[112:113], v[58:59]
  v_pk_add_f32 v[114:115], v[114:115], v[58:59]
  v_rcp_f32 v112, v112
  v_rcp_f32 v113, v113
  v_rcp_f32 v114, v114
  v_rcp_f32 v115, v115
  v_pk_add_f32 v[116:117], v[116:117], v[120:121]
  v_pk_add_f32 v[118:119], v[118:119], v[122:123]
  v_lshlrev_b32 v120, 16, v88
  v_and_b32 v121, 0xffff0000, v88
  v_lshlrev_b32 v122, 16, v89
  v_and_b32 v123, 0xffff0000, v89
  v_pk_mul_f32 v[112:113], v[112:113], v[132:133]
  v_pk_mul_f32 v[114:115], v[114:115], v[134:135]
  v_pk_fma_f32 v[112:113], v[112:113], v[116:117], v[120:121]
  v_pk_fma_f32 v[114:115], v[114:115], v[118:119], v[122:123]
  v_cvt_pk_bf16_f32 v44, v112, v113
  v_cvt_pk_bf16_f32 v45, v114, v115
  ds_write_b64 v30, v[44:45] offset:4096
  v_pk_mul_f32 v[112:113], v[140:141], v[56:57]
  v_pk_mul_f32 v[114:115], v[142:143], v[56:57]
  v_exp_f32 v112, v112
  v_exp_f32 v113, v113
  v_exp_f32 v114, v114
  v_exp_f32 v115, v115
  v_lshlrev_b32 v116, 16, v96
  v_and_b32 v117, 0xffff0000, v96
  v_lshlrev_b32 v120, 16, v98
  v_and_b32 v121, 0xffff0000, v98
  v_lshlrev_b32 v118, 16, v97
  v_and_b32 v119, 0xffff0000, v97
  v_lshlrev_b32 v122, 16, v99
  v_and_b32 v123, 0xffff0000, v99
  v_pk_add_f32 v[112:113], v[112:113], v[58:59]
  v_pk_add_f32 v[114:115], v[114:115], v[58:59]
  v_rcp_f32 v112, v112
  v_rcp_f32 v113, v113
  v_rcp_f32 v114, v114
  v_rcp_f32 v115, v115
  v_pk_add_f32 v[116:117], v[116:117], v[120:121]
  v_pk_add_f32 v[118:119], v[118:119], v[122:123]
  v_lshlrev_b32 v120, 16, v94
  v_and_b32 v121, 0xffff0000, v94
  v_lshlrev_b32 v122, 16, v95
  v_and_b32 v123, 0xffff0000, v95
  v_pk_mul_f32 v[112:113], v[112:113], v[140:141]
  v_pk_mul_f32 v[114:115], v[114:115], v[142:143]
  v_pk_fma_f32 v[112:113], v[112:113], v[116:117], v[120:121]
  v_pk_fma_f32 v[114:115], v[114:115], v[118:119], v[122:123]
  v_cvt_pk_bf16_f32 v46, v112, v113
  v_cvt_pk_bf16_f32 v47, v114, v115
  ds_write_b64 v31, v[46:47] offset:4096
  v_pk_mul_f32 v[112:113], v[148:149], v[56:57]
  v_pk_mul_f32 v[114:115], v[150:151], v[56:57]
  v_exp_f32 v112, v112
  v_exp_f32 v113, v113
  v_exp_f32 v114, v114
  v_exp_f32 v115, v115
  v_lshlrev_b32 v116, 16, v102
  v_and_b32 v117, 0xffff0000, v102
  v_lshlrev_b32 v120, 16, v104
  v_and_b32 v121, 0xffff0000, v104
  v_lshlrev_b32 v118, 16, v103
  v_and_b32 v119, 0xffff0000, v103
  v_lshlrev_b32 v122, 16, v105
  v_and_b32 v123, 0xffff0000, v105
  v_pk_add_f32 v[112:113], v[112:113], v[58:59]
  v_pk_add_f32 v[114:115], v[114:115], v[58:59]
  v_rcp_f32 v112, v112
  v_rcp_f32 v113, v113
  v_rcp_f32 v114, v114
  v_rcp_f32 v115, v115
  v_pk_add_f32 v[116:117], v[116:117], v[120:121]
  v_pk_add_f32 v[118:119], v[118:119], v[122:123]
  v_lshlrev_b32 v120, 16, v100
  v_and_b32 v121, 0xffff0000, v100
  v_lshlrev_b32 v122, 16, v101
  v_and_b32 v123, 0xffff0000, v101
  v_pk_mul_f32 v[112:113], v[112:113], v[148:149]
  v_pk_mul_f32 v[114:115], v[114:115], v[150:151]
  v_pk_fma_f32 v[112:113], v[112:113], v[116:117], v[120:121]
  v_pk_fma_f32 v[114:115], v[114:115], v[118:119], v[122:123]
  v_cvt_pk_bf16_f32 v48, v112, v113
  v_cvt_pk_bf16_f32 v49, v114, v115
  ds_write_b64 v32, v[48:49] offset:4096
  v_pk_mul_f32 v[112:113], v[156:157], v[56:57]
  v_pk_mul_f32 v[114:115], v[158:159], v[56:57]
  v_exp_f32 v112, v112
  v_exp_f32 v113, v113
  v_exp_f32 v114, v114
  v_exp_f32 v115, v115
  v_lshlrev_b32 v116, 16, v108
  v_and_b32 v117, 0xffff0000, v108
  v_lshlrev_b32 v120, 16, v110
  v_and_b32 v121, 0xffff0000, v110
  v_lshlrev_b32 v118, 16, v109
  v_and_b32 v119, 0xffff0000, v109
  v_lshlrev_b32 v122, 16, v111
  v_and_b32 v123, 0xffff0000, v111
  v_pk_add_f32 v[112:113], v[112:113], v[58:59]
  v_pk_add_f32 v[114:115], v[114:115], v[58:59]
  v_rcp_f32 v112, v112
  v_rcp_f32 v113, v113
  v_rcp_f32 v114, v114
  v_rcp_f32 v115, v115
  v_pk_add_f32 v[116:117], v[116:117], v[120:121]
  v_pk_add_f32 v[118:119], v[118:119], v[122:123]
  v_lshlrev_b32 v120, 16, v106
  v_and_b32 v121, 0xffff0000, v106
  v_lshlrev_b32 v122, 16, v107
  v_and_b32 v123, 0xffff0000, v107
  v_pk_mul_f32 v[112:113], v[112:113], v[156:157]
  v_pk_mul_f32 v[114:115], v[114:115], v[158:159]
  v_pk_fma_f32 v[112:113], v[112:113], v[116:117], v[120:121]
  v_pk_fma_f32 v[114:115], v[114:115], v[118:119], v[122:123]
  v_cvt_pk_bf16_f32 v50, v112, v113
  v_cvt_pk_bf16_f32 v51, v114, v115
  ds_write_b64 v33, v[50:51] offset:4096
  s_waitcnt lgkmcnt(4)
  buffer_store_dwordx4 v[160:163], v42, s[16:19], s30 offen sc1
  s_add_u32 s30, s30, 16384
  buffer_store_dwordx4 v[164:167], v42, s[16:19], s30 offen sc1
  s_add_u32 s30, s30, 16384
  ds_read_b128 v[168:171], v38 offset:4096
  ds_read_b128 v[172:175], v39 offset:6144
  s_waitcnt lgkmcnt(0)
  buffer_store_dwordx4 v[168:171], v42, s[16:19], s30 offen sc1
  s_add_u32 s30, s30, 16384
  buffer_store_dwordx4 v[172:175], v42, s[16:19], s30 offen sc1
  s_add_u32 s30, s30, 16384
all_done:
  s_endpgm
att_ln:
  s_waitcnt lgkmcnt(0)
  s_lshl_b32 s42, s25, 8
  s_add_u32 s42, s42, 0
  v_mov_b32 v100, s42
  s_mov_b64 exec, 1
  s_mov_b32 s42, 0x20000
att_poll:
  global_load_dword v101, v100, s[70:71] sc1
  s_waitcnt vmcnt(0)
  v_readfirstlane_b32 s43, v101
  s_sub_u32 s42, s42, 1
  s_cbranch_scc1 att_poll_ok
  s_nop 1
  s_cmp_ge_u32 s43, 14
  s_cbranch_scc1 att_poll_ok
  s_sleep 8
  s_branch att_poll
att_poll_ok:
  s_mov_b64 exec, -1
  s_add_u32 s8, s6, 16777216
  s_addc_u32 s9, s7, 0
  s_mov_b32 s10, 7340032
  s_mov_b32 s11, 0x20000
  s_add_u32 s12, s6, 25165824
  s_addc_u32 s13, s7, 0
  s_mov_b32 s14, 7340032
  s_mov_b32 s15, 0x20000
  s_lshl_b32 s44, s25, 2
  s_and_b32 s42, s24, 3
  s_add_u32 s44, s44, s42
  s_lshl_b32 s44, s44, 2
  s_add_u32 s44, s44, s3
  s_mul_i32 s44, s44, 57344
  v_and_b32 v152, 63, v0
  v_lshlrev_b32 v153, 3, v152
  v_lshlrev_b32 v152, 4, v152
  s_add_u32 s45, s44, 3584
  buffer_load_dwordx4 v[32:35], v152, s[8:11], s44 offen offset:0 sc1
  buffer_load_dwordx4 v[36:39], v152, s[8:11], s44 offen offset:1024 sc1
  buffer_load_dwordx4 v[40:43], v152, s[8:11], s44 offen offset:2048 sc1
  buffer_load_dwordx2 v[44:45], v153, s[8:11], s44 offen offset:3072 sc1
  buffer_load_dwordx4 v[48:51], v152, s[8:11], s45 offen offset:0 sc1
  buffer_load_dwordx4 v[52:55], v152, s[8:11], s45 offen offset:1024 sc1
  buffer_load_dwordx4 v[56:59], v152, s[8:11], s45 offen offset:2048 sc1
  buffer_load_dwordx2 v[60:61], v153, s[8:11], s45 offen offset:3072 sc1
  s_add_u32 s42, s44, 7168
  s_add_u32 s45, s42, 3584
  s_mov_b32 s43, 4
  buffer_load_dwordx4 v[64:67], v152, s[8:11], s42 offen offset:0 sc1
  buffer_load_dwordx4 v[68:71], v152, s[8:11], s42 offen offset:1024 sc1
  buffer_load_dwordx4 v[72:75], v152, s[8:11], s42 offen offset:2048 sc1
  buffer_load_dwordx2 v[76:77], v153, s[8:11], s42 offen offset:3072 sc1
  buffer_load_dwordx4 v[80:83], v152, s[8:11], s45 offen offset:0 sc1
  buffer_load_dwordx4 v[84:87], v152, s[8:11], s45 offen offset:1024 sc1
  buffer_load_dwordx4 v[88:91], v152, s[8:11], s45 offen offset:2048 sc1
  buffer_load_dwordx2 v[92:93], v153, s[8:11], s45 offen offset:3072 sc1
  buffer_load_dwordx4 v[216:219], v152, s[8:11], s42 offen offset:0 sc1
  buffer_load_dwordx4 v[220:223], v152, s[8:11], s42 offen offset:1024 sc1
  buffer_load_dwordx4 v[224:227], v152, s[8:11], s42 offen offset:2048 sc1
  buffer_load_dwordx2 v[228:229], v153, s[8:11], s42 offen offset:3072 sc1
  buffer_load_dwordx4 v[216:219], v152, s[8:11], s45 offen offset:0 sc1
  buffer_load_dwordx4 v[220:223], v152, s[8:11], s45 offen offset:1024 sc1
  buffer_load_dwordx4 v[224:227], v152, s[8:11], s45 offen offset:2048 sc1
  buffer_load_dwordx2 v[228:229], v153, s[8:11], s45 offen offset:3072 sc1
  s_waitcnt vmcnt(16)
att_nr:
  v_lshlrev_b32 v96, 16, v32
  v_and_b32 v97, 0xffff0000, v32
  v_lshlrev_b32 v124, 16, v48
  v_and_b32 v125, 0xffff0000, v48
  v_lshlrev_b32 v98, 16, v33
  v_and_b32 v99, 0xffff0000, v33
  v_lshlrev_b32 v126, 16, v49
  v_and_b32 v127, 0xffff0000, v49
  v_lshlrev_b32 v100, 16, v34
  v_and_b32 v101, 0xffff0000, v34
  v_lshlrev_b32 v128, 16, v50
  v_and_b32 v129, 0xffff0000, v50
  v_lshlrev_b32 v102, 16, v35
  v_and_b32 v103, 0xffff0000, v35
  v_lshlrev_b32 v130, 16, v51
  v_and_b32 v131, 0xffff0000, v51
  v_lshlrev_b32 v104, 16, v36
  v_and_b32 v105, 0xffff0000, v36
  v_lshlrev_b32 v132, 16, v52
  v_and_b32 v133, 0xffff0000, v52
  v_lshlrev_b32 v106, 16, v37
  v_and_b32 v107, 0xffff0000, v37
  v_lshlrev_b32 v134, 16, v53
  v_and_b32 v135, 0xffff0000, v53
  v_lshlrev_b32 v108, 16, v38
  v_and_b32 v109, 0xffff0000, v38
  v_lshlrev_b32 v136, 16, v54
  v_and_b32 v137, 0xffff0000, v54
  v_lshlrev_b32 v110, 16, v39
  v_and_b32 v111, 0xffff0000, v39
  v_lshlrev_b32 v138, 16, v55
  v_and_b32 v139, 0xffff0000, v55
  v_lshlrev_b32 v112, 16, v40
  v_and_b32 v113, 0xffff0000, v40
  v_lshlrev_b32 v140, 16, v56
  v_and_b32 v141, 0xffff0000, v56
  v_lshlrev_b32 v114, 16, v41
  v_and_b32 v115, 0xffff0000, v41
  v_lshlrev_b32 v142, 16, v57
  v_and_b32 v143, 0xffff0000, v57
  v_lshlrev_b32 v116, 16, v42
  v_and_b32 v117, 0xffff0000, v42
  v_lshlrev_b32 v144, 16, v58
  v_and_b32 v145, 0xffff0000, v58
  v_lshlrev_b32 v118, 16, v43
  v_and_b32 v119, 0xffff0000, v43
  v_lshlrev_b32 v146, 16, v59
  v_and_b32 v147, 0xffff0000, v59
  v_lshlrev_b32 v120, 16, v44
  v_and_b32 v121, 0xffff0000, v44
  v_lshlrev_b32 v148, 16, v60
  v_and_b32 v149, 0xffff0000, v60
  v_lshlrev_b32 v122, 16, v45
  v_and_b32 v123, 0xffff0000, v45
  v_lshlrev_b32 v150, 16, v61
  v_and_b32 v151, 0xffff0000, v61
  s_add_u32 s42, s42, 7168
  s_add_u32 s45, s42, 3584
  buffer_load_dwordx4 v[32:35], v152, s[8:11], s42 offen offset:0 sc1
  buffer_load_dwordx4 v[36:39], v152, s[8:11], s42 offen offset:1024 sc1
  buffer_load_dwordx4 v[40:43], v152, s[8:11], s42 offen offset:2048 sc1
  buffer_load_dwordx2 v[44:45], v153, s[8:11], s42 offen offset:3072 sc1
  buffer_load_dwordx4 v[48:51], v152, s[8:11], s45 offen offset:0 sc1
  buffer_load_dwordx4 v[52:55], v152, s[8:11], s45 offen offset:1024 sc1
  buffer_load_dwordx4 v[56:59], v152, s[8:11], s45 offen offset:2048 sc1
  buffer_load_dwordx2 v[60:61], v153, s[8:11], s45 offen offset:3072 sc1
  v_pk_add_f32 v[154:155], v[96:97], v[98:99]
  v_pk_add_f32 v[156:157], v[100:101], v[102:103]
  v_pk_add_f32 v[158:159], v[124:125], v[126:127]
  v_pk_add_f32 v[160:161], v[128:129], v[130:131]
  v_pk_add_f32 v[154:155], v[154:155], v[104:105]
  v_pk_add_f32 v[158:159], v[158:159], v[132:133]
  v_pk_add_f32 v[156:157], v[156:157], v[106:107]
  v_pk_add_f32 v[160:161], v[160:161], v[134:135]
  v_pk_add_f32 v[154:155], v[154:155], v[108:109]
  v_pk_add_f32 v[158:159], v[158:159], v[136:137]
  v_pk_add_f32 v[156:157], v[156:157], v[110:111]
  v_pk_add_f32 v[160:161], v[160:161], v[138:139]
  v_pk_add_f32 v[154:155], v[154:155], v[112:113]
  v_pk_add_f32 v[158:159], v[158:159], v[140:141]
  v_pk_add_f32 v[156:157], v[156:157], v[114:115]
  v_pk_add_f32 v[160:161], v[160:161], v[142:143]
  v_pk_add_f32 v[154:155], v[154:155], v[116:117]
  v_pk_add_f32 v[158:159], v[158:159], v[144:145]
  v_pk_add_f32 v[156:157], v[156:157], v[118:119]
  v_pk_add_f32 v[160:161], v[160:161], v[146:147]
  v_pk_add_f32 v[154:155], v[154:155], v[120:121]
  v_pk_add_f32 v[158:159], v[158:159], v[148:149]
  v_pk_add_f32 v[156:157], v[156:157], v[122:123]
  v_pk_add_f32 v[160:161], v[160:161], v[150:151]
  v_pk_add_f32 v[154:155], v[154:155], v[156:157]
  v_pk_add_f32 v[158:159], v[158:159], v[160:161]
  v_add_f32 v162, v154, v155
  v_add_f32 v163, v158, v159
  s_nop 0
  v_add_f32_dpp v162, v162, v162 row_shr:1 row_mask:0xf bank_mask:0xf bound_ctrl:0
  v_add_f32_dpp v163, v163, v163 row_shr:1 row_mask:0xf bank_mask:0xf bound_ctrl:0
  s_nop 0
  v_add_f32_dpp v162, v162, v162 row_shr:2 row_mask:0xf bank_mask:0xf bound_ctrl:0
  v_add_f32_dpp v163, v163, v163 row_shr:2 row_mask:0xf bank_mask:0xf bound_ctrl:0
  s_nop 0
  v_add_f32_dpp v162, v162, v162 row_shr:4 row_mask:0xf bank_mask:0xf bound_ctrl:0
  v_add_f32_dpp v163, v163, v163 row_shr:4 row_mask:0xf bank_mask:0xf bound_ctrl:0
  s_nop 0
  v_add_f32_dpp v162, v162, v162 row_shr:8 row_mask:0xf bank_mask:0xf bound_ctrl:0
  v_add_f32_dpp v163, v163, v163 row_shr:8 row_mask:0xf bank_mask:0xf bound_ctrl:0
  s_nop 0
  v_add_f32_dpp v162, v162, v162 row_bcast:15 row_mask:0xa bank_mask:0xf
  v_add_f32_dpp v163, v163, v163 row_bcast:15 row_mask:0xa bank_mask:0xf
  s_nop 0
  v_add_f32_dpp v162, v162, v162 row_bcast:31 row_mask:0xc bank_mask:0xf
  v_add_f32_dpp v163, v163, v163 row_bcast:31 row_mask:0xc bank_mask:0xf
  s_nop 0
  v_readlane_b32 s40, v162, 63
  v_readlane_b32 s41, v163, 63
  s_nop 2
  v_mov_b32 v164, s40
  v_mov_b32 v166, s41
  v_mul_f32 v164, 0xba124925, v164
  v_mul_f32 v166, 0xba124925, v166
  v_mov_b32 v165, v164
  v_mov_b32 v167, v166
  v_pk_add_f32 v[172:173], v[96:97], v[164:165]
  v_pk_add_f32 v[176:177], v[124:125], v[166:167]
  v_pk_mul_f32 v[154:155], v[172:173], v[172:173]
  v_pk_mul_f32 v[158:159], v[176:177], v[176:177]
  v_pk_add_f32 v[174:175], v[98:99], v[164:165]
  v_pk_add_f32 v[178:179], v[126:127], v[166:167]
  v_pk_mul_f32 v[156:157], v[174:175], v[174:175]
  v_pk_mul_f32 v[160:161], v[178:179], v[178:179]
  v_pk_add_f32 v[172:173], v[100:101], v[164:165]
  v_pk_add_f32 v[176:177], v[128:129], v[166:167]
  v_pk_fma_f32 v[154:155], v[172:173], v[172:173], v[154:155]
  v_pk_fma_f32 v[158:159], v[176:177], v[176:177], v[158:159]
  v_pk_add_f32 v[174:175], v[102:103], v[164:165]
  v_pk_add_f32 v[178:179], v[130:131], v[166:167]
  v_pk_fma_f32 v[156:157], v[174:175], v[174:175], v[156:157]
  v_pk_fma_f32 v[160:161], v[178:179], v[178:179], v[160:161]
  v_pk_add_f32 v[172:173], v[104:105], v[164:165]
  v_pk_add_f32 v[176:177], v[132:133], v[166:167]
  v_pk_fma_f32 v[154:155], v[172:173], v[172:173], v[154:155]
  v_pk_fma_f32 v[158:159], v[176:177], v[176:177], v[158:159]
  v_pk_add_f32 v[174:175], v[106:107], v[164:165]
  v_pk_add_f32 v[178:179], v[134:135], v[166:167]
  v_pk_fma_f32 v[156:157], v[174:175], v[174:175], v[156:157]
  v_pk_fma_f32 v[160:161], v[178:179], v[178:179], v[160:161]
  v_pk_add_f32 v[172:173], v[108:109], v[164:165]
  v_pk_add_f32 v[176:177], v[136:137], v[166:167]
  v_pk_fma_f32 v[154:155], v[172:173], v[172:173], v[154:155]
  v_pk_fma_f32 v[158:159], v[176:177], v[176:177], v[158:159]
  v_pk_add_f32 v[174:175], v[110:111], v[164:165]
  v_pk_add_f32 v[178:179], v[138:139], v[166:167]
  v_pk_fma_f32 v[156:157], v[174:175], v[174:175], v[156:157]
  v_pk_fma_f32 v[160:161], v[178:179], v[178:179], v[160:161]
  v_pk_add_f32 v[172:173], v[112:113], v[164:165]
  v_pk_add_f32 v[176:177], v[140:141], v[166:167]
  v_pk_fma_f32 v[154:155], v[172:173], v[172:173], v[154:155]
  v_pk_fma_f32 v[158:159], v[176:177], v[176:177], v[158:159]
  v_pk_add_f32 v[174:175], v[114:115], v[164:165]
  v_pk_add_f32 v[178:179], v[142:143], v[166:167]
  v_pk_fma_f32 v[156:157], v[174:175], v[174:175], v[156:157]
  v_pk_fma_f32 v[160:161], v[178:179], v[178:179], v[160:161]
  v_pk_add_f32 v[172:173], v[116:117], v[164:165]
  v_pk_add_f32 v[176:177], v[144:145], v[166:167]
  v_pk_fma_f32 v[154:155], v[172:173], v[172:173], v[154:155]
  v_pk_fma_f32 v[158:159], v[176:177], v[176:177], v[158:159]
  v_pk_add_f32 v[174:175], v[118:119], v[164:165]
  v_pk_add_f32 v[178:179], v[146:147], v[166:167]
  v_pk_fma_f32 v[156:157], v[174:175], v[174:175], v[156:157]
  v_pk_fma_f32 v[160:161], v[178:179], v[178:179], v[160:161]
  v_pk_add_f32 v[172:173], v[120:121], v[164:165]
  v_pk_add_f32 v[176:177], v[148:149], v[166:167]
  v_pk_fma_f32 v[154:155], v[172:173], v[172:173], v[154:155]
  v_pk_fma_f32 v[158:159], v[176:177], v[176:177], v[158:159]
  v_pk_add_f32 v[174:175], v[122:123], v[164:165]
  v_pk_add_f32 v[178:179], v[150:151], v[166:167]
  v_pk_fma_f32 v[156:157], v[174:175], v[174:175], v[156:157]
  v_pk_fma_f32 v[160:161], v[178:179], v[178:179], v[160:161]
  v_pk_add_f32 v[154:155], v[154:155], v[156:157]
  v_pk_add_f32 v[158:159], v[158:159], v[160:161]
  v_add_f32 v162, v154, v155
  v_add_f32 v163, v158, v159
  s_nop 0
  v_add_f32_dpp v162, v162, v162 row_shr:1 row_mask:0xf bank_mask:0xf bound_ctrl:0
  v_add_f32_dpp v163, v163, v163 row_shr:1 row_mask:0xf bank_mask:0xf bound_ctrl:0
  s_nop 0
  v_add_f32_dpp v162, v162, v162 row_shr:2 row_mask:0xf bank_mask:0xf bound_ctrl:0
  v_add_f32_dpp v163, v163, v163 row_shr:2 row_mask:0xf bank_mask:0xf bound_ctrl:0
  s_nop 0
  v_add_f32_dpp v162, v162, v162 row_shr:4 row_mask:0xf bank_mask:0xf bound_ctrl:0
  v_add_f32_dpp v163, v163, v163 row_shr:4 row_mask:0xf bank_mask:0xf bound_ctrl:0
  s_nop 0
  v_add_f32_dpp v162, v162, v162 row_shr:8 row_mask:0xf bank_mask:0xf bound_ctrl:0
  v_add_f32_dpp v163, v163, v163 row_shr:8 row_mask:0xf bank_mask:0xf bound_ctrl:0
  s_nop 0
  v_add_f32_dpp v162, v162, v162 row_bcast:15 row_mask:0xa bank_mask:0xf
  v_add_f32_dpp v163, v163, v163 row_bcast:15 row_mask:0xa bank_mask:0xf
  s_nop 0
  v_add_f32_dpp v162, v162, v162 row_bcast:31 row_mask:0xc bank_mask:0xf
  v_add_f32_dpp v163, v163, v163 row_bcast:31 row_mask:0xc bank_mask:0xf
  s_nop 0
  v_readlane_b32 s40, v162, 63
  v_readlane_b32 s41, v163, 63
  s_nop 2
  v_mov_b32 v168, s40
  v_mov_b32 v170, s41
  v_mul_f32 v168, 0x3a124925, v168
  v_mul_f32 v170, 0x3a124925, v170
  v_cvt_pk_bf16_f32 v180, v164, v164
  v_cvt_pk_bf16_f32 v181, v166, v166
  v_lshlrev_b32 v164, 16, v180
  v_lshlrev_b32 v166, 16, v181
  v_cvt_pk_bf16_f32 v180, v168, v168
  v_cvt_pk_bf16_f32 v181, v170, v170
  v_lshlrev_b32 v168, 16, v180
  v_lshlrev_b32 v170, 16, v181
  v_add_f32 v168, 0x3727c5ac, v168
  v_add_f32 v170, 0x3727c5ac, v170
  v_cvt_pk_bf16_f32 v180, v168, v168
  v_cvt_pk_bf16_f32 v181, v170, v170
  v_lshlrev_b32 v168, 16, v180
  v_lshlrev_b32 v170, 16, v181
  v_sqrt_f32 v168, v168
  v_sqrt_f32 v170, v170
  s_nop 0
  v_cvt_pk_bf16_f32 v180, v168, v168
  v_cvt_pk_bf16_f32 v181, v170, v170
  v_lshlrev_b32 v168, 16, v180
  v_lshlrev_b32 v170, 16, v181
  v_rcp_f32 v168, v168
  v_rcp_f32 v170, v170
  s_nop 0
  v_mov_b32 v169, v168
  v_mov_b32 v171, v170
  v_mul_f32 v164, v164, v168
  v_mul_f32 v166, v166, v170
  v_mov_b32 v165, v164
  v_mov_b32 v167, v166
  v_pk_fma_f32 v[96:97], v[96:97], v[168:169], v[164:165]
  v_pk_fma_f32 v[124:125], v[124:125], v[170:171], v[166:167]
  v_cvt_pk_bf16_f32 v184, v96, v97
  v_cvt_pk_bf16_f32 v200, v124, v125
  v_pk_fma_f32 v[98:99], v[98:99], v[168:169], v[164:165]
  v_pk_fma_f32 v[126:127], v[126:127], v[170:171], v[166:167]
  v_cvt_pk_bf16_f32 v185, v98, v99
  v_cvt_pk_bf16_f32 v201, v126, v127
  v_pk_fma_f32 v[100:101], v[100:101], v[168:169], v[164:165]
  v_pk_fma_f32 v[128:129], v[128:129], v[170:171], v[166:167]
  v_cvt_pk_bf16_f32 v186, v100, v101
  v_cvt_pk_bf16_f32 v202, v128, v129
  v_pk_fma_f32 v[102:103], v[102:103], v[168:169], v[164:165]
  v_pk_fma_f32 v[130:131], v[130:131], v[170:171], v[166:167]
  v_cvt_pk_bf16_f32 v187, v102, v103
  v_cvt_pk_bf16_f32 v203, v130, v131
  v_pk_fma_f32 v[104:105], v[104:105], v[168:169], v[164:165]
  v_pk_fma_f32 v[132:133], v[132:133], v[170:171], v[166:167]
  v_cvt_pk_bf16_f32 v188, v104, v105
  v_cvt_pk_bf16_f32 v204, v132, v133
  v_pk_fma_f32 v[106:107], v[106:107], v[168:169], v[164:165]
  v_pk_fma_f32 v[134:135], v[134:135], v[170:171], v[166:167]
  v_cvt_pk_bf16_f32 v189, v106, v107
  v_cvt_pk_bf16_f32 v205, v134, v135
  v_pk_fma_f32 v[108:109], v[108:109], v[168:169], v[164:165]
  v_pk_fma_f32 v[136:137], v[136:137], v[170:171], v[166:167]
  v_cvt_pk_bf16_f32 v190, v108, v109
  v_cvt_pk_bf16_f32 v206, v136, v137
  v_pk_fma_f32 v[110:111], v[110:111], v[168:169], v[164:165]
  v_pk_fma_f32 v[138:139], v[138:139], v[170:171], v[166:167]
  v_cvt_pk_bf16_f32 v191, v110, v111
  v_cvt_pk_bf16_f32 v207, v138, v139
  v_pk_fma_f32 v[112:113], v[112:113], v[168:169], v[164:165]
  v_pk_fma_f32 v[140:141], v[140:141], v[170:171], v[166:167]
  v_cvt_pk_bf16_f32 v192, v112, v113
  v_cvt_pk_bf16_f32 v208, v140, v141
  v_pk_fma_f32 v[114:115], v[114:115], v[168:169], v[164:165]
  v_pk_fma_f32 v[142:143], v[142:143], v[170:171], v[166:167]
  v_cvt_pk_bf16_f32 v193, v114, v115
  v_cvt_pk_bf16_f32 v209, v142, v143
  v_pk_fma_f32 v[116:117], v[116:117], v[168:169], v[164:165]
  v_pk_fma_f32 v[144:145], v[144:145], v[170:171], v[166:167]
  v_cvt_pk_bf16_f32 v194, v116, v117
  v_cvt_pk_bf16_f32 v210, v144, v145
  v_pk_fma_f32 v[118:119], v[118:119], v[168:169], v[164:165]
  v_pk_fma_f32 v[146:147], v[146:147], v[170:171], v[166:167]
  v_cvt_pk_bf16_f32 v195, v118, v119
  v_cvt_pk_bf16_f32 v211, v146, v147
  v_pk_fma_f32 v[120:121], v[120:121], v[168:169], v[164:165]
  v_pk_fma_f32 v[148:149], v[148:149], v[170:171], v[166:167]
  v_cvt_pk_bf16_f32 v196, v120, v121
  v_cvt_pk_bf16_f32 v212, v148, v149
  v_pk_fma_f32 v[122:123], v[122:123], v[168:169], v[164:165]
  v_pk_fma_f32 v[150:151], v[150:151], v[170:171], v[166:167]
  v_cvt_pk_bf16_f32 v197, v122, v123
  v_cvt_pk_bf16_f32 v213, v150, v151
  s_add_u32 s45, s44, 3584
  buffer_store_dwordx4 v[184:187], v152, s[12:15], s44 offen offset:0 sc1
  buffer_store_dwordx4 v[188:191], v152, s[12:15], s44 offen offset:1024 sc1
  buffer_store_dwordx4 v[192:195], v152, s[12:15], s44 offen offset:2048 sc1
  buffer_store_dwordx2 v[196:197], v153, s[12:15], s44 offen offset:3072 sc1
  buffer_store_dwordx4 v[200:203], v152, s[12:15], s45 offen offset:0 sc1
  buffer_store_dwordx4 v[204:207], v152, s[12:15], s45 offen offset:1024 sc1
  buffer_store_dwordx4 v[208:211], v152, s[12:15], s45 offen offset:2048 sc1
  buffer_store_dwordx2 v[212:213], v153, s[12:15], s45 offen offset:3072 sc1
  s_add_u32 s44, s44, 7168
  s_waitcnt vmcnt(24)
  v_lshlrev_b32 v96, 16, v64
  v_and_b32 v97, 0xffff0000, v64
  v_lshlrev_b32 v124, 16, v80
  v_and_b32 v125, 0xffff0000, v80
  v_lshlrev_b32 v98, 16, v65
  v_and_b32 v99, 0xffff0000, v65
  v_lshlrev_b32 v126, 16, v81
  v_and_b32 v127, 0xffff0000, v81
  v_lshlrev_b32 v100, 16, v66
  v_and_b32 v101, 0xffff0000, v66
  v_lshlrev_b32 v128, 16, v82
  v_and_b32 v129, 0xffff0000, v82
  v_lshlrev_b32 v102, 16, v67
  v_and_b32 v103, 0xffff0000, v67
  v_lshlrev_b32 v130, 16, v83
  v_and_b32 v131, 0xffff0000, v83
  v_lshlrev_b32 v104, 16, v68
  v_and_b32 v105, 0xffff0000, v68
  v_lshlrev_b32 v132, 16, v84
  v_and_b32 v133, 0xffff0000, v84
  v_lshlrev_b32 v106, 16, v69
  v_and_b32 v107, 0xffff0000, v69
  v_lshlrev_b32 v134, 16, v85
  v_and_b32 v135, 0xffff0000, v85
  v_lshlrev_b32 v108, 16, v70
  v_and_b32 v109, 0xffff0000, v70
  v_lshlrev_b32 v136, 16, v86
  v_and_b32 v137, 0xffff0000, v86
  v_lshlrev_b32 v110, 16, v71
  v_and_b32 v111, 0xffff0000, v71
  v_lshlrev_b32 v138, 16, v87
  v_and_b32 v139, 0xffff0000, v87
  v_lshlrev_b32 v112, 16, v72
  v_and_b32 v113, 0xffff0000, v72
  v_lshlrev_b32 v140, 16, v88
  v_and_b32 v141, 0xffff0000, v88
  v_lshlrev_b32 v114, 16, v73
  v_and_b32 v115, 0xffff0000, v73
  v_lshlrev_b32 v142, 16, v89
  v_and_b32 v143, 0xffff0000, v89
  v_lshlrev_b32 v116, 16, v74
  v_and_b32 v117, 0xffff0000, v74
  v_lshlrev_b32 v144, 16, v90
  v_and_b32 v145, 0xffff0000, v90
  v_lshlrev_b32 v118, 16, v75
  v_and_b32 v119, 0xffff0000, v75
  v_lshlrev_b32 v146, 16, v91
  v_and_b32 v147, 0xffff0000, v91
  v_lshlrev_b32 v120, 16, v76
  v_and_b32 v121, 0xffff0000, v76
  v_lshlrev_b32 v148, 16, v92
  v_and_b32 v149, 0xffff0000, v92
  v_lshlrev_b32 v122, 16, v77
  v_and_b32 v123, 0xffff0000, v77
  v_lshlrev_b32 v150, 16, v93
  v_and_b32 v151, 0xffff0000, v93
  s_add_u32 s42, s42, 7168
  s_add_u32 s45, s42, 3584
  buffer_load_dwordx4 v[64:67], v152, s[8:11], s42 offen offset:0 sc1
  buffer_load_dwordx4 v[68:71], v152, s[8:11], s42 offen offset:1024 sc1
  buffer_load_dwordx4 v[72:75], v152, s[8:11], s42 offen offset:2048 sc1
  buffer_load_dwordx2 v[76:77], v153, s[8:11], s42 offen offset:3072 sc1
  buffer_load_dwordx4 v[80:83], v152, s[8:11], s45 offen offset:0 sc1
  buffer_load_dwordx4 v[84:87], v152, s[8:11], s45 offen offset:1024 sc1
  buffer_load_dwordx4 v[88:91], v152, s[8:11], s45 offen offset:2048 sc1
  buffer_load_dwordx2 v[92:93], v153, s[8:11], s45 offen offset:3072 sc1
  v_pk_add_f32 v[154:155], v[96:97], v[98:99]
  v_pk_add_f32 v[156:157], v[100:101], v[102:103]
  v_pk_add_f32 v[158:159], v[124:125], v[126:127]
  v_pk_add_f32 v[160:161], v[128:129], v[130:131]
  v_pk_add_f32 v[154:155], v[154:155], v[104:105]
  v_pk_add_f32 v[158:159], v[158:159], v[132:133]
  v_pk_add_f32 v[156:157], v[156:157], v[106:107]
  v_pk_add_f32 v[160:161], v[160:161], v[134:135]
  v_pk_add_f32 v[154:155], v[154:155], v[108:109]
  v_pk_add_f32 v[158:159], v[158:159], v[136:137]
  v_pk_add_f32 v[156:157], v[156:157], v[110:111]
  v_pk_add_f32 v[160:161], v[160:161], v[138:139]
  v_pk_add_f32 v[154:155], v[154:155], v[112:113]
  v_pk_add_f32 v[158:159], v[158:159], v[140:141]
  v_pk_add_f32 v[156:157], v[156:157], v[114:115]
  v_pk_add_f32 v[160:161], v[160:161], v[142:143]
  v_pk_add_f32 v[154:155], v[154:155], v[116:117]
  v_pk_add_f32 v[158:159], v[158:159], v[144:145]
  v_pk_add_f32 v[156:157], v[156:157], v[118:119]
  v_pk_add_f32 v[160:161], v[160:161], v[146:147]
  v_pk_add_f32 v[154:155], v[154:155], v[120:121]
  v_pk_add_f32 v[158:159], v[158:159], v[148:149]
  v_pk_add_f32 v[156:157], v[156:157], v[122:123]
  v_pk_add_f32 v[160:161], v[160:161], v[150:151]
  v_pk_add_f32 v[154:155], v[154:155], v[156:157]
  v_pk_add_f32 v[158:159], v[158:159], v[160:161]
  v_add_f32 v162, v154, v155
  v_add_f32 v163, v158, v159
  s_nop 0
  v_add_f32_dpp v162, v162, v162 row_shr:1 row_mask:0xf bank_mask:0xf bound_ctrl:0
  v_add_f32_dpp v163, v163, v163 row_shr:1 row_mask:0xf bank_mask:0xf bound_ctrl:0
  s_nop 0
  v_add_f32_dpp v162, v162, v162 row_shr:2 row_mask:0xf bank_mask:0xf bound_ctrl:0
  v_add_f32_dpp v163, v163, v163 row_shr:2 row_mask:0xf bank_mask:0xf bound_ctrl:0
  s_nop 0
  v_add_f32_dpp v162, v162, v162 row_shr:4 row_mask:0xf bank_mask:0xf bound_ctrl:0
  v_add_f32_dpp v163, v163, v163 row_shr:4 row_mask:0xf bank_mask:0xf bound_ctrl:0
  s_nop 0
  v_add_f32_dpp v162, v162, v162 row_shr:8 row_mask:0xf bank_mask:0xf bound_ctrl:0
  v_add_f32_dpp v163, v163, v163 row_shr:8 row_mask:0xf bank_mask:0xf bound_ctrl:0
  s_nop 0
  v_add_f32_dpp v162, v162, v162 row_bcast:15 row_mask:0xa bank_mask:0xf
  v_add_f32_dpp v163, v163, v163 row_bcast:15 row_mask:0xa bank_mask:0xf
  s_nop 0
  v_add_f32_dpp v162, v162, v162 row_bcast:31 row_mask:0xc bank_mask:0xf
  v_add_f32_dpp v163, v163, v163 row_bcast:31 row_mask:0xc bank_mask:0xf
  s_nop 0
  v_readlane_b32 s40, v162, 63
  v_readlane_b32 s41, v163, 63
  s_nop 2
  v_mov_b32 v164, s40
  v_mov_b32 v166, s41
  v_mul_f32 v164, 0xba124925, v164
  v_mul_f32 v166, 0xba124925, v166
  v_mov_b32 v165, v164
  v_mov_b32 v167, v166
  v_pk_add_f32 v[172:173], v[96:97], v[164:165]
  v_pk_add_f32 v[176:177], v[124:125], v[166:167]
  v_pk_mul_f32 v[154:155], v[172:173], v[172:173]
  v_pk_mul_f32 v[158:159], v[176:177], v[176:177]
  v_pk_add_f32 v[174:175], v[98:99], v[164:165]
  v_pk_add_f32 v[178:179], v[126:127], v[166:167]
  v_pk_mul_f32 v[156:157], v[174:175], v[174:175]
  v_pk_mul_f32 v[160:161], v[178:179], v[178:179]
  v_pk_add_f32 v[172:173], v[100:101], v[164:165]
  v_pk_add_f32 v[176:177], v[128:129], v[166:167]
  v_pk_fma_f32 v[154:155], v[172:173], v[172:173], v[154:155]
  v_pk_fma_f32 v[158:159], v[176:177], v[176:177], v[158:159]
  v_pk_add_f32 v[174:175], v[102:103], v[164:165]
  v_pk_add_f32 v[178:179], v[130:131], v[166:167]
  v_pk_fma_f32 v[156:157], v[174:175], v[174:175], v[156:157]
  v_pk_fma_f32 v[160:161], v[178:179], v[178:179], v[160:161]
  v_pk_add_f32 v[172:173], v[104:105], v[164:165]
  v_pk_add_f32 v[176:177], v[132:133], v[166:167]
  v_pk_fma_f32 v[154:155], v[172:173], v[172:173], v[154:155]
  v_pk_fma_f32 v[158:159], v[176:177], v[176:177], v[158:159]
  v_pk_add_f32 v[174:175], v[106:107], v[164:165]
  v_pk_add_f32 v[178:179], v[134:135], v[166:167]
  v_pk_fma_f32 v[156:157], v[174:175], v[174:175], v[156:157]
  v_pk_fma_f32 v[160:161], v[178:179], v[178:179], v[160:161]
  v_pk_add_f32 v[172:173], v[108:109], v[164:165]
  v_pk_add_f32 v[176:177], v[136:137], v[166:167]
  v_pk_fma_f32 v[154:155], v[172:173], v[172:173], v[154:155]
  v_pk_fma_f32 v[158:159], v[176:177], v[176:177], v[158:159]
  v_pk_add_f32 v[174:175], v[110:111], v[164:165]
  v_pk_add_f32 v[178:179], v[138:139], v[166:167]
  v_pk_fma_f32 v[156:157], v[174:175], v[174:175], v[156:157]
  v_pk_fma_f32 v[160:161], v[178:179], v[178:179], v[160:161]
  v_pk_add_f32 v[172:173], v[112:113], v[164:165]
  v_pk_add_f32 v[176:177], v[140:141], v[166:167]
  v_pk_fma_f32 v[154:155], v[172:173], v[172:173], v[154:155]
  v_pk_fma_f32 v[158:159], v[176:177], v[176:177], v[158:159]
  v_pk_add_f32 v[174:175], v[114:115], v[164:165]
  v_pk_add_f32 v[178:179], v[142:143], v[166:167]
  v_pk_fma_f32 v[156:157], v[174:175], v[174:175], v[156:157]
  v_pk_fma_f32 v[160:161], v[178:179], v[178:179], v[160:161]
  v_pk_add_f32 v[172:173], v[116:117], v[164:165]
  v_pk_add_f32 v[176:177], v[144:145], v[166:167]
  v_pk_fma_f32 v[154:155], v[172:173], v[172:173], v[154:155]
  v_pk_fma_f32 v[158:159], v[176:177], v[176:177], v[158:159]
  v_pk_add_f32 v[174:175], v[118:119], v[164:165]
  v_pk_add_f32 v[178:179], v[146:147], v[166:167]
  v_pk_fma_f32 v[156:157], v[174:175], v[174:175], v[156:157]
  v_pk_fma_f32 v[160:161], v[178:179], v[178:179], v[160:161]
  v_pk_add_f32 v[172:173], v[120:121], v[164:165]
  v_pk_add_f32 v[176:177], v[148:149], v[166:167]
  v_pk_fma_f32 v[154:155], v[172:173], v[172:173], v[154:155]
  v_pk_fma_f32 v[158:159], v[176:177], v[176:177], v[158:159]
  v_pk_add_f32 v[174:175], v[122:123], v[164:165]
  v_pk_add_f32 v[178:179], v[150:151], v[166:167]
  v_pk_fma_f32 v[156:157], v[174:175], v[174:175], v[156:157]
  v_pk_fma_f32 v[160:161], v[178:179], v[178:179], v[160:161]
  v_pk_add_f32 v[154:155], v[154:155], v[156:157]
  v_pk_add_f32 v[158:159], v[158:159], v[160:161]
  v_add_f32 v162, v154, v155
  v_add_f32 v163, v158, v159
  s_nop 0
  v_add_f32_dpp v162, v162, v162 row_shr:1 row_mask:0xf bank_mask:0xf bound_ctrl:0
  v_add_f32_dpp v163, v163, v163 row_shr:1 row_mask:0xf bank_mask:0xf bound_ctrl:0
  s_nop 0
  v_add_f32_dpp v162, v162, v162 row_shr:2 row_mask:0xf bank_mask:0xf bound_ctrl:0
  v_add_f32_dpp v163, v163, v163 row_shr:2 row_mask:0xf bank_mask:0xf bound_ctrl:0
  s_nop 0
  v_add_f32_dpp v162, v162, v162 row_shr:4 row_mask:0xf bank_mask:0xf bound_ctrl:0
  v_add_f32_dpp v163, v163, v163 row_shr:4 row_mask:0xf bank_mask:0xf bound_ctrl:0
  s_nop 0
  v_add_f32_dpp v162, v162, v162 row_shr:8 row_mask:0xf bank_mask:0xf bound_ctrl:0
  v_add_f32_dpp v163, v163, v163 row_shr:8 row_mask:0xf bank_mask:0xf bound_ctrl:0
  s_nop 0
  v_add_f32_dpp v162, v162, v162 row_bcast:15 row_mask:0xa bank_mask:0xf
  v_add_f32_dpp v163, v163, v163 row_bcast:15 row_mask:0xa bank_mask:0xf
  s_nop 0
  v_add_f32_dpp v162, v162, v162 row_bcast:31 row_mask:0xc bank_mask:0xf
  v_add_f32_dpp v163, v163, v163 row_bcast:31 row_mask:0xc bank_mask:0xf
  s_nop 0
  v_readlane_b32 s40, v162, 63
  v_readlane_b32 s41, v163, 63
  s_nop 2
  v_mov_b32 v168, s40
  v_mov_b32 v170, s41
  v_mul_f32 v168, 0x3a124925, v168
  v_mul_f32 v170, 0x3a124925, v170
  v_cvt_pk_bf16_f32 v180, v164, v164
  v_cvt_pk_bf16_f32 v181, v166, v166
  v_lshlrev_b32 v164, 16, v180
  v_lshlrev_b32 v166, 16, v181
  v_cvt_pk_bf16_f32 v180, v168, v168
  v_cvt_pk_bf16_f32 v181, v170, v170
  v_lshlrev_b32 v168, 16, v180
  v_lshlrev_b32 v170, 16, v181
  v_add_f32 v168, 0x3727c5ac, v168
  v_add_f32 v170, 0x3727c5ac, v170
  v_cvt_pk_bf16_f32 v180, v168, v168
  v_cvt_pk_bf16_f32 v181, v170, v170
  v_lshlrev_b32 v168, 16, v180
  v_lshlrev_b32 v170, 16, v181
  v_sqrt_f32 v168, v168
  v_sqrt_f32 v170, v170
  s_nop 0
  v_cvt_pk_bf16_f32 v180, v168, v168
  v_cvt_pk_bf16_f32 v181, v170, v170
  v_lshlrev_b32 v168, 16, v180
  v_lshlrev_b32 v170, 16, v181
  v_rcp_f32 v168, v168
  v_rcp_f32 v170, v170
  s_nop 0
  v_mov_b32 v169, v168
  v_mov_b32 v171, v170
  v_mul_f32 v164, v164, v168
  v_mul_f32 v166, v166, v170
  v_mov_b32 v165, v164
  v_mov_b32 v167, v166
  v_pk_fma_f32 v[96:97], v[96:97], v[168:169], v[164:165]
  v_pk_fma_f32 v[124:125], v[124:125], v[170:171], v[166:167]
  v_cvt_pk_bf16_f32 v184, v96, v97
  v_cvt_pk_bf16_f32 v200, v124, v125
  v_pk_fma_f32 v[98:99], v[98:99], v[168:169], v[164:165]
  v_pk_fma_f32 v[126:127], v[126:127], v[170:171], v[166:167]
  v_cvt_pk_bf16_f32 v185, v98, v99
  v_cvt_pk_bf16_f32 v201, v126, v127
  v_pk_fma_f32 v[100:101], v[100:101], v[168:169], v[164:165]
  v_pk_fma_f32 v[128:129], v[128:129], v[170:171], v[166:167]
  v_cvt_pk_bf16_f32 v186, v100, v101
  v_cvt_pk_bf16_f32 v202, v128, v129
  v_pk_fma_f32 v[102:103], v[102:103], v[168:169], v[164:165]
  v_pk_fma_f32 v[130:131], v[130:131], v[170:171], v[166:167]
  v_cvt_pk_bf16_f32 v187, v102, v103
  v_cvt_pk_bf16_f32 v203, v130, v131
  v_pk_fma_f32 v[104:105], v[104:105], v[168:169], v[164:165]
  v_pk_fma_f32 v[132:133], v[132:133], v[170:171], v[166:167]
  v_cvt_pk_bf16_f32 v188, v104, v105
  v_cvt_pk_bf16_f32 v204, v132, v133
  v_pk_fma_f32 v[106:107], v[106:107], v[168:169], v[164:165]
  v_pk_fma_f32 v[134:135], v[134:135], v[170:171], v[166:167]
  v_cvt_pk_bf16_f32 v189, v106, v107
  v_cvt_pk_bf16_f32 v205, v134, v135
  v_pk_fma_f32 v[108:109], v[108:109], v[168:169], v[164:165]
  v_pk_fma_f32 v[136:137], v[136:137], v[170:171], v[166:167]
  v_cvt_pk_bf16_f32 v190, v108, v109
  v_cvt_pk_bf16_f32 v206, v136, v137
  v_pk_fma_f32 v[110:111], v[110:111], v[168:169], v[164:165]
  v_pk_fma_f32 v[138:139], v[138:139], v[170:171], v[166:167]
  v_cvt_pk_bf16_f32 v191, v110, v111
  v_cvt_pk_bf16_f32 v207, v138, v139
  v_pk_fma_f32 v[112:113], v[112:113], v[168:169], v[164:165]
  v_pk_fma_f32 v[140:141], v[140:141], v[170:171], v[166:167]
  v_cvt_pk_bf16_f32 v192, v112, v113
  v_cvt_pk_bf16_f32 v208, v140, v141
  v_pk_fma_f32 v[114:115], v[114:115], v[168:169], v[164:165]
  v_pk_fma_f32 v[142:143], v[142:143], v[170:171], v[166:167]
  v_cvt_pk_bf16_f32 v193, v114, v115
  v_cvt_pk_bf16_f32 v209, v142, v143
  v_pk_fma_f32 v[116:117], v[116:117], v[168:169], v[164:165]
  v_pk_fma_f32 v[144:145], v[144:145], v[170:171], v[166:167]
  v_cvt_pk_bf16_f32 v194, v116, v117
  v_cvt_pk_bf16_f32 v210, v144, v145
  v_pk_fma_f32 v[118:119], v[118:119], v[168:169], v[164:165]
  v_pk_fma_f32 v[146:147], v[146:147], v[170:171], v[166:167]
  v_cvt_pk_bf16_f32 v195, v118, v119
  v_cvt_pk_bf16_f32 v211, v146, v147
  v_pk_fma_f32 v[120:121], v[120:121], v[168:169], v[164:165]
  v_pk_fma_f32 v[148:149], v[148:149], v[170:171], v[166:167]
  v_cvt_pk_bf16_f32 v196, v120, v121
  v_cvt_pk_bf16_f32 v212, v148, v149
  v_pk_fma_f32 v[122:123], v[122:123], v[168:169], v[164:165]
  v_pk_fma_f32 v[150:151], v[150:151], v[170:171], v[166:167]
  v_cvt_pk_bf16_f32 v197, v122, v123
  v_cvt_pk_bf16_f32 v213, v150, v151
  s_add_u32 s45, s44, 3584
  buffer_store_dwordx4 v[184:187], v152, s[12:15], s44 offen offset:0 sc1
  buffer_store_dwordx4 v[188:191], v152, s[12:15], s44 offen offset:1024 sc1
  buffer_store_dwordx4 v[192:195], v152, s[12:15], s44 offen offset:2048 sc1
  buffer_store_dwordx2 v[196:197], v153, s[12:15], s44 offen offset:3072 sc1
  buffer_store_dwordx4 v[200:203], v152, s[12:15], s45 offen offset:0 sc1
  buffer_store_dwordx4 v[204:207], v152, s[12:15], s45 offen offset:1024 sc1
  buffer_store_dwordx4 v[208:211], v152, s[12:15], s45 offen offset:2048 sc1
  buffer_store_dwordx2 v[212:213], v153, s[12:15], s45 offen offset:3072 sc1
  s_add_u32 s44, s44, 7168
  s_waitcnt vmcnt(24)
  s_sub_u32 s43, s43, 1
  s_cmp_lg_u32 s43, 0
  s_cbranch_scc1 att_nr
  s_waitcnt vmcnt(0)
  s_barrier
  s_mov_b32 s42, 34816
  s_cmp_eq_u32 s3, 0
  s_cbranch_scc0 att_pubz
  v_and_b32 v100, 7, v0
  v_lshlrev_b32 v100, 8, v100
  v_add_u32 v100, s42, v100
  v_mov_b32 v101, 1
  s_mov_b64 exec, 0xff
  global_atomic_add v100, v101, s[70:71] sc1
  s_mov_b64 exec, -1
att_pubz:
  s_branch att_ln_ret
att_fb:
  s_waitcnt vmcnt(0)
  s_mov_b32 s90, 1
  s_lshl_b32 s50, s24, 19
  s_mov_b32 s91, 32
  v_mov_b32 v180, 0xff800000
  v_mov_b32 v181, 0xff800000
  v_mov_b32 v182, 0xff800000
  v_mov_b32 v183, 0xff800000
att_fb_loop:
  s_barrier
  s_add_u32 m0, s60, 0
  s_nop 0
  buffer_load_dwordx4 v26, s[52:55], s50 offen lds
  buffer_load_dwordx4 v27, s[52:55], s50 offen offset:1024 lds
  buffer_load_dwordx4 v28, s[52:55], s50 offen offset:2048 lds
  buffer_load_dwordx4 v29, s[52:55], s50 offen offset:3072 lds
  s_add_u32 s50, s50, 16384
  s_waitcnt vmcnt(0)
  s_barrier
  ds_read_b128 a[192:195], v2 offset:0
  ds_read_b128 a[196:199], v3 offset:0
  ds_read_b128 a[200:203], v4 offset:0
  ds_read_b128 a[204:207], v5 offset:0
  ds_read_b128 a[208:211], v2 offset:4096
  ds_read_b128 a[212:215], v3 offset:4096
  ds_read_b128 a[216:219], v4 offset:4096
  ds_read_b128 a[220:223], v5 offset:4096
  s_waitcnt lgkmcnt(0)
  v_mfma_f32_16x16x32_bf16 v[32:35], a[192:195], a[128:131], 0
  v_mfma_f32_16x16x32_bf16 v[32:35], a[196:199], a[132:135], v[32:35]
  v_mfma_f32_16x16x32_bf16 v[32:35], a[200:203], a[136:139], v[32:35]
  v_mfma_f32_16x16x32_bf16 v[32:35], a[204:207], a[140:143], v[32:35]
  v_mfma_f32_16x16x32_bf16 v[36:39], a[204:207], a[156:159], 0
  v_mfma_f32_16x16x32_bf16 v[36:39], a[200:203], a[152:155], v[36:39]
  v_mfma_f32_16x16x32_bf16 v[36:39], a[196:199], a[148:151], v[36:39]
  v_mfma_f32_16x16x32_bf16 v[36:39], a[192:195], a[144:147], v[36:39]
  v_mfma_f32_16x16x32_bf16 v[40:43], a[192:195], a[160:163], 0
  v_mfma_f32_16x16x32_bf16 v[40:43], a[196:199], a[164:167], v[40:43]
  v_mfma_f32_16x16x32_bf16 v[40:43], a[200:203], a[168:171], v[40:43]
  v_mfma_f32_16x16x32_bf16 v[40:43], a[204:207], a[172:175], v[40:43]
  v_mfma_f32_16x16x32_bf16 v[44:47], a[204:207], a[188:191], 0
  v_mfma_f32_16x16x32_bf16 v[44:47], a[200:203], a[184:187], v[44:47]
  v_mfma_f32_16x16x32_bf16 v[44:47], a[196:199], a[180:183], v[44:47]
  v_mfma_f32_16x16x32_bf16 v[44:47], a[192:195], a[176:179], v[44:47]
  v_mfma_f32_16x16x32_bf16 v[48:51], a[208:211], a[128:131], 0
  v_mfma_f32_16x16x32_bf16 v[48:51], a[212:215], a[132:135], v[48:51]
  v_mfma_f32_16x16x32_bf16 v[48:51], a[216:219], a[136:139], v[48:51]
  v_mfma_f32_16x16x32_bf16 v[48:51], a[220:223], a[140:143], v[48:51]
  v_mfma_f32_16x16x32_bf16 v[52:55], a[220:223], a[156:159], 0
  v_mfma_f32_16x16x32_bf16 v[52:55], a[216:219], a[152:155], v[52:55]
  v_mfma_f32_16x16x32_bf16 v[52:55], a[212:215], a[148:151], v[52:55]
  v_mfma_f32_16x16x32_bf16 v[52:55], a[208:211], a[144:147], v[52:55]
  v_mfma_f32_16x16x32_bf16 v[56:59], a[208:211], a[160:163], 0
  v_mfma_f32_16x16x32_bf16 v[56:59], a[212:215], a[164:167], v[56:59]
  v_mfma_f32_16x16x32_bf16 v[56:59], a[216:219], a[168:171], v[56:59]
  v_mfma_f32_16x16x32_bf16 v[56:59], a[220:223], a[172:175], v[56:59]
  v_mfma_f32_16x16x32_bf16 v[60:63], a[220:223], a[188:191], 0
  v_mfma_f32_16x16x32_bf16 v[60:63], a[216:219], a[184:187], v[60:63]
  v_mfma_f32_16x16x32_bf16 v[60:63], a[212:215], a[180:183], v[60:63]
  v_mfma_f32_16x16x32_bf16 v[60:63], a[208:211], a[176:179], v[60:63]
  s_nop 7
  s_nop 7
  s_nop 7
  v_max3_f32 v180, v180, v32, v33
  v_max3_f32 v180, v180, v34, v35
  v_max3_f32 v180, v180, v48, v49
  v_max3_f32 v180, v180, v50, v51
  v_max3_f32 v181, v181, v36, v37
  v_max3_f32 v181, v181, v38, v39
  v_max3_f32 v181, v181, v52, v53
  v_max3_f32 v181, v181, v54, v55
  v_max3_f32 v182, v182, v40, v41
  v_max3_f32 v182, v182, v42, v43
  v_max3_f32 v182, v182, v56, v57
  v_max3_f32 v182, v182, v58, v59
  v_max3_f32 v183, v183, v44, v45
  v_max3_f32 v183, v183, v46, v47
  v_max3_f32 v183, v183, v60, v61
  v_max3_f32 v183, v183, v62, v63
  ds_read_b128 a[192:195], v2 offset:8192
  ds_read_b128 a[196:199], v3 offset:8192
  ds_read_b128 a[200:203], v4 offset:8192
  ds_read_b128 a[204:207], v5 offset:8192
  ds_read_b128 a[208:211], v2 offset:12288
  ds_read_b128 a[212:215], v3 offset:12288
  ds_read_b128 a[216:219], v4 offset:12288
  ds_read_b128 a[220:223], v5 offset:12288
  s_waitcnt lgkmcnt(0)
  v_mfma_f32_16x16x32_bf16 v[32:35], a[192:195], a[128:131], 0
  v_mfma_f32_16x16x32_bf16 v[32:35], a[196:199], a[132:135], v[32:35]
  v_mfma_f32_16x16x32_bf16 v[32:35], a[200:203], a[136:139], v[32:35]
  v_mfma_f32_16x16x32_bf16 v[32:35], a[204:207], a[140:143], v[32:35]
  v_mfma_f32_16x16x32_bf16 v[36:39], a[204:207], a[156:159], 0
  v_mfma_f32_16x16x32_bf16 v[36:39], a[200:203], a[152:155], v[36:39]
  v_mfma_f32_16x16x32_bf16 v[36:39], a[196:199], a[148:151], v[36:39]
  v_mfma_f32_16x16x32_bf16 v[36:39], a[192:195], a[144:147], v[36:39]
  v_mfma_f32_16x16x32_bf16 v[40:43], a[192:195], a[160:163], 0
  v_mfma_f32_16x16x32_bf16 v[40:43], a[196:199], a[164:167], v[40:43]
  v_mfma_f32_16x16x32_bf16 v[40:43], a[200:203], a[168:171], v[40:43]
  v_mfma_f32_16x16x32_bf16 v[40:43], a[204:207], a[172:175], v[40:43]
  v_mfma_f32_16x16x32_bf16 v[44:47], a[204:207], a[188:191], 0
  v_mfma_f32_16x16x32_bf16 v[44:47], a[200:203], a[184:187], v[44:47]
  v_mfma_f32_16x16x32_bf16 v[44:47], a[196:199], a[180:183], v[44:47]
  v_mfma_f32_16x16x32_bf16 v[44:47], a[192:195], a[176:179], v[44:47]
  v_mfma_f32_16x16x32_bf16 v[48:51], a[208:211], a[128:131], 0
  v_mfma_f32_16x16x32_bf16 v[48:51], a[212:215], a[132:135], v[48:51]
  v_mfma_f32_16x16x32_bf16 v[48:51], a[216:219], a[136:139], v[48:51]
  v_mfma_f32_16x16x32_bf16 v[48:51], a[220:223], a[140:143], v[48:51]
  v_mfma_f32_16x16x32_bf16 v[52:55], a[220:223], a[156:159], 0
  v_mfma_f32_16x16x32_bf16 v[52:55], a[216:219], a[152:155], v[52:55]
  v_mfma_f32_16x16x32_bf16 v[52:55], a[212:215], a[148:151], v[52:55]
  v_mfma_f32_16x16x32_bf16 v[52:55], a[208:211], a[144:147], v[52:55]
  v_mfma_f32_16x16x32_bf16 v[56:59], a[208:211], a[160:163], 0
  v_mfma_f32_16x16x32_bf16 v[56:59], a[212:215], a[164:167], v[56:59]
  v_mfma_f32_16x16x32_bf16 v[56:59], a[216:219], a[168:171], v[56:59]
  v_mfma_f32_16x16x32_bf16 v[56:59], a[220:223], a[172:175], v[56:59]
  v_mfma_f32_16x16x32_bf16 v[60:63], a[220:223], a[188:191], 0
  v_mfma_f32_16x16x32_bf16 v[60:63], a[216:219], a[184:187], v[60:63]
  v_mfma_f32_16x16x32_bf16 v[60:63], a[212:215], a[180:183], v[60:63]
  v_mfma_f32_16x16x32_bf16 v[60:63], a[208:211], a[176:179], v[60:63]
  s_nop 7
  s_nop 7
  s_nop 7
  v_max3_f32 v180, v180, v32, v33
  v_max3_f32 v180, v180, v34, v35
  v_max3_f32 v180, v180, v48, v49
  v_max3_f32 v180, v180, v50, v51
  v_max3_f32 v181, v181, v36, v37
  v_max3_f32 v181, v181, v38, v39
  v_max3_f32 v181, v181, v52, v53
  v_max3_f32 v181, v181, v54, v55
  v_max3_f32 v182, v182, v40, v41
  v_max3_f32 v182, v182, v42, v43
  v_max3_f32 v182, v182, v56, v57
  v_max3_f32 v182, v182, v58, v59
  v_max3_f32 v183, v183, v44, v45
  v_max3_f32 v183, v183, v46, v47
  v_max3_f32 v183, v183, v60, v61
  v_max3_f32 v183, v183, v62, v63
  s_sub_u32 s91, s91, 1
  s_cmp_lg_u32 s91, 0
  s_cbranch_scc1 att_fb_loop
  v_mov_b32 v184, v180
  v_mov_b32 v185, v181
  v_mov_b32 v186, v182
  v_mov_b32 v187, v183
  s_nop 1
  v_permlane16_swap_b32 v180, v184
  v_permlane16_swap_b32 v181, v185
  v_permlane16_swap_b32 v182, v186
  v_permlane16_swap_b32 v183, v187
  s_nop 1
  v_max_f32 v180, v180, v184
  v_max_f32 v181, v181, v185
  v_max_f32 v182, v182, v186
  v_max_f32 v183, v183, v187
  v_mov_b32 v184, v180
  v_mov_b32 v185, v181
  v_mov_b32 v186, v182
  v_mov_b32 v187, v183
  s_nop 1
  v_permlane32_swap_b32 v180, v184
  v_permlane32_swap_b32 v181, v185
  v_permlane32_swap_b32 v182, v186
  v_permlane32_swap_b32 v183, v187
  s_nop 1
  v_max_f32 v180, v180, v184
  v_max_f32 v181, v181, v185
  v_max_f32 v182, v182, v186
  v_max_f32 v183, v183, v187
  s_lshl_b32 s50, s24, 19
  s_mov_b32 s51, s50
  s_sub_u32 s35, s35, 540672
  s_barrier
  s_add_u32 m0, s60, 0
  s_nop 0
  buffer_load_dwordx4 v26, s[52:55], s50 offen lds
  buffer_load_dwordx4 v27, s[52:55], s50 offen offset:1024 lds
  buffer_load_dwordx4 v28, s[52:55], s50 offen offset:2048 lds
  buffer_load_dwordx4 v29, s[52:55], s50 offen offset:3072 lds
  s_add_u32 s50, s50, 16384
  s_add_u32 m0, s60, 16384
  s_nop 0
  buffer_load_dwordx4 v26, s[52:55], s50 offen lds
  buffer_load_dwordx4 v27, s[52:55], s50 offen offset:1024 lds
  buffer_load_dwordx4 v28, s[52:55], s50 offen offset:2048 lds
  buffer_load_dwordx4 v29, s[52:55], s50 offen offset:3072 lds
  s_add_u32 s50, s50, 16384
  s_add_u32 m0, s60, 32768
  s_nop 0
  buffer_load_dwordx4 v26, s[52:55], s50 offen lds
  buffer_load_dwordx4 v27, s[52:55], s50 offen offset:1024 lds
  buffer_load_dwordx4 v28, s[52:55], s50 offen offset:2048 lds
  buffer_load_dwordx4 v29, s[52:55], s50 offen offset:3072 lds
  s_add_u32 s50, s50, 16384
  s_add_u32 m0, s61, 0
  s_nop 0
  buffer_load_dwordx4 v30, s[56:59], s51 offen lds
  buffer_load_dwordx4 v31, s[56:59], s51 offen offset:1024 lds
  buffer_load_dwordx4 v30, s[56:59], s51 offen offset:2048 lds
  buffer_load_dwordx4 v31, s[56:59], s51 offen offset:3072 lds
  s_add_u32 s51, s51, 16384
  s_add_u32 m0, s61, 16384
  s_nop 0
  buffer_load_dwordx4 v30, s[56:59], s51 offen lds
  buffer_load_dwordx4 v31, s[56:59], s51 offen offset:1024 lds
  buffer_load_dwordx4 v30, s[56:59], s51 offen offset:2048 lds
  buffer_load_dwordx4 v31, s[56:59], s51 offen offset:3072 lds
  s_add_u32 s51, s51, 16384
  s_branch att_rerun
att_nz:
  v_and_b32 v100, 15, v0
  v_bfe_u32 v101, v0, 4, 2
  v_lshlrev_b32 v32, 1, v101
  v_xor_b32 v100, v100, v32
  v_lshlrev_b32 v100, 4, v100
  s_lshl_b32 s40, s3, 4
  v_add_u32 v101, s40, v101
  v_mul_u32_u24 v101, 8192, v101
  v_add_u32 v32, v101, v100
  v_xor_b32 v100, 128, v32
  v_add_u32 v33, 31744, v32
  v_add_u32 v34, 63488, v100
  v_add_u32 v35, 95232, v100
  s_mov_b32 s36, s44
  s_mov_b32 s37, s45
  s_mov_b32 s38, 8388608
  s_mov_b32 s39, 0x20000
  s_add_u32 m0, s28, 65536
  s_nop 0
  buffer_load_dwordx4 v2, s[8:11], s32 offen offset:0 lds
  buffer_load_dwordx4 v3, s[8:11], s32 offen offset:1024 lds
  buffer_load_dwordx4 v4, s[8:11], s32 offen offset:2048 lds
  buffer_load_dwordx4 v5, s[8:11], s32 offen offset:3072 lds
  s_add_u32 m0, s28, 69632
  s_nop 0
  buffer_load_dwordx4 v6, s[8:11], s32 offen offset:0 lds
  buffer_load_dwordx4 v7, s[8:11], s32 offen offset:1024 lds
  buffer_load_dwordx4 v8, s[8:11], s32 offen offset:2048 lds
  buffer_load_dwordx4 v9, s[8:11], s32 offen offset:3072 lds
  s_add_u32 m0, s29, 32768
  s_nop 0
  buffer_load_dwordx4 v32, s[36:39], s33 offen offset:0 lds
  buffer_load_dwordx4 v33, s[36:39], s33 offen offset:1024 lds
  buffer_load_dwordx4 v34, s[36:39], s33 offen offset:2048 lds
  buffer_load_dwordx4 v35, s[36:39], s33 offen offset:3072 lds
  s_add_u32 s32, s32, 128
  s_add_u32 s33, s33, 524288
  s_add_u32 m0, s28, 0
  s_nop 0
  buffer_load_dwordx4 v2, s[8:11], s32 offen offset:0 lds
  buffer_load_dwordx4 v3, s[8:11], s32 offen offset:1024 lds
  buffer_load_dwordx4 v4, s[8:11], s32 offen offset:2048 lds
  buffer_load_dwordx4 v5, s[8:11], s32 offen offset:3072 lds
  s_add_u32 m0, s28, 4096
  s_nop 0
  buffer_load_dwordx4 v6, s[8:11], s32 offen offset:0 lds
  buffer_load_dwordx4 v7, s[8:11], s32 offen offset:1024 lds
  buffer_load_dwordx4 v8, s[8:11], s32 offen offset:2048 lds
  buffer_load_dwordx4 v9, s[8:11], s32 offen offset:3072 lds
  s_add_u32 m0, s29, 0
  s_nop 0
  buffer_load_dwordx4 v32, s[36:39], s33 offen offset:0 lds
  buffer_load_dwordx4 v33, s[36:39], s33 offen offset:1024 lds
  buffer_load_dwordx4 v34, s[36:39], s33 offen offset:2048 lds
  buffer_load_dwordx4 v35, s[36:39], s33 offen offset:3072 lds
  s_add_u32 s32, s32, 128
  s_add_u32 s33, s33, 524288
  s_add_u32 m0, s28, 32768
  s_nop 0
  buffer_load_dwordx4 v2, s[8:11], s32 offen offset:0 lds
  buffer_load_dwordx4 v3, s[8:11], s32 offen offset:1024 lds
  buffer_load_dwordx4 v4, s[8:11], s32 offen offset:2048 lds
  buffer_load_dwordx4 v5, s[8:11], s32 offen offset:3072 lds
  s_add_u32 m0, s28, 36864
  s_nop 0
  buffer_load_dwordx4 v6, s[8:11], s32 offen offset:0 lds
  buffer_load_dwordx4 v7, s[8:11], s32 offen offset:1024 lds
  v_and_b32 v105, 63, v0
  s_and_b32 s40, s3, 3
  s_lshr_b32 s41, s3, 2
  v_and_b32 v100, 15, v105
  v_lshrrev_b32 v101, 4, v105
  v_lshrrev_b32 v102, 1, v100
  v_xor_b32 v102, v102, v101
  v_lshlrev_b32 v102, 4, v102
  s_mul_i32 s42, s40, 8192
  v_lshlrev_b32 v103, 7, v100
  v_add3_u32 v102, v102, v103, s42
  v_add_u32 v14, 0, v102
  v_xor_b32 v15, 64, v14
  v_add_u32 v16, 65536, v102
  v_xor_b32 v17, 64, v16
  v_lshrrev_b32 v102, 2, v100
  v_lshl_add_u32 v103, v101, 3, v102
  v_mul_u32_u24 v103, 256, v103
  v_and_b32 v104, 3, v100
  v_lshl_add_u32 v103, v104, 3, v103
  v_and_b32 v104, 1, v101
  v_lshl_or_b32 v102, v104, 2, v102
  s_mul_i32 s42, s41, 8
  s_add_u32 s43, s42, 0
  v_xor_b32 v104, s43, v102
  v_lshl_add_u32 v104, v104, 5, v103
  v_add_u32 v18, 98304, v104
  s_add_u32 s43, s42, 1
  v_xor_b32 v104, s43, v102
  v_lshl_add_u32 v104, v104, 5, v103
  v_add_u32 v19, 98304, v104
  s_add_u32 s43, s42, 2
  v_xor_b32 v104, s43, v102
  v_lshl_add_u32 v104, v104, 5, v103
  v_add_u32 v20, 98304, v104
  s_add_u32 s43, s42, 3
  v_xor_b32 v104, s43, v102
  v_lshl_add_u32 v104, v104, 5, v103
  v_add_u32 v21, 98304, v104
  s_add_u32 s43, s42, 4
  v_xor_b32 v104, s43, v102
  v_lshl_add_u32 v104, v104, 5, v103
  v_add_u32 v22, 98304, v104
  s_add_u32 s43, s42, 5
  v_xor_b32 v104, s43, v102
  v_lshl_add_u32 v104, v104, 5, v103
  v_add_u32 v23, 98304, v104
  s_add_u32 s43, s42, 6
  v_xor_b32 v104, s43, v102
  v_lshl_add_u32 v104, v104, 5, v103
  v_add_u32 v24, 98304, v104
  s_add_u32 s43, s42, 7
  v_xor_b32 v104, s43, v102
  v_lshl_add_u32 v104, v104, 5, v103
  v_add_u32 v25, 98304, v104
  s_mov_b32 s52, s20
  s_mov_b32 s53, s21
  s_mov_b32 s54, 16777216
  s_mov_b32 s55, 0x20000
  s_mov_b32 s56, s22
  s_mov_b32 s57, s23
  s_mov_b32 s58, 16777216
  s_mov_b32 s59, 0x20000
  s_add_u32 s64, s6, 33554432
  s_addc_u32 s65, s7, 0
  s_mov_b32 s66, 17301504
  s_mov_b32 s67, 0x20000
  s_lshl_b32 s50, s24, 19
  s_mov_b32 s51, s50
  v_and_b32 v103, 63, v0
  v_lshrrev_b32 v100, 4, v103
  v_and_b32 v101, 15, v103
  s_lshl_b32 s40, s3, 4
  v_add_u32 v102, 0, v100
  v_xor_b32 v102, v102, v101
  v_lshlrev_b32 v102, 4, v102
  v_add_u32 v26, s40, v100
  v_lshl_add_u32 v26, v26, 8, v102
  v_add_u32 v102, 4, v100
  v_xor_b32 v102, v102, v101
  v_lshlrev_b32 v102, 4, v102
  v_add_u32 v27, s40, v100
  v_lshl_add_u32 v27, v27, 8, v102
  v_add_u32 v102, 8, v100
  v_xor_b32 v102, v102, v101
  v_lshlrev_b32 v102, 4, v102
  v_add_u32 v28, s40, v100
  v_lshl_add_u32 v28, v28, 8, v102
  v_add_u32 v102, 12, v100
  v_xor_b32 v102, v102, v101
  v_lshlrev_b32 v102, 4, v102
  v_add_u32 v29, s40, v100
  v_lshl_add_u32 v29, v29, 8, v102
  v_add_u32 v102, 0, v100
  v_lshlrev_b32 v102, 1, v102
  v_xor_b32 v102, v102, v101
  v_lshlrev_b32 v102, 4, v102
  v_add_u32 v30, s40, v100
  v_lshl_add_u32 v30, v30, 8, v102
  v_add_u32 v102, 4, v100
  v_lshlrev_b32 v102, 1, v102
  v_xor_b32 v102, v102, v101
  v_lshlrev_b32 v102, 4, v102
  v_add_u32 v31, s40, v100
  v_lshl_add_u32 v31, v31, 8, v102
  s_lshl_b32 s60, s3, 12
  s_add_u32 s61, s60, 65536
  s_lshl_b32 s48, s3, 12
  s_add_u32 s48, s48, 147456
  v_and_b32 v103, 63, v0
  v_and_b32 v100, 15, v103
  v_lshrrev_b32 v101, 4, v103
  v_lshrrev_b32 v102, 1, v101
  v_xor_b32 v102, v102, v100
  v_lshlrev_b32 v102, 4, v102
  v_and_b32 v101, 1, v101
  v_lshl_add_u32 v102, v101, 3, v102
  v_lshl_add_u32 v102, v100, 8, v102
  v_add_u32 v36, s48, v102
  v_xor_b32 v37, 32, v36
  v_xor_b32 v38, 64, v36
  v_xor_b32 v39, 96, v36
  v_xor_b32 v40, 128, v36
  v_xor_b32 v41, 160, v36
  v_xor_b32 v42, 192, v36
  v_xor_b32 v43, 224, v36
  v_lshrrev_b32 v100, 4, v103
  v_and_b32 v101, 15, v103
  v_xor_b32 v102, v101, v100
  v_lshlrev_b32 v102, 4, v102
  v_lshl_add_u32 v102, v100, 8, v102
  v_add_u32 v44, s48, v102
  v_xor_b32 v45, 64, v44
  v_xor_b32 v46, 128, v44
  v_xor_b32 v47, 192, v44
  s_lshl_b32 s35, s25, 2
  s_add_u32 s35, s35, s3
  s_mul_i32 s35, s35, 540672
  s_and_b32 s42, s24, 16
  s_and_b32 s43, s24, 1
  s_lshl_b32 s43, s43, 3
  s_or_b32 s42, s42, s43
  s_bfe_u32 s43, s24, 0x30001
  s_or_b32 s42, s42, s43
  s_lshl_b32 s42, s42, 8
  s_add_u32 s35, s35, s42
  s_cmp_lt_u32 s2, 80
  s_cselect_b32 s92, s46, s96
  s_cselect_b32 s93, s47, s97
  s_cselect_b32 s42, 0, 80
  s_mov_b32 s94, 8388608
  s_cmp_ge_u32 s2, 160
  s_cselect_b32 s92, s98, s92
  s_cselect_b32 s93, s99, s93
  s_cselect_b32 s42, 160, s42
  s_cselect_b32 s94, 3670016, s94
  s_cmp_ge_u32 s2, 200
  s_cselect_b32 s94, 0, s94
  s_mov_b32 s95, 0x20000
  s_sub_u32 s42, s2, s42
  s_lshl_b32 s42, s42, 2
  s_add_u32 s42, s42, s3
  s_mul_i32 s100, s42, 28672
  s_mov_b32 s63, 0
  s_waitcnt vmcnt(6)
  s_barrier
  ds_read_b64_tr_b16 a[64:65], v18 offset:32768
  ds_read_b64_tr_b16 a[66:67], v18 offset:33792
  ds_read_b64_tr_b16 a[68:69], v18 offset:40960
  ds_read_b64_tr_b16 a[70:71], v18 offset:41984
  ds_read_b128 a[0:3], v16 offset:0
  ds_read_b128 a[16:19], v17 offset:0
  ds_read_b128 a[4:7], v16 offset:2048
  ds_read_b128 a[20:23], v17 offset:2048
  ds_read_b128 a[8:11], v16 offset:4096
  ds_read_b128 a[24:27], v17 offset:4096
  ds_read_b128 a[12:15], v16 offset:6144
  ds_read_b128 a[28:31], v17 offset:6144
  ds_read_b64_tr_b16 a[72:73], v19 offset:32768
  ds_read_b64_tr_b16 a[74:75], v19 offset:33792
  ds_read_b64_tr_b16 a[76:77], v19 offset:40960
  ds_read_b64_tr_b16 a[78:79], v19 offset:41984
  ds_read_b64_tr_b16 a[80:81], v20 offset:32768
  ds_read_b64_tr_b16 a[82:83], v20 offset:33792
  ds_read_b64_tr_b16 a[84:85], v20 offset:40960
  ds_read_b64_tr_b16 a[86:87], v20 offset:41984
  ds_read_b64_tr_b16 a[88:89], v21 offset:32768
  ds_read_b64_tr_b16 a[90:91], v21 offset:33792
  ds_read_b64_tr_b16 a[92:93], v21 offset:40960
  ds_read_b64_tr_b16 a[94:95], v21 offset:41984
  s_waitcnt lgkmcnt(0)
  s_branch att_q
mid_idle:
  s_waitcnt vmcnt(0) lgkmcnt(0)
  s_barrier
  s_cmp_eq_u32 s69, 0
  s_cbranch_scc0 mid_pubd
  s_cmp_eq_u32 s3, 0
  s_cbranch_scc0 mid_pubd
  v_and_b32 v104, 7, v0
  v_lshlrev_b32 v104, 8, v104
  v_add_u32 v104, s91, v104
  v_mov_b32 v105, 1
  s_mov_b64 exec, 0xff
  global_atomic_add v104, v105, s[70:71] sc1
  s_mov_b64 exec, -1
mid_pubd:
  s_mov_b32 s69, 1
  s_mov_b32 s69, 1
  s_branch fin_entry
mid_opoll:
  v_mov_b32 v104, s63
  s_mov_b64 exec, 1
  s_mov_b32 s42, 0x20000
mid_opoll_l:
  global_load_dword v105, v104, s[70:71] sc1
  s_waitcnt vmcnt(0)
  v_readfirstlane_b32 s43, v105
  s_sub_u32 s42, s42, 1
  s_cbranch_scc1 mid_opoll_l_ok
  s_nop 1
  s_cmp_ge_u32 s43, 8
  s_cbranch_scc1 mid_opoll_l_ok
  s_sleep 2
  s_branch mid_opoll_l
mid_opoll_l_ok:
  s_mov_b64 exec, -1
  s_branch mid_opoll_ret
mid_latepub:
  s_cmp_eq_u32 s3, 0
  s_cbranch_scc0 mid_latepub_l
  v_and_b32 v104, 7, v0
  v_lshlrev_b32 v104, 8, v104
  v_add_u32 v104, s91, v104
  v_mov_b32 v105, 1
  s_mov_b64 exec, 0xff
  global_atomic_add v104, v105, s[70:71] sc1
  s_mov_b64 exec, -1
mid_latepub_l:
  s_mov_b32 s69, 1
  s_branch mid_latepub_ret
fin_hpoll:
  s_add_u32 s45, s51, 64
  v_mov_b32 v20, s45
  s_mov_b64 exec, 1
  s_mov_b32 s42, 0x20000
fin_hpoll_l:
  global_load_dword v21, v20, s[70:71] sc1
  s_waitcnt vmcnt(0)
  v_readfirstlane_b32 s43, v21
  s_sub_u32 s42, s42, 1
  s_cbranch_scc1 fin_hpoll_l_ok
  s_nop 1
  s_cmp_ge_u32 s43, 7
  s_cbranch_scc1 fin_hpoll_l_ok
  s_sleep 2
  s_branch fin_hpoll_l
fin_hpoll_l_ok:
  s_mov_b64 exec, -1
  s_branch fin_hpoll_ret
fin_spoll:
  s_add_u32 s51, s51, 128
  v_mov_b32 v20, s51
  s_mov_b64 exec, 1
  s_mov_b32 s42, 0x20000
fin_spoll_l:
  global_load_dword v21, v20, s[70:71] sc1
  s_waitcnt vmcnt(0)
  v_readfirstlane_b32 s43, v21
  s_sub_u32 s42, s42, 1
  s_cbranch_scc1 fin_spoll_l_ok
  s_nop 1
  s_cmp_ge_u32 s43, 2
  s_cbranch_scc1 fin_spoll_l_ok
  s_sleep 2
  s_branch fin_spoll_l
fin_spoll_l_ok:
  s_mov_b64 exec, -1
  s_branch fin_spoll_ret
code_end:
  s_endpgm
.section .rodata,"a"
.p2align 6
.amdhsa_kernel ln_kernel
  .amdhsa_next_free_vgpr 64
  .amdhsa_next_free_sgpr 102
  .amdhsa_accum_offset 64
  .amdhsa_group_segment_fixed_size 0
  .amdhsa_kernarg_size 104
  .amdhsa_user_sgpr_count 2
  .amdhsa_user_sgpr_kernarg_segment_ptr 1
  .amdhsa_system_sgpr_workgroup_id_x 1
  .amdhsa_float_denorm_mode_32 3
  .amdhsa_ieee_mode 0
  .amdhsa_dx10_clamp 0
.end_amdhsa_kernel
.text
.section .rodata,"a"
.p2align 6
.amdhsa_kernel mega_kernel
  .amdhsa_next_free_vgpr 512
  .amdhsa_next_free_sgpr 102
  .amdhsa_accum_offset 256
  .amdhsa_group_segment_fixed_size 0
  .amdhsa_kernarg_size 104
  .amdhsa_user_sgpr_count 2
  .amdhsa_user_sgpr_kernarg_segment_ptr 1
  .amdhsa_system_sgpr_workgroup_id_x 1
  .amdhsa_float_denorm_mode_32 3
  .amdhsa_ieee_mode 0
  .amdhsa_dx10_clamp 0
.end_amdhsa_kernel
.text
```
